```python
import torch

def _softmax(x, axis=-1):
    return torch.softmax(x, dim=axis)
def _gelu(x):
    return torch.nn.functional.gelu(x, approximate="tanh")
def _silu(x):
    return torch.nn.functional.silu(x)
def _sigmoid(x):
    return torch.sigmoid(x)
def _layernorm(x, axis=-1, eps=1e-5):
    m = x.mean(dim=axis, keepdim=True)
    v = x.var(dim=axis, keepdim=True, unbiased=False)
    return (x - m) / torch.sqrt(v + eps)
def _scatter_add(tgt, idx, src, axis=0):
    return tgt.clone().index_add_(axis, idx, src)
def _segment_sum(src, seg, n):
    out = torch.zeros((n,) + src.shape[1:], dtype=src.dtype)
    return out.index_add_(0, seg, src)
def _pad(x, pw):
    flat = tuple(v for pair in reversed(pw) for v in pair)
    return torch.nn.functional.pad(x, flat)

kernel_name = 'recurrent_scan__spectral_gfnet__glu_gated_glu__prompt'

def setup_inputs():

    _w = (lambda a: (lambda t: t.to(torch.bfloat16) if t.is_floating_point() else t)(torch.as_tensor(a)))
    def _A_setup():
        B, S, D = 1, 2048, 576
        Df = D // 2 + 1
        return {
            "x": _w((lambda *s: torch.randn(*s, dtype=torch.bfloat16) * 0.05)(B, S, D)),
            "w_r": _w((lambda *s: torch.randn(*s, dtype=torch.bfloat16) * 0.05)(S, Df) * 0.02),
            "w_i": _w((lambda *s: torch.randn(*s, dtype=torch.bfloat16) * 0.05)(S, Df) * 0.02),
        }
    _A_in = _A_setup()

    def _B_setup():
        B, S, D, F = 1, 2048, 576, 4608
        return {
            "x": _w((lambda *s: torch.randn(*s, dtype=torch.bfloat16) * 0.05)(B, S, D)),
            "w_gate": _w((lambda *s: torch.randn(*s, dtype=torch.bfloat16) * 0.2)(D, F)),
            "w_up": _w((lambda *s: torch.randn(*s, dtype=torch.bfloat16) * 0.05)(D, F)),
            "w_down": _w((lambda *s: torch.randn(*s, dtype=torch.bfloat16) * 0.05)(F, D)),
        }
    _B_in = _B_setup()

    return {
        "A_x": _A_in["x"],
        "A_w_r": _A_in["w_r"],
        "A_w_i": _A_in["w_i"],
        "B_x": _B_in["x"],
        "B_w_gate": _B_in["w_gate"],
        "B_w_up": _B_in["w_up"],
        "B_w_down": _B_in["w_down"],
    }

def reference(A_x, A_w_r, A_w_i, B_x, B_w_gate, B_w_up, B_w_down):
    def _A_ref(x, w_r, w_i):
        B, S, D = x.shape
        X = (lambda x, axes=(-2,-1): torch.fft.rfft2(x.float(), dim=axes))(x, axes=(-2, -1))
        W = w_r + 1j * w_i
        X = X * W
        y = (lambda x, s, axes=(-2,-1): torch.fft.irfft2(x, s=s, dim=axes).to(torch.bfloat16))(X, (S, D), axes=(-2, -1))
        return y

    def _B_ref(x, w_gate, w_up, w_down):
        g = torch.einsum("bsd,df->bsf", x, w_gate)
        u = torch.einsum("bsd,df->bsf", x, w_up)
        h = _sigmoid(g) * u
        return torch.einsum("bsf,fd->bsd", h, w_down)

    x = A_x
    xn = _layernorm(x, axis=-1)
    s = _A_ref(xn, A_w_r, A_w_i)
    g = _silu(_B_ref(xn, B_w_gate, B_w_up, B_w_down))
    return x + s * g
```

```asm
; @launch kernel=l1_kernel grid=(256,1,1) block=(256,1,1) lds=163840
; @launch kernel=l2_kernel grid=(228,1,1) block=(512,1,1) lds=147456
.amdgcn_target "amdgcn-amd-amdhsa--gfx950"
.text
.globl l1_kernel
.p2align 8
.type l1_kernel,@function
l1_kernel:
    s_cmp_ge_u32 s2, 256
    s_cbranch_scc1 l1_kernel_exit
    s_getpc_b64 s[84:85]
l1_kernel_pc_l1_kernel:
    s_sub_u32 s84, s84, l1_kernel_pc_l1_kernel-l1_kernel
    s_subb_u32 s85, s85, 0
    v_lshlrev_b32 v46, 7, v0
    s_mov_b32 s86, l1_kernel_exit-l1_kernel
    v_cmp_gt_u32 vcc, s86, v46
    s_nop 3
    s_and_saveexec_b64 s[88:89], vcc
    global_load_dword v87, v46, s[84:85]
    s_mov_b64 exec, s[88:89]
    v_add_u32 v46, 32768, v46
    v_cmp_gt_u32 vcc, s86, v46
    s_nop 3
    s_and_saveexec_b64 s[88:89], vcc
    global_load_dword v87, v46, s[84:85]
    s_mov_b64 exec, s[88:89]
    s_load_dwordx4 s[4:7], s[0:1], 32
    s_load_dwordx4 s[8:11], s[0:1], 64
    s_load_dwordx2 s[62:63], s[0:1], 0
    s_load_dwordx4 s[44:47], s[0:1], 8
    s_load_dwordx2 s[68:69], s[0:1], 48
    v_lshrrev_b32 v10, 6, v0
    v_and_b32 v11, 63, v0
    v_lshlrev_b32 v0, 4, v11
    v_readfirstlane_b32 s3, v10
    s_lshr_b32 s37, s2, 4
    s_and_b32 s38, s2, 15
    s_sub_u32 s83, s38, s37
    s_and_b32 s83, s83, 15
    s_and_b32 s28, s3, 1
    s_lshr_b32 s29, s3, 1
    s_lshl_b32 s30, s37, 2
    s_lshl_b32 s43, s28, 1
    s_add_u32 s30, s30, s43
    s_waitcnt lgkmcnt(0)
    s_mov_b32 s24, s62
    s_mov_b32 s25, s63
    s_mov_b32 s26, 2359296
    s_mov_b32 s27, 0x20000
    s_mov_b32 s20, s10
    s_mov_b32 s21, s11
    s_mov_b32 s22, 47185920
    s_mov_b32 s23, 0x20000
    v_mov_b32 v90, 0x40000000
    s_mov_b32 s64, 0
    s_and_b32 s66, s37, 3
    s_lshr_b32 s67, s38, 2
    s_cmp_eq_u32 s66, s67
    s_cbranch_scc0 l1_kernel_nox
    v_lshrrev_b32 v12, 3, v11
    v_and_b32 v13, 7, v11
    s_lshl_b32 s43, s3, 3
    v_add_u32 v12, s43, v12
    s_lshl_b32 s49, s37, 2
    s_and_b32 s43, s38, 3
    s_add_u32 s49, s49, s43
    v_lshlrev_b32 v14, 6, v12
    v_add_u32 v14, s49, v14
    v_mul_u32_u24 v14, 1152, v14
    v_lshl_add_u32 v14, v13, 4, v14
    buffer_load_dwordx4 v[128:131], v14, s[24:27], 0 offen offset:0
    buffer_load_dwordx4 v[132:135], v14, s[24:27], 0 offen offset:128
    buffer_load_dwordx4 v[136:139], v14, s[24:27], 0 offen offset:256
    buffer_load_dwordx4 v[140:143], v14, s[24:27], 0 offen offset:384
    buffer_load_dwordx4 v[144:147], v14, s[24:27], 0 offen offset:512
    buffer_load_dwordx4 v[148:151], v14, s[24:27], 0 offen offset:640
    buffer_load_dwordx4 v[152:155], v14, s[24:27], 0 offen offset:768
    buffer_load_dwordx4 v[156:159], v14, s[24:27], 0 offen offset:896
    buffer_load_dwordx4 v[160:163], v14, s[24:27], 0 offen offset:1024
    v_lshrrev_b32 v16, 2, v13
    v_and_b32 v17, 3, v13
    v_lshlrev_b32 v16, 10, v16
    v_lshl_add_u32 v16, v17, 8, v16
    v_and_b32 v17, 15, v12
    v_lshl_add_u32 v16, v17, 4, v16
    v_lshrrev_b32 v17, 4, v12
    v_mul_u32_u24 v17, 18432, v17
    v_add_u32 v90, v16, v17
    s_mul_i32 s49, s49, 36864
    s_add_u32 s64, s49, 0
    s_mov_b32 s60, 0xffff0000
    s_mov_b32 s61, 0x3f803f80
    s_mov_b32 s24, s8
    s_mov_b32 s25, s9
    s_mov_b32 s26, 256
    s_mov_b32 s27, 0x20000
    s_lshl_b32 s43, s37, 4
    v_mov_b32 v46, s43
    v_mov_b32 v20, 0
    v_mov_b32 v21, 0
    v_mov_b32 v22, 0
    v_mov_b32 v23, 0
    v_mov_b32 v24, 0
    v_mov_b32 v25, 0
    v_mov_b32 v26, 0
    v_mov_b32 v27, 0
    s_waitcnt vmcnt(0)
    v_dot2c_f32_bf16 v20, s61, v128
    v_dot2c_f32_bf16 v24, v128, v128
    v_dot2c_f32_bf16 v21, s61, v129
    v_dot2c_f32_bf16 v25, v129, v129
    v_dot2c_f32_bf16 v22, s61, v130
    v_dot2c_f32_bf16 v26, v130, v130
    v_dot2c_f32_bf16 v23, s61, v131
    v_dot2c_f32_bf16 v27, v131, v131
    v_dot2c_f32_bf16 v20, s61, v132
    v_dot2c_f32_bf16 v24, v132, v132
    v_dot2c_f32_bf16 v21, s61, v133
    v_dot2c_f32_bf16 v25, v133, v133
    v_dot2c_f32_bf16 v22, s61, v134
    v_dot2c_f32_bf16 v26, v134, v134
    v_dot2c_f32_bf16 v23, s61, v135
    v_dot2c_f32_bf16 v27, v135, v135
    v_dot2c_f32_bf16 v20, s61, v136
    v_dot2c_f32_bf16 v24, v136, v136
    v_dot2c_f32_bf16 v21, s61, v137
    v_dot2c_f32_bf16 v25, v137, v137
    v_dot2c_f32_bf16 v22, s61, v138
    v_dot2c_f32_bf16 v26, v138, v138
    v_dot2c_f32_bf16 v23, s61, v139
    v_dot2c_f32_bf16 v27, v139, v139
    v_dot2c_f32_bf16 v20, s61, v140
    v_dot2c_f32_bf16 v24, v140, v140
    v_dot2c_f32_bf16 v21, s61, v141
    v_dot2c_f32_bf16 v25, v141, v141
    v_dot2c_f32_bf16 v22, s61, v142
    v_dot2c_f32_bf16 v26, v142, v142
    v_dot2c_f32_bf16 v23, s61, v143
    v_dot2c_f32_bf16 v27, v143, v143
    v_dot2c_f32_bf16 v20, s61, v144
    v_dot2c_f32_bf16 v24, v144, v144
    v_dot2c_f32_bf16 v21, s61, v145
    v_dot2c_f32_bf16 v25, v145, v145
    v_dot2c_f32_bf16 v22, s61, v146
    v_dot2c_f32_bf16 v26, v146, v146
    v_dot2c_f32_bf16 v23, s61, v147
    v_dot2c_f32_bf16 v27, v147, v147
    v_dot2c_f32_bf16 v20, s61, v148
    v_dot2c_f32_bf16 v24, v148, v148
    v_dot2c_f32_bf16 v21, s61, v149
    v_dot2c_f32_bf16 v25, v149, v149
    v_dot2c_f32_bf16 v22, s61, v150
    v_dot2c_f32_bf16 v26, v150, v150
    v_dot2c_f32_bf16 v23, s61, v151
    v_dot2c_f32_bf16 v27, v151, v151
    v_dot2c_f32_bf16 v20, s61, v152
    v_dot2c_f32_bf16 v24, v152, v152
    v_dot2c_f32_bf16 v21, s61, v153
    v_dot2c_f32_bf16 v25, v153, v153
    v_dot2c_f32_bf16 v22, s61, v154
    v_dot2c_f32_bf16 v26, v154, v154
    v_dot2c_f32_bf16 v23, s61, v155
    v_dot2c_f32_bf16 v27, v155, v155
    v_dot2c_f32_bf16 v20, s61, v156
    v_dot2c_f32_bf16 v24, v156, v156
    v_dot2c_f32_bf16 v21, s61, v157
    v_dot2c_f32_bf16 v25, v157, v157
    v_dot2c_f32_bf16 v22, s61, v158
    v_dot2c_f32_bf16 v26, v158, v158
    v_dot2c_f32_bf16 v23, s61, v159
    v_dot2c_f32_bf16 v27, v159, v159
    v_dot2c_f32_bf16 v20, s61, v160
    v_dot2c_f32_bf16 v24, v160, v160
    v_dot2c_f32_bf16 v21, s61, v161
    v_dot2c_f32_bf16 v25, v161, v161
    v_dot2c_f32_bf16 v22, s61, v162
    v_dot2c_f32_bf16 v26, v162, v162
    v_dot2c_f32_bf16 v23, s61, v163
    v_dot2c_f32_bf16 v27, v163, v163
    v_add_f32 v20, v20, v21
    s_nop 0
    v_add_f32 v22, v22, v23
    v_add_f32 v24, v24, v25
    v_add_f32 v26, v26, v27
    v_add_f32 v20, v20, v22
    v_add_f32 v22, v24, v26
    s_nop 0
    v_add_f32_dpp v20, v20, v20 quad_perm:[1,0,3,2] row_mask:0xf bank_mask:0xf
    v_add_f32_dpp v22, v22, v22 quad_perm:[1,0,3,2] row_mask:0xf bank_mask:0xf
    s_nop 0
    v_add_f32_dpp v20, v20, v20 quad_perm:[2,3,0,1] row_mask:0xf bank_mask:0xf
    v_add_f32_dpp v22, v22, v22 quad_perm:[2,3,0,1] row_mask:0xf bank_mask:0xf
    s_nop 0
    v_add_f32_dpp v20, v20, v20 row_half_mirror row_mask:0xf bank_mask:0xf
    v_add_f32_dpp v22, v22, v22 row_half_mirror row_mask:0xf bank_mask:0xf
    v_mul_f32 v20, 0x3ae38e39, v20
    v_mul_f32 v22, 0x3ae38e39, v22
    v_fma_f32 v22, -v20, v20, v22
    v_max_f32 v22, 0, v22
    v_add_f32 v22, 0x3727c5ac, v22
    v_rsq_f32 v24, v22
    s_nop 0
    v_mul_f32 v25, v20, v24
    v_xor_b32 v25, 0x80000000, v25
    v_lshlrev_b32 v28, 16, v128
    v_and_b32 v29, s60, v128
    v_pk_fma_f32 v[28:29], v[28:29], v[24:25], v[24:25] op_sel:[0,0,1] op_sel_hi:[1,0,1]
    s_nop 0
    v_cvt_pk_bf16_f32 v128, v28, v29
    v_lshlrev_b32 v30, 16, v129
    v_and_b32 v31, s60, v129
    v_pk_fma_f32 v[30:31], v[30:31], v[24:25], v[24:25] op_sel:[0,0,1] op_sel_hi:[1,0,1]
    s_nop 0
    v_cvt_pk_bf16_f32 v129, v30, v31
    v_lshlrev_b32 v32, 16, v130
    v_and_b32 v33, s60, v130
    v_pk_fma_f32 v[32:33], v[32:33], v[24:25], v[24:25] op_sel:[0,0,1] op_sel_hi:[1,0,1]
    s_nop 0
    v_cvt_pk_bf16_f32 v130, v32, v33
    v_lshlrev_b32 v34, 16, v131
    v_and_b32 v35, s60, v131
    v_pk_fma_f32 v[34:35], v[34:35], v[24:25], v[24:25] op_sel:[0,0,1] op_sel_hi:[1,0,1]
    s_nop 0
    v_cvt_pk_bf16_f32 v131, v34, v35
    s_add_u32 s62, s64, 0
    buffer_store_dwordx4 v[128:131], v90, s[20:23], s62 offen sc1
    v_lshlrev_b32 v28, 16, v132
    v_and_b32 v29, s60, v132
    v_pk_fma_f32 v[28:29], v[28:29], v[24:25], v[24:25] op_sel:[0,0,1] op_sel_hi:[1,0,1]
    s_nop 0
    v_cvt_pk_bf16_f32 v132, v28, v29
    v_lshlrev_b32 v30, 16, v133
    v_and_b32 v31, s60, v133
    v_pk_fma_f32 v[30:31], v[30:31], v[24:25], v[24:25] op_sel:[0,0,1] op_sel_hi:[1,0,1]
    s_nop 0
    v_cvt_pk_bf16_f32 v133, v30, v31
    v_lshlrev_b32 v32, 16, v134
    v_and_b32 v33, s60, v134
    v_pk_fma_f32 v[32:33], v[32:33], v[24:25], v[24:25] op_sel:[0,0,1] op_sel_hi:[1,0,1]
    s_nop 0
    v_cvt_pk_bf16_f32 v134, v32, v33
    v_lshlrev_b32 v34, 16, v135
    v_and_b32 v35, s60, v135
    v_pk_fma_f32 v[34:35], v[34:35], v[24:25], v[24:25] op_sel:[0,0,1] op_sel_hi:[1,0,1]
    s_nop 0
    v_cvt_pk_bf16_f32 v135, v34, v35
    s_add_u32 s62, s64, 2048
    buffer_store_dwordx4 v[132:135], v90, s[20:23], s62 offen sc1
    v_lshlrev_b32 v28, 16, v136
    v_and_b32 v29, s60, v136
    v_pk_fma_f32 v[28:29], v[28:29], v[24:25], v[24:25] op_sel:[0,0,1] op_sel_hi:[1,0,1]
    s_nop 0
    v_cvt_pk_bf16_f32 v136, v28, v29
    v_lshlrev_b32 v30, 16, v137
    v_and_b32 v31, s60, v137
    v_pk_fma_f32 v[30:31], v[30:31], v[24:25], v[24:25] op_sel:[0,0,1] op_sel_hi:[1,0,1]
    s_nop 0
    v_cvt_pk_bf16_f32 v137, v30, v31
    v_lshlrev_b32 v32, 16, v138
    v_and_b32 v33, s60, v138
    v_pk_fma_f32 v[32:33], v[32:33], v[24:25], v[24:25] op_sel:[0,0,1] op_sel_hi:[1,0,1]
    s_nop 0
    v_cvt_pk_bf16_f32 v138, v32, v33
    v_lshlrev_b32 v34, 16, v139
    v_and_b32 v35, s60, v139
    v_pk_fma_f32 v[34:35], v[34:35], v[24:25], v[24:25] op_sel:[0,0,1] op_sel_hi:[1,0,1]
    s_nop 0
    v_cvt_pk_bf16_f32 v139, v34, v35
    s_add_u32 s62, s64, 4096
    buffer_store_dwordx4 v[136:139], v90, s[20:23], s62 offen sc1
    v_lshlrev_b32 v28, 16, v140
    v_and_b32 v29, s60, v140
    v_pk_fma_f32 v[28:29], v[28:29], v[24:25], v[24:25] op_sel:[0,0,1] op_sel_hi:[1,0,1]
    s_nop 0
    v_cvt_pk_bf16_f32 v140, v28, v29
    v_lshlrev_b32 v30, 16, v141
    v_and_b32 v31, s60, v141
    v_pk_fma_f32 v[30:31], v[30:31], v[24:25], v[24:25] op_sel:[0,0,1] op_sel_hi:[1,0,1]
    s_nop 0
    v_cvt_pk_bf16_f32 v141, v30, v31
    v_lshlrev_b32 v32, 16, v142
    v_and_b32 v33, s60, v142
    v_pk_fma_f32 v[32:33], v[32:33], v[24:25], v[24:25] op_sel:[0,0,1] op_sel_hi:[1,0,1]
    s_nop 0
    v_cvt_pk_bf16_f32 v142, v32, v33
    v_lshlrev_b32 v34, 16, v143
    v_and_b32 v35, s60, v143
    v_pk_fma_f32 v[34:35], v[34:35], v[24:25], v[24:25] op_sel:[0,0,1] op_sel_hi:[1,0,1]
    s_nop 0
    v_cvt_pk_bf16_f32 v143, v34, v35
    s_add_u32 s62, s64, 6144
    buffer_store_dwordx4 v[140:143], v90, s[20:23], s62 offen sc1
    v_lshlrev_b32 v28, 16, v144
    v_and_b32 v29, s60, v144
    v_pk_fma_f32 v[28:29], v[28:29], v[24:25], v[24:25] op_sel:[0,0,1] op_sel_hi:[1,0,1]
    s_nop 0
    v_cvt_pk_bf16_f32 v144, v28, v29
    v_lshlrev_b32 v30, 16, v145
    v_and_b32 v31, s60, v145
    v_pk_fma_f32 v[30:31], v[30:31], v[24:25], v[24:25] op_sel:[0,0,1] op_sel_hi:[1,0,1]
    s_nop 0
    v_cvt_pk_bf16_f32 v145, v30, v31
    v_lshlrev_b32 v32, 16, v146
    v_and_b32 v33, s60, v146
    v_pk_fma_f32 v[32:33], v[32:33], v[24:25], v[24:25] op_sel:[0,0,1] op_sel_hi:[1,0,1]
    s_nop 0
    v_cvt_pk_bf16_f32 v146, v32, v33
    v_lshlrev_b32 v34, 16, v147
    v_and_b32 v35, s60, v147
    v_pk_fma_f32 v[34:35], v[34:35], v[24:25], v[24:25] op_sel:[0,0,1] op_sel_hi:[1,0,1]
    s_nop 0
    v_cvt_pk_bf16_f32 v147, v34, v35
    s_add_u32 s62, s64, 8192
    buffer_store_dwordx4 v[144:147], v90, s[20:23], s62 offen sc1
    v_lshlrev_b32 v28, 16, v148
    v_and_b32 v29, s60, v148
    v_pk_fma_f32 v[28:29], v[28:29], v[24:25], v[24:25] op_sel:[0,0,1] op_sel_hi:[1,0,1]
    s_nop 0
    v_cvt_pk_bf16_f32 v148, v28, v29
    v_lshlrev_b32 v30, 16, v149
    v_and_b32 v31, s60, v149
    v_pk_fma_f32 v[30:31], v[30:31], v[24:25], v[24:25] op_sel:[0,0,1] op_sel_hi:[1,0,1]
    s_nop 0
    v_cvt_pk_bf16_f32 v149, v30, v31
    v_lshlrev_b32 v32, 16, v150
    v_and_b32 v33, s60, v150
    v_pk_fma_f32 v[32:33], v[32:33], v[24:25], v[24:25] op_sel:[0,0,1] op_sel_hi:[1,0,1]
    s_nop 0
    v_cvt_pk_bf16_f32 v150, v32, v33
    v_lshlrev_b32 v34, 16, v151
    v_and_b32 v35, s60, v151
    v_pk_fma_f32 v[34:35], v[34:35], v[24:25], v[24:25] op_sel:[0,0,1] op_sel_hi:[1,0,1]
    s_nop 0
    v_cvt_pk_bf16_f32 v151, v34, v35
    s_add_u32 s62, s64, 10240
    buffer_store_dwordx4 v[148:151], v90, s[20:23], s62 offen sc1
    v_lshlrev_b32 v28, 16, v152
    v_and_b32 v29, s60, v152
    v_pk_fma_f32 v[28:29], v[28:29], v[24:25], v[24:25] op_sel:[0,0,1] op_sel_hi:[1,0,1]
    s_nop 0
    v_cvt_pk_bf16_f32 v152, v28, v29
    v_lshlrev_b32 v30, 16, v153
    v_and_b32 v31, s60, v153
    v_pk_fma_f32 v[30:31], v[30:31], v[24:25], v[24:25] op_sel:[0,0,1] op_sel_hi:[1,0,1]
    s_nop 0
    v_cvt_pk_bf16_f32 v153, v30, v31
    v_lshlrev_b32 v32, 16, v154
    v_and_b32 v33, s60, v154
    v_pk_fma_f32 v[32:33], v[32:33], v[24:25], v[24:25] op_sel:[0,0,1] op_sel_hi:[1,0,1]
    s_nop 0
    v_cvt_pk_bf16_f32 v154, v32, v33
    v_lshlrev_b32 v34, 16, v155
    v_and_b32 v35, s60, v155
    v_pk_fma_f32 v[34:35], v[34:35], v[24:25], v[24:25] op_sel:[0,0,1] op_sel_hi:[1,0,1]
    s_nop 0
    v_cvt_pk_bf16_f32 v155, v34, v35
    s_add_u32 s62, s64, 12288
    buffer_store_dwordx4 v[152:155], v90, s[20:23], s62 offen sc1
    v_lshlrev_b32 v28, 16, v156
    v_and_b32 v29, s60, v156
    v_pk_fma_f32 v[28:29], v[28:29], v[24:25], v[24:25] op_sel:[0,0,1] op_sel_hi:[1,0,1]
    s_nop 0
    v_cvt_pk_bf16_f32 v156, v28, v29
    v_lshlrev_b32 v30, 16, v157
    v_and_b32 v31, s60, v157
    v_pk_fma_f32 v[30:31], v[30:31], v[24:25], v[24:25] op_sel:[0,0,1] op_sel_hi:[1,0,1]
    s_nop 0
    v_cvt_pk_bf16_f32 v157, v30, v31
    v_lshlrev_b32 v32, 16, v158
    v_and_b32 v33, s60, v158
    v_pk_fma_f32 v[32:33], v[32:33], v[24:25], v[24:25] op_sel:[0,0,1] op_sel_hi:[1,0,1]
    s_nop 0
    v_cvt_pk_bf16_f32 v158, v32, v33
    v_lshlrev_b32 v34, 16, v159
    v_and_b32 v35, s60, v159
    v_pk_fma_f32 v[34:35], v[34:35], v[24:25], v[24:25] op_sel:[0,0,1] op_sel_hi:[1,0,1]
    s_nop 0
    v_cvt_pk_bf16_f32 v159, v34, v35
    s_add_u32 s62, s64, 14336
    buffer_store_dwordx4 v[156:159], v90, s[20:23], s62 offen sc1
    v_lshlrev_b32 v28, 16, v160
    v_and_b32 v29, s60, v160
    v_pk_fma_f32 v[28:29], v[28:29], v[24:25], v[24:25] op_sel:[0,0,1] op_sel_hi:[1,0,1]
    s_nop 0
    v_cvt_pk_bf16_f32 v160, v28, v29
    v_lshlrev_b32 v30, 16, v161
    v_and_b32 v31, s60, v161
    v_pk_fma_f32 v[30:31], v[30:31], v[24:25], v[24:25] op_sel:[0,0,1] op_sel_hi:[1,0,1]
    s_nop 0
    v_cvt_pk_bf16_f32 v161, v30, v31
    v_lshlrev_b32 v32, 16, v162
    v_and_b32 v33, s60, v162
    v_pk_fma_f32 v[32:33], v[32:33], v[24:25], v[24:25] op_sel:[0,0,1] op_sel_hi:[1,0,1]
    s_nop 0
    v_cvt_pk_bf16_f32 v162, v32, v33
    v_lshlrev_b32 v34, 16, v163
    v_and_b32 v35, s60, v163
    v_pk_fma_f32 v[34:35], v[34:35], v[24:25], v[24:25] op_sel:[0,0,1] op_sel_hi:[1,0,1]
    s_nop 0
    v_cvt_pk_bf16_f32 v163, v34, v35
    s_add_u32 s62, s64, 16384
    buffer_store_dwordx4 v[160:163], v90, s[20:23], s62 offen sc1
    s_waitcnt vmcnt(0)
    s_barrier
    v_mov_b32 v10, 1
    v_cmp_gt_u32 vcc, 1, v11
    s_cmp_eq_u32 s3, 0
    s_nop 2
    s_cselect_b64 vcc, vcc, 0
    s_and_saveexec_b64 s[42:43], vcc
    buffer_atomic_add v10, v46, s[24:27], 0 offen sc1
    s_mov_b64 exec, s[42:43]
l1_kernel_nox:
    s_mov_b32 s24, s8
    s_mov_b32 s25, s9
    s_mov_b32 s26, 256
    s_mov_b32 s27, 0x20000
    s_lshl_b32 s43, s37, 4
    v_mov_b32 v46, s43
    v_lshlrev_b32 v12, 7, v11
    v_add_u32 v12, 46137344, v12
    v_mov_b32 v13, 0x40000000
    s_cmp_eq_u32 s2, 255
    s_cselect_b64 vcc, -1, 0
    s_cmp_eq_u32 s3, 3
    s_cselect_b64 vcc, vcc, 0
    s_nop 0
    v_cndmask_b32 v12, v13, v12, vcc
    v_mov_b32 v13, 0
    buffer_store_dword v13, v12, s[20:23], 0 offen
    s_mov_b32 s12, s4
    s_mov_b32 s13, s5
    s_mov_b32 s14, 5308416
    s_mov_b32 s15, 0x20000
    s_mov_b32 s16, s6
    s_mov_b32 s17, s7
    s_mov_b32 s18, 5308416
    s_mov_b32 s19, 0x20000
    s_mov_b32 s8, s44
    s_mov_b32 s9, s45
    s_mov_b32 s10, 1183744
    s_mov_b32 s11, 0x20000
    s_mov_b32 s4, s46
    s_mov_b32 s5, s47
    s_mov_b32 s6, 1183744
    s_mov_b32 s7, 0x20000
    s_lshr_b32 s39, s38, 1
    s_and_b32 s40, s38, 1
    s_mul_i32 s41, s39, 9
    s_mul_i32 s42, s40, 5
    s_add_u32 s42, s42, s41
    s_add_u32 s41, s41, 4
    s_add_u32 s43, s42, 0
    s_lshl_b32 s32, s43, 7
    s_add_u32 s43, s42, 1
    s_lshl_b32 s33, s43, 7
    s_add_u32 s43, s42, 2
    s_lshl_b32 s34, s43, 7
    s_lshl_b32 s35, s41, 7
    s_add_u32 s43, s42, 3
    s_lshl_b32 s36, s43, 7
    s_lshl_b32 s53, s3, 10
    s_lshl_b32 s58, s3, 11
    v_lshrrev_b32 v12, 3, v11
    v_and_b32 v13, 7, v11
    v_and_b32 v15, 2, v12
    s_and_b32 s43, s3, 1
    s_lshl_b32 s43, s43, 2
    v_or_b32 v15, s43, v15
    v_xor_b32 v15, v13, v15
    s_lshl_b32 s43, s3, 3
    v_add_u32 v16, s43, v12
    s_movk_i32 s43, 9216
    v_mul_lo_u32 v16, v16, s43
    v_lshl_add_u32 v1, v15, 4, v16
    s_lshl_b32 s50, s37, 2
    s_add_u32 s50, s50, s3
    s_mul_i32 s50, s50, 36864
    s_add_u32 s50, s50, 0
    s_lshl_b32 s52, s3, 12
    s_add_u32 m0, s53, 16384
    s_add_u32 s57, s32, 0
    buffer_load_dwordx4 v1, s[12:15], s57 offen lds
    s_add_u32 m0, s53, 20480
    s_add_u32 s57, s32, 294912
    buffer_load_dwordx4 v1, s[12:15], s57 offen lds
    s_add_u32 m0, s53, 24576
    s_add_u32 s57, s32, 0
    buffer_load_dwordx4 v1, s[16:19], s57 offen lds
    s_add_u32 m0, s53, 28672
    s_add_u32 s57, s32, 294912
    buffer_load_dwordx4 v1, s[16:19], s57 offen lds
    s_add_u32 m0, s53, 49152
    s_add_u32 s57, s32, 589824
    buffer_load_dwordx4 v1, s[12:15], s57 offen lds
    s_add_u32 m0, s53, 53248
    s_add_u32 s57, s32, 884736
    buffer_load_dwordx4 v1, s[12:15], s57 offen lds
    s_add_u32 m0, s53, 57344
    s_add_u32 s57, s32, 589824
    buffer_load_dwordx4 v1, s[16:19], s57 offen lds
    s_add_u32 m0, s53, 61440
    s_add_u32 s57, s32, 884736
    buffer_load_dwordx4 v1, s[16:19], s57 offen lds
    s_add_u32 m0, s53, 81920
    s_add_u32 s57, s32, 1179648
    buffer_load_dwordx4 v1, s[12:15], s57 offen lds
    s_add_u32 m0, s53, 86016
    s_add_u32 s57, s32, 1474560
    buffer_load_dwordx4 v1, s[12:15], s57 offen lds
    s_add_u32 m0, s53, 90112
    s_add_u32 s57, s32, 1179648
    buffer_load_dwordx4 v1, s[16:19], s57 offen lds
    s_add_u32 m0, s53, 94208
    s_add_u32 s57, s32, 1474560
    buffer_load_dwordx4 v1, s[16:19], s57 offen lds
    s_add_u32 m0, s53, 114688
    s_add_u32 s57, s32, 1769472
    buffer_load_dwordx4 v1, s[12:15], s57 offen lds
    s_add_u32 m0, s53, 118784
    s_add_u32 s57, s32, 2064384
    buffer_load_dwordx4 v1, s[12:15], s57 offen lds
    s_add_u32 m0, s53, 122880
    s_add_u32 s57, s32, 1769472
    buffer_load_dwordx4 v1, s[16:19], s57 offen lds
    s_add_u32 m0, s53, 126976
    s_add_u32 s57, s32, 2064384
    buffer_load_dwordx4 v1, s[16:19], s57 offen lds
    s_mul_i32 s43, s37, 36
    v_add_u32 v18, s43, v11
    s_movk_i32 s62, 9216
    v_mul_lo_u32 v18, v18, s62
    v_mov_b32 v19, 0x40000000
    v_cmp_gt_u32 vcc, 36, v11
    s_cmp_eq_u32 s3, 3
    s_nop 2
    s_cselect_b64 vcc, vcc, 0
    s_nop 0
    v_cndmask_b32 v43, v19, v18, vcc
    buffer_load_dword v37, v43, s[12:15], s32 offen
    buffer_load_dword v37, v43, s[16:19], s32 offen
    buffer_load_dword v37, v43, s[12:15], s33 offen
    buffer_load_dword v37, v43, s[16:19], s33 offen
    s_mul_i32 s49, s30, 294912
    s_add_u32 s49, s49, 16777216
    s_add_u32 s43, s42, 0
    s_lshl_b32 s43, s43, 1
    s_add_u32 s43, s43, s29
    s_lshl_b32 s43, s43, 10
    s_add_u32 s44, s49, s43
    s_add_u32 s43, s42, 1
    s_lshl_b32 s43, s43, 1
    s_add_u32 s43, s43, s29
    s_lshl_b32 s43, s43, 10
    s_add_u32 s45, s49, s43
    s_add_u32 s43, s42, 2
    s_lshl_b32 s43, s43, 1
    s_add_u32 s43, s43, s29
    s_lshl_b32 s43, s43, 10
    s_add_u32 s46, s49, s43
    s_lshl_b32 s43, s41, 1
    s_add_u32 s43, s43, s40
    s_lshl_b32 s43, s43, 10
    s_add_u32 s47, s49, s43
    s_add_u32 s43, s42, 3
    s_lshl_b32 s43, s43, 1
    s_add_u32 s43, s43, s29
    s_lshl_b32 s43, s43, 10
    s_add_u32 s48, s49, s43
    s_lshl_b32 s54, s29, 1
    v_lshrrev_b32 v13, 4, v11
    v_bfe_u32 v14, v11, 2, 2
    v_and_b32 v15, 3, v11
    v_lshlrev_b32 v16, 10, v13
    v_lshl_add_u32 v16, v14, 7, v16
    v_lshrrev_b32 v17, 1, v15
    s_lshl_b32 s43, s54, 1
    v_add_u32 v17, s43, v17
    v_and_b32 v18, 2, v14
    v_and_b32 v13, 1, v13
    v_lshl_add_u32 v18, v13, 2, v18
    v_xor_b32 v17, v17, v18
    v_lshl_add_u32 v16, v17, 4, v16
    v_and_b32 v15, 1, v15
    v_lshl_add_u32 v3, v15, 3, v16
    v_add_u32 v4, 0x10000, v3
    v_xor_b32 v5, 32, v3
    v_xor_b32 v6, 32, v4
    v_add_u32 v38, 0x20000, v3
    v_add_u32 v39, 0x20000, v5
    s_lshl_b32 s54, s40, 1
    s_add_u32 s54, s54, s29
    v_lshrrev_b32 v13, 4, v11
    v_bfe_u32 v14, v11, 2, 2
    v_and_b32 v15, 3, v11
    v_lshlrev_b32 v16, 10, v13
    v_lshl_add_u32 v16, v14, 7, v16
    v_lshrrev_b32 v17, 1, v15
    s_lshl_b32 s43, s54, 1
    v_add_u32 v17, s43, v17
    v_and_b32 v18, 2, v14
    v_and_b32 v13, 1, v13
    v_lshl_add_u32 v18, v13, 2, v18
    v_xor_b32 v17, v17, v18
    v_lshl_add_u32 v16, v17, 4, v16
    v_and_b32 v15, 1, v15
    v_lshl_add_u32 v7, v15, 3, v16
    v_add_u32 v8, 0x10000, v7
    v_add_u32 v40, 0x20000, v7
    s_lshl_b32 s43, s28, 13
    v_add_u32 v88, s43, v0
    v_add_u32 v89, 0x10000, v88
    v_add_u32 v41, 0x20000, v88
    v_and_b32 v12, 15, v11
    v_lshrrev_b32 v13, 4, v11
    v_lshlrev_b32 v9, 12, v12
    v_lshl_add_u32 v9, v13, 4, v9
    s_lshl_b32 s43, s83, 1
    s_add_u32 s43, s43, s29
    s_lshl_b32 s43, s43, 17
    s_lshl_b32 s55, s30, 6
    s_add_u32 s55, s55, s43
    s_add_u32 s55, s55, 7340032
    s_mov_b32 s56, 0xbfb8aa3b
    s_lshl_b32 s43, s29, 3
    v_add_u32 v2, s43, v0
    v_add_u32 v94, s58, v0
    v_add_u32 v95, 0x10000, v94
    v_add_u32 v42, 0x20000, v94
    s_and_b32 s70, s37, 3
    s_lshr_b32 s71, s38, 2
    s_cmp_eq_u32 s70, s71
    s_cbranch_scc1 l1_kernel_noside
    s_cmp_gt_u32 s71, s70
    s_cselect_b32 s71, 4, 0
    s_sub_u32 s70, s38, s71
    s_mul_i32 s71, s37, 12
    s_add_u32 s70, s70, s71
    s_max_u32 s51, s3, 1
    s_sub_u32 s51, s51, 1
    s_mul_i32 s51, s51, 96
    v_lshl_add_u32 v84, v11, 1, s51
    v_lshlrev_b32 v85, 13, v84
    v_lshl_add_u32 v84, v84, 1, 2
    v_mov_b32 v86, 0x40000000
    v_cmp_gt_u32 vcc, 48, v11
    s_nop 1
    v_cndmask_b32 v84, v86, v84, vcc
    v_cndmask_b32 v85, v86, v85, vcc
    s_mov_b32 s66, 0x40000000
    s_mov_b32 s67, 0x40000000
    s_cmp_eq_u32 s3, 0
    s_cbranch_scc1 l1_kernel_nowp0
    s_add_u32 s74, s70, 0
    s_and_b32 s76, s74, 15
    s_lshr_b32 s77, s74, 4
    s_lshl_b32 s78, s76, 1
    s_lshl_b32 s79, s77, 7
    s_add_u32 s78, s78, s79
    s_mul_i32 s31, s78, 578
    s_lshr_b32 s79, s77, 2
    s_lshl_b32 s79, s79, 1
    s_lshr_b32 s80, s76, 3
    s_add_u32 s79, s79, s80
    s_lshl_b32 s79, s79, 6
    s_and_b32 s80, s77, 3
    s_lshl_b32 s80, s80, 4
    s_add_u32 s79, s79, s80
    s_lshl_b32 s80, s76, 1
    s_and_b32 s80, s80, 15
    s_add_u32 s79, s79, s80
    s_lshl_b32 s79, s79, 4
    s_add_u32 s66, s79, 4194304
    s_cmp_lt_u32 s74, 256
    s_cselect_b32 s66, s66, 0x40000000
    s_cselect_b32 s31, s31, 0x40000000
    s_add_u32 s64, s31, 0
    buffer_load_dword v224, v84, s[8:11], s64 offen
    buffer_load_dword v232, v84, s[4:7], s64 offen
    s_add_u32 s64, s31, 18496
    buffer_load_dword v225, v84, s[8:11], s64 offen
    buffer_load_dword v233, v84, s[4:7], s64 offen
    s_add_u32 s64, s31, 36992
    buffer_load_dword v226, v84, s[8:11], s64 offen
    buffer_load_dword v234, v84, s[4:7], s64 offen
    s_add_u32 s64, s31, 55488
    buffer_load_dword v227, v84, s[8:11], s64 offen
    buffer_load_dword v235, v84, s[4:7], s64 offen
    s_add_u32 s64, s31, 578
    buffer_load_dword v228, v84, s[8:11], s64 offen
    buffer_load_dword v236, v84, s[4:7], s64 offen
    s_add_u32 s64, s31, 19074
    buffer_load_dword v229, v84, s[8:11], s64 offen
    buffer_load_dword v237, v84, s[4:7], s64 offen
    s_add_u32 s64, s31, 37570
    buffer_load_dword v230, v84, s[8:11], s64 offen
    buffer_load_dword v238, v84, s[4:7], s64 offen
    s_add_u32 s64, s31, 56066
    buffer_load_dword v231, v84, s[8:11], s64 offen
    buffer_load_dword v239, v84, s[4:7], s64 offen
    s_cmp_lt_u32 s70, 64
    s_cbranch_scc0 l1_kernel_nowp0
    s_add_u32 s74, s70, 192
    s_and_b32 s76, s74, 15
    s_lshr_b32 s77, s74, 4
    s_lshl_b32 s78, s76, 1
    s_lshl_b32 s79, s77, 7
    s_add_u32 s78, s78, s79
    s_mul_i32 s31, s78, 578
    s_lshr_b32 s79, s77, 2
    s_lshl_b32 s79, s79, 1
    s_lshr_b32 s80, s76, 3
    s_add_u32 s79, s79, s80
    s_lshl_b32 s79, s79, 6
    s_and_b32 s80, s77, 3
    s_lshl_b32 s80, s80, 4
    s_add_u32 s79, s79, s80
    s_lshl_b32 s80, s76, 1
    s_and_b32 s80, s80, 15
    s_add_u32 s79, s79, s80
    s_lshl_b32 s79, s79, 4
    s_add_u32 s67, s79, 4194304
    s_cmp_lt_u32 s74, 256
    s_cselect_b32 s67, s67, 0x40000000
    s_cselect_b32 s31, s31, 0x40000000
    s_add_u32 s64, s31, 0
    buffer_load_dword v68, v84, s[8:11], s64 offen
    buffer_load_dword v76, v84, s[4:7], s64 offen
    s_add_u32 s64, s31, 18496
    buffer_load_dword v69, v84, s[8:11], s64 offen
    buffer_load_dword v77, v84, s[4:7], s64 offen
    s_add_u32 s64, s31, 36992
    buffer_load_dword v70, v84, s[8:11], s64 offen
    buffer_load_dword v78, v84, s[4:7], s64 offen
    s_add_u32 s64, s31, 55488
    buffer_load_dword v71, v84, s[8:11], s64 offen
    buffer_load_dword v79, v84, s[4:7], s64 offen
    s_add_u32 s64, s31, 578
    buffer_load_dword v72, v84, s[8:11], s64 offen
    buffer_load_dword v80, v84, s[4:7], s64 offen
    s_add_u32 s64, s31, 19074
    buffer_load_dword v73, v84, s[8:11], s64 offen
    buffer_load_dword v81, v84, s[4:7], s64 offen
    s_add_u32 s64, s31, 37570
    buffer_load_dword v74, v84, s[8:11], s64 offen
    buffer_load_dword v82, v84, s[4:7], s64 offen
    s_add_u32 s64, s31, 56066
    buffer_load_dword v75, v84, s[8:11], s64 offen
    buffer_load_dword v83, v84, s[4:7], s64 offen
l1_kernel_nowp0:
    s_lshl_b32 s72, s70, 2
    s_add_u32 s72, s72, s3
    v_and_b32 v12, 15, v11
    v_lshrrev_b32 v13, 4, v11
    s_cmp_lt_u32 s72, 648
    s_cbranch_scc0 l1_kernel_small
    s_mul_hi_u32 s73, s72, 238609295
    s_mul_i32 s74, s73, 18
    s_sub_u32 s74, s72, s74
    s_lshl_b32 s73, s73, 4
    s_lshl_b32 s74, s74, 4
    s_add_u32 s74, s74, 1
    v_add_u32 v14, s73, v12
    v_cvt_f32_u32 v14, v14
    v_lshl_add_u32 v15, v13, 2, s74
    v_cvt_f32_u32 v16, v15
    s_mov_b32 s73, 0x3ae38e39
    s_mov_b32 s74, 0xc4100000
    v_mov_b32 v17, 0x3b638e39
    v_mov_b32 v18, 0x3ae38e39
    v_cmp_eq_u32 vcc, 0x11d, v15
    s_nop 1
    v_cndmask_b32 v18, v17, v18, vcc
    v_mul_f32 v19, v16, v14
    v_mul_f32 v20, s73, v19
    v_floor_f32 v20, v20
    v_fma_f32 v20, v20, s74, v19
    v_mul_f32 v20, s73, v20
    v_cos_f32 v24, v20
    v_add_f32 v19, 0x43100000, v19
    v_mul_f32 v21, s73, v19
    v_floor_f32 v21, v21
    v_fma_f32 v21, v21, s74, v19
    v_mul_f32 v21, s73, v21
    v_cos_f32 v25, v21
    v_add_f32 v16, 1.0, v16
    v_mul_f32 v19, v16, v14
    v_mul_f32 v20, s73, v19
    v_floor_f32 v20, v20
    v_fma_f32 v20, v20, s74, v19
    v_mul_f32 v20, s73, v20
    v_cos_f32 v26, v20
    v_add_f32 v19, 0x43100000, v19
    v_mul_f32 v21, s73, v19
    v_floor_f32 v21, v21
    v_fma_f32 v21, v21, s74, v19
    v_mul_f32 v21, s73, v21
    v_cos_f32 v27, v21
    v_add_f32 v16, 1.0, v16
    v_mul_f32 v19, v16, v14
    v_mul_f32 v20, s73, v19
    v_floor_f32 v20, v20
    v_fma_f32 v20, v20, s74, v19
    v_mul_f32 v20, s73, v20
    v_cos_f32 v28, v20
    v_add_f32 v19, 0x43100000, v19
    v_mul_f32 v21, s73, v19
    v_floor_f32 v21, v21
    v_fma_f32 v21, v21, s74, v19
    v_mul_f32 v21, s73, v21
    v_cos_f32 v29, v21
    v_add_f32 v16, 1.0, v16
    v_mul_f32 v19, v16, v14
    v_mul_f32 v20, s73, v19
    v_floor_f32 v20, v20
    v_fma_f32 v20, v20, s74, v19
    v_mul_f32 v20, s73, v20
    v_cos_f32 v30, v20
    v_add_f32 v19, 0x43100000, v19
    v_mul_f32 v21, s73, v19
    v_floor_f32 v21, v21
    v_fma_f32 v21, v21, s74, v19
    v_mul_f32 v21, s73, v21
    v_cos_f32 v31, v21
    v_mul_f32 v24, v17, v24
    v_mul_f32 v25, v17, v25
    v_mul_f32 v26, v17, v26
    v_mul_f32 v27, v17, v27
    v_mul_f32 v28, v17, v28
    v_mul_f32 v29, v17, v29
    v_mul_f32 v30, v18, v30
    v_mul_f32 v31, v18, v31
    v_cvt_pk_bf16_f32 v32, v24, v25
    v_cvt_pk_bf16_f32 v33, v26, v27
    v_cvt_pk_bf16_f32 v34, v28, v29
    v_cvt_pk_bf16_f32 v35, v30, v31
    s_lshl_b32 s75, s72, 10
    s_add_u32 s75, s75, 3145728
    buffer_store_dwordx4 v[32:35], v0, s[20:23], s75 offen
    s_branch l1_kernel_tabend
l1_kernel_small:
    s_sub_u32 s72, s72, 648
    s_cmp_lt_u32 s72, 6
    s_cbranch_scc1 l1_kernel_c32
    s_cmp_lt_u32 s72, 30
    s_cbranch_scc1 l1_kernel_c64
    s_cmp_lt_u32 s72, 46
    s_cbranch_scc1 l1_kernel_tw1
    s_cmp_lt_u32 s72, 62
    s_cbranch_scc1 l1_kernel_tw2
    s_branch l1_kernel_tabend
l1_kernel_c32:
    s_lshr_b32 s73, s72, 1
    s_and_b32 s74, s72, 1
    s_mov_b32 s76, 0
    s_cmp_eq_u32 s73, 1
    s_cselect_b32 s76, 24, s76
    s_cmp_eq_u32 s73, 2
    s_cselect_b32 s76, 8, s76
    s_lshl_b32 s74, s74, 4
    v_add_u32 v14, s74, v12
    s_mov_b32 s77, 0x3d000000
    v_lshl_add_u32 v18, v13, 2, 0
    v_mul_lo_u32 v18, v18, v14
    v_add_u32 v18, s76, v18
    v_and_b32 v18, 31, v18
    v_cvt_f32_u32 v18, v18
    v_mul_f32 v18, s77, v18
    v_cos_f32 v24, v18
    v_lshl_add_u32 v18, v13, 2, 1
    v_mul_lo_u32 v18, v18, v14
    v_add_u32 v18, s76, v18
    v_and_b32 v18, 31, v18
    v_cvt_f32_u32 v18, v18
    v_mul_f32 v18, s77, v18
    v_cos_f32 v25, v18
    v_lshl_add_u32 v18, v13, 2, 2
    v_mul_lo_u32 v18, v18, v14
    v_add_u32 v18, s76, v18
    v_and_b32 v18, 31, v18
    v_cvt_f32_u32 v18, v18
    v_mul_f32 v18, s77, v18
    v_cos_f32 v26, v18
    v_lshl_add_u32 v18, v13, 2, 3
    v_mul_lo_u32 v18, v18, v14
    v_add_u32 v18, s76, v18
    v_and_b32 v18, 31, v18
    v_cvt_f32_u32 v18, v18
    v_mul_f32 v18, s77, v18
    v_cos_f32 v27, v18
    v_lshl_add_u32 v18, v13, 2, 16
    v_mul_lo_u32 v18, v18, v14
    v_add_u32 v18, s76, v18
    v_and_b32 v18, 31, v18
    v_cvt_f32_u32 v18, v18
    v_mul_f32 v18, s77, v18
    v_cos_f32 v28, v18
    v_lshl_add_u32 v18, v13, 2, 17
    v_mul_lo_u32 v18, v18, v14
    v_add_u32 v18, s76, v18
    v_and_b32 v18, 31, v18
    v_cvt_f32_u32 v18, v18
    v_mul_f32 v18, s77, v18
    v_cos_f32 v29, v18
    v_lshl_add_u32 v18, v13, 2, 18
    v_mul_lo_u32 v18, v18, v14
    v_add_u32 v18, s76, v18
    v_and_b32 v18, 31, v18
    v_cvt_f32_u32 v18, v18
    v_mul_f32 v18, s77, v18
    v_cos_f32 v30, v18
    v_lshl_add_u32 v18, v13, 2, 19
    v_mul_lo_u32 v18, v18, v14
    v_add_u32 v18, s76, v18
    v_and_b32 v18, 31, v18
    v_cvt_f32_u32 v18, v18
    v_mul_f32 v18, s77, v18
    v_cos_f32 v31, v18
    v_cvt_pk_bf16_f32 v32, v24, v25
    v_cvt_pk_bf16_f32 v33, v26, v27
    v_cvt_pk_bf16_f32 v34, v28, v29
    v_cvt_pk_bf16_f32 v35, v30, v31
    s_lshl_b32 s75, s72, 10
    s_add_u32 s75, s75, 3932160
    buffer_store_dwordx4 v[32:35], v0, s[20:23], s75 offen
    s_branch l1_kernel_tabend
l1_kernel_c64:
    s_sub_u32 s72, s72, 6
    s_lshr_b32 s73, s72, 3
    s_lshr_b32 s74, s72, 1
    s_and_b32 s74, s74, 3
    s_and_b32 s78, s72, 1
    s_lshl_b32 s78, s78, 5
    s_mov_b32 s76, 0
    s_cmp_eq_u32 s73, 1
    s_cselect_b32 s76, 48, s76
    s_cmp_eq_u32 s73, 2
    s_cselect_b32 s76, 16, s76
    s_lshl_b32 s74, s74, 4
    v_add_u32 v14, s74, v12
    s_mov_b32 s77, 0x3c800000
    v_lshl_add_u32 v18, v13, 2, 0
    v_add_u32 v18, s78, v18
    v_mul_lo_u32 v18, v18, v14
    v_add_u32 v18, s76, v18
    v_and_b32 v18, 63, v18
    v_cvt_f32_u32 v18, v18
    v_mul_f32 v18, s77, v18
    v_cos_f32 v24, v18
    v_lshl_add_u32 v18, v13, 2, 1
    v_add_u32 v18, s78, v18
    v_mul_lo_u32 v18, v18, v14
    v_add_u32 v18, s76, v18
    v_and_b32 v18, 63, v18
    v_cvt_f32_u32 v18, v18
    v_mul_f32 v18, s77, v18
    v_cos_f32 v25, v18
    v_lshl_add_u32 v18, v13, 2, 2
    v_add_u32 v18, s78, v18
    v_mul_lo_u32 v18, v18, v14
    v_add_u32 v18, s76, v18
    v_and_b32 v18, 63, v18
    v_cvt_f32_u32 v18, v18
    v_mul_f32 v18, s77, v18
    v_cos_f32 v26, v18
    v_lshl_add_u32 v18, v13, 2, 3
    v_add_u32 v18, s78, v18
    v_mul_lo_u32 v18, v18, v14
    v_add_u32 v18, s76, v18
    v_and_b32 v18, 63, v18
    v_cvt_f32_u32 v18, v18
    v_mul_f32 v18, s77, v18
    v_cos_f32 v27, v18
    v_lshl_add_u32 v18, v13, 2, 16
    v_add_u32 v18, s78, v18
    v_mul_lo_u32 v18, v18, v14
    v_add_u32 v18, s76, v18
    v_and_b32 v18, 63, v18
    v_cvt_f32_u32 v18, v18
    v_mul_f32 v18, s77, v18
    v_cos_f32 v28, v18
    v_lshl_add_u32 v18, v13, 2, 17
    v_add_u32 v18, s78, v18
    v_mul_lo_u32 v18, v18, v14
    v_add_u32 v18, s76, v18
    v_and_b32 v18, 63, v18
    v_cvt_f32_u32 v18, v18
    v_mul_f32 v18, s77, v18
    v_cos_f32 v29, v18
    v_lshl_add_u32 v18, v13, 2, 18
    v_add_u32 v18, s78, v18
    v_mul_lo_u32 v18, v18, v14
    v_add_u32 v18, s76, v18
    v_and_b32 v18, 63, v18
    v_cvt_f32_u32 v18, v18
    v_mul_f32 v18, s77, v18
    v_cos_f32 v30, v18
    v_lshl_add_u32 v18, v13, 2, 19
    v_add_u32 v18, s78, v18
    v_mul_lo_u32 v18, v18, v14
    v_add_u32 v18, s76, v18
    v_and_b32 v18, 63, v18
    v_cvt_f32_u32 v18, v18
    v_mul_f32 v18, s77, v18
    v_cos_f32 v31, v18
    v_cvt_pk_bf16_f32 v32, v24, v25
    v_cvt_pk_bf16_f32 v33, v26, v27
    v_cvt_pk_bf16_f32 v34, v28, v29
    v_cvt_pk_bf16_f32 v35, v30, v31
    s_lshl_b32 s75, s72, 10
    s_add_u32 s75, s75, 3940352
    buffer_store_dwordx4 v[32:35], v0, s[20:23], s75 offen
    s_branch l1_kernel_tabend
l1_kernel_tw1:
    s_sub_u32 s72, s72, 30
    s_lshr_b32 s73, s72, 2
    s_lshl_b32 s73, s73, 4
    s_lshr_b32 s74, s72, 1
    s_and_b32 s74, s74, 1
    s_lshl_b32 s74, s74, 4
    s_and_b32 s78, s72, 1
    s_mov_b32 s76, 0
    s_cmp_eq_u32 s78, 1
    s_cselect_b32 s76, 1536, s76
    s_cmp_eq_u32 s78, 2
    s_cselect_b32 s76, 512, s76
    v_add_u32 v14, s74, v12
    s_mov_b32 s77, 0x3a000000
    v_lshl_add_u32 v18, v13, 2, 0
    v_add_u32 v18, s73, v18
    v_mul_lo_u32 v18, v18, v14
    v_add_u32 v18, s76, v18
    v_and_b32 v18, 2047, v18
    v_cvt_f32_u32 v18, v18
    v_mul_f32 v18, s77, v18
    v_cos_f32 v32, v18
    v_lshl_add_u32 v18, v13, 2, 1
    v_add_u32 v18, s73, v18
    v_mul_lo_u32 v18, v18, v14
    v_add_u32 v18, s76, v18
    v_and_b32 v18, 2047, v18
    v_cvt_f32_u32 v18, v18
    v_mul_f32 v18, s77, v18
    v_cos_f32 v33, v18
    v_lshl_add_u32 v18, v13, 2, 2
    v_add_u32 v18, s73, v18
    v_mul_lo_u32 v18, v18, v14
    v_add_u32 v18, s76, v18
    v_and_b32 v18, 2047, v18
    v_cvt_f32_u32 v18, v18
    v_mul_f32 v18, s77, v18
    v_cos_f32 v34, v18
    v_lshl_add_u32 v18, v13, 2, 3
    v_add_u32 v18, s73, v18
    v_mul_lo_u32 v18, v18, v14
    v_add_u32 v18, s76, v18
    v_and_b32 v18, 2047, v18
    v_cvt_f32_u32 v18, v18
    v_mul_f32 v18, s77, v18
    v_cos_f32 v35, v18
    s_lshl_b32 s75, s72, 10
    s_add_u32 s75, s75, 3964928
    buffer_store_dwordx4 v[32:35], v0, s[20:23], s75 offen
    s_branch l1_kernel_tabend
l1_kernel_tw2:
    s_sub_u32 s72, s72, 46
    s_lshr_b32 s73, s72, 3
    s_lshl_b32 s73, s73, 4
    s_lshr_b32 s74, s72, 1
    s_and_b32 s74, s74, 3
    s_lshl_b32 s74, s74, 4
    s_and_b32 s78, s72, 1
    s_mov_b32 s76, 0
    s_cmp_eq_u32 s78, 1
    s_cselect_b32 s76, 1536, s76
    s_cmp_eq_u32 s78, 2
    s_cselect_b32 s76, 512, s76
    v_add_u32 v14, s74, v12
    s_mov_b32 s77, 0x3a000000
    v_lshl_add_u32 v18, v13, 2, 0
    v_add_u32 v18, s73, v18
    v_mul_lo_u32 v18, v18, v14
    v_add_u32 v18, s76, v18
    v_and_b32 v18, 2047, v18
    v_cvt_f32_u32 v18, v18
    v_mul_f32 v18, s77, v18
    v_cos_f32 v32, v18
    s_nop 0
    v_mul_f32 v32, s77, v32
    v_lshl_add_u32 v18, v13, 2, 1
    v_add_u32 v18, s73, v18
    v_mul_lo_u32 v18, v18, v14
    v_add_u32 v18, s76, v18
    v_and_b32 v18, 2047, v18
    v_cvt_f32_u32 v18, v18
    v_mul_f32 v18, s77, v18
    v_cos_f32 v33, v18
    s_nop 0
    v_mul_f32 v33, s77, v33
    v_lshl_add_u32 v18, v13, 2, 2
    v_add_u32 v18, s73, v18
    v_mul_lo_u32 v18, v18, v14
    v_add_u32 v18, s76, v18
    v_and_b32 v18, 2047, v18
    v_cvt_f32_u32 v18, v18
    v_mul_f32 v18, s77, v18
    v_cos_f32 v34, v18
    s_nop 0
    v_mul_f32 v34, s77, v34
    v_lshl_add_u32 v18, v13, 2, 3
    v_add_u32 v18, s73, v18
    v_mul_lo_u32 v18, v18, v14
    v_add_u32 v18, s76, v18
    v_and_b32 v18, 2047, v18
    v_cvt_f32_u32 v18, v18
    v_mul_f32 v18, s77, v18
    v_cos_f32 v35, v18
    s_nop 0
    v_mul_f32 v35, s77, v35
    s_lshl_b32 s75, s72, 10
    s_add_u32 s75, s75, 3981312
    buffer_store_dwordx4 v[32:35], v0, s[20:23], s75 offen
l1_kernel_tabend:
    s_cmp_eq_u32 s3, 0
    s_cbranch_scc1 l1_kernel_noside
    s_mov_b32 s62, 0x05040100
    s_mov_b32 s63, 0x07060302
    s_waitcnt vmcnt(0)
    v_perm_b32 v128, v232, v224, s63
    v_perm_b32 v224, v232, v224, s62
    v_perm_b32 v129, v233, v225, s63
    v_perm_b32 v225, v233, v225, s62
    v_perm_b32 v130, v234, v226, s63
    v_perm_b32 v226, v234, v226, s62
    v_perm_b32 v131, v235, v227, s63
    v_perm_b32 v227, v235, v227, s62
    v_perm_b32 v132, v236, v228, s63
    v_perm_b32 v228, v236, v228, s62
    v_perm_b32 v133, v237, v229, s63
    v_perm_b32 v229, v237, v229, s62
    v_perm_b32 v134, v238, v230, s63
    v_perm_b32 v230, v238, v230, s62
    v_perm_b32 v135, v239, v231, s63
    v_perm_b32 v231, v239, v231, s62
    v_add_u32 v136, 0x2000, v85
    buffer_store_dwordx4 v[224:227], v85, s[20:23], s66 offen
    buffer_store_dwordx4 v[228:231], v85, s[20:23], s66 offen offset:16
    buffer_store_dwordx4 v[128:131], v136, s[20:23], s66 offen
    buffer_store_dwordx4 v[132:135], v136, s[20:23], s66 offen offset:16
    s_nop 1
    s_cmp_lt_u32 s70, 64
    s_cbranch_scc0 l1_kernel_noside
    v_perm_b32 v128, v76, v68, s63
    v_perm_b32 v68, v76, v68, s62
    v_perm_b32 v129, v77, v69, s63
    v_perm_b32 v69, v77, v69, s62
    v_perm_b32 v130, v78, v70, s63
    v_perm_b32 v70, v78, v70, s62
    v_perm_b32 v131, v79, v71, s63
    v_perm_b32 v71, v79, v71, s62
    v_perm_b32 v132, v80, v72, s63
    v_perm_b32 v72, v80, v72, s62
    v_perm_b32 v133, v81, v73, s63
    v_perm_b32 v73, v81, v73, s62
    v_perm_b32 v134, v82, v74, s63
    v_perm_b32 v74, v82, v74, s62
    v_perm_b32 v135, v83, v75, s63
    v_perm_b32 v75, v83, v75, s62
    v_add_u32 v136, 0x2000, v85
    buffer_store_dwordx4 v[68:71], v85, s[20:23], s67 offen
    buffer_store_dwordx4 v[72:75], v85, s[20:23], s67 offen offset:16
    buffer_store_dwordx4 v[128:131], v136, s[20:23], s67 offen
    buffer_store_dwordx4 v[132:135], v136, s[20:23], s67 offen offset:16
    s_nop 1
l1_kernel_noside:
    s_lshl_b32 s62, s83, 2
    s_add_u32 s62, s62, s3
    s_lshl_b32 s62, s62, 4
    v_and_b32 v12, 15, v11
    v_lshrrev_b32 v13, 4, v11
    v_add_u32 v14, s62, v12
    v_and_b32 v15, 1, v14
    v_lshrrev_b32 v14, 1, v14
    v_add_u32 v14, 1, v14
    v_mul_u32_u24 v15, 144, v15
    v_lshlrev_b32 v16, 3, v13
    v_mul_u32_u24 v16, v16, v14
    v_add_u32 v16, v16, v15
    v_cvt_f32_u32 v16, v16
    v_cvt_f32_u32 v14, v14
    s_mov_b32 s63, 0x3ae38e39
    s_mov_b32 s64, 0xc4100000
    v_mul_f32 v17, 0x44080000, v14
    v_mul_f32 v18, s63, v16
    v_floor_f32 v18, v18
    v_fma_f32 v18, v18, s64, v16
    v_mul_f32 v18, s63, v18
    v_cos_f32 v28, v18
    v_add_f32 v15, v16, v17
    v_mul_f32 v19, s63, v15
    v_floor_f32 v19, v19
    v_fma_f32 v19, v19, s64, v15
    v_mul_f32 v19, s63, v19
    v_cos_f32 v20, v19
    v_add_f32 v16, v16, v14
    v_mul_f32 v18, s63, v16
    v_floor_f32 v18, v18
    v_fma_f32 v18, v18, s64, v16
    v_mul_f32 v18, s63, v18
    v_cos_f32 v29, v18
    v_add_f32 v15, v16, v17
    v_mul_f32 v19, s63, v15
    v_floor_f32 v19, v19
    v_fma_f32 v19, v19, s64, v15
    v_mul_f32 v19, s63, v19
    v_cos_f32 v21, v19
    v_add_f32 v16, v16, v14
    v_mul_f32 v18, s63, v16
    v_floor_f32 v18, v18
    v_fma_f32 v18, v18, s64, v16
    v_mul_f32 v18, s63, v18
    v_cos_f32 v30, v18
    v_add_f32 v15, v16, v17
    v_mul_f32 v19, s63, v15
    v_floor_f32 v19, v19
    v_fma_f32 v19, v19, s64, v15
    v_mul_f32 v19, s63, v19
    v_cos_f32 v22, v19
    v_add_f32 v16, v16, v14
    v_mul_f32 v18, s63, v16
    v_floor_f32 v18, v18
    v_fma_f32 v18, v18, s64, v16
    v_mul_f32 v18, s63, v18
    v_cos_f32 v31, v18
    v_add_f32 v15, v16, v17
    v_mul_f32 v19, s63, v15
    v_floor_f32 v19, v19
    v_fma_f32 v19, v19, s64, v15
    v_mul_f32 v19, s63, v19
    v_cos_f32 v23, v19
    v_add_f32 v16, v16, v14
    v_mul_f32 v18, s63, v16
    v_floor_f32 v18, v18
    v_fma_f32 v18, v18, s64, v16
    v_mul_f32 v18, s63, v18
    v_cos_f32 v32, v18
    v_add_f32 v15, v16, v17
    v_mul_f32 v19, s63, v15
    v_floor_f32 v19, v19
    v_fma_f32 v19, v19, s64, v15
    v_mul_f32 v19, s63, v19
    v_cos_f32 v24, v19
    v_add_f32 v16, v16, v14
    v_mul_f32 v18, s63, v16
    v_floor_f32 v18, v18
    v_fma_f32 v18, v18, s64, v16
    v_mul_f32 v18, s63, v18
    v_cos_f32 v33, v18
    v_add_f32 v15, v16, v17
    v_mul_f32 v19, s63, v15
    v_floor_f32 v19, v19
    v_fma_f32 v19, v19, s64, v15
    v_mul_f32 v19, s63, v19
    v_cos_f32 v25, v19
    v_add_f32 v16, v16, v14
    v_mul_f32 v18, s63, v16
    v_floor_f32 v18, v18
    v_fma_f32 v18, v18, s64, v16
    v_mul_f32 v18, s63, v18
    v_cos_f32 v34, v18
    v_add_f32 v15, v16, v17
    v_mul_f32 v19, s63, v15
    v_floor_f32 v19, v19
    v_fma_f32 v19, v19, s64, v15
    v_mul_f32 v19, s63, v19
    v_cos_f32 v26, v19
    v_add_f32 v16, v16, v14
    v_mul_f32 v18, s63, v16
    v_floor_f32 v18, v18
    v_fma_f32 v18, v18, s64, v16
    v_mul_f32 v18, s63, v18
    v_cos_f32 v35, v18
    v_add_f32 v15, v16, v17
    v_mul_f32 v19, s63, v15
    v_floor_f32 v19, v19
    v_fma_f32 v19, v19, s64, v15
    v_mul_f32 v19, s63, v19
    v_cos_f32 v27, v19
    v_mul_f32 v15, 0x42000000, v14
    v_mul_f32 v18, s63, v15
    v_floor_f32 v18, v18
    v_fma_f32 v18, v18, s64, v15
    v_mul_f32 v18, s63, v18
    v_cos_f32 v36, v18
    s_nop 0
    v_add_f32 v36, v36, v36
    s_cmp_eq_u32 s3, 0
    s_cbranch_scc0 l1_kernel_xskip
    s_and_b32 s70, s37, 3
    s_lshr_b32 s71, s38, 2
    s_cmp_eq_u32 s70, s71
    s_cbranch_scc1 l1_kernel_nonap
    s_sleep 60
l1_kernel_nonap:
    s_mov_b32 s41, 2097152
    buffer_load_dword v14, v46, s[24:27], 0 offen sc1
    s_sleep 8
    buffer_load_dword v15, v46, s[24:27], 0 offen sc1
l1_kernel_x_spin:
    s_waitcnt vmcnt(1)
    v_cmp_gt_u32 vcc, 4, v14
    s_sub_u32 s41, s41, 1
    s_cmp_eq_u32 s41, 0
    s_cbranch_scc1 l1_kernel_x_done
    s_nop 0
    s_cmp_eq_u64 vcc, 0
    s_cbranch_scc1 l1_kernel_x_done
    s_sleep 8
    buffer_load_dword v14, v46, s[24:27], 0 offen sc1
    s_waitcnt vmcnt(1)
    v_cmp_gt_u32 vcc, 4, v15
    s_sub_u32 s41, s41, 1
    s_cmp_eq_u32 s41, 0
    s_cbranch_scc1 l1_kernel_x_done
    s_nop 0
    s_cmp_eq_u64 vcc, 0
    s_cbranch_scc1 l1_kernel_x_done
    s_sleep 8
    buffer_load_dword v15, v46, s[24:27], 0 offen sc1
    s_branch l1_kernel_x_spin
l1_kernel_x_done:
l1_kernel_xskip:
    s_barrier
    s_add_u32 m0, s52, 0
    s_add_u32 s57, s50, 0
    buffer_load_dwordx4 v0, s[20:23], s57 offen sc1 lds
    buffer_load_dwordx4 v0, s[20:23], s57 offen offset:1024 sc1 lds
    s_add_u32 m0, s52, 2048
    s_add_u32 s57, s50, 18432
    buffer_load_dwordx4 v0, s[20:23], s57 offen sc1 lds
    buffer_load_dwordx4 v0, s[20:23], s57 offen offset:1024 sc1 lds
    s_add_u32 m0, s52, 32768
    s_add_u32 s57, s50, 2048
    buffer_load_dwordx4 v0, s[20:23], s57 offen sc1 lds
    buffer_load_dwordx4 v0, s[20:23], s57 offen offset:1024 sc1 lds
    s_add_u32 m0, s52, 34816
    s_add_u32 s57, s50, 20480
    buffer_load_dwordx4 v0, s[20:23], s57 offen sc1 lds
    buffer_load_dwordx4 v0, s[20:23], s57 offen offset:1024 sc1 lds
    s_add_u32 m0, s52, 65536
    s_add_u32 s57, s50, 4096
    buffer_load_dwordx4 v0, s[20:23], s57 offen sc1 lds
    buffer_load_dwordx4 v0, s[20:23], s57 offen offset:1024 sc1 lds
    s_add_u32 m0, s52, 67584
    s_add_u32 s57, s50, 22528
    buffer_load_dwordx4 v0, s[20:23], s57 offen sc1 lds
    buffer_load_dwordx4 v0, s[20:23], s57 offen offset:1024 sc1 lds
    s_waitcnt vmcnt(8)
    s_barrier
    ds_read_b128 a[0:3], v88 offset:0
    ds_read_b128 a[72:75], v88 offset:2048
    ds_read_b128 a[144:147], v88 offset:4096
    ds_read_b128 a[216:219], v88 offset:6144
    ds_read_b64_tr_b16 v[48:49], v3 offset:16384
    ds_read_b64_tr_b16 v[50:51], v3 offset:16896
    ds_read_b64_tr_b16 v[52:53], v3 offset:24576
    ds_read_b64_tr_b16 v[54:55], v3 offset:25088
    s_waitcnt lgkmcnt(2)
    v_mfma_f32_16x16x32_bf16 v[128:131], v[48:51], a[0:3], 0
    ds_read_b64_tr_b16 v[56:57], v5 offset:16384
    s_add_u32 m0, s52, 98304
    s_add_u32 s57, s50, 6144
    v_mfma_f32_16x16x32_bf16 v[132:135], v[48:51], a[72:75], 0
    ds_read_b64_tr_b16 v[58:59], v5 offset:16896
    buffer_load_dwordx4 v0, s[20:23], s57 offen sc1 lds
    v_mfma_f32_16x16x32_bf16 v[136:139], v[48:51], a[144:147], 0
    ds_read_b64_tr_b16 v[60:61], v5 offset:24576
    v_mfma_f32_16x16x32_bf16 v[140:143], v[48:51], a[216:219], 0
    ds_read_b64_tr_b16 v[62:63], v5 offset:25088
    s_waitcnt lgkmcnt(4)
    v_mfma_f32_16x16x32_bf16 v[144:147], v[52:55], a[0:3], 0
    ds_read_b128 a[4:7], v88 offset:1024
    buffer_load_dwordx4 v0, s[20:23], s57 offen offset:1024 sc1 lds
    s_add_u32 m0, s52, 100352
    v_mfma_f32_16x16x32_bf16 v[148:151], v[52:55], a[72:75], 0
    ds_read_b128 a[76:79], v88 offset:3072
    s_add_u32 s57, s50, 24576
    v_mfma_f32_16x16x32_bf16 v[152:155], v[52:55], a[144:147], 0
    ds_read_b128 a[148:151], v88 offset:5120
    v_mfma_f32_16x16x32_bf16 v[156:159], v[52:55], a[216:219], 0
    ds_read_b128 a[220:223], v88 offset:7168
    buffer_load_dwordx4 v0, s[20:23], s57 offen sc1 lds
    s_waitcnt lgkmcnt(6)
    v_mfma_f32_16x16x32_bf16 v[160:163], v[56:59], a[0:3], 0
    ds_read_b64_tr_b16 v[64:65], v3 offset:20480
    v_mfma_f32_16x16x32_bf16 v[164:167], v[56:59], a[72:75], 0
    ds_read_b64_tr_b16 v[66:67], v3 offset:20992
    v_mfma_f32_16x16x32_bf16 v[168:171], v[56:59], a[144:147], 0
    ds_read_b64_tr_b16 v[48:49], v3 offset:28672
    buffer_load_dwordx4 v0, s[20:23], s57 offen offset:1024 sc1 lds
    s_add_u32 m0, s52, 131072
    v_mfma_f32_16x16x32_bf16 v[172:175], v[56:59], a[216:219], 0
    ds_read_b64_tr_b16 v[50:51], v3 offset:29184
    s_add_u32 s57, s50, 8192
    s_waitcnt lgkmcnt(8)
    v_mfma_f32_16x16x32_bf16 v[176:179], v[60:63], a[0:3], 0
    ds_read_b64_tr_b16 v[52:53], v5 offset:20480
    v_mfma_f32_16x16x32_bf16 v[180:183], v[60:63], a[72:75], 0
    ds_read_b64_tr_b16 v[54:55], v5 offset:20992
    buffer_load_dwordx4 v0, s[20:23], s57 offen sc1 lds
    v_mfma_f32_16x16x32_bf16 v[184:187], v[60:63], a[144:147], 0
    v_mfma_f32_16x16x32_bf16 v[188:191], v[60:63], a[216:219], 0
    s_waitcnt lgkmcnt(4)
    v_mfma_f32_16x16x32_bf16 v[128:131], v[64:67], a[4:7], v[128:131]
    ds_read_b64_tr_b16 v[56:57], v5 offset:28672
    buffer_load_dwordx4 v0, s[20:23], s57 offen offset:1024 sc1 lds
    s_add_u32 m0, s52, 133120
    v_mfma_f32_16x16x32_bf16 v[132:135], v[64:67], a[76:79], v[132:135]
    ds_read_b64_tr_b16 v[58:59], v5 offset:29184
    s_add_u32 s57, s50, 26624
    v_mfma_f32_16x16x32_bf16 v[136:139], v[64:67], a[148:151], v[136:139]
    v_mfma_f32_16x16x32_bf16 v[140:143], v[64:67], a[220:223], v[140:143]
    buffer_load_dwordx4 v0, s[20:23], s57 offen sc1 lds
    s_waitcnt lgkmcnt(4)
    v_mfma_f32_16x16x32_bf16 v[144:147], v[48:51], a[4:7], v[144:147]
    s_waitcnt vmcnt(11)
    s_barrier
    ds_read_b128 a[8:11], v88 offset:32768
    v_mfma_f32_16x16x32_bf16 v[148:151], v[48:51], a[76:79], v[148:151]
    ds_read_b128 a[80:83], v88 offset:34816
    v_mfma_f32_16x16x32_bf16 v[152:155], v[48:51], a[148:151], v[152:155]
    ds_read_b128 a[152:155], v88 offset:36864
    buffer_load_dwordx4 v0, s[20:23], s57 offen offset:1024 sc1 lds
    s_add_u32 m0, s53, 147456
    v_mfma_f32_16x16x32_bf16 v[156:159], v[48:51], a[220:223], v[156:159]
    ds_read_b128 a[224:227], v88 offset:38912
    s_add_u32 s57, s32, 2359296
    s_waitcnt lgkmcnt(6)
    v_mfma_f32_16x16x32_bf16 v[160:163], v[52:55], a[4:7], v[160:163]
    ds_read_b64_tr_b16 v[60:61], v3 offset:49152
    v_mfma_f32_16x16x32_bf16 v[164:167], v[52:55], a[76:79], v[164:167]
    ds_read_b64_tr_b16 v[62:63], v3 offset:49664
    buffer_load_dwordx4 v1, s[12:15], s57 offen lds
    s_add_u32 m0, s53, 151552
    v_mfma_f32_16x16x32_bf16 v[168:171], v[52:55], a[148:151], v[168:171]
    ds_read_b64_tr_b16 v[64:65], v3 offset:57344
    s_add_u32 s57, s32, 2654208
    v_mfma_f32_16x16x32_bf16 v[172:175], v[52:55], a[220:223], v[172:175]
    ds_read_b64_tr_b16 v[66:67], v3 offset:57856
    s_waitcnt lgkmcnt(8)
    v_mfma_f32_16x16x32_bf16 v[176:179], v[56:59], a[4:7], v[176:179]
    ds_read_b64_tr_b16 v[48:49], v5 offset:49152
    buffer_load_dwordx4 v1, s[12:15], s57 offen lds
    s_add_u32 m0, s53, 155648
    v_mfma_f32_16x16x32_bf16 v[180:183], v[56:59], a[76:79], v[180:183]
    ds_read_b64_tr_b16 v[50:51], v5 offset:49664
    s_add_u32 s57, s32, 2359296
    v_mfma_f32_16x16x32_bf16 v[184:187], v[56:59], a[148:151], v[184:187]
    v_mfma_f32_16x16x32_bf16 v[188:191], v[56:59], a[220:223], v[188:191]
    buffer_load_dwordx4 v1, s[16:19], s57 offen lds
    s_add_u32 m0, s53, 159744
    s_waitcnt lgkmcnt(4)
    v_mfma_f32_16x16x32_bf16 v[128:131], v[60:63], a[8:11], v[128:131]
    ds_read_b64_tr_b16 v[52:53], v5 offset:57344
    s_add_u32 s57, s32, 2654208
    v_mfma_f32_16x16x32_bf16 v[132:135], v[60:63], a[80:83], v[132:135]
    ds_read_b64_tr_b16 v[54:55], v5 offset:57856
    v_mfma_f32_16x16x32_bf16 v[136:139], v[60:63], a[152:155], v[136:139]
    buffer_load_dwordx4 v1, s[16:19], s57 offen lds
    v_mfma_f32_16x16x32_bf16 v[140:143], v[60:63], a[224:227], v[140:143]
    s_waitcnt lgkmcnt(4)
    v_mfma_f32_16x16x32_bf16 v[144:147], v[64:67], a[8:11], v[144:147]
    ds_read_b128 a[12:15], v88 offset:33792
    v_mfma_f32_16x16x32_bf16 v[148:151], v[64:67], a[80:83], v[148:151]
    ds_read_b128 a[84:87], v88 offset:35840
    buffer_load_dword v37, v43, s[12:15], s34 offen
    v_mfma_f32_16x16x32_bf16 v[152:155], v[64:67], a[152:155], v[152:155]
    ds_read_b128 a[156:159], v88 offset:37888
    v_mfma_f32_16x16x32_bf16 v[156:159], v[64:67], a[224:227], v[156:159]
    ds_read_b128 a[228:231], v88 offset:39936
    s_waitcnt lgkmcnt(6)
    v_mfma_f32_16x16x32_bf16 v[160:163], v[48:51], a[8:11], v[160:163]
    ds_read_b64_tr_b16 v[56:57], v3 offset:53248
    buffer_load_dword v37, v43, s[16:19], s34 offen
    v_mfma_f32_16x16x32_bf16 v[164:167], v[48:51], a[80:83], v[164:167]
    ds_read_b64_tr_b16 v[58:59], v3 offset:53760
    v_mfma_f32_16x16x32_bf16 v[168:171], v[48:51], a[152:155], v[168:171]
    ds_read_b64_tr_b16 v[60:61], v3 offset:61440
    v_mfma_f32_16x16x32_bf16 v[172:175], v[48:51], a[224:227], v[172:175]
    ds_read_b64_tr_b16 v[62:63], v3 offset:61952
    s_waitcnt lgkmcnt(8)
    v_mfma_f32_16x16x32_bf16 v[176:179], v[52:55], a[8:11], v[176:179]
    ds_read_b64_tr_b16 v[64:65], v5 offset:53248
    v_mfma_f32_16x16x32_bf16 v[180:183], v[52:55], a[80:83], v[180:183]
    ds_read_b64_tr_b16 v[66:67], v5 offset:53760
    v_mfma_f32_16x16x32_bf16 v[184:187], v[52:55], a[152:155], v[184:187]
    v_mfma_f32_16x16x32_bf16 v[188:191], v[52:55], a[224:227], v[188:191]
    s_waitcnt lgkmcnt(4)
    v_mfma_f32_16x16x32_bf16 v[128:131], v[56:59], a[12:15], v[128:131]
    ds_read_b64_tr_b16 v[48:49], v5 offset:61440
    v_mfma_f32_16x16x32_bf16 v[132:135], v[56:59], a[84:87], v[132:135]
    ds_read_b64_tr_b16 v[50:51], v5 offset:61952
    v_mfma_f32_16x16x32_bf16 v[136:139], v[56:59], a[156:159], v[136:139]
    v_mfma_f32_16x16x32_bf16 v[140:143], v[56:59], a[228:231], v[140:143]
    s_waitcnt lgkmcnt(4)
    v_mfma_f32_16x16x32_bf16 v[144:147], v[60:63], a[12:15], v[144:147]
    s_waitcnt vmcnt(14)
    s_barrier
    ds_read_b128 a[16:19], v89 offset:0
    v_mfma_f32_16x16x32_bf16 v[148:151], v[60:63], a[84:87], v[148:151]
    ds_read_b128 a[88:91], v89 offset:2048
    s_add_u32 m0, s52, 0
    s_add_u32 s57, s50, 10240
    v_mfma_f32_16x16x32_bf16 v[152:155], v[60:63], a[156:159], v[152:155]
    ds_read_b128 a[160:163], v89 offset:4096
    buffer_load_dwordx4 v0, s[20:23], s57 offen sc1 lds
    v_mfma_f32_16x16x32_bf16 v[156:159], v[60:63], a[228:231], v[156:159]
    ds_read_b128 a[232:235], v89 offset:6144
    s_waitcnt lgkmcnt(6)
    v_mfma_f32_16x16x32_bf16 v[160:163], v[64:67], a[12:15], v[160:163]
    ds_read_b64_tr_b16 v[52:53], v4 offset:16384
    v_mfma_f32_16x16x32_bf16 v[164:167], v[64:67], a[84:87], v[164:167]
    ds_read_b64_tr_b16 v[54:55], v4 offset:16896
    buffer_load_dwordx4 v0, s[20:23], s57 offen offset:1024 sc1 lds
    s_add_u32 m0, s52, 2048
    v_mfma_f32_16x16x32_bf16 v[168:171], v[64:67], a[156:159], v[168:171]
    ds_read_b64_tr_b16 v[56:57], v4 offset:24576
    s_add_u32 s57, s50, 28672
    v_mfma_f32_16x16x32_bf16 v[172:175], v[64:67], a[228:231], v[172:175]
    ds_read_b64_tr_b16 v[58:59], v4 offset:25088
    s_waitcnt lgkmcnt(8)
    v_mfma_f32_16x16x32_bf16 v[176:179], v[48:51], a[12:15], v[176:179]
    ds_read_b64_tr_b16 v[60:61], v6 offset:16384
    buffer_load_dwordx4 v0, s[20:23], s57 offen sc1 lds
    v_mfma_f32_16x16x32_bf16 v[180:183], v[48:51], a[84:87], v[180:183]
    ds_read_b64_tr_b16 v[62:63], v6 offset:16896
    v_mfma_f32_16x16x32_bf16 v[184:187], v[48:51], a[156:159], v[184:187]
    v_mfma_f32_16x16x32_bf16 v[188:191], v[48:51], a[228:231], v[188:191]
    buffer_load_dwordx4 v0, s[20:23], s57 offen offset:1024 sc1 lds
    s_add_u32 m0, s53, 16384
    s_waitcnt lgkmcnt(4)
    v_mfma_f32_16x16x32_bf16 v[128:131], v[52:55], a[16:19], v[128:131]
    ds_read_b64_tr_b16 v[64:65], v6 offset:24576
    s_add_u32 s57, s32, 2949120
    v_mfma_f32_16x16x32_bf16 v[132:135], v[52:55], a[88:91], v[132:135]
    ds_read_b64_tr_b16 v[66:67], v6 offset:25088
    v_mfma_f32_16x16x32_bf16 v[136:139], v[52:55], a[160:163], v[136:139]
    buffer_load_dwordx4 v1, s[12:15], s57 offen lds
    s_add_u32 m0, s53, 20480
    s_add_u32 s57, s32, 3244032
    v_mfma_f32_16x16x32_bf16 v[140:143], v[52:55], a[232:235], v[140:143]
    s_waitcnt lgkmcnt(4)
    v_mfma_f32_16x16x32_bf16 v[144:147], v[56:59], a[16:19], v[144:147]
    ds_read_b128 a[20:23], v89 offset:1024
    v_mfma_f32_16x16x32_bf16 v[148:151], v[56:59], a[88:91], v[148:151]
    ds_read_b128 a[92:95], v89 offset:3072
    buffer_load_dwordx4 v1, s[12:15], s57 offen lds
    s_add_u32 m0, s53, 24576
    v_mfma_f32_16x16x32_bf16 v[152:155], v[56:59], a[160:163], v[152:155]
    ds_read_b128 a[164:167], v89 offset:5120
    s_add_u32 s57, s32, 2949120
    v_mfma_f32_16x16x32_bf16 v[156:159], v[56:59], a[232:235], v[156:159]
    ds_read_b128 a[236:239], v89 offset:7168
    s_waitcnt lgkmcnt(6)
    v_mfma_f32_16x16x32_bf16 v[160:163], v[60:63], a[16:19], v[160:163]
    ds_read_b64_tr_b16 v[48:49], v4 offset:20480
    buffer_load_dwordx4 v1, s[16:19], s57 offen lds
    s_add_u32 m0, s53, 28672
    v_mfma_f32_16x16x32_bf16 v[164:167], v[60:63], a[88:91], v[164:167]
    ds_read_b64_tr_b16 v[50:51], v4 offset:20992
    s_add_u32 s57, s32, 3244032
    v_mfma_f32_16x16x32_bf16 v[168:171], v[60:63], a[160:163], v[168:171]
    ds_read_b64_tr_b16 v[52:53], v4 offset:28672
    v_mfma_f32_16x16x32_bf16 v[172:175], v[60:63], a[232:235], v[172:175]
    ds_read_b64_tr_b16 v[54:55], v4 offset:29184
    buffer_load_dwordx4 v1, s[16:19], s57 offen lds
    s_waitcnt lgkmcnt(8)
    v_mfma_f32_16x16x32_bf16 v[176:179], v[64:67], a[16:19], v[176:179]
    ds_read_b64_tr_b16 v[56:57], v6 offset:20480
    v_mfma_f32_16x16x32_bf16 v[180:183], v[64:67], a[88:91], v[180:183]
    ds_read_b64_tr_b16 v[58:59], v6 offset:20992
    v_mfma_f32_16x16x32_bf16 v[184:187], v[64:67], a[160:163], v[184:187]
    v_mfma_f32_16x16x32_bf16 v[188:191], v[64:67], a[232:235], v[188:191]
    s_waitcnt lgkmcnt(4)
    v_mfma_f32_16x16x32_bf16 v[128:131], v[48:51], a[20:23], v[128:131]
    ds_read_b64_tr_b16 v[60:61], v6 offset:28672
    v_mfma_f32_16x16x32_bf16 v[132:135], v[48:51], a[92:95], v[132:135]
    ds_read_b64_tr_b16 v[62:63], v6 offset:29184
    v_mfma_f32_16x16x32_bf16 v[136:139], v[48:51], a[164:167], v[136:139]
    v_mfma_f32_16x16x32_bf16 v[140:143], v[48:51], a[236:239], v[140:143]
    s_waitcnt lgkmcnt(4)
    v_mfma_f32_16x16x32_bf16 v[144:147], v[52:55], a[20:23], v[144:147]
    s_waitcnt vmcnt(18)
    s_barrier
    ds_read_b128 a[24:27], v89 offset:32768
    v_mfma_f32_16x16x32_bf16 v[148:151], v[52:55], a[92:95], v[148:151]
    ds_read_b128 a[96:99], v89 offset:34816
    s_add_u32 m0, s52, 32768
    s_add_u32 s57, s50, 12288
    v_mfma_f32_16x16x32_bf16 v[152:155], v[52:55], a[164:167], v[152:155]
    ds_read_b128 a[168:171], v89 offset:36864
    buffer_load_dwordx4 v0, s[20:23], s57 offen sc1 lds
    v_mfma_f32_16x16x32_bf16 v[156:159], v[52:55], a[236:239], v[156:159]
    ds_read_b128 a[240:243], v89 offset:38912
    s_waitcnt lgkmcnt(6)
    v_mfma_f32_16x16x32_bf16 v[160:163], v[56:59], a[20:23], v[160:163]
    ds_read_b64_tr_b16 v[64:65], v4 offset:49152
    v_mfma_f32_16x16x32_bf16 v[164:167], v[56:59], a[92:95], v[164:167]
    ds_read_b64_tr_b16 v[66:67], v4 offset:49664
    buffer_load_dwordx4 v0, s[20:23], s57 offen offset:1024 sc1 lds
    s_add_u32 m0, s52, 34816
    v_mfma_f32_16x16x32_bf16 v[168:171], v[56:59], a[164:167], v[168:171]
    ds_read_b64_tr_b16 v[48:49], v4 offset:57344
    s_add_u32 s57, s50, 30720
    v_mfma_f32_16x16x32_bf16 v[172:175], v[56:59], a[236:239], v[172:175]
    ds_read_b64_tr_b16 v[50:51], v4 offset:57856
    s_waitcnt lgkmcnt(8)
    v_mfma_f32_16x16x32_bf16 v[176:179], v[60:63], a[20:23], v[176:179]
    ds_read_b64_tr_b16 v[52:53], v6 offset:49152
    buffer_load_dwordx4 v0, s[20:23], s57 offen sc1 lds
    v_mfma_f32_16x16x32_bf16 v[180:183], v[60:63], a[92:95], v[180:183]
    ds_read_b64_tr_b16 v[54:55], v6 offset:49664
    v_mfma_f32_16x16x32_bf16 v[184:187], v[60:63], a[164:167], v[184:187]
    v_mfma_f32_16x16x32_bf16 v[188:191], v[60:63], a[236:239], v[188:191]
    buffer_load_dwordx4 v0, s[20:23], s57 offen offset:1024 sc1 lds
    s_add_u32 m0, s53, 49152
    s_waitcnt lgkmcnt(4)
    v_mfma_f32_16x16x32_bf16 v[128:131], v[64:67], a[24:27], v[128:131]
    ds_read_b64_tr_b16 v[56:57], v6 offset:57344
    s_add_u32 s57, s32, 3538944
    v_mfma_f32_16x16x32_bf16 v[132:135], v[64:67], a[96:99], v[132:135]
    ds_read_b64_tr_b16 v[58:59], v6 offset:57856
    v_mfma_f32_16x16x32_bf16 v[136:139], v[64:67], a[168:171], v[136:139]
    buffer_load_dwordx4 v1, s[12:15], s57 offen lds
    s_add_u32 m0, s53, 53248
    s_add_u32 s57, s32, 3833856
    v_mfma_f32_16x16x32_bf16 v[140:143], v[64:67], a[240:243], v[140:143]
    s_waitcnt lgkmcnt(4)
    v_mfma_f32_16x16x32_bf16 v[144:147], v[48:51], a[24:27], v[144:147]
    ds_read_b128 a[28:31], v89 offset:33792
    v_mfma_f32_16x16x32_bf16 v[148:151], v[48:51], a[96:99], v[148:151]
    ds_read_b128 a[100:103], v89 offset:35840
    buffer_load_dwordx4 v1, s[12:15], s57 offen lds
    s_add_u32 m0, s53, 57344
    v_mfma_f32_16x16x32_bf16 v[152:155], v[48:51], a[168:171], v[152:155]
    ds_read_b128 a[172:175], v89 offset:37888
    s_add_u32 s57, s32, 3538944
    v_mfma_f32_16x16x32_bf16 v[156:159], v[48:51], a[240:243], v[156:159]
    ds_read_b128 a[244:247], v89 offset:39936
    s_waitcnt lgkmcnt(6)
    v_mfma_f32_16x16x32_bf16 v[160:163], v[52:55], a[24:27], v[160:163]
    ds_read_b64_tr_b16 v[60:61], v4 offset:53248
    buffer_load_dwordx4 v1, s[16:19], s57 offen lds
    s_add_u32 m0, s53, 61440
    v_mfma_f32_16x16x32_bf16 v[164:167], v[52:55], a[96:99], v[164:167]
    ds_read_b64_tr_b16 v[62:63], v4 offset:53760
    s_add_u32 s57, s32, 3833856
    v_mfma_f32_16x16x32_bf16 v[168:171], v[52:55], a[168:171], v[168:171]
    ds_read_b64_tr_b16 v[64:65], v4 offset:61440
    v_mfma_f32_16x16x32_bf16 v[172:175], v[52:55], a[240:243], v[172:175]
    ds_read_b64_tr_b16 v[66:67], v4 offset:61952
    buffer_load_dwordx4 v1, s[16:19], s57 offen lds
    s_waitcnt lgkmcnt(8)
    v_mfma_f32_16x16x32_bf16 v[176:179], v[56:59], a[24:27], v[176:179]
    ds_read_b64_tr_b16 v[48:49], v6 offset:53248
    v_mfma_f32_16x16x32_bf16 v[180:183], v[56:59], a[96:99], v[180:183]
    ds_read_b64_tr_b16 v[50:51], v6 offset:53760
    v_mfma_f32_16x16x32_bf16 v[184:187], v[56:59], a[168:171], v[184:187]
    v_mfma_f32_16x16x32_bf16 v[188:191], v[56:59], a[240:243], v[188:191]
    s_waitcnt lgkmcnt(4)
    v_mfma_f32_16x16x32_bf16 v[128:131], v[60:63], a[28:31], v[128:131]
    ds_read_b64_tr_b16 v[52:53], v6 offset:61440
    v_mfma_f32_16x16x32_bf16 v[132:135], v[60:63], a[100:103], v[132:135]
    ds_read_b64_tr_b16 v[54:55], v6 offset:61952
    v_mfma_f32_16x16x32_bf16 v[136:139], v[60:63], a[172:175], v[136:139]
    v_mfma_f32_16x16x32_bf16 v[140:143], v[60:63], a[244:247], v[140:143]
    s_waitcnt lgkmcnt(4)
    v_mfma_f32_16x16x32_bf16 v[144:147], v[64:67], a[28:31], v[144:147]
    s_waitcnt vmcnt(18)
    s_barrier
    ds_read_b128 a[32:35], v41 offset:0
    v_mfma_f32_16x16x32_bf16 v[148:151], v[64:67], a[100:103], v[148:151]
    ds_read_b128 a[104:107], v41 offset:2048
    s_add_u32 m0, s52, 65536
    s_add_u32 s57, s50, 14336
    v_mfma_f32_16x16x32_bf16 v[152:155], v[64:67], a[172:175], v[152:155]
    ds_read_b128 a[176:179], v41 offset:4096
    buffer_load_dwordx4 v0, s[20:23], s57 offen sc1 lds
    v_mfma_f32_16x16x32_bf16 v[156:159], v[64:67], a[244:247], v[156:159]
    ds_read_b128 a[248:251], v41 offset:6144
    s_waitcnt lgkmcnt(6)
    v_mfma_f32_16x16x32_bf16 v[160:163], v[48:51], a[28:31], v[160:163]
    ds_read_b64_tr_b16 v[56:57], v38 offset:16384
    v_mfma_f32_16x16x32_bf16 v[164:167], v[48:51], a[100:103], v[164:167]
    ds_read_b64_tr_b16 v[58:59], v38 offset:16896
    buffer_load_dwordx4 v0, s[20:23], s57 offen offset:1024 sc1 lds
    s_add_u32 m0, s52, 67584
    v_mfma_f32_16x16x32_bf16 v[168:171], v[48:51], a[172:175], v[168:171]
    ds_read_b64_tr_b16 v[60:61], v38 offset:24576
    s_add_u32 s57, s50, 32768
    v_mfma_f32_16x16x32_bf16 v[172:175], v[48:51], a[244:247], v[172:175]
    ds_read_b64_tr_b16 v[62:63], v38 offset:25088
    s_waitcnt lgkmcnt(8)
    v_mfma_f32_16x16x32_bf16 v[176:179], v[52:55], a[28:31], v[176:179]
    ds_read_b64_tr_b16 v[64:65], v39 offset:16384
    buffer_load_dwordx4 v0, s[20:23], s57 offen sc1 lds
    v_mfma_f32_16x16x32_bf16 v[180:183], v[52:55], a[100:103], v[180:183]
    ds_read_b64_tr_b16 v[66:67], v39 offset:16896
    v_mfma_f32_16x16x32_bf16 v[184:187], v[52:55], a[172:175], v[184:187]
    v_mfma_f32_16x16x32_bf16 v[188:191], v[52:55], a[244:247], v[188:191]
    buffer_load_dwordx4 v0, s[20:23], s57 offen offset:1024 sc1 lds
    s_add_u32 m0, s53, 81920
    s_waitcnt lgkmcnt(4)
    v_mfma_f32_16x16x32_bf16 v[128:131], v[56:59], a[32:35], v[128:131]
    ds_read_b64_tr_b16 v[48:49], v39 offset:24576
    s_add_u32 s57, s32, 4128768
    v_mfma_f32_16x16x32_bf16 v[132:135], v[56:59], a[104:107], v[132:135]
    ds_read_b64_tr_b16 v[50:51], v39 offset:25088
    v_mfma_f32_16x16x32_bf16 v[136:139], v[56:59], a[176:179], v[136:139]
    buffer_load_dwordx4 v1, s[12:15], s57 offen lds
    s_add_u32 m0, s53, 86016
    s_add_u32 s57, s32, 4423680
    v_mfma_f32_16x16x32_bf16 v[140:143], v[56:59], a[248:251], v[140:143]
    s_waitcnt lgkmcnt(4)
    v_mfma_f32_16x16x32_bf16 v[144:147], v[60:63], a[32:35], v[144:147]
    ds_read_b128 a[36:39], v41 offset:1024
    v_mfma_f32_16x16x32_bf16 v[148:151], v[60:63], a[104:107], v[148:151]
    ds_read_b128 a[108:111], v41 offset:3072
    buffer_load_dwordx4 v1, s[12:15], s57 offen lds
    s_add_u32 m0, s53, 90112
    v_mfma_f32_16x16x32_bf16 v[152:155], v[60:63], a[176:179], v[152:155]
    ds_read_b128 a[180:183], v41 offset:5120
    s_add_u32 s57, s32, 4128768
    v_mfma_f32_16x16x32_bf16 v[156:159], v[60:63], a[248:251], v[156:159]
    ds_read_b128 a[252:255], v41 offset:7168
    s_waitcnt lgkmcnt(6)
    v_mfma_f32_16x16x32_bf16 v[160:163], v[64:67], a[32:35], v[160:163]
    ds_read_b64_tr_b16 v[52:53], v38 offset:20480
    buffer_load_dwordx4 v1, s[16:19], s57 offen lds
    s_add_u32 m0, s53, 94208
    v_mfma_f32_16x16x32_bf16 v[164:167], v[64:67], a[104:107], v[164:167]
    ds_read_b64_tr_b16 v[54:55], v38 offset:20992
    s_add_u32 s57, s32, 4423680
    v_mfma_f32_16x16x32_bf16 v[168:171], v[64:67], a[176:179], v[168:171]
    ds_read_b64_tr_b16 v[56:57], v38 offset:28672
    v_mfma_f32_16x16x32_bf16 v[172:175], v[64:67], a[248:251], v[172:175]
    ds_read_b64_tr_b16 v[58:59], v38 offset:29184
    buffer_load_dwordx4 v1, s[16:19], s57 offen lds
    s_waitcnt lgkmcnt(8)
    v_mfma_f32_16x16x32_bf16 v[176:179], v[48:51], a[32:35], v[176:179]
    ds_read_b64_tr_b16 v[60:61], v39 offset:20480
    v_mfma_f32_16x16x32_bf16 v[180:183], v[48:51], a[104:107], v[180:183]
    ds_read_b64_tr_b16 v[62:63], v39 offset:20992
    v_mfma_f32_16x16x32_bf16 v[184:187], v[48:51], a[176:179], v[184:187]
    v_mfma_f32_16x16x32_bf16 v[188:191], v[48:51], a[248:251], v[188:191]
    s_waitcnt lgkmcnt(4)
    v_mfma_f32_16x16x32_bf16 v[128:131], v[52:55], a[36:39], v[128:131]
    ds_read_b64_tr_b16 v[64:65], v39 offset:28672
    v_mfma_f32_16x16x32_bf16 v[132:135], v[52:55], a[108:111], v[132:135]
    ds_read_b64_tr_b16 v[66:67], v39 offset:29184
    v_mfma_f32_16x16x32_bf16 v[136:139], v[52:55], a[180:183], v[136:139]
    v_mfma_f32_16x16x32_bf16 v[140:143], v[52:55], a[252:255], v[140:143]
    s_waitcnt lgkmcnt(4)
    v_mfma_f32_16x16x32_bf16 v[144:147], v[56:59], a[36:39], v[144:147]
    s_waitcnt vmcnt(16)
    s_barrier
    ds_read_b128 a[40:43], v88 offset:0
    v_mfma_f32_16x16x32_bf16 v[148:151], v[56:59], a[108:111], v[148:151]
    ds_read_b128 a[112:115], v88 offset:2048
    s_add_u32 m0, s52, 98304
    s_add_u32 s57, s50, 16384
    v_mfma_f32_16x16x32_bf16 v[152:155], v[56:59], a[180:183], v[152:155]
    ds_read_b128 a[184:187], v88 offset:4096
    buffer_load_dwordx4 v0, s[20:23], s57 offen sc1 lds
    v_mfma_f32_16x16x32_bf16 v[156:159], v[56:59], a[252:255], v[156:159]
    ds_read_b128 v[96:99], v88 offset:6144
    s_waitcnt lgkmcnt(6)
    v_mfma_f32_16x16x32_bf16 v[160:163], v[60:63], a[36:39], v[160:163]
    ds_read_b64_tr_b16 v[48:49], v3 offset:16384
    v_mfma_f32_16x16x32_bf16 v[164:167], v[60:63], a[108:111], v[164:167]
    ds_read_b64_tr_b16 v[50:51], v3 offset:16896
    buffer_load_dwordx4 v0, s[20:23], s57 offen offset:1024 sc1 lds
    s_add_u32 m0, s52, 100352
    v_mfma_f32_16x16x32_bf16 v[168:171], v[60:63], a[180:183], v[168:171]
    ds_read_b64_tr_b16 v[52:53], v3 offset:24576
    s_add_u32 s57, s50, 34816
    v_mfma_f32_16x16x32_bf16 v[172:175], v[60:63], a[252:255], v[172:175]
    ds_read_b64_tr_b16 v[54:55], v3 offset:25088
    s_waitcnt lgkmcnt(8)
    v_mfma_f32_16x16x32_bf16 v[176:179], v[64:67], a[36:39], v[176:179]
    ds_read_b64_tr_b16 v[56:57], v5 offset:16384
    buffer_load_dwordx4 v0, s[20:23], s57 offen sc1 lds
    v_mfma_f32_16x16x32_bf16 v[180:183], v[64:67], a[108:111], v[180:183]
    ds_read_b64_tr_b16 v[58:59], v5 offset:16896
    v_mfma_f32_16x16x32_bf16 v[184:187], v[64:67], a[180:183], v[184:187]
    v_mfma_f32_16x16x32_bf16 v[188:191], v[64:67], a[252:255], v[188:191]
    buffer_load_dwordx4 v0, s[20:23], s57 offen offset:1024 sc1 lds
    s_add_u32 m0, s53, 114688
    s_waitcnt lgkmcnt(4)
    v_mfma_f32_16x16x32_bf16 v[128:131], v[48:51], a[40:43], v[128:131]
    ds_read_b64_tr_b16 v[60:61], v5 offset:24576
    s_add_u32 s57, s32, 4718592
    v_mfma_f32_16x16x32_bf16 v[132:135], v[48:51], a[112:115], v[132:135]
    ds_read_b64_tr_b16 v[62:63], v5 offset:25088
    v_mfma_f32_16x16x32_bf16 v[136:139], v[48:51], a[184:187], v[136:139]
    buffer_load_dwordx4 v1, s[12:15], s57 offen lds
    s_add_u32 m0, s53, 118784
    s_add_u32 s57, s32, 5013504
    v_mfma_f32_16x16x32_bf16 v[140:143], v[48:51], v[96:99], v[140:143]
    s_waitcnt lgkmcnt(4)
    v_mfma_f32_16x16x32_bf16 v[144:147], v[52:55], a[40:43], v[144:147]
    ds_read_b128 a[44:47], v88 offset:1024
    v_mfma_f32_16x16x32_bf16 v[148:151], v[52:55], a[112:115], v[148:151]
    ds_read_b128 a[116:119], v88 offset:3072
    buffer_load_dwordx4 v1, s[12:15], s57 offen lds
    s_add_u32 m0, s53, 122880
    v_mfma_f32_16x16x32_bf16 v[152:155], v[52:55], a[184:187], v[152:155]
    ds_read_b128 a[188:191], v88 offset:5120
    s_add_u32 s57, s32, 4718592
    v_mfma_f32_16x16x32_bf16 v[156:159], v[52:55], v[96:99], v[156:159]
    ds_read_b128 v[100:103], v88 offset:7168
    s_waitcnt lgkmcnt(6)
    v_mfma_f32_16x16x32_bf16 v[160:163], v[56:59], a[40:43], v[160:163]
    ds_read_b64_tr_b16 v[64:65], v3 offset:20480
    buffer_load_dwordx4 v1, s[16:19], s57 offen lds
    s_add_u32 m0, s53, 126976
    v_mfma_f32_16x16x32_bf16 v[164:167], v[56:59], a[112:115], v[164:167]
    ds_read_b64_tr_b16 v[66:67], v3 offset:20992
    s_add_u32 s57, s32, 5013504
    v_mfma_f32_16x16x32_bf16 v[168:171], v[56:59], a[184:187], v[168:171]
    ds_read_b64_tr_b16 v[48:49], v3 offset:28672
    v_mfma_f32_16x16x32_bf16 v[172:175], v[56:59], v[96:99], v[172:175]
    ds_read_b64_tr_b16 v[50:51], v3 offset:29184
    buffer_load_dwordx4 v1, s[16:19], s57 offen lds
    s_waitcnt lgkmcnt(8)
    v_mfma_f32_16x16x32_bf16 v[176:179], v[60:63], a[40:43], v[176:179]
    ds_read_b64_tr_b16 v[52:53], v5 offset:20480
    v_mfma_f32_16x16x32_bf16 v[180:183], v[60:63], a[112:115], v[180:183]
    ds_read_b64_tr_b16 v[54:55], v5 offset:20992
    v_mfma_f32_16x16x32_bf16 v[184:187], v[60:63], a[184:187], v[184:187]
    v_mfma_f32_16x16x32_bf16 v[188:191], v[60:63], v[96:99], v[188:191]
    s_waitcnt lgkmcnt(4)
    v_mfma_f32_16x16x32_bf16 v[128:131], v[64:67], a[44:47], v[128:131]
    ds_read_b64_tr_b16 v[56:57], v5 offset:28672
    v_mfma_f32_16x16x32_bf16 v[132:135], v[64:67], a[116:119], v[132:135]
    ds_read_b64_tr_b16 v[58:59], v5 offset:29184
    v_mfma_f32_16x16x32_bf16 v[136:139], v[64:67], a[188:191], v[136:139]
    v_mfma_f32_16x16x32_bf16 v[140:143], v[64:67], v[100:103], v[140:143]
    s_waitcnt lgkmcnt(4)
    v_mfma_f32_16x16x32_bf16 v[144:147], v[48:51], a[44:47], v[144:147]
    s_waitcnt vmcnt(16)
    s_barrier
    ds_read_b128 a[48:51], v88 offset:32768
    v_mfma_f32_16x16x32_bf16 v[148:151], v[48:51], a[116:119], v[148:151]
    ds_read_b128 a[120:123], v88 offset:34816
    s_add_u32 m0, s53, 131072
    s_add_u32 s57, s33, 0
    v_mfma_f32_16x16x32_bf16 v[152:155], v[48:51], a[188:191], v[152:155]
    ds_read_b128 a[192:195], v88 offset:36864
    buffer_load_dwordx4 v1, s[12:15], s57 offen lds
    s_add_u32 m0, s53, 135168
    v_mfma_f32_16x16x32_bf16 v[156:159], v[48:51], v[100:103], v[156:159]
    ds_read_b128 v[104:107], v88 offset:38912
    s_add_u32 s57, s33, 294912
    s_waitcnt lgkmcnt(6)
    v_mfma_f32_16x16x32_bf16 v[160:163], v[52:55], a[44:47], v[160:163]
    ds_read_b64_tr_b16 v[60:61], v3 offset:49152
    v_mfma_f32_16x16x32_bf16 v[164:167], v[52:55], a[116:119], v[164:167]
    ds_read_b64_tr_b16 v[62:63], v3 offset:49664
    buffer_load_dwordx4 v1, s[12:15], s57 offen lds
    s_add_u32 m0, s53, 139264
    v_mfma_f32_16x16x32_bf16 v[168:171], v[52:55], a[188:191], v[168:171]
    ds_read_b64_tr_b16 v[64:65], v3 offset:57344
    s_add_u32 s57, s33, 0
    v_mfma_f32_16x16x32_bf16 v[172:175], v[52:55], v[100:103], v[172:175]
    ds_read_b64_tr_b16 v[66:67], v3 offset:57856
    s_waitcnt lgkmcnt(8)
    v_mfma_f32_16x16x32_bf16 v[176:179], v[56:59], a[44:47], v[176:179]
    ds_read_b64_tr_b16 v[48:49], v5 offset:49152
    buffer_load_dwordx4 v1, s[16:19], s57 offen lds
    s_add_u32 m0, s53, 143360
    v_mfma_f32_16x16x32_bf16 v[180:183], v[56:59], a[116:119], v[180:183]
    ds_read_b64_tr_b16 v[50:51], v5 offset:49664
    s_add_u32 s57, s33, 294912
    v_mfma_f32_16x16x32_bf16 v[184:187], v[56:59], a[188:191], v[184:187]
    v_mfma_f32_16x16x32_bf16 v[188:191], v[56:59], v[100:103], v[188:191]
    buffer_load_dwordx4 v1, s[16:19], s57 offen lds
    s_add_u32 m0, s53, 147456
    s_waitcnt lgkmcnt(4)
    v_mfma_f32_16x16x32_bf16 v[128:131], v[60:63], a[48:51], v[128:131]
    ds_read_b64_tr_b16 v[52:53], v5 offset:57344
    s_add_u32 s57, s33, 589824
    v_mfma_f32_16x16x32_bf16 v[132:135], v[60:63], a[120:123], v[132:135]
    ds_read_b64_tr_b16 v[54:55], v5 offset:57856
    v_mfma_f32_16x16x32_bf16 v[136:139], v[60:63], a[192:195], v[136:139]
    buffer_load_dwordx4 v1, s[12:15], s57 offen lds
    s_add_u32 m0, s53, 151552
    s_add_u32 s57, s33, 884736
    v_mfma_f32_16x16x32_bf16 v[140:143], v[60:63], v[104:107], v[140:143]
    s_waitcnt lgkmcnt(4)
    v_mfma_f32_16x16x32_bf16 v[144:147], v[64:67], a[48:51], v[144:147]
    ds_read_b128 a[52:55], v88 offset:33792
    v_mfma_f32_16x16x32_bf16 v[148:151], v[64:67], a[120:123], v[148:151]
    ds_read_b128 a[124:127], v88 offset:35840
    buffer_load_dwordx4 v1, s[12:15], s57 offen lds
    s_add_u32 m0, s53, 155648
    v_mfma_f32_16x16x32_bf16 v[152:155], v[64:67], a[192:195], v[152:155]
    ds_read_b128 a[196:199], v88 offset:37888
    s_add_u32 s57, s33, 589824
    v_mfma_f32_16x16x32_bf16 v[156:159], v[64:67], v[104:107], v[156:159]
    ds_read_b128 v[108:111], v88 offset:39936
    s_waitcnt lgkmcnt(6)
    v_mfma_f32_16x16x32_bf16 v[160:163], v[48:51], a[48:51], v[160:163]
    ds_read_b64_tr_b16 v[56:57], v3 offset:53248
    buffer_load_dwordx4 v1, s[16:19], s57 offen lds
    s_add_u32 m0, s53, 159744
    v_mfma_f32_16x16x32_bf16 v[164:167], v[48:51], a[120:123], v[164:167]
    ds_read_b64_tr_b16 v[58:59], v3 offset:53760
    s_add_u32 s57, s33, 884736
    v_mfma_f32_16x16x32_bf16 v[168:171], v[48:51], a[192:195], v[168:171]
    ds_read_b64_tr_b16 v[60:61], v3 offset:61440
    v_mfma_f32_16x16x32_bf16 v[172:175], v[48:51], v[104:107], v[172:175]
    ds_read_b64_tr_b16 v[62:63], v3 offset:61952
    buffer_load_dwordx4 v1, s[16:19], s57 offen lds
    s_waitcnt lgkmcnt(8)
    v_mfma_f32_16x16x32_bf16 v[176:179], v[52:55], a[48:51], v[176:179]
    ds_read_b64_tr_b16 v[64:65], v5 offset:53248
    v_mfma_f32_16x16x32_bf16 v[180:183], v[52:55], a[120:123], v[180:183]
    ds_read_b64_tr_b16 v[66:67], v5 offset:53760
    v_mfma_f32_16x16x32_bf16 v[184:187], v[52:55], a[192:195], v[184:187]
    v_mfma_f32_16x16x32_bf16 v[188:191], v[52:55], v[104:107], v[188:191]
    s_waitcnt lgkmcnt(4)
    v_mfma_f32_16x16x32_bf16 v[128:131], v[56:59], a[52:55], v[128:131]
    ds_read_b64_tr_b16 v[48:49], v5 offset:61440
    v_mfma_f32_16x16x32_bf16 v[132:135], v[56:59], a[124:127], v[132:135]
    ds_read_b64_tr_b16 v[50:51], v5 offset:61952
    v_mfma_f32_16x16x32_bf16 v[136:139], v[56:59], a[196:199], v[136:139]
    v_mfma_f32_16x16x32_bf16 v[140:143], v[56:59], v[108:111], v[140:143]
    s_waitcnt lgkmcnt(4)
    v_mfma_f32_16x16x32_bf16 v[144:147], v[60:63], a[52:55], v[144:147]
    s_waitcnt vmcnt(16)
    s_barrier
    ds_read_b128 a[56:59], v89 offset:0
    v_mfma_f32_16x16x32_bf16 v[148:151], v[60:63], a[124:127], v[148:151]
    ds_read_b128 a[128:131], v89 offset:2048
    s_add_u32 m0, s53, 0
    s_add_u32 s57, s33, 1179648
    v_mfma_f32_16x16x32_bf16 v[152:155], v[60:63], a[196:199], v[152:155]
    ds_read_b128 a[200:203], v89 offset:4096
    buffer_load_dwordx4 v1, s[12:15], s57 offen lds
    s_add_u32 m0, s53, 4096
    v_mfma_f32_16x16x32_bf16 v[156:159], v[60:63], v[108:111], v[156:159]
    ds_read_b128 v[112:115], v89 offset:6144
    s_add_u32 s57, s33, 1474560
    s_waitcnt lgkmcnt(6)
    v_mfma_f32_16x16x32_bf16 v[160:163], v[64:67], a[52:55], v[160:163]
    ds_read_b64_tr_b16 v[52:53], v4 offset:16384
    v_mfma_f32_16x16x32_bf16 v[164:167], v[64:67], a[124:127], v[164:167]
    ds_read_b64_tr_b16 v[54:55], v4 offset:16896
    buffer_load_dwordx4 v1, s[12:15], s57 offen lds
    s_add_u32 m0, s53, 8192
    v_mfma_f32_16x16x32_bf16 v[168:171], v[64:67], a[196:199], v[168:171]
    ds_read_b64_tr_b16 v[56:57], v4 offset:24576
    s_add_u32 s57, s33, 1179648
    v_mfma_f32_16x16x32_bf16 v[172:175], v[64:67], v[108:111], v[172:175]
    ds_read_b64_tr_b16 v[58:59], v4 offset:25088
    s_waitcnt lgkmcnt(8)
    v_mfma_f32_16x16x32_bf16 v[176:179], v[48:51], a[52:55], v[176:179]
    ds_read_b64_tr_b16 v[60:61], v6 offset:16384
    buffer_load_dwordx4 v1, s[16:19], s57 offen lds
    s_add_u32 m0, s53, 12288
    v_mfma_f32_16x16x32_bf16 v[180:183], v[48:51], a[124:127], v[180:183]
    ds_read_b64_tr_b16 v[62:63], v6 offset:16896
    s_add_u32 s57, s33, 1474560
    v_mfma_f32_16x16x32_bf16 v[184:187], v[48:51], a[196:199], v[184:187]
    v_mfma_f32_16x16x32_bf16 v[188:191], v[48:51], v[108:111], v[188:191]
    buffer_load_dwordx4 v1, s[16:19], s57 offen lds
    s_add_u32 m0, s53, 16384
    s_waitcnt lgkmcnt(4)
    v_mfma_f32_16x16x32_bf16 v[128:131], v[52:55], a[56:59], v[128:131]
    ds_read_b64_tr_b16 v[64:65], v6 offset:24576
    s_add_u32 s57, s33, 1769472
    v_mfma_f32_16x16x32_bf16 v[132:135], v[52:55], a[128:131], v[132:135]
    ds_read_b64_tr_b16 v[66:67], v6 offset:25088
    v_mfma_f32_16x16x32_bf16 v[136:139], v[52:55], a[200:203], v[136:139]
    buffer_load_dwordx4 v1, s[12:15], s57 offen lds
    s_add_u32 m0, s53, 20480
    s_add_u32 s57, s33, 2064384
    v_mfma_f32_16x16x32_bf16 v[140:143], v[52:55], v[112:115], v[140:143]
    s_waitcnt lgkmcnt(4)
    v_mfma_f32_16x16x32_bf16 v[144:147], v[56:59], a[56:59], v[144:147]
    ds_read_b128 a[60:63], v89 offset:1024
    v_mfma_f32_16x16x32_bf16 v[148:151], v[56:59], a[128:131], v[148:151]
    ds_read_b128 a[132:135], v89 offset:3072
    buffer_load_dwordx4 v1, s[12:15], s57 offen lds
    s_add_u32 m0, s53, 24576
    v_mfma_f32_16x16x32_bf16 v[152:155], v[56:59], a[200:203], v[152:155]
    ds_read_b128 a[204:207], v89 offset:5120
    s_add_u32 s57, s33, 1769472
    v_mfma_f32_16x16x32_bf16 v[156:159], v[56:59], v[112:115], v[156:159]
    ds_read_b128 v[116:119], v89 offset:7168
    s_waitcnt lgkmcnt(6)
    v_mfma_f32_16x16x32_bf16 v[160:163], v[60:63], a[56:59], v[160:163]
    ds_read_b64_tr_b16 v[48:49], v4 offset:20480
    buffer_load_dwordx4 v1, s[16:19], s57 offen lds
    s_add_u32 m0, s53, 28672
    v_mfma_f32_16x16x32_bf16 v[164:167], v[60:63], a[128:131], v[164:167]
    ds_read_b64_tr_b16 v[50:51], v4 offset:20992
    s_add_u32 s57, s33, 2064384
    v_mfma_f32_16x16x32_bf16 v[168:171], v[60:63], a[200:203], v[168:171]
    ds_read_b64_tr_b16 v[52:53], v4 offset:28672
    v_mfma_f32_16x16x32_bf16 v[172:175], v[60:63], v[112:115], v[172:175]
    ds_read_b64_tr_b16 v[54:55], v4 offset:29184
    buffer_load_dwordx4 v1, s[16:19], s57 offen lds
    s_waitcnt lgkmcnt(8)
    v_mfma_f32_16x16x32_bf16 v[176:179], v[64:67], a[56:59], v[176:179]
    ds_read_b64_tr_b16 v[56:57], v6 offset:20480
    v_mfma_f32_16x16x32_bf16 v[180:183], v[64:67], a[128:131], v[180:183]
    ds_read_b64_tr_b16 v[58:59], v6 offset:20992
    v_mfma_f32_16x16x32_bf16 v[184:187], v[64:67], a[200:203], v[184:187]
    v_mfma_f32_16x16x32_bf16 v[188:191], v[64:67], v[112:115], v[188:191]
    s_waitcnt lgkmcnt(4)
    v_mfma_f32_16x16x32_bf16 v[128:131], v[48:51], a[60:63], v[128:131]
    ds_read_b64_tr_b16 v[60:61], v6 offset:28672
    v_mfma_f32_16x16x32_bf16 v[132:135], v[48:51], a[132:135], v[132:135]
    ds_read_b64_tr_b16 v[62:63], v6 offset:29184
    v_mfma_f32_16x16x32_bf16 v[136:139], v[48:51], a[204:207], v[136:139]
    v_mfma_f32_16x16x32_bf16 v[140:143], v[48:51], v[116:119], v[140:143]
    s_waitcnt lgkmcnt(4)
    v_mfma_f32_16x16x32_bf16 v[144:147], v[52:55], a[60:63], v[144:147]
    s_waitcnt vmcnt(16)
    s_barrier
    ds_read_b128 a[64:67], v89 offset:32768
    v_mfma_f32_16x16x32_bf16 v[148:151], v[52:55], a[132:135], v[148:151]
    ds_read_b128 a[136:139], v89 offset:34816
    s_add_u32 m0, s53, 32768
    s_add_u32 s57, s33, 2359296
    v_mfma_f32_16x16x32_bf16 v[152:155], v[52:55], a[204:207], v[152:155]
    ds_read_b128 a[208:211], v89 offset:36864
    buffer_load_dwordx4 v1, s[12:15], s57 offen lds
    s_add_u32 m0, s53, 36864
    v_mfma_f32_16x16x32_bf16 v[156:159], v[52:55], v[116:119], v[156:159]
    ds_read_b128 v[120:123], v89 offset:38912
    s_add_u32 s57, s33, 2654208
    s_waitcnt lgkmcnt(6)
    v_mfma_f32_16x16x32_bf16 v[160:163], v[56:59], a[60:63], v[160:163]
    ds_read_b64_tr_b16 v[64:65], v4 offset:49152
    v_mfma_f32_16x16x32_bf16 v[164:167], v[56:59], a[132:135], v[164:167]
    ds_read_b64_tr_b16 v[66:67], v4 offset:49664
    buffer_load_dwordx4 v1, s[12:15], s57 offen lds
    s_add_u32 m0, s53, 40960
    v_mfma_f32_16x16x32_bf16 v[168:171], v[56:59], a[204:207], v[168:171]
    ds_read_b64_tr_b16 v[48:49], v4 offset:57344
    s_add_u32 s57, s33, 2359296
    v_mfma_f32_16x16x32_bf16 v[172:175], v[56:59], v[116:119], v[172:175]
    ds_read_b64_tr_b16 v[50:51], v4 offset:57856
    s_waitcnt lgkmcnt(8)
    v_mfma_f32_16x16x32_bf16 v[176:179], v[60:63], a[60:63], v[176:179]
    ds_read_b64_tr_b16 v[52:53], v6 offset:49152
    buffer_load_dwordx4 v1, s[16:19], s57 offen lds
    s_add_u32 m0, s53, 45056
    v_mfma_f32_16x16x32_bf16 v[180:183], v[60:63], a[132:135], v[180:183]
    ds_read_b64_tr_b16 v[54:55], v6 offset:49664
    s_add_u32 s57, s33, 2654208
    v_mfma_f32_16x16x32_bf16 v[184:187], v[60:63], a[204:207], v[184:187]
    v_mfma_f32_16x16x32_bf16 v[188:191], v[60:63], v[116:119], v[188:191]
    buffer_load_dwordx4 v1, s[16:19], s57 offen lds
    s_add_u32 m0, s53, 49152
    s_waitcnt lgkmcnt(4)
    v_mfma_f32_16x16x32_bf16 v[128:131], v[64:67], a[64:67], v[128:131]
    ds_read_b64_tr_b16 v[56:57], v6 offset:57344
    s_add_u32 s57, s33, 2949120
    v_mfma_f32_16x16x32_bf16 v[132:135], v[64:67], a[136:139], v[132:135]
    ds_read_b64_tr_b16 v[58:59], v6 offset:57856
    v_mfma_f32_16x16x32_bf16 v[136:139], v[64:67], a[208:211], v[136:139]
    buffer_load_dwordx4 v1, s[12:15], s57 offen lds
    s_add_u32 m0, s53, 53248
    s_add_u32 s57, s33, 3244032
    v_mfma_f32_16x16x32_bf16 v[140:143], v[64:67], v[120:123], v[140:143]
    s_waitcnt lgkmcnt(4)
    v_mfma_f32_16x16x32_bf16 v[144:147], v[48:51], a[64:67], v[144:147]
    ds_read_b128 a[68:71], v89 offset:33792
    v_mfma_f32_16x16x32_bf16 v[148:151], v[48:51], a[136:139], v[148:151]
    ds_read_b128 a[140:143], v89 offset:35840
    buffer_load_dwordx4 v1, s[12:15], s57 offen lds
    s_add_u32 m0, s53, 57344
    v_mfma_f32_16x16x32_bf16 v[152:155], v[48:51], a[208:211], v[152:155]
    ds_read_b128 a[212:215], v89 offset:37888
    s_add_u32 s57, s33, 2949120
    v_mfma_f32_16x16x32_bf16 v[156:159], v[48:51], v[120:123], v[156:159]
    ds_read_b128 v[124:127], v89 offset:39936
    s_waitcnt lgkmcnt(6)
    v_mfma_f32_16x16x32_bf16 v[160:163], v[52:55], a[64:67], v[160:163]
    ds_read_b64_tr_b16 v[60:61], v4 offset:53248
    buffer_load_dwordx4 v1, s[16:19], s57 offen lds
    s_add_u32 m0, s53, 61440
    v_mfma_f32_16x16x32_bf16 v[164:167], v[52:55], a[136:139], v[164:167]
    ds_read_b64_tr_b16 v[62:63], v4 offset:53760
    s_add_u32 s57, s33, 3244032
    v_mfma_f32_16x16x32_bf16 v[168:171], v[52:55], a[208:211], v[168:171]
    ds_read_b64_tr_b16 v[64:65], v4 offset:61440
    v_mfma_f32_16x16x32_bf16 v[172:175], v[52:55], v[120:123], v[172:175]
    ds_read_b64_tr_b16 v[66:67], v4 offset:61952
    buffer_load_dwordx4 v1, s[16:19], s57 offen lds
    s_waitcnt lgkmcnt(8)
    v_mfma_f32_16x16x32_bf16 v[176:179], v[56:59], a[64:67], v[176:179]
    ds_read_b64_tr_b16 v[48:49], v6 offset:53248
    v_mfma_f32_16x16x32_bf16 v[180:183], v[56:59], a[136:139], v[180:183]
    ds_read_b64_tr_b16 v[50:51], v6 offset:53760
    v_mfma_f32_16x16x32_bf16 v[184:187], v[56:59], a[208:211], v[184:187]
    v_mfma_f32_16x16x32_bf16 v[188:191], v[56:59], v[120:123], v[188:191]
    s_waitcnt lgkmcnt(4)
    v_mfma_f32_16x16x32_bf16 v[128:131], v[60:63], a[68:71], v[128:131]
    ds_read_b64_tr_b16 v[52:53], v6 offset:61440
    v_mfma_f32_16x16x32_bf16 v[132:135], v[60:63], a[140:143], v[132:135]
    ds_read_b64_tr_b16 v[54:55], v6 offset:61952
    v_mfma_f32_16x16x32_bf16 v[136:139], v[60:63], a[212:215], v[136:139]
    v_mfma_f32_16x16x32_bf16 v[140:143], v[60:63], v[124:127], v[140:143]
    s_waitcnt lgkmcnt(4)
    v_mfma_f32_16x16x32_bf16 v[144:147], v[64:67], a[68:71], v[144:147]
    s_waitcnt vmcnt(20)
    s_barrier
    ds_read_b64_tr_b16 v[56:57], v38 offset:0
    v_mfma_f32_16x16x32_bf16 v[148:151], v[64:67], a[140:143], v[148:151]
    ds_read_b64_tr_b16 v[58:59], v38 offset:512
    s_add_u32 m0, s53, 65536
    s_add_u32 s57, s33, 3538944
    v_mfma_f32_16x16x32_bf16 v[152:155], v[64:67], a[212:215], v[152:155]
    buffer_load_dwordx4 v1, s[12:15], s57 offen lds
    s_add_u32 m0, s53, 69632
    s_add_u32 s57, s33, 3833856
    v_mfma_f32_16x16x32_bf16 v[156:159], v[64:67], v[124:127], v[156:159]
    s_waitcnt lgkmcnt(4)
    v_mfma_f32_16x16x32_bf16 v[160:163], v[48:51], a[68:71], v[160:163]
    ds_read_b64_tr_b16 v[60:61], v38 offset:8192
    v_mfma_f32_16x16x32_bf16 v[164:167], v[48:51], a[140:143], v[164:167]
    ds_read_b64_tr_b16 v[62:63], v38 offset:8704
    buffer_load_dwordx4 v1, s[12:15], s57 offen lds
    s_add_u32 m0, s53, 73728
    v_mfma_f32_16x16x32_bf16 v[168:171], v[48:51], a[212:215], v[168:171]
    s_add_u32 s57, s33, 3538944
    v_mfma_f32_16x16x32_bf16 v[172:175], v[48:51], v[124:127], v[172:175]
    s_waitcnt lgkmcnt(4)
    v_mfma_f32_16x16x32_bf16 v[176:179], v[52:55], a[68:71], v[176:179]
    ds_read_b64_tr_b16 v[64:65], v39 offset:0
    buffer_load_dwordx4 v1, s[16:19], s57 offen lds
    s_add_u32 m0, s53, 77824
    v_mfma_f32_16x16x32_bf16 v[180:183], v[52:55], a[140:143], v[180:183]
    ds_read_b64_tr_b16 v[66:67], v39 offset:512
    s_add_u32 s57, s33, 3833856
    v_mfma_f32_16x16x32_bf16 v[184:187], v[52:55], a[212:215], v[184:187]
    v_mfma_f32_16x16x32_bf16 v[188:191], v[52:55], v[124:127], v[188:191]
    buffer_load_dwordx4 v1, s[16:19], s57 offen lds
    s_add_u32 m0, s53, 81920
    s_waitcnt lgkmcnt(4)
    v_mfma_f32_16x16x32_bf16 v[192:195], v[56:59], a[0:3], 0
    ds_read_b64_tr_b16 v[48:49], v39 offset:8192
    s_add_u32 s57, s33, 4128768
    v_mfma_f32_16x16x32_bf16 v[196:199], v[56:59], a[72:75], 0
    ds_read_b64_tr_b16 v[50:51], v39 offset:8704
    v_mfma_f32_16x16x32_bf16 v[200:203], v[56:59], a[144:147], 0
    buffer_load_dwordx4 v1, s[12:15], s57 offen lds
    s_add_u32 m0, s53, 86016
    s_add_u32 s57, s33, 4423680
    v_mfma_f32_16x16x32_bf16 v[204:207], v[56:59], a[216:219], 0
    s_waitcnt lgkmcnt(4)
    v_mfma_f32_16x16x32_bf16 v[208:211], v[60:63], a[0:3], 0
    ds_read_b64_tr_b16 v[52:53], v38 offset:4096
    v_mfma_f32_16x16x32_bf16 v[212:215], v[60:63], a[72:75], 0
    ds_read_b64_tr_b16 v[54:55], v38 offset:4608
    buffer_load_dwordx4 v1, s[12:15], s57 offen lds
    s_add_u32 m0, s53, 90112
    v_mfma_f32_16x16x32_bf16 v[216:219], v[60:63], a[144:147], 0
    s_add_u32 s57, s33, 4128768
    v_mfma_f32_16x16x32_bf16 v[220:223], v[60:63], a[216:219], 0
    s_waitcnt lgkmcnt(4)
    v_mfma_f32_16x16x32_bf16 v[224:227], v[64:67], a[0:3], 0
    ds_read_b64_tr_b16 v[56:57], v38 offset:12288
    buffer_load_dwordx4 v1, s[16:19], s57 offen lds
    s_add_u32 m0, s53, 94208
    v_mfma_f32_16x16x32_bf16 v[228:231], v[64:67], a[72:75], 0
    ds_read_b64_tr_b16 v[58:59], v38 offset:12800
    s_add_u32 s57, s33, 4423680
    v_mul_f32 v128, s56, v128
    v_mfma_f32_16x16x32_bf16 v[232:235], v[64:67], a[144:147], 0
    v_mul_f32 v129, s56, v129
    v_mul_f32 v130, s56, v130
    v_mfma_f32_16x16x32_bf16 v[236:239], v[64:67], a[216:219], 0
    buffer_load_dwordx4 v1, s[16:19], s57 offen lds
    v_mul_f32 v131, s56, v131
    s_waitcnt lgkmcnt(4)
    v_mfma_f32_16x16x32_bf16 v[240:243], v[48:51], a[0:3], 0
    ds_read_b64_tr_b16 v[60:61], v39 offset:4096
    v_mul_f32 v160, s56, v160
    v_mfma_f32_16x16x32_bf16 v[244:247], v[48:51], a[72:75], 0
    ds_read_b64_tr_b16 v[62:63], v39 offset:4608
    v_mul_f32 v161, s56, v161
    v_mfma_f32_16x16x32_bf16 v[248:251], v[48:51], a[144:147], 0
    v_mul_f32 v162, s56, v162
    v_mul_f32 v163, s56, v163
    v_mfma_f32_16x16x32_bf16 v[252:255], v[48:51], a[216:219], 0
    v_exp_f32 v128, v128
    s_waitcnt lgkmcnt(4)
    v_mfma_f32_16x16x32_bf16 v[192:195], v[52:55], a[4:7], v[192:195]
    ds_read_b64_tr_b16 v[64:65], v39 offset:12288
    buffer_load_dword v37, v43, s[12:15], s35 offen
    v_mfma_f32_16x16x32_bf16 v[196:199], v[52:55], a[76:79], v[196:199]
    ds_read_b64_tr_b16 v[66:67], v39 offset:12800
    v_mfma_f32_16x16x32_bf16 v[200:203], v[52:55], a[148:151], v[200:203]
    v_exp_f32 v129, v129
    v_mfma_f32_16x16x32_bf16 v[204:207], v[52:55], a[220:223], v[204:207]
    v_exp_f32 v130, v130
    s_waitcnt lgkmcnt(4)
    v_mfma_f32_16x16x32_bf16 v[208:211], v[56:59], a[4:7], v[208:211]
    s_waitcnt vmcnt(21)
    s_barrier
    ds_read_b64_tr_b16 v[48:49], v38 offset:16384
    v_mfma_f32_16x16x32_bf16 v[212:215], v[56:59], a[76:79], v[212:215]
    ds_read_b64_tr_b16 v[50:51], v38 offset:16896
    s_add_u32 m0, s53, 98304
    s_add_u32 s57, s33, 4718592
    v_mfma_f32_16x16x32_bf16 v[216:219], v[56:59], a[148:151], v[216:219]
    buffer_load_dwordx4 v1, s[12:15], s57 offen lds
    s_add_u32 m0, s53, 102400
    s_add_u32 s57, s33, 5013504
    v_mfma_f32_16x16x32_bf16 v[220:223], v[56:59], a[220:223], v[220:223]
    v_exp_f32 v131, v131
    s_waitcnt lgkmcnt(4)
    v_mfma_f32_16x16x32_bf16 v[224:227], v[60:63], a[4:7], v[224:227]
    ds_read_b64_tr_b16 v[52:53], v38 offset:24576
    v_mfma_f32_16x16x32_bf16 v[228:231], v[60:63], a[76:79], v[228:231]
    ds_read_b64_tr_b16 v[54:55], v38 offset:25088
    buffer_load_dwordx4 v1, s[12:15], s57 offen lds
    s_add_u32 m0, s53, 106496
    v_mfma_f32_16x16x32_bf16 v[232:235], v[60:63], a[148:151], v[232:235]
    s_add_u32 s57, s33, 4718592
    v_exp_f32 v160, v160
    v_mfma_f32_16x16x32_bf16 v[236:239], v[60:63], a[220:223], v[236:239]
    v_exp_f32 v161, v161
    s_waitcnt lgkmcnt(4)
    v_mfma_f32_16x16x32_bf16 v[240:243], v[64:67], a[4:7], v[240:243]
    ds_read_b64_tr_b16 v[56:57], v39 offset:16384
    buffer_load_dwordx4 v1, s[16:19], s57 offen lds
    s_add_u32 m0, s53, 110592
    v_mfma_f32_16x16x32_bf16 v[244:247], v[64:67], a[76:79], v[244:247]
    ds_read_b64_tr_b16 v[58:59], v39 offset:16896
    s_add_u32 s57, s33, 5013504
    v_mfma_f32_16x16x32_bf16 v[248:251], v[64:67], a[148:151], v[248:251]
    v_exp_f32 v162, v162
    v_mfma_f32_16x16x32_bf16 v[252:255], v[64:67], a[220:223], v[252:255]
    buffer_load_dwordx4 v1, s[16:19], s57 offen lds
    s_add_u32 m0, s53, 114688
    s_waitcnt lgkmcnt(4)
    v_mfma_f32_16x16x32_bf16 v[192:195], v[48:51], a[8:11], v[192:195]
    ds_read_b64_tr_b16 v[60:61], v39 offset:24576
    s_add_u32 s57, s34, 0
    v_mfma_f32_16x16x32_bf16 v[196:199], v[48:51], a[80:83], v[196:199]
    ds_read_b64_tr_b16 v[62:63], v39 offset:25088
    v_mfma_f32_16x16x32_bf16 v[200:203], v[48:51], a[152:155], v[200:203]
    buffer_load_dwordx4 v1, s[12:15], s57 offen lds
    s_add_u32 m0, s53, 118784
    s_add_u32 s57, s34, 294912
    v_mfma_f32_16x16x32_bf16 v[204:207], v[48:51], a[224:227], v[204:207]
    v_exp_f32 v163, v163
    s_waitcnt lgkmcnt(4)
    v_mfma_f32_16x16x32_bf16 v[208:211], v[52:55], a[8:11], v[208:211]
    ds_read_b64_tr_b16 v[64:65], v38 offset:20480
    v_add_f32 v128, 1.0, v128
    v_mfma_f32_16x16x32_bf16 v[212:215], v[52:55], a[80:83], v[212:215]
    ds_read_b64_tr_b16 v[66:67], v38 offset:20992
    buffer_load_dwordx4 v1, s[12:15], s57 offen lds
    s_add_u32 m0, s53, 122880
    v_mfma_f32_16x16x32_bf16 v[216:219], v[52:55], a[152:155], v[216:219]
    s_add_u32 s57, s34, 0
    v_add_f32 v129, 1.0, v129
    v_add_f32 v130, 1.0, v130
    v_mfma_f32_16x16x32_bf16 v[220:223], v[52:55], a[224:227], v[220:223]
    v_add_f32 v131, 1.0, v131
    v_add_f32 v160, 1.0, v160
    s_waitcnt lgkmcnt(4)
    v_mfma_f32_16x16x32_bf16 v[224:227], v[56:59], a[8:11], v[224:227]
    ds_read_b64_tr_b16 v[48:49], v38 offset:28672
    buffer_load_dwordx4 v1, s[16:19], s57 offen lds
    s_add_u32 m0, s53, 126976
    v_mfma_f32_16x16x32_bf16 v[228:231], v[56:59], a[80:83], v[228:231]
    ds_read_b64_tr_b16 v[50:51], v38 offset:29184
    s_add_u32 s57, s34, 294912
    v_add_f32 v161, 1.0, v161
    v_mfma_f32_16x16x32_bf16 v[232:235], v[56:59], a[152:155], v[232:235]
    v_add_f32 v162, 1.0, v162
    v_add_f32 v163, 1.0, v163
    v_mfma_f32_16x16x32_bf16 v[236:239], v[56:59], a[224:227], v[236:239]
    buffer_load_dwordx4 v1, s[16:19], s57 offen lds
    s_waitcnt lgkmcnt(4)
    v_mfma_f32_16x16x32_bf16 v[240:243], v[60:63], a[8:11], v[240:243]
    ds_read_b64_tr_b16 v[52:53], v39 offset:20480
    v_mfma_f32_16x16x32_bf16 v[244:247], v[60:63], a[80:83], v[244:247]
    ds_read_b64_tr_b16 v[54:55], v39 offset:20992
    v_mfma_f32_16x16x32_bf16 v[248:251], v[60:63], a[152:155], v[248:251]
    v_rcp_f32 v128, v128
    v_mfma_f32_16x16x32_bf16 v[252:255], v[60:63], a[224:227], v[252:255]
    v_rcp_f32 v129, v129
    s_waitcnt lgkmcnt(4)
    v_mfma_f32_16x16x32_bf16 v[192:195], v[64:67], a[12:15], v[192:195]
    ds_read_b64_tr_b16 v[56:57], v39 offset:28672
    buffer_load_dword v37, v43, s[16:19], s35 offen
    s_sub_u32 s71, s83, 9
    v_mfma_f32_16x16x32_bf16 v[196:199], v[64:67], a[84:87], v[196:199]
    ds_read_b64_tr_b16 v[58:59], v39 offset:29184
    s_mul_i32 s70, s37, 7
    s_add_u32 s71, s71, s70
    v_mfma_f32_16x16x32_bf16 v[200:203], v[64:67], a[156:159], v[200:203]
    v_rcp_f32 v130, v130
    s_lshl_b32 s71, s71, 8
    v_mfma_f32_16x16x32_bf16 v[204:207], v[64:67], a[228:231], v[204:207]
    v_rcp_f32 v131, v131
    s_waitcnt lgkmcnt(4)
    v_mfma_f32_16x16x32_bf16 v[208:211], v[48:51], a[12:15], v[208:211]
    ds_read_b64_tr_b16 v[60:61], v3 offset:0
    v_lshl_add_u32 v17, s3, 6, v11
    v_mfma_f32_16x16x32_bf16 v[212:215], v[48:51], a[84:87], v[212:215]
    ds_read_b64_tr_b16 v[62:63], v3 offset:512
    v_add_u32 v17, s71, v17
    v_mfma_f32_16x16x32_bf16 v[216:219], v[48:51], a[156:159], v[216:219]
    v_rcp_f32 v160, v160
    v_mfma_f32_16x16x32_bf16 v[220:223], v[48:51], a[228:231], v[220:223]
    v_rcp_f32 v161, v161
    s_waitcnt lgkmcnt(4)
    v_mfma_f32_16x16x32_bf16 v[224:227], v[52:55], a[12:15], v[224:227]
    ds_read_b64_tr_b16 v[64:65], v3 offset:8192
    v_lshlrev_b32 v17, 7, v17
    s_cmp_lt_u32 s83, 9
    s_cselect_b32 s70, 0x40000000, 0
    v_mfma_f32_16x16x32_bf16 v[228:231], v[52:55], a[84:87], v[228:231]
    ds_read_b64_tr_b16 v[66:67], v3 offset:8704
    v_or_b32 v17, s70, v17
    s_mov_b32 s76, s68
    v_mfma_f32_16x16x32_bf16 v[232:235], v[52:55], a[156:159], v[232:235]
    v_rcp_f32 v162, v162
    s_mov_b32 s77, s69
    s_mov_b32 s78, 5308416
    v_mfma_f32_16x16x32_bf16 v[236:239], v[52:55], a[228:231], v[236:239]
    v_rcp_f32 v163, v163
    s_mov_b32 s79, 0x20000
    s_waitcnt lgkmcnt(4)
    v_mfma_f32_16x16x32_bf16 v[240:243], v[56:59], a[12:15], v[240:243]
    ds_read_b64_tr_b16 v[48:49], v5 offset:0
    v_mul_f32 v144, v128, v144
    v_mfma_f32_16x16x32_bf16 v[244:247], v[56:59], a[84:87], v[244:247]
    ds_read_b64_tr_b16 v[50:51], v5 offset:512
    v_mul_f32 v145, v129, v145
    v_mfma_f32_16x16x32_bf16 v[248:251], v[56:59], a[156:159], v[248:251]
    v_mul_f32 v146, v130, v146
    v_mul_f32 v147, v131, v147
    v_mfma_f32_16x16x32_bf16 v[252:255], v[56:59], a[228:231], v[252:255]
    v_mul_f32 v176, v160, v176
    v_mul_f32 v177, v161, v177
    s_waitcnt lgkmcnt(4)
    v_mfma_f32_16x16x32_bf16 v[192:195], v[60:63], a[16:19], v[192:195]
    ds_read_b64_tr_b16 v[52:53], v5 offset:8192
    v_mul_f32 v178, v162, v178
    v_mfma_f32_16x16x32_bf16 v[196:199], v[60:63], a[88:91], v[196:199]
    ds_read_b64_tr_b16 v[54:55], v5 offset:8704
    v_mul_f32 v179, v163, v179
    v_mfma_f32_16x16x32_bf16 v[200:203], v[60:63], a[160:163], v[200:203]
    v_cvt_pk_bf16_f32 v128, v144, v145
    v_cvt_pk_bf16_f32 v129, v146, v147
    v_mfma_f32_16x16x32_bf16 v[204:207], v[60:63], a[232:235], v[204:207]
    v_cvt_pk_bf16_f32 v130, v176, v177
    v_cvt_pk_bf16_f32 v131, v178, v179
    s_waitcnt lgkmcnt(4)
    v_mfma_f32_16x16x32_bf16 v[208:211], v[64:67], a[16:19], v[208:211]
    ds_read_b64_tr_b16 v[56:57], v3 offset:4096
    s_add_u32 s59, s44, 0
    buffer_store_dwordx4 v[128:131], v0, s[20:23], s59 offen sc1
    v_mfma_f32_16x16x32_bf16 v[212:215], v[64:67], a[88:91], v[212:215]
    ds_read_b64_tr_b16 v[58:59], v3 offset:4608
    v_mul_f32 v132, s56, v132
    v_mfma_f32_16x16x32_bf16 v[216:219], v[64:67], a[160:163], v[216:219]
    v_mul_f32 v133, s56, v133
    v_mul_f32 v134, s56, v134
    v_mfma_f32_16x16x32_bf16 v[220:223], v[64:67], a[232:235], v[220:223]
    v_mul_f32 v135, s56, v135
    v_mul_f32 v164, s56, v164
    s_waitcnt lgkmcnt(4)
    v_mfma_f32_16x16x32_bf16 v[224:227], v[48:51], a[16:19], v[224:227]
    ds_read_b64_tr_b16 v[60:61], v3 offset:12288
    v_mul_f32 v165, s56, v165
    v_mfma_f32_16x16x32_bf16 v[228:231], v[48:51], a[88:91], v[228:231]
    ds_read_b64_tr_b16 v[62:63], v3 offset:12800
    v_mul_f32 v166, s56, v166
    v_mfma_f32_16x16x32_bf16 v[232:235], v[48:51], a[160:163], v[232:235]
    v_mul_f32 v167, s56, v167
    buffer_load_dword v37, v17, s[76:79], 0 offen
    v_mfma_f32_16x16x32_bf16 v[236:239], v[48:51], a[232:235], v[236:239]
    v_exp_f32 v132, v132
    s_waitcnt lgkmcnt(4)
    v_mfma_f32_16x16x32_bf16 v[240:243], v[52:55], a[16:19], v[240:243]
    ds_read_b64_tr_b16 v[64:65], v5 offset:4096
    v_add_u32 v17, 3670016, v17
    v_mfma_f32_16x16x32_bf16 v[244:247], v[52:55], a[88:91], v[244:247]
    ds_read_b64_tr_b16 v[66:67], v5 offset:4608
    buffer_load_dword v37, v17, s[76:79], 0 offen
    v_mfma_f32_16x16x32_bf16 v[248:251], v[52:55], a[160:163], v[248:251]
    v_exp_f32 v133, v133
    v_mfma_f32_16x16x32_bf16 v[252:255], v[52:55], a[232:235], v[252:255]
    v_exp_f32 v134, v134
    s_waitcnt lgkmcnt(4)
    v_mfma_f32_16x16x32_bf16 v[192:195], v[56:59], a[20:23], v[192:195]
    ds_read_b64_tr_b16 v[48:49], v5 offset:12288
    v_mfma_f32_16x16x32_bf16 v[196:199], v[56:59], a[92:95], v[196:199]
    ds_read_b64_tr_b16 v[50:51], v5 offset:12800
    v_mfma_f32_16x16x32_bf16 v[200:203], v[56:59], a[164:167], v[200:203]
    v_exp_f32 v135, v135
    v_mfma_f32_16x16x32_bf16 v[204:207], v[56:59], a[236:239], v[204:207]
    v_exp_f32 v164, v164
    s_waitcnt lgkmcnt(4)
    v_mfma_f32_16x16x32_bf16 v[208:211], v[60:63], a[20:23], v[208:211]
    s_waitcnt vmcnt(25)
    s_barrier
    ds_read_b64_tr_b16 v[52:53], v3 offset:16384
    v_mfma_f32_16x16x32_bf16 v[212:215], v[60:63], a[92:95], v[212:215]
    ds_read_b64_tr_b16 v[54:55], v3 offset:16896
    s_add_u32 m0, s53, 131072
    s_add_u32 s57, s34, 589824
    v_mfma_f32_16x16x32_bf16 v[216:219], v[60:63], a[164:167], v[216:219]
    buffer_load_dwordx4 v1, s[12:15], s57 offen lds
    s_add_u32 m0, s53, 135168
    s_add_u32 s57, s34, 884736
    v_mfma_f32_16x16x32_bf16 v[220:223], v[60:63], a[236:239], v[220:223]
    v_exp_f32 v165, v165
    s_waitcnt lgkmcnt(4)
    v_mfma_f32_16x16x32_bf16 v[224:227], v[64:67], a[20:23], v[224:227]
    ds_read_b64_tr_b16 v[56:57], v3 offset:24576
    v_mfma_f32_16x16x32_bf16 v[228:231], v[64:67], a[92:95], v[228:231]
    ds_read_b64_tr_b16 v[58:59], v3 offset:25088
    buffer_load_dwordx4 v1, s[12:15], s57 offen lds
    s_add_u32 m0, s53, 139264
    v_mfma_f32_16x16x32_bf16 v[232:235], v[64:67], a[164:167], v[232:235]
    s_add_u32 s57, s34, 589824
    v_exp_f32 v166, v166
    v_mfma_f32_16x16x32_bf16 v[236:239], v[64:67], a[236:239], v[236:239]
    v_exp_f32 v167, v167
    s_waitcnt lgkmcnt(4)
    v_mfma_f32_16x16x32_bf16 v[240:243], v[48:51], a[20:23], v[240:243]
    ds_read_b64_tr_b16 v[60:61], v5 offset:16384
    buffer_load_dwordx4 v1, s[16:19], s57 offen lds
    s_add_u32 m0, s53, 143360
    v_mfma_f32_16x16x32_bf16 v[244:247], v[48:51], a[92:95], v[244:247]
    ds_read_b64_tr_b16 v[62:63], v5 offset:16896
    s_add_u32 s57, s34, 884736
    v_add_f32 v132, 1.0, v132
    v_mfma_f32_16x16x32_bf16 v[248:251], v[48:51], a[164:167], v[248:251]
    v_add_f32 v133, 1.0, v133
    v_add_f32 v134, 1.0, v134
    v_mfma_f32_16x16x32_bf16 v[252:255], v[48:51], a[236:239], v[252:255]
    buffer_load_dwordx4 v1, s[16:19], s57 offen lds
    s_add_u32 m0, s53, 147456
    s_waitcnt lgkmcnt(4)
    v_mfma_f32_16x16x32_bf16 v[192:195], v[52:55], a[24:27], v[192:195]
    ds_read_b64_tr_b16 v[64:65], v5 offset:24576
    s_add_u32 s57, s34, 1179648
    v_add_f32 v135, 1.0, v135
    v_mfma_f32_16x16x32_bf16 v[196:199], v[52:55], a[96:99], v[196:199]
    ds_read_b64_tr_b16 v[66:67], v5 offset:25088
    v_add_f32 v164, 1.0, v164
    v_mfma_f32_16x16x32_bf16 v[200:203], v[52:55], a[168:171], v[200:203]
    buffer_load_dwordx4 v1, s[12:15], s57 offen lds
    s_add_u32 m0, s53, 151552
    s_add_u32 s57, s34, 1474560
    v_mfma_f32_16x16x32_bf16 v[204:207], v[52:55], a[240:243], v[204:207]
    v_add_f32 v165, 1.0, v165
    v_add_f32 v166, 1.0, v166
    s_waitcnt lgkmcnt(4)
    v_mfma_f32_16x16x32_bf16 v[208:211], v[56:59], a[24:27], v[208:211]
    ds_read_b64_tr_b16 v[48:49], v3 offset:20480
    v_add_f32 v167, 1.0, v167
    v_mfma_f32_16x16x32_bf16 v[212:215], v[56:59], a[96:99], v[212:215]
    ds_read_b64_tr_b16 v[50:51], v3 offset:20992
    buffer_load_dwordx4 v1, s[12:15], s57 offen lds
    s_add_u32 m0, s53, 155648
    v_mfma_f32_16x16x32_bf16 v[216:219], v[56:59], a[168:171], v[216:219]
    s_add_u32 s57, s34, 1179648
    v_rcp_f32 v132, v132
    v_mfma_f32_16x16x32_bf16 v[220:223], v[56:59], a[240:243], v[220:223]
    v_rcp_f32 v133, v133
    s_waitcnt lgkmcnt(4)
    v_mfma_f32_16x16x32_bf16 v[224:227], v[60:63], a[24:27], v[224:227]
    ds_read_b64_tr_b16 v[52:53], v3 offset:28672
    buffer_load_dwordx4 v1, s[16:19], s57 offen lds
    s_add_u32 m0, s53, 159744
    v_mfma_f32_16x16x32_bf16 v[228:231], v[60:63], a[96:99], v[228:231]
    ds_read_b64_tr_b16 v[54:55], v3 offset:29184
    s_add_u32 s57, s34, 1474560
    v_mfma_f32_16x16x32_bf16 v[232:235], v[60:63], a[168:171], v[232:235]
    v_rcp_f32 v134, v134
    v_mfma_f32_16x16x32_bf16 v[236:239], v[60:63], a[240:243], v[236:239]
    buffer_load_dwordx4 v1, s[16:19], s57 offen lds
    s_waitcnt lgkmcnt(4)
    v_mfma_f32_16x16x32_bf16 v[240:243], v[64:67], a[24:27], v[240:243]
    ds_read_b64_tr_b16 v[56:57], v5 offset:20480
    v_mfma_f32_16x16x32_bf16 v[244:247], v[64:67], a[96:99], v[244:247]
    ds_read_b64_tr_b16 v[58:59], v5 offset:20992
    v_mfma_f32_16x16x32_bf16 v[248:251], v[64:67], a[168:171], v[248:251]
    v_rcp_f32 v135, v135
    v_mfma_f32_16x16x32_bf16 v[252:255], v[64:67], a[240:243], v[252:255]
    v_rcp_f32 v164, v164
    s_waitcnt lgkmcnt(4)
    v_mfma_f32_16x16x32_bf16 v[192:195], v[48:51], a[28:31], v[192:195]
    ds_read_b64_tr_b16 v[60:61], v5 offset:28672
    v_mfma_f32_16x16x32_bf16 v[196:199], v[48:51], a[100:103], v[196:199]
    ds_read_b64_tr_b16 v[62:63], v5 offset:29184
    v_mfma_f32_16x16x32_bf16 v[200:203], v[48:51], a[172:175], v[200:203]
    v_rcp_f32 v165, v165
    v_mfma_f32_16x16x32_bf16 v[204:207], v[48:51], a[244:247], v[204:207]
    v_rcp_f32 v166, v166
    s_waitcnt lgkmcnt(4)
    v_mfma_f32_16x16x32_bf16 v[208:211], v[52:55], a[28:31], v[208:211]
    ds_read_b64_tr_b16 v[64:65], v3 offset:32768
    v_mfma_f32_16x16x32_bf16 v[212:215], v[52:55], a[100:103], v[212:215]
    ds_read_b64_tr_b16 v[66:67], v3 offset:33280
    v_mfma_f32_16x16x32_bf16 v[216:219], v[52:55], a[172:175], v[216:219]
    v_rcp_f32 v167, v167
    v_mfma_f32_16x16x32_bf16 v[220:223], v[52:55], a[244:247], v[220:223]
    v_mul_f32 v148, v132, v148
    v_mul_f32 v149, v133, v149
    s_waitcnt lgkmcnt(4)
    v_mfma_f32_16x16x32_bf16 v[224:227], v[56:59], a[28:31], v[224:227]
    ds_read_b64_tr_b16 v[48:49], v3 offset:40960
    v_mul_f32 v150, v134, v150
    v_mfma_f32_16x16x32_bf16 v[228:231], v[56:59], a[100:103], v[228:231]
    ds_read_b64_tr_b16 v[50:51], v3 offset:41472
    v_mul_f32 v151, v135, v151
    v_mfma_f32_16x16x32_bf16 v[232:235], v[56:59], a[172:175], v[232:235]
    v_mul_f32 v180, v164, v180
    v_mul_f32 v181, v165, v181
    v_mfma_f32_16x16x32_bf16 v[236:239], v[56:59], a[244:247], v[236:239]
    v_mul_f32 v182, v166, v182
    v_mul_f32 v183, v167, v183
    s_waitcnt lgkmcnt(4)
    v_mfma_f32_16x16x32_bf16 v[240:243], v[60:63], a[28:31], v[240:243]
    ds_read_b64_tr_b16 v[52:53], v5 offset:32768
    v_cvt_pk_bf16_f32 v132, v148, v149
    v_mfma_f32_16x16x32_bf16 v[244:247], v[60:63], a[100:103], v[244:247]
    ds_read_b64_tr_b16 v[54:55], v5 offset:33280
    v_cvt_pk_bf16_f32 v133, v150, v151
    v_mfma_f32_16x16x32_bf16 v[248:251], v[60:63], a[172:175], v[248:251]
    v_cvt_pk_bf16_f32 v134, v180, v181
    v_cvt_pk_bf16_f32 v135, v182, v183
    s_add_u32 s59, s44, 147456
    v_mfma_f32_16x16x32_bf16 v[252:255], v[60:63], a[244:247], v[252:255]
    buffer_store_dwordx4 v[132:135], v0, s[20:23], s59 offen sc1
    v_mul_f32 v136, s56, v136
    s_waitcnt lgkmcnt(4)
    v_mfma_f32_16x16x32_bf16 v[192:195], v[64:67], a[32:35], v[192:195]
    ds_read_b64_tr_b16 v[56:57], v5 offset:40960
    v_mul_f32 v137, s56, v137
    v_mfma_f32_16x16x32_bf16 v[196:199], v[64:67], a[104:107], v[196:199]
    ds_read_b64_tr_b16 v[58:59], v5 offset:41472
    v_mul_f32 v138, s56, v138
    v_mfma_f32_16x16x32_bf16 v[200:203], v[64:67], a[176:179], v[200:203]
    v_mul_f32 v139, s56, v139
    v_mul_f32 v168, s56, v168
    v_mfma_f32_16x16x32_bf16 v[204:207], v[64:67], a[248:251], v[204:207]
    v_mul_f32 v169, s56, v169
    v_mul_f32 v170, s56, v170
    s_waitcnt lgkmcnt(4)
    v_mfma_f32_16x16x32_bf16 v[208:211], v[48:51], a[32:35], v[208:211]
    ds_read_b64_tr_b16 v[60:61], v3 offset:36864
    v_mul_f32 v171, s56, v171
    v_mfma_f32_16x16x32_bf16 v[212:215], v[48:51], a[104:107], v[212:215]
    ds_read_b64_tr_b16 v[62:63], v3 offset:37376
    v_mfma_f32_16x16x32_bf16 v[216:219], v[48:51], a[176:179], v[216:219]
    v_exp_f32 v136, v136
    v_mfma_f32_16x16x32_bf16 v[220:223], v[48:51], a[248:251], v[220:223]
    v_exp_f32 v137, v137
    s_waitcnt lgkmcnt(4)
    v_mfma_f32_16x16x32_bf16 v[224:227], v[52:55], a[32:35], v[224:227]
    ds_read_b64_tr_b16 v[64:65], v3 offset:45056
    v_mfma_f32_16x16x32_bf16 v[228:231], v[52:55], a[104:107], v[228:231]
    ds_read_b64_tr_b16 v[66:67], v3 offset:45568
    v_mfma_f32_16x16x32_bf16 v[232:235], v[52:55], a[176:179], v[232:235]
    v_exp_f32 v138, v138
    v_mfma_f32_16x16x32_bf16 v[236:239], v[52:55], a[248:251], v[236:239]
    v_exp_f32 v139, v139
    s_waitcnt lgkmcnt(4)
    v_mfma_f32_16x16x32_bf16 v[240:243], v[56:59], a[32:35], v[240:243]
    ds_read_b64_tr_b16 v[48:49], v5 offset:36864
    v_mfma_f32_16x16x32_bf16 v[244:247], v[56:59], a[104:107], v[244:247]
    ds_read_b64_tr_b16 v[50:51], v5 offset:37376
    v_mfma_f32_16x16x32_bf16 v[248:251], v[56:59], a[176:179], v[248:251]
    v_exp_f32 v168, v168
    v_mfma_f32_16x16x32_bf16 v[252:255], v[56:59], a[248:251], v[252:255]
    v_exp_f32 v169, v169
    s_waitcnt lgkmcnt(4)
    v_mfma_f32_16x16x32_bf16 v[192:195], v[60:63], a[36:39], v[192:195]
    ds_read_b64_tr_b16 v[52:53], v5 offset:45056
    v_mfma_f32_16x16x32_bf16 v[196:199], v[60:63], a[108:111], v[196:199]
    ds_read_b64_tr_b16 v[54:55], v5 offset:45568
    v_mfma_f32_16x16x32_bf16 v[200:203], v[60:63], a[180:183], v[200:203]
    v_exp_f32 v170, v170
    v_mfma_f32_16x16x32_bf16 v[204:207], v[60:63], a[252:255], v[204:207]
    v_exp_f32 v171, v171
    s_waitcnt lgkmcnt(4)
    v_mfma_f32_16x16x32_bf16 v[208:211], v[64:67], a[36:39], v[208:211]
    s_waitcnt vmcnt(26)
    s_barrier
    ds_read_b64_tr_b16 v[56:57], v3 offset:49152
    v_mfma_f32_16x16x32_bf16 v[212:215], v[64:67], a[108:111], v[212:215]
    ds_read_b64_tr_b16 v[58:59], v3 offset:49664
    s_add_u32 m0, s53, 0
    s_add_u32 s57, s34, 1769472
    v_mfma_f32_16x16x32_bf16 v[216:219], v[64:67], a[180:183], v[216:219]
    buffer_load_dwordx4 v1, s[12:15], s57 offen lds
    s_add_u32 m0, s53, 4096
    s_add_u32 s57, s34, 2064384
    v_mfma_f32_16x16x32_bf16 v[220:223], v[64:67], a[252:255], v[220:223]
    v_add_f32 v136, 1.0, v136
    v_add_f32 v137, 1.0, v137
    s_waitcnt lgkmcnt(4)
    v_mfma_f32_16x16x32_bf16 v[224:227], v[48:51], a[36:39], v[224:227]
    ds_read_b64_tr_b16 v[60:61], v3 offset:57344
    v_add_f32 v138, 1.0, v138
    v_mfma_f32_16x16x32_bf16 v[228:231], v[48:51], a[108:111], v[228:231]
    ds_read_b64_tr_b16 v[62:63], v3 offset:57856
    buffer_load_dwordx4 v1, s[12:15], s57 offen lds
    s_add_u32 m0, s53, 8192
    v_mfma_f32_16x16x32_bf16 v[232:235], v[48:51], a[180:183], v[232:235]
    s_add_u32 s57, s34, 1769472
    v_add_f32 v139, 1.0, v139
    v_add_f32 v168, 1.0, v168
    v_mfma_f32_16x16x32_bf16 v[236:239], v[48:51], a[252:255], v[236:239]
    v_add_f32 v169, 1.0, v169
    v_add_f32 v170, 1.0, v170
    s_waitcnt lgkmcnt(4)
    v_mfma_f32_16x16x32_bf16 v[240:243], v[52:55], a[36:39], v[240:243]
    ds_read_b64_tr_b16 v[64:65], v5 offset:49152
    buffer_load_dwordx4 v1, s[16:19], s57 offen lds
    s_add_u32 m0, s53, 12288
    v_mfma_f32_16x16x32_bf16 v[244:247], v[52:55], a[108:111], v[244:247]
    ds_read_b64_tr_b16 v[66:67], v5 offset:49664
    s_add_u32 s57, s34, 2064384
    v_add_f32 v171, 1.0, v171
    v_mfma_f32_16x16x32_bf16 v[248:251], v[52:55], a[180:183], v[248:251]
    v_rcp_f32 v136, v136
    v_mfma_f32_16x16x32_bf16 v[252:255], v[52:55], a[252:255], v[252:255]
    buffer_load_dwordx4 v1, s[16:19], s57 offen lds
    s_add_u32 m0, s53, 16384
    s_waitcnt lgkmcnt(4)
    v_mfma_f32_16x16x32_bf16 v[192:195], v[56:59], a[40:43], v[192:195]
    ds_read_b64_tr_b16 v[48:49], v5 offset:57344
    s_add_u32 s57, s34, 2359296
    v_mfma_f32_16x16x32_bf16 v[196:199], v[56:59], a[112:115], v[196:199]
    ds_read_b64_tr_b16 v[50:51], v5 offset:57856
    v_mfma_f32_16x16x32_bf16 v[200:203], v[56:59], a[184:187], v[200:203]
    buffer_load_dwordx4 v1, s[12:15], s57 offen lds
    s_add_u32 m0, s53, 20480
    s_add_u32 s57, s34, 2654208
    v_mfma_f32_16x16x32_bf16 v[204:207], v[56:59], v[96:99], v[204:207]
    v_rcp_f32 v137, v137
    s_waitcnt lgkmcnt(4)
    v_mfma_f32_16x16x32_bf16 v[208:211], v[60:63], a[40:43], v[208:211]
    ds_read_b64_tr_b16 v[52:53], v3 offset:53248
    v_mfma_f32_16x16x32_bf16 v[212:215], v[60:63], a[112:115], v[212:215]
    ds_read_b64_tr_b16 v[54:55], v3 offset:53760
    buffer_load_dwordx4 v1, s[12:15], s57 offen lds
    s_add_u32 m0, s53, 24576
    v_mfma_f32_16x16x32_bf16 v[216:219], v[60:63], a[184:187], v[216:219]
    s_add_u32 s57, s34, 2359296
    v_rcp_f32 v138, v138
    v_mfma_f32_16x16x32_bf16 v[220:223], v[60:63], v[96:99], v[220:223]
    v_rcp_f32 v139, v139
    s_waitcnt lgkmcnt(4)
    v_mfma_f32_16x16x32_bf16 v[224:227], v[64:67], a[40:43], v[224:227]
    ds_read_b64_tr_b16 v[56:57], v3 offset:61440
    buffer_load_dwordx4 v1, s[16:19], s57 offen lds
    s_add_u32 m0, s53, 28672
    v_mfma_f32_16x16x32_bf16 v[228:231], v[64:67], a[112:115], v[228:231]
    ds_read_b64_tr_b16 v[58:59], v3 offset:61952
    s_add_u32 s57, s34, 2654208
    v_mfma_f32_16x16x32_bf16 v[232:235], v[64:67], a[184:187], v[232:235]
    v_rcp_f32 v168, v168
    v_mfma_f32_16x16x32_bf16 v[236:239], v[64:67], v[96:99], v[236:239]
    buffer_load_dwordx4 v1, s[16:19], s57 offen lds
    s_waitcnt lgkmcnt(4)
    v_mfma_f32_16x16x32_bf16 v[240:243], v[48:51], a[40:43], v[240:243]
    ds_read_b64_tr_b16 v[60:61], v5 offset:53248
    v_mfma_f32_16x16x32_bf16 v[244:247], v[48:51], a[112:115], v[244:247]
    ds_read_b64_tr_b16 v[62:63], v5 offset:53760
    v_mfma_f32_16x16x32_bf16 v[248:251], v[48:51], a[184:187], v[248:251]
    v_rcp_f32 v169, v169
    v_mfma_f32_16x16x32_bf16 v[252:255], v[48:51], v[96:99], v[252:255]
    v_rcp_f32 v170, v170
    s_waitcnt lgkmcnt(4)
    v_mfma_f32_16x16x32_bf16 v[192:195], v[52:55], a[44:47], v[192:195]
    ds_read_b64_tr_b16 v[64:65], v5 offset:61440
    v_mfma_f32_16x16x32_bf16 v[196:199], v[52:55], a[116:119], v[196:199]
    ds_read_b64_tr_b16 v[66:67], v5 offset:61952
    v_mfma_f32_16x16x32_bf16 v[200:203], v[52:55], a[188:191], v[200:203]
    v_rcp_f32 v171, v171
    v_mfma_f32_16x16x32_bf16 v[204:207], v[52:55], v[100:103], v[204:207]
    v_mul_f32 v152, v136, v152
    v_mul_f32 v153, v137, v153
    s_waitcnt lgkmcnt(4)
    v_mfma_f32_16x16x32_bf16 v[208:211], v[56:59], a[44:47], v[208:211]
    ds_read_b64_tr_b16 v[48:49], v4 offset:0
    v_mul_f32 v154, v138, v154
    v_mfma_f32_16x16x32_bf16 v[212:215], v[56:59], a[116:119], v[212:215]
    ds_read_b64_tr_b16 v[50:51], v4 offset:512
    v_mul_f32 v155, v139, v155
    v_mfma_f32_16x16x32_bf16 v[216:219], v[56:59], a[188:191], v[216:219]
    v_mul_f32 v184, v168, v184
    v_mul_f32 v185, v169, v185
    v_mfma_f32_16x16x32_bf16 v[220:223], v[56:59], v[100:103], v[220:223]
    v_mul_f32 v186, v170, v186
    v_mul_f32 v187, v171, v187
    s_waitcnt lgkmcnt(4)
    v_mfma_f32_16x16x32_bf16 v[224:227], v[60:63], a[44:47], v[224:227]
    ds_read_b64_tr_b16 v[52:53], v4 offset:8192
    v_cvt_pk_bf16_f32 v136, v152, v153
    v_mfma_f32_16x16x32_bf16 v[228:231], v[60:63], a[116:119], v[228:231]
    ds_read_b64_tr_b16 v[54:55], v4 offset:8704
    v_cvt_pk_bf16_f32 v137, v154, v155
    v_mfma_f32_16x16x32_bf16 v[232:235], v[60:63], a[188:191], v[232:235]
    v_cvt_pk_bf16_f32 v138, v184, v185
    v_cvt_pk_bf16_f32 v139, v186, v187
    s_add_u32 s59, s44, 294912
    v_mfma_f32_16x16x32_bf16 v[236:239], v[60:63], v[100:103], v[236:239]
    buffer_store_dwordx4 v[136:139], v0, s[20:23], s59 offen sc1
    v_mul_f32 v140, s56, v140
    s_waitcnt lgkmcnt(4)
    v_mfma_f32_16x16x32_bf16 v[240:243], v[64:67], a[44:47], v[240:243]
    ds_read_b64_tr_b16 v[56:57], v6 offset:0
    v_mul_f32 v141, s56, v141
    v_mfma_f32_16x16x32_bf16 v[244:247], v[64:67], a[116:119], v[244:247]
    ds_read_b64_tr_b16 v[58:59], v6 offset:512
    v_mul_f32 v142, s56, v142
    v_mfma_f32_16x16x32_bf16 v[248:251], v[64:67], a[188:191], v[248:251]
    v_mul_f32 v143, s56, v143
    v_mul_f32 v172, s56, v172
    v_mfma_f32_16x16x32_bf16 v[252:255], v[64:67], v[100:103], v[252:255]
    v_mul_f32 v173, s56, v173
    v_mul_f32 v174, s56, v174
    s_waitcnt lgkmcnt(4)
    v_mfma_f32_16x16x32_bf16 v[192:195], v[48:51], a[48:51], v[192:195]
    ds_read_b64_tr_b16 v[60:61], v6 offset:8192
    v_mul_f32 v175, s56, v175
    v_mfma_f32_16x16x32_bf16 v[196:199], v[48:51], a[120:123], v[196:199]
    ds_read_b64_tr_b16 v[62:63], v6 offset:8704
    v_mfma_f32_16x16x32_bf16 v[200:203], v[48:51], a[192:195], v[200:203]
    v_exp_f32 v140, v140
    v_mfma_f32_16x16x32_bf16 v[204:207], v[48:51], v[104:107], v[204:207]
    v_exp_f32 v141, v141
    s_waitcnt lgkmcnt(4)
    v_mfma_f32_16x16x32_bf16 v[208:211], v[52:55], a[48:51], v[208:211]
    ds_read_b64_tr_b16 v[64:65], v4 offset:4096
    v_mfma_f32_16x16x32_bf16 v[212:215], v[52:55], a[120:123], v[212:215]
    ds_read_b64_tr_b16 v[66:67], v4 offset:4608
    v_mfma_f32_16x16x32_bf16 v[216:219], v[52:55], a[192:195], v[216:219]
    v_exp_f32 v142, v142
    v_mfma_f32_16x16x32_bf16 v[220:223], v[52:55], v[104:107], v[220:223]
    v_exp_f32 v143, v143
    s_waitcnt lgkmcnt(4)
    v_mfma_f32_16x16x32_bf16 v[224:227], v[56:59], a[48:51], v[224:227]
    ds_read_b64_tr_b16 v[48:49], v4 offset:12288
    v_mfma_f32_16x16x32_bf16 v[228:231], v[56:59], a[120:123], v[228:231]
    ds_read_b64_tr_b16 v[50:51], v4 offset:12800
    v_mfma_f32_16x16x32_bf16 v[232:235], v[56:59], a[192:195], v[232:235]
    v_exp_f32 v172, v172
    v_mfma_f32_16x16x32_bf16 v[236:239], v[56:59], v[104:107], v[236:239]
    v_exp_f32 v173, v173
    s_waitcnt lgkmcnt(4)
    v_mfma_f32_16x16x32_bf16 v[240:243], v[60:63], a[48:51], v[240:243]
    ds_read_b64_tr_b16 v[52:53], v6 offset:4096
    v_mfma_f32_16x16x32_bf16 v[244:247], v[60:63], a[120:123], v[244:247]
    ds_read_b64_tr_b16 v[54:55], v6 offset:4608
    v_mfma_f32_16x16x32_bf16 v[248:251], v[60:63], a[192:195], v[248:251]
    v_exp_f32 v174, v174
    v_mfma_f32_16x16x32_bf16 v[252:255], v[60:63], v[104:107], v[252:255]
    v_exp_f32 v175, v175
    s_waitcnt lgkmcnt(4)
    v_mfma_f32_16x16x32_bf16 v[192:195], v[64:67], a[52:55], v[192:195]
    ds_read_b64_tr_b16 v[56:57], v6 offset:12288
    v_add_f32 v140, 1.0, v140
    v_mfma_f32_16x16x32_bf16 v[196:199], v[64:67], a[124:127], v[196:199]
    ds_read_b64_tr_b16 v[58:59], v6 offset:12800
    v_add_f32 v141, 1.0, v141
    v_mfma_f32_16x16x32_bf16 v[200:203], v[64:67], a[196:199], v[200:203]
    v_add_f32 v142, 1.0, v142
    v_add_f32 v143, 1.0, v143
    v_mfma_f32_16x16x32_bf16 v[204:207], v[64:67], v[108:111], v[204:207]
    v_add_f32 v172, 1.0, v172
    v_add_f32 v173, 1.0, v173
    s_waitcnt lgkmcnt(4)
    v_mfma_f32_16x16x32_bf16 v[208:211], v[48:51], a[52:55], v[208:211]
    s_waitcnt vmcnt(26)
    s_barrier
    ds_read_b64_tr_b16 v[60:61], v4 offset:16384
    v_mfma_f32_16x16x32_bf16 v[212:215], v[48:51], a[124:127], v[212:215]
    ds_read_b64_tr_b16 v[62:63], v4 offset:16896
    s_add_u32 m0, s53, 32768
    s_add_u32 s57, s34, 2949120
    v_mfma_f32_16x16x32_bf16 v[216:219], v[48:51], a[196:199], v[216:219]
    buffer_load_dwordx4 v1, s[12:15], s57 offen lds
    s_add_u32 m0, s53, 36864
    s_add_u32 s57, s34, 3244032
    v_mfma_f32_16x16x32_bf16 v[220:223], v[48:51], v[108:111], v[220:223]
    v_add_f32 v174, 1.0, v174
    v_add_f32 v175, 1.0, v175
    s_waitcnt lgkmcnt(4)
    v_mfma_f32_16x16x32_bf16 v[224:227], v[52:55], a[52:55], v[224:227]
    ds_read_b64_tr_b16 v[64:65], v4 offset:24576
    v_mfma_f32_16x16x32_bf16 v[228:231], v[52:55], a[124:127], v[228:231]
    ds_read_b64_tr_b16 v[66:67], v4 offset:25088
    buffer_load_dwordx4 v1, s[12:15], s57 offen lds
    s_add_u32 m0, s53, 40960
    v_mfma_f32_16x16x32_bf16 v[232:235], v[52:55], a[196:199], v[232:235]
    s_add_u32 s57, s34, 2949120
    v_rcp_f32 v140, v140
    v_mfma_f32_16x16x32_bf16 v[236:239], v[52:55], v[108:111], v[236:239]
    v_rcp_f32 v141, v141
    s_waitcnt lgkmcnt(4)
    v_mfma_f32_16x16x32_bf16 v[240:243], v[56:59], a[52:55], v[240:243]
    ds_read_b64_tr_b16 v[48:49], v6 offset:16384
    buffer_load_dwordx4 v1, s[16:19], s57 offen lds
    s_add_u32 m0, s53, 45056
    v_mfma_f32_16x16x32_bf16 v[244:247], v[56:59], a[124:127], v[244:247]
    ds_read_b64_tr_b16 v[50:51], v6 offset:16896
    s_add_u32 s57, s34, 3244032
    v_mfma_f32_16x16x32_bf16 v[248:251], v[56:59], a[196:199], v[248:251]
    v_rcp_f32 v142, v142
    v_mfma_f32_16x16x32_bf16 v[252:255], v[56:59], v[108:111], v[252:255]
    buffer_load_dwordx4 v1, s[16:19], s57 offen lds
    s_add_u32 m0, s53, 49152
    s_waitcnt lgkmcnt(4)
    v_mfma_f32_16x16x32_bf16 v[192:195], v[60:63], a[56:59], v[192:195]
    ds_read_b64_tr_b16 v[52:53], v6 offset:24576
    s_add_u32 s57, s34, 3538944
    v_mfma_f32_16x16x32_bf16 v[196:199], v[60:63], a[128:131], v[196:199]
    ds_read_b64_tr_b16 v[54:55], v6 offset:25088
    v_mfma_f32_16x16x32_bf16 v[200:203], v[60:63], a[200:203], v[200:203]
    buffer_load_dwordx4 v1, s[12:15], s57 offen lds
    s_add_u32 m0, s53, 53248
    s_add_u32 s57, s34, 3833856
    v_mfma_f32_16x16x32_bf16 v[204:207], v[60:63], v[112:115], v[204:207]
    v_rcp_f32 v143, v143
    s_waitcnt lgkmcnt(4)
    v_mfma_f32_16x16x32_bf16 v[208:211], v[64:67], a[56:59], v[208:211]
    ds_read_b64_tr_b16 v[56:57], v4 offset:20480
    v_mfma_f32_16x16x32_bf16 v[212:215], v[64:67], a[128:131], v[212:215]
    ds_read_b64_tr_b16 v[58:59], v4 offset:20992
    buffer_load_dwordx4 v1, s[12:15], s57 offen lds
    s_add_u32 m0, s53, 57344
    v_mfma_f32_16x16x32_bf16 v[216:219], v[64:67], a[200:203], v[216:219]
    s_add_u32 s57, s34, 3538944
    v_rcp_f32 v172, v172
    v_mfma_f32_16x16x32_bf16 v[220:223], v[64:67], v[112:115], v[220:223]
    v_rcp_f32 v173, v173
    s_waitcnt lgkmcnt(4)
    v_mfma_f32_16x16x32_bf16 v[224:227], v[48:51], a[56:59], v[224:227]
    ds_read_b64_tr_b16 v[60:61], v4 offset:28672
    buffer_load_dwordx4 v1, s[16:19], s57 offen lds
    s_add_u32 m0, s53, 61440
    v_mfma_f32_16x16x32_bf16 v[228:231], v[48:51], a[128:131], v[228:231]
    ds_read_b64_tr_b16 v[62:63], v4 offset:29184
    s_add_u32 s57, s34, 3833856
    v_mfma_f32_16x16x32_bf16 v[232:235], v[48:51], a[200:203], v[232:235]
    v_rcp_f32 v174, v174
    v_mfma_f32_16x16x32_bf16 v[236:239], v[48:51], v[112:115], v[236:239]
    buffer_load_dwordx4 v1, s[16:19], s57 offen lds
    s_waitcnt lgkmcnt(4)
    v_mfma_f32_16x16x32_bf16 v[240:243], v[52:55], a[56:59], v[240:243]
    ds_read_b64_tr_b16 v[64:65], v6 offset:20480
    v_mfma_f32_16x16x32_bf16 v[244:247], v[52:55], a[128:131], v[244:247]
    ds_read_b64_tr_b16 v[66:67], v6 offset:20992
    v_mfma_f32_16x16x32_bf16 v[248:251], v[52:55], a[200:203], v[248:251]
    v_rcp_f32 v175, v175
    v_mfma_f32_16x16x32_bf16 v[252:255], v[52:55], v[112:115], v[252:255]
    v_mul_f32 v156, v140, v156
    v_mul_f32 v157, v141, v157
    s_waitcnt lgkmcnt(4)
    v_mfma_f32_16x16x32_bf16 v[192:195], v[56:59], a[60:63], v[192:195]
    ds_read_b64_tr_b16 v[48:49], v6 offset:28672
    v_mul_f32 v158, v142, v158
    v_mfma_f32_16x16x32_bf16 v[196:199], v[56:59], a[132:135], v[196:199]
    ds_read_b64_tr_b16 v[50:51], v6 offset:29184
    v_mul_f32 v159, v143, v159
    v_mfma_f32_16x16x32_bf16 v[200:203], v[56:59], a[204:207], v[200:203]
    v_mul_f32 v188, v172, v188
    v_mul_f32 v189, v173, v189
    v_mfma_f32_16x16x32_bf16 v[204:207], v[56:59], v[116:119], v[204:207]
    v_mul_f32 v190, v174, v190
    v_mul_f32 v191, v175, v191
    s_waitcnt lgkmcnt(4)
    v_mfma_f32_16x16x32_bf16 v[208:211], v[60:63], a[60:63], v[208:211]
    ds_read_b64_tr_b16 v[52:53], v4 offset:32768
    v_cvt_pk_bf16_f32 v140, v156, v157
    v_mfma_f32_16x16x32_bf16 v[212:215], v[60:63], a[132:135], v[212:215]
    ds_read_b64_tr_b16 v[54:55], v4 offset:33280
    v_cvt_pk_bf16_f32 v141, v158, v159
    v_mfma_f32_16x16x32_bf16 v[216:219], v[60:63], a[204:207], v[216:219]
    v_cvt_pk_bf16_f32 v142, v188, v189
    v_cvt_pk_bf16_f32 v143, v190, v191
    s_add_u32 s59, s44, 442368
    v_mfma_f32_16x16x32_bf16 v[220:223], v[60:63], v[116:119], v[220:223]
    buffer_store_dwordx4 v[140:143], v0, s[20:23], s59 offen sc1
    s_waitcnt lgkmcnt(4)
    v_mfma_f32_16x16x32_bf16 v[224:227], v[64:67], a[60:63], v[224:227]
    ds_read_b64_tr_b16 v[56:57], v4 offset:40960
    v_mfma_f32_16x16x32_bf16 v[228:231], v[64:67], a[132:135], v[228:231]
    ds_read_b64_tr_b16 v[58:59], v4 offset:41472
    v_mfma_f32_16x16x32_bf16 v[232:235], v[64:67], a[204:207], v[232:235]
    v_mfma_f32_16x16x32_bf16 v[236:239], v[64:67], v[116:119], v[236:239]
    s_waitcnt lgkmcnt(4)
    v_mfma_f32_16x16x32_bf16 v[240:243], v[48:51], a[60:63], v[240:243]
    ds_read_b64_tr_b16 v[60:61], v6 offset:32768
    v_mfma_f32_16x16x32_bf16 v[244:247], v[48:51], a[132:135], v[244:247]
    ds_read_b64_tr_b16 v[62:63], v6 offset:33280
    v_mfma_f32_16x16x32_bf16 v[248:251], v[48:51], a[204:207], v[248:251]
    v_mfma_f32_16x16x32_bf16 v[252:255], v[48:51], v[116:119], v[252:255]
    s_waitcnt lgkmcnt(4)
    v_mfma_f32_16x16x32_bf16 v[192:195], v[52:55], a[64:67], v[192:195]
    ds_read_b64_tr_b16 v[64:65], v6 offset:40960
    v_mfma_f32_16x16x32_bf16 v[196:199], v[52:55], a[136:139], v[196:199]
    ds_read_b64_tr_b16 v[66:67], v6 offset:41472
    v_mfma_f32_16x16x32_bf16 v[200:203], v[52:55], a[208:211], v[200:203]
    v_mfma_f32_16x16x32_bf16 v[204:207], v[52:55], v[120:123], v[204:207]
    s_waitcnt lgkmcnt(4)
    v_mfma_f32_16x16x32_bf16 v[208:211], v[56:59], a[64:67], v[208:211]
    ds_read_b64_tr_b16 v[48:49], v4 offset:36864
    v_mfma_f32_16x16x32_bf16 v[212:215], v[56:59], a[136:139], v[212:215]
    ds_read_b64_tr_b16 v[50:51], v4 offset:37376
    v_mfma_f32_16x16x32_bf16 v[216:219], v[56:59], a[208:211], v[216:219]
    v_mfma_f32_16x16x32_bf16 v[220:223], v[56:59], v[120:123], v[220:223]
    s_waitcnt lgkmcnt(4)
    v_mfma_f32_16x16x32_bf16 v[224:227], v[60:63], a[64:67], v[224:227]
    ds_read_b64_tr_b16 v[52:53], v4 offset:45056
    v_mfma_f32_16x16x32_bf16 v[228:231], v[60:63], a[136:139], v[228:231]
    ds_read_b64_tr_b16 v[54:55], v4 offset:45568
    v_mfma_f32_16x16x32_bf16 v[232:235], v[60:63], a[208:211], v[232:235]
    v_mfma_f32_16x16x32_bf16 v[236:239], v[60:63], v[120:123], v[236:239]
    s_waitcnt lgkmcnt(4)
    v_mfma_f32_16x16x32_bf16 v[240:243], v[64:67], a[64:67], v[240:243]
    ds_read_b64_tr_b16 v[56:57], v6 offset:36864
    v_mfma_f32_16x16x32_bf16 v[244:247], v[64:67], a[136:139], v[244:247]
    ds_read_b64_tr_b16 v[58:59], v6 offset:37376
    v_mfma_f32_16x16x32_bf16 v[248:251], v[64:67], a[208:211], v[248:251]
    v_mfma_f32_16x16x32_bf16 v[252:255], v[64:67], v[120:123], v[252:255]
    s_waitcnt lgkmcnt(4)
    v_mfma_f32_16x16x32_bf16 v[192:195], v[48:51], a[68:71], v[192:195]
    ds_read_b64_tr_b16 v[60:61], v6 offset:45056
    v_mfma_f32_16x16x32_bf16 v[196:199], v[48:51], a[140:143], v[196:199]
    ds_read_b64_tr_b16 v[62:63], v6 offset:45568
    v_mfma_f32_16x16x32_bf16 v[200:203], v[48:51], a[212:215], v[200:203]
    v_mfma_f32_16x16x32_bf16 v[204:207], v[48:51], v[124:127], v[204:207]
    s_waitcnt lgkmcnt(4)
    v_mfma_f32_16x16x32_bf16 v[208:211], v[52:55], a[68:71], v[208:211]
    s_waitcnt vmcnt(23)
    s_barrier
    ds_read_b64_tr_b16 v[64:65], v4 offset:49152
    v_mfma_f32_16x16x32_bf16 v[212:215], v[52:55], a[140:143], v[212:215]
    ds_read_b64_tr_b16 v[66:67], v4 offset:49664
    s_add_u32 m0, s53, 65536
    s_add_u32 s57, s34, 4128768
    v_mfma_f32_16x16x32_bf16 v[216:219], v[52:55], a[212:215], v[216:219]
    buffer_load_dwordx4 v1, s[12:15], s57 offen lds
    s_add_u32 m0, s53, 69632
    s_add_u32 s57, s34, 4423680
    v_mfma_f32_16x16x32_bf16 v[220:223], v[52:55], v[124:127], v[220:223]
    s_waitcnt lgkmcnt(4)
    v_mfma_f32_16x16x32_bf16 v[224:227], v[56:59], a[68:71], v[224:227]
    ds_read_b64_tr_b16 v[48:49], v4 offset:57344
    v_mfma_f32_16x16x32_bf16 v[228:231], v[56:59], a[140:143], v[228:231]
    ds_read_b64_tr_b16 v[50:51], v4 offset:57856
    buffer_load_dwordx4 v1, s[12:15], s57 offen lds
    s_add_u32 m0, s53, 73728
    v_mfma_f32_16x16x32_bf16 v[232:235], v[56:59], a[212:215], v[232:235]
    s_add_u32 s57, s34, 4128768
    v_mfma_f32_16x16x32_bf16 v[236:239], v[56:59], v[124:127], v[236:239]
    s_waitcnt lgkmcnt(4)
    v_mfma_f32_16x16x32_bf16 v[240:243], v[60:63], a[68:71], v[240:243]
    ds_read_b64_tr_b16 v[52:53], v6 offset:49152
    buffer_load_dwordx4 v1, s[16:19], s57 offen lds
    s_add_u32 m0, s53, 77824
    v_mfma_f32_16x16x32_bf16 v[244:247], v[60:63], a[140:143], v[244:247]
    ds_read_b64_tr_b16 v[54:55], v6 offset:49664
    s_add_u32 s57, s34, 4423680
    v_mfma_f32_16x16x32_bf16 v[248:251], v[60:63], a[212:215], v[248:251]
    v_mfma_f32_16x16x32_bf16 v[252:255], v[60:63], v[124:127], v[252:255]
    buffer_load_dwordx4 v1, s[16:19], s57 offen lds
    s_add_u32 m0, s53, 81920
    s_waitcnt lgkmcnt(4)
    v_mfma_f32_16x16x32_bf16 v[128:131], v[64:67], a[0:3], 0
    ds_read_b64_tr_b16 v[56:57], v6 offset:57344
    s_add_u32 s57, s34, 4718592
    v_mfma_f32_16x16x32_bf16 v[132:135], v[64:67], a[72:75], 0
    ds_read_b64_tr_b16 v[58:59], v6 offset:57856
    v_mfma_f32_16x16x32_bf16 v[136:139], v[64:67], a[144:147], 0
    buffer_load_dwordx4 v1, s[12:15], s57 offen lds
    s_add_u32 m0, s53, 86016
    s_add_u32 s57, s34, 5013504
    v_mfma_f32_16x16x32_bf16 v[140:143], v[64:67], a[216:219], 0
    s_waitcnt lgkmcnt(4)
    v_mfma_f32_16x16x32_bf16 v[144:147], v[48:51], a[0:3], 0
    ds_read_b64_tr_b16 v[60:61], v4 offset:53248
    v_mfma_f32_16x16x32_bf16 v[148:151], v[48:51], a[72:75], 0
    ds_read_b64_tr_b16 v[62:63], v4 offset:53760
    buffer_load_dwordx4 v1, s[12:15], s57 offen lds
    s_add_u32 m0, s53, 90112
    v_mfma_f32_16x16x32_bf16 v[152:155], v[48:51], a[144:147], 0
    s_add_u32 s57, s34, 4718592
    v_mfma_f32_16x16x32_bf16 v[156:159], v[48:51], a[216:219], 0
    s_waitcnt lgkmcnt(4)
    v_mfma_f32_16x16x32_bf16 v[160:163], v[52:55], a[0:3], 0
    ds_read_b64_tr_b16 v[64:65], v4 offset:61440
    buffer_load_dwordx4 v1, s[16:19], s57 offen lds
    s_add_u32 m0, s53, 94208
    v_mfma_f32_16x16x32_bf16 v[164:167], v[52:55], a[72:75], 0
    ds_read_b64_tr_b16 v[66:67], v4 offset:61952
    s_add_u32 s57, s34, 5013504
    v_mul_f32 v192, s56, v192
    v_mfma_f32_16x16x32_bf16 v[168:171], v[52:55], a[144:147], 0
    v_mul_f32 v193, s56, v193
    v_mul_f32 v194, s56, v194
    v_mfma_f32_16x16x32_bf16 v[172:175], v[52:55], a[216:219], 0
    buffer_load_dwordx4 v1, s[16:19], s57 offen lds
    v_mul_f32 v195, s56, v195
    s_waitcnt lgkmcnt(4)
    v_mfma_f32_16x16x32_bf16 v[176:179], v[56:59], a[0:3], 0
    ds_read_b64_tr_b16 v[48:49], v6 offset:53248
    v_mul_f32 v224, s56, v224
    v_mfma_f32_16x16x32_bf16 v[180:183], v[56:59], a[72:75], 0
    ds_read_b64_tr_b16 v[50:51], v6 offset:53760
    v_mul_f32 v225, s56, v225
    v_mfma_f32_16x16x32_bf16 v[184:187], v[56:59], a[144:147], 0
    v_mul_f32 v226, s56, v226
    v_mul_f32 v227, s56, v227
    v_mfma_f32_16x16x32_bf16 v[188:191], v[56:59], a[216:219], 0
    v_exp_f32 v192, v192
    s_waitcnt lgkmcnt(4)
    v_mfma_f32_16x16x32_bf16 v[128:131], v[60:63], a[4:7], v[128:131]
    ds_read_b64_tr_b16 v[52:53], v6 offset:61440
    buffer_load_dword v37, v43, s[12:15], s36 offen
    v_mfma_f32_16x16x32_bf16 v[132:135], v[60:63], a[76:79], v[132:135]
    ds_read_b64_tr_b16 v[54:55], v6 offset:61952
    v_mfma_f32_16x16x32_bf16 v[136:139], v[60:63], a[148:151], v[136:139]
    v_exp_f32 v193, v193
    v_mfma_f32_16x16x32_bf16 v[140:143], v[60:63], a[220:223], v[140:143]
    v_exp_f32 v194, v194
    s_waitcnt lgkmcnt(4)
    v_mfma_f32_16x16x32_bf16 v[144:147], v[64:67], a[4:7], v[144:147]
    ds_read_b64_tr_b16 v[56:57], v38 offset:0
    buffer_load_dword v37, v43, s[16:19], s36 offen
    v_mfma_f32_16x16x32_bf16 v[148:151], v[64:67], a[76:79], v[148:151]
    ds_read_b64_tr_b16 v[58:59], v38 offset:512
    v_mfma_f32_16x16x32_bf16 v[152:155], v[64:67], a[148:151], v[152:155]
    v_exp_f32 v195, v195
    v_mfma_f32_16x16x32_bf16 v[156:159], v[64:67], a[220:223], v[156:159]
    v_exp_f32 v224, v224
    s_waitcnt lgkmcnt(4)
    v_mfma_f32_16x16x32_bf16 v[160:163], v[48:51], a[4:7], v[160:163]
    ds_read_b64_tr_b16 v[60:61], v38 offset:8192
    v_mfma_f32_16x16x32_bf16 v[164:167], v[48:51], a[76:79], v[164:167]
    ds_read_b64_tr_b16 v[62:63], v38 offset:8704
    v_mfma_f32_16x16x32_bf16 v[168:171], v[48:51], a[148:151], v[168:171]
    v_exp_f32 v225, v225
    v_mfma_f32_16x16x32_bf16 v[172:175], v[48:51], a[220:223], v[172:175]
    v_exp_f32 v226, v226
    s_waitcnt lgkmcnt(4)
    v_mfma_f32_16x16x32_bf16 v[176:179], v[52:55], a[4:7], v[176:179]
    ds_read_b64_tr_b16 v[64:65], v39 offset:0
    v_mfma_f32_16x16x32_bf16 v[180:183], v[52:55], a[76:79], v[180:183]
    ds_read_b64_tr_b16 v[66:67], v39 offset:512
    v_mfma_f32_16x16x32_bf16 v[184:187], v[52:55], a[148:151], v[184:187]
    v_exp_f32 v227, v227
    v_mfma_f32_16x16x32_bf16 v[188:191], v[52:55], a[220:223], v[188:191]
    v_add_f32 v192, 1.0, v192
    v_add_f32 v193, 1.0, v193
    s_waitcnt lgkmcnt(4)
    v_mfma_f32_16x16x32_bf16 v[128:131], v[56:59], a[8:11], v[128:131]
    ds_read_b64_tr_b16 v[48:49], v39 offset:8192
    v_add_f32 v194, 1.0, v194
    v_mfma_f32_16x16x32_bf16 v[132:135], v[56:59], a[80:83], v[132:135]
    ds_read_b64_tr_b16 v[50:51], v39 offset:8704
    v_add_f32 v195, 1.0, v195
    v_mfma_f32_16x16x32_bf16 v[136:139], v[56:59], a[152:155], v[136:139]
    v_add_f32 v224, 1.0, v224
    v_add_f32 v225, 1.0, v225
    v_mfma_f32_16x16x32_bf16 v[140:143], v[56:59], a[224:227], v[140:143]
    v_add_f32 v226, 1.0, v226
    v_add_f32 v227, 1.0, v227
    s_waitcnt lgkmcnt(4)
    v_mfma_f32_16x16x32_bf16 v[144:147], v[60:63], a[8:11], v[144:147]
    ds_read_b64_tr_b16 v[52:53], v38 offset:4096
    v_mfma_f32_16x16x32_bf16 v[148:151], v[60:63], a[80:83], v[148:151]
    ds_read_b64_tr_b16 v[54:55], v38 offset:4608
    v_mfma_f32_16x16x32_bf16 v[152:155], v[60:63], a[152:155], v[152:155]
    v_rcp_f32 v192, v192
    v_mfma_f32_16x16x32_bf16 v[156:159], v[60:63], a[224:227], v[156:159]
    v_rcp_f32 v193, v193
    s_waitcnt lgkmcnt(4)
    v_mfma_f32_16x16x32_bf16 v[160:163], v[64:67], a[8:11], v[160:163]
    ds_read_b64_tr_b16 v[56:57], v38 offset:12288
    v_mfma_f32_16x16x32_bf16 v[164:167], v[64:67], a[80:83], v[164:167]
    ds_read_b64_tr_b16 v[58:59], v38 offset:12800
    v_mfma_f32_16x16x32_bf16 v[168:171], v[64:67], a[152:155], v[168:171]
    v_rcp_f32 v194, v194
    v_mfma_f32_16x16x32_bf16 v[172:175], v[64:67], a[224:227], v[172:175]
    v_rcp_f32 v195, v195
    s_waitcnt lgkmcnt(4)
    v_mfma_f32_16x16x32_bf16 v[176:179], v[48:51], a[8:11], v[176:179]
    ds_read_b64_tr_b16 v[60:61], v39 offset:4096
    v_mfma_f32_16x16x32_bf16 v[180:183], v[48:51], a[80:83], v[180:183]
    ds_read_b64_tr_b16 v[62:63], v39 offset:4608
    v_mfma_f32_16x16x32_bf16 v[184:187], v[48:51], a[152:155], v[184:187]
    v_rcp_f32 v224, v224
    v_mfma_f32_16x16x32_bf16 v[188:191], v[48:51], a[224:227], v[188:191]
    v_rcp_f32 v225, v225
    s_waitcnt lgkmcnt(4)
    v_mfma_f32_16x16x32_bf16 v[128:131], v[52:55], a[12:15], v[128:131]
    ds_read_b64_tr_b16 v[64:65], v39 offset:12288
    v_mfma_f32_16x16x32_bf16 v[132:135], v[52:55], a[84:87], v[132:135]
    ds_read_b64_tr_b16 v[66:67], v39 offset:12800
    v_mfma_f32_16x16x32_bf16 v[136:139], v[52:55], a[156:159], v[136:139]
    v_rcp_f32 v226, v226
    v_mfma_f32_16x16x32_bf16 v[140:143], v[52:55], a[228:231], v[140:143]
    v_rcp_f32 v227, v227
    s_waitcnt lgkmcnt(4)
    v_mfma_f32_16x16x32_bf16 v[144:147], v[56:59], a[12:15], v[144:147]
    s_waitcnt vmcnt(24)
    s_barrier
    ds_read_b64_tr_b16 v[48:49], v38 offset:16384
    v_mfma_f32_16x16x32_bf16 v[148:151], v[56:59], a[84:87], v[148:151]
    ds_read_b64_tr_b16 v[50:51], v38 offset:16896
    s_add_u32 m0, s53, 98304
    s_add_u32 s57, s35, 0
    v_mfma_f32_16x16x32_bf16 v[152:155], v[56:59], a[156:159], v[152:155]
    buffer_load_dwordx4 v1, s[12:15], s57 offen lds
    s_add_u32 m0, s53, 102400
    s_add_u32 s57, s35, 294912
    v_mfma_f32_16x16x32_bf16 v[156:159], v[56:59], a[228:231], v[156:159]
    v_mul_f32 v208, v192, v208
    v_mul_f32 v209, v193, v209
    s_waitcnt lgkmcnt(4)
    v_mfma_f32_16x16x32_bf16 v[160:163], v[60:63], a[12:15], v[160:163]
    ds_read_b64_tr_b16 v[52:53], v38 offset:24576
    v_mul_f32 v210, v194, v210
    v_mfma_f32_16x16x32_bf16 v[164:167], v[60:63], a[84:87], v[164:167]
    ds_read_b64_tr_b16 v[54:55], v38 offset:25088
    buffer_load_dwordx4 v1, s[12:15], s57 offen lds
    s_add_u32 m0, s53, 106496
    v_mfma_f32_16x16x32_bf16 v[168:171], v[60:63], a[156:159], v[168:171]
    s_add_u32 s57, s35, 0
    v_mul_f32 v211, v195, v211
    v_mul_f32 v240, v224, v240
    v_mfma_f32_16x16x32_bf16 v[172:175], v[60:63], a[228:231], v[172:175]
    v_mul_f32 v241, v225, v241
    v_mul_f32 v242, v226, v242
    s_waitcnt lgkmcnt(4)
    v_mfma_f32_16x16x32_bf16 v[176:179], v[64:67], a[12:15], v[176:179]
    ds_read_b64_tr_b16 v[56:57], v39 offset:16384
    buffer_load_dwordx4 v1, s[16:19], s57 offen lds
    s_add_u32 m0, s53, 110592
    v_mfma_f32_16x16x32_bf16 v[180:183], v[64:67], a[84:87], v[180:183]
    ds_read_b64_tr_b16 v[58:59], v39 offset:16896
    s_add_u32 s57, s35, 294912
    v_mul_f32 v243, v227, v243
    v_mfma_f32_16x16x32_bf16 v[184:187], v[64:67], a[156:159], v[184:187]
    v_cvt_pk_bf16_f32 v192, v208, v209
    v_cvt_pk_bf16_f32 v193, v210, v211
    v_mfma_f32_16x16x32_bf16 v[188:191], v[64:67], a[228:231], v[188:191]
    buffer_load_dwordx4 v1, s[16:19], s57 offen lds
    s_add_u32 m0, s53, 114688
    s_waitcnt lgkmcnt(4)
    v_mfma_f32_16x16x32_bf16 v[128:131], v[48:51], a[16:19], v[128:131]
    ds_read_b64_tr_b16 v[60:61], v39 offset:24576
    s_add_u32 s57, s35, 589824
    v_cvt_pk_bf16_f32 v194, v240, v241
    v_mfma_f32_16x16x32_bf16 v[132:135], v[48:51], a[88:91], v[132:135]
    ds_read_b64_tr_b16 v[62:63], v39 offset:25088
    v_cvt_pk_bf16_f32 v195, v242, v243
    s_add_u32 s59, s45, 0
    v_mfma_f32_16x16x32_bf16 v[136:139], v[48:51], a[160:163], v[136:139]
    buffer_load_dwordx4 v1, s[12:15], s57 offen lds
    s_add_u32 m0, s53, 118784
    s_add_u32 s57, s35, 884736
    v_mfma_f32_16x16x32_bf16 v[140:143], v[48:51], a[232:235], v[140:143]
    s_waitcnt lgkmcnt(4)
    v_mfma_f32_16x16x32_bf16 v[144:147], v[52:55], a[16:19], v[144:147]
    ds_read_b64_tr_b16 v[64:65], v38 offset:20480
    v_mfma_f32_16x16x32_bf16 v[148:151], v[52:55], a[88:91], v[148:151]
    ds_read_b64_tr_b16 v[66:67], v38 offset:20992
    buffer_load_dwordx4 v1, s[12:15], s57 offen lds
    s_add_u32 m0, s53, 122880
    v_mfma_f32_16x16x32_bf16 v[152:155], v[52:55], a[160:163], v[152:155]
    s_add_u32 s57, s35, 589824
    v_mfma_f32_16x16x32_bf16 v[156:159], v[52:55], a[232:235], v[156:159]
    s_waitcnt lgkmcnt(4)
    v_mfma_f32_16x16x32_bf16 v[160:163], v[56:59], a[16:19], v[160:163]
    ds_read_b64_tr_b16 v[48:49], v38 offset:28672
    buffer_load_dwordx4 v1, s[16:19], s57 offen lds
    s_add_u32 m0, s53, 126976
    v_mfma_f32_16x16x32_bf16 v[164:167], v[56:59], a[88:91], v[164:167]
    ds_read_b64_tr_b16 v[50:51], v38 offset:29184
    s_add_u32 s57, s35, 884736
    v_mfma_f32_16x16x32_bf16 v[168:171], v[56:59], a[160:163], v[168:171]
    v_mfma_f32_16x16x32_bf16 v[172:175], v[56:59], a[232:235], v[172:175]
    buffer_load_dwordx4 v1, s[16:19], s57 offen lds
    s_waitcnt lgkmcnt(4)
    v_mfma_f32_16x16x32_bf16 v[176:179], v[60:63], a[16:19], v[176:179]
    ds_read_b64_tr_b16 v[52:53], v39 offset:20480
    v_mfma_f32_16x16x32_bf16 v[180:183], v[60:63], a[88:91], v[180:183]
    ds_read_b64_tr_b16 v[54:55], v39 offset:20992
    v_mfma_f32_16x16x32_bf16 v[184:187], v[60:63], a[160:163], v[184:187]
    buffer_store_dwordx4 v[192:195], v0, s[20:23], s59 offen sc1
    v_mul_f32 v196, s56, v196
    v_mfma_f32_16x16x32_bf16 v[188:191], v[60:63], a[232:235], v[188:191]
    v_mul_f32 v197, s56, v197
    v_mul_f32 v198, s56, v198
    s_waitcnt lgkmcnt(4)
    v_mfma_f32_16x16x32_bf16 v[128:131], v[64:67], a[20:23], v[128:131]
    ds_read_b64_tr_b16 v[56:57], v39 offset:28672
    v_mul_f32 v199, s56, v199
    v_mfma_f32_16x16x32_bf16 v[132:135], v[64:67], a[92:95], v[132:135]
    ds_read_b64_tr_b16 v[58:59], v39 offset:29184
    v_mul_f32 v228, s56, v228
    v_mfma_f32_16x16x32_bf16 v[136:139], v[64:67], a[164:167], v[136:139]
    v_mul_f32 v229, s56, v229
    v_mul_f32 v230, s56, v230
    v_mfma_f32_16x16x32_bf16 v[140:143], v[64:67], a[236:239], v[140:143]
    v_mul_f32 v231, s56, v231
    s_waitcnt lgkmcnt(4)
    v_mfma_f32_16x16x32_bf16 v[144:147], v[48:51], a[20:23], v[144:147]
    ds_read_b64_tr_b16 v[60:61], v3 offset:0
    v_mfma_f32_16x16x32_bf16 v[148:151], v[48:51], a[92:95], v[148:151]
    ds_read_b64_tr_b16 v[62:63], v3 offset:512
    v_mfma_f32_16x16x32_bf16 v[152:155], v[48:51], a[164:167], v[152:155]
    v_exp_f32 v196, v196
    v_mfma_f32_16x16x32_bf16 v[156:159], v[48:51], a[236:239], v[156:159]
    v_exp_f32 v197, v197
    s_waitcnt lgkmcnt(4)
    v_mfma_f32_16x16x32_bf16 v[160:163], v[52:55], a[20:23], v[160:163]
    ds_read_b64_tr_b16 v[64:65], v3 offset:8192
    v_mfma_f32_16x16x32_bf16 v[164:167], v[52:55], a[92:95], v[164:167]
    ds_read_b64_tr_b16 v[66:67], v3 offset:8704
    v_mfma_f32_16x16x32_bf16 v[168:171], v[52:55], a[164:167], v[168:171]
    v_exp_f32 v198, v198
    v_mfma_f32_16x16x32_bf16 v[172:175], v[52:55], a[236:239], v[172:175]
    v_exp_f32 v199, v199
    s_waitcnt lgkmcnt(4)
    v_mfma_f32_16x16x32_bf16 v[176:179], v[56:59], a[20:23], v[176:179]
    ds_read_b64_tr_b16 v[48:49], v5 offset:0
    v_mfma_f32_16x16x32_bf16 v[180:183], v[56:59], a[92:95], v[180:183]
    ds_read_b64_tr_b16 v[50:51], v5 offset:512
    v_mfma_f32_16x16x32_bf16 v[184:187], v[56:59], a[164:167], v[184:187]
    v_exp_f32 v228, v228
    v_mfma_f32_16x16x32_bf16 v[188:191], v[56:59], a[236:239], v[188:191]
    v_exp_f32 v229, v229
    s_waitcnt lgkmcnt(4)
    v_mfma_f32_16x16x32_bf16 v[128:131], v[60:63], a[24:27], v[128:131]
    ds_read_b64_tr_b16 v[52:53], v5 offset:8192
    v_mfma_f32_16x16x32_bf16 v[132:135], v[60:63], a[96:99], v[132:135]
    ds_read_b64_tr_b16 v[54:55], v5 offset:8704
    v_mfma_f32_16x16x32_bf16 v[136:139], v[60:63], a[168:171], v[136:139]
    v_exp_f32 v230, v230
    v_mfma_f32_16x16x32_bf16 v[140:143], v[60:63], a[240:243], v[140:143]
    v_exp_f32 v231, v231
    s_waitcnt lgkmcnt(4)
    v_mfma_f32_16x16x32_bf16 v[144:147], v[64:67], a[24:27], v[144:147]
    ds_read_b64_tr_b16 v[56:57], v3 offset:4096
    v_add_f32 v196, 1.0, v196
    v_mfma_f32_16x16x32_bf16 v[148:151], v[64:67], a[96:99], v[148:151]
    ds_read_b64_tr_b16 v[58:59], v3 offset:4608
    v_add_f32 v197, 1.0, v197
    v_mfma_f32_16x16x32_bf16 v[152:155], v[64:67], a[168:171], v[152:155]
    v_add_f32 v198, 1.0, v198
    v_add_f32 v199, 1.0, v199
    v_mfma_f32_16x16x32_bf16 v[156:159], v[64:67], a[240:243], v[156:159]
    v_add_f32 v228, 1.0, v228
    v_add_f32 v229, 1.0, v229
    s_waitcnt lgkmcnt(4)
    v_mfma_f32_16x16x32_bf16 v[160:163], v[48:51], a[24:27], v[160:163]
    ds_read_b64_tr_b16 v[60:61], v3 offset:12288
    v_add_f32 v230, 1.0, v230
    v_mfma_f32_16x16x32_bf16 v[164:167], v[48:51], a[96:99], v[164:167]
    ds_read_b64_tr_b16 v[62:63], v3 offset:12800
    v_add_f32 v231, 1.0, v231
    v_mfma_f32_16x16x32_bf16 v[168:171], v[48:51], a[168:171], v[168:171]
    v_rcp_f32 v196, v196
    v_mfma_f32_16x16x32_bf16 v[172:175], v[48:51], a[240:243], v[172:175]
    v_rcp_f32 v197, v197
    s_waitcnt lgkmcnt(4)
    v_mfma_f32_16x16x32_bf16 v[176:179], v[52:55], a[24:27], v[176:179]
    ds_read_b64_tr_b16 v[64:65], v5 offset:4096
    v_mfma_f32_16x16x32_bf16 v[180:183], v[52:55], a[96:99], v[180:183]
    ds_read_b64_tr_b16 v[66:67], v5 offset:4608
    v_mfma_f32_16x16x32_bf16 v[184:187], v[52:55], a[168:171], v[184:187]
    v_rcp_f32 v198, v198
    v_mfma_f32_16x16x32_bf16 v[188:191], v[52:55], a[240:243], v[188:191]
    v_rcp_f32 v199, v199
    s_waitcnt lgkmcnt(4)
    v_mfma_f32_16x16x32_bf16 v[128:131], v[56:59], a[28:31], v[128:131]
    ds_read_b64_tr_b16 v[48:49], v5 offset:12288
    v_mfma_f32_16x16x32_bf16 v[132:135], v[56:59], a[100:103], v[132:135]
    ds_read_b64_tr_b16 v[50:51], v5 offset:12800
    v_mfma_f32_16x16x32_bf16 v[136:139], v[56:59], a[172:175], v[136:139]
    v_rcp_f32 v228, v228
    v_mfma_f32_16x16x32_bf16 v[140:143], v[56:59], a[244:247], v[140:143]
    v_rcp_f32 v229, v229
    s_waitcnt lgkmcnt(4)
    v_mfma_f32_16x16x32_bf16 v[144:147], v[60:63], a[28:31], v[144:147]
    s_waitcnt vmcnt(24)
    s_barrier
    ds_read_b64_tr_b16 v[52:53], v3 offset:16384
    v_mfma_f32_16x16x32_bf16 v[148:151], v[60:63], a[100:103], v[148:151]
    ds_read_b64_tr_b16 v[54:55], v3 offset:16896
    s_add_u32 m0, s53, 131072
    s_add_u32 s57, s35, 1179648
    v_mfma_f32_16x16x32_bf16 v[152:155], v[60:63], a[172:175], v[152:155]
    buffer_load_dwordx4 v1, s[12:15], s57 offen lds
    s_add_u32 m0, s53, 135168
    s_add_u32 s57, s35, 1474560
    v_mfma_f32_16x16x32_bf16 v[156:159], v[60:63], a[244:247], v[156:159]
    v_rcp_f32 v230, v230
    s_waitcnt lgkmcnt(4)
    v_mfma_f32_16x16x32_bf16 v[160:163], v[64:67], a[28:31], v[160:163]
    ds_read_b64_tr_b16 v[56:57], v3 offset:24576
    v_mfma_f32_16x16x32_bf16 v[164:167], v[64:67], a[100:103], v[164:167]
    ds_read_b64_tr_b16 v[58:59], v3 offset:25088
    buffer_load_dwordx4 v1, s[12:15], s57 offen lds
    s_add_u32 m0, s53, 139264
    v_mfma_f32_16x16x32_bf16 v[168:171], v[64:67], a[172:175], v[168:171]
    s_add_u32 s57, s35, 1179648
    v_rcp_f32 v231, v231
    v_mfma_f32_16x16x32_bf16 v[172:175], v[64:67], a[244:247], v[172:175]
    v_mul_f32 v212, v196, v212
    v_mul_f32 v213, v197, v213
    s_waitcnt lgkmcnt(4)
    v_mfma_f32_16x16x32_bf16 v[176:179], v[48:51], a[28:31], v[176:179]
    ds_read_b64_tr_b16 v[60:61], v5 offset:16384
    buffer_load_dwordx4 v1, s[16:19], s57 offen lds
    s_add_u32 m0, s53, 143360
    v_mfma_f32_16x16x32_bf16 v[180:183], v[48:51], a[100:103], v[180:183]
    ds_read_b64_tr_b16 v[62:63], v5 offset:16896
    s_add_u32 s57, s35, 1474560
    v_mul_f32 v214, v198, v214
    v_mfma_f32_16x16x32_bf16 v[184:187], v[48:51], a[172:175], v[184:187]
    v_mul_f32 v215, v199, v215
    v_mul_f32 v244, v228, v244
    v_mfma_f32_16x16x32_bf16 v[188:191], v[48:51], a[244:247], v[188:191]
    buffer_load_dwordx4 v1, s[16:19], s57 offen lds
    s_add_u32 m0, s53, 147456
    s_waitcnt lgkmcnt(4)
    v_mfma_f32_16x16x32_bf16 v[128:131], v[52:55], a[32:35], v[128:131]
    ds_read_b64_tr_b16 v[64:65], v5 offset:24576
    s_add_u32 s57, s35, 1769472
    v_mul_f32 v245, v229, v245
    v_mfma_f32_16x16x32_bf16 v[132:135], v[52:55], a[104:107], v[132:135]
    ds_read_b64_tr_b16 v[66:67], v5 offset:25088
    v_mul_f32 v246, v230, v246
    v_mfma_f32_16x16x32_bf16 v[136:139], v[52:55], a[176:179], v[136:139]
    buffer_load_dwordx4 v1, s[12:15], s57 offen lds
    s_add_u32 m0, s53, 151552
    s_add_u32 s57, s35, 2064384
    v_mfma_f32_16x16x32_bf16 v[140:143], v[52:55], a[248:251], v[140:143]
    v_mul_f32 v247, v231, v247
    v_cvt_pk_bf16_f32 v196, v212, v213
    s_waitcnt lgkmcnt(4)
    v_mfma_f32_16x16x32_bf16 v[144:147], v[56:59], a[32:35], v[144:147]
    ds_read_b64_tr_b16 v[48:49], v3 offset:20480
    v_cvt_pk_bf16_f32 v197, v214, v215
    v_mfma_f32_16x16x32_bf16 v[148:151], v[56:59], a[104:107], v[148:151]
    ds_read_b64_tr_b16 v[50:51], v3 offset:20992
    buffer_load_dwordx4 v1, s[12:15], s57 offen lds
    s_add_u32 m0, s53, 155648
    v_mfma_f32_16x16x32_bf16 v[152:155], v[56:59], a[176:179], v[152:155]
    s_add_u32 s57, s35, 1769472
    v_cvt_pk_bf16_f32 v198, v244, v245
    v_cvt_pk_bf16_f32 v199, v246, v247
    v_mfma_f32_16x16x32_bf16 v[156:159], v[56:59], a[248:251], v[156:159]
    s_add_u32 s59, s45, 147456
    s_waitcnt lgkmcnt(4)
    v_mfma_f32_16x16x32_bf16 v[160:163], v[60:63], a[32:35], v[160:163]
    ds_read_b64_tr_b16 v[52:53], v3 offset:28672
    buffer_load_dwordx4 v1, s[16:19], s57 offen lds
    s_add_u32 m0, s53, 159744
    v_mfma_f32_16x16x32_bf16 v[164:167], v[60:63], a[104:107], v[164:167]
    ds_read_b64_tr_b16 v[54:55], v3 offset:29184
    s_add_u32 s57, s35, 2064384
    v_mfma_f32_16x16x32_bf16 v[168:171], v[60:63], a[176:179], v[168:171]
    v_mfma_f32_16x16x32_bf16 v[172:175], v[60:63], a[248:251], v[172:175]
    buffer_load_dwordx4 v1, s[16:19], s57 offen lds
    s_waitcnt lgkmcnt(4)
    v_mfma_f32_16x16x32_bf16 v[176:179], v[64:67], a[32:35], v[176:179]
    ds_read_b64_tr_b16 v[56:57], v5 offset:20480
    v_mfma_f32_16x16x32_bf16 v[180:183], v[64:67], a[104:107], v[180:183]
    ds_read_b64_tr_b16 v[58:59], v5 offset:20992
    v_mfma_f32_16x16x32_bf16 v[184:187], v[64:67], a[176:179], v[184:187]
    buffer_store_dwordx4 v[196:199], v0, s[20:23], s59 offen sc1
    v_mul_f32 v200, s56, v200
    v_mfma_f32_16x16x32_bf16 v[188:191], v[64:67], a[248:251], v[188:191]
    v_mul_f32 v201, s56, v201
    v_mul_f32 v202, s56, v202
    s_waitcnt lgkmcnt(4)
    v_mfma_f32_16x16x32_bf16 v[128:131], v[48:51], a[36:39], v[128:131]
    ds_read_b64_tr_b16 v[60:61], v5 offset:28672
    v_mul_f32 v203, s56, v203
    v_mfma_f32_16x16x32_bf16 v[132:135], v[48:51], a[108:111], v[132:135]
    ds_read_b64_tr_b16 v[62:63], v5 offset:29184
    v_mul_f32 v232, s56, v232
    v_mfma_f32_16x16x32_bf16 v[136:139], v[48:51], a[180:183], v[136:139]
    v_mul_f32 v233, s56, v233
    v_mul_f32 v234, s56, v234
    v_mfma_f32_16x16x32_bf16 v[140:143], v[48:51], a[252:255], v[140:143]
    v_mul_f32 v235, s56, v235
    s_waitcnt lgkmcnt(4)
    v_mfma_f32_16x16x32_bf16 v[144:147], v[52:55], a[36:39], v[144:147]
    ds_read_b64_tr_b16 v[64:65], v3 offset:32768
    v_mfma_f32_16x16x32_bf16 v[148:151], v[52:55], a[108:111], v[148:151]
    ds_read_b64_tr_b16 v[66:67], v3 offset:33280
    v_mfma_f32_16x16x32_bf16 v[152:155], v[52:55], a[180:183], v[152:155]
    v_exp_f32 v200, v200
    v_mfma_f32_16x16x32_bf16 v[156:159], v[52:55], a[252:255], v[156:159]
    v_exp_f32 v201, v201
    s_waitcnt lgkmcnt(4)
    v_mfma_f32_16x16x32_bf16 v[160:163], v[56:59], a[36:39], v[160:163]
    ds_read_b64_tr_b16 v[48:49], v3 offset:40960
    v_mfma_f32_16x16x32_bf16 v[164:167], v[56:59], a[108:111], v[164:167]
    ds_read_b64_tr_b16 v[50:51], v3 offset:41472
    v_mfma_f32_16x16x32_bf16 v[168:171], v[56:59], a[180:183], v[168:171]
    v_exp_f32 v202, v202
    v_mfma_f32_16x16x32_bf16 v[172:175], v[56:59], a[252:255], v[172:175]
    v_exp_f32 v203, v203
    s_waitcnt lgkmcnt(4)
    v_mfma_f32_16x16x32_bf16 v[176:179], v[60:63], a[36:39], v[176:179]
    ds_read_b64_tr_b16 v[52:53], v5 offset:32768
    v_mfma_f32_16x16x32_bf16 v[180:183], v[60:63], a[108:111], v[180:183]
    ds_read_b64_tr_b16 v[54:55], v5 offset:33280
    v_mfma_f32_16x16x32_bf16 v[184:187], v[60:63], a[180:183], v[184:187]
    v_exp_f32 v232, v232
    v_mfma_f32_16x16x32_bf16 v[188:191], v[60:63], a[252:255], v[188:191]
    v_exp_f32 v233, v233
    s_waitcnt lgkmcnt(4)
    v_mfma_f32_16x16x32_bf16 v[128:131], v[64:67], a[40:43], v[128:131]
    ds_read_b64_tr_b16 v[56:57], v5 offset:40960
    v_mfma_f32_16x16x32_bf16 v[132:135], v[64:67], a[112:115], v[132:135]
    ds_read_b64_tr_b16 v[58:59], v5 offset:41472
    v_mfma_f32_16x16x32_bf16 v[136:139], v[64:67], a[184:187], v[136:139]
    v_exp_f32 v234, v234
    v_mfma_f32_16x16x32_bf16 v[140:143], v[64:67], v[96:99], v[140:143]
    v_exp_f32 v235, v235
    s_waitcnt lgkmcnt(4)
    v_mfma_f32_16x16x32_bf16 v[144:147], v[48:51], a[40:43], v[144:147]
    ds_read_b64_tr_b16 v[60:61], v3 offset:36864
    v_add_f32 v200, 1.0, v200
    v_mfma_f32_16x16x32_bf16 v[148:151], v[48:51], a[112:115], v[148:151]
    ds_read_b64_tr_b16 v[62:63], v3 offset:37376
    v_add_f32 v201, 1.0, v201
    v_mfma_f32_16x16x32_bf16 v[152:155], v[48:51], a[184:187], v[152:155]
    v_add_f32 v202, 1.0, v202
    v_add_f32 v203, 1.0, v203
    v_mfma_f32_16x16x32_bf16 v[156:159], v[48:51], v[96:99], v[156:159]
    v_add_f32 v232, 1.0, v232
    v_add_f32 v233, 1.0, v233
    s_waitcnt lgkmcnt(4)
    v_mfma_f32_16x16x32_bf16 v[160:163], v[52:55], a[40:43], v[160:163]
    ds_read_b64_tr_b16 v[64:65], v3 offset:45056
    v_add_f32 v234, 1.0, v234
    v_mfma_f32_16x16x32_bf16 v[164:167], v[52:55], a[112:115], v[164:167]
    ds_read_b64_tr_b16 v[66:67], v3 offset:45568
    v_add_f32 v235, 1.0, v235
    v_mfma_f32_16x16x32_bf16 v[168:171], v[52:55], a[184:187], v[168:171]
    v_rcp_f32 v200, v200
    v_mfma_f32_16x16x32_bf16 v[172:175], v[52:55], v[96:99], v[172:175]
    v_rcp_f32 v201, v201
    s_waitcnt lgkmcnt(4)
    v_mfma_f32_16x16x32_bf16 v[176:179], v[56:59], a[40:43], v[176:179]
    ds_read_b64_tr_b16 v[48:49], v5 offset:36864
    v_mfma_f32_16x16x32_bf16 v[180:183], v[56:59], a[112:115], v[180:183]
    ds_read_b64_tr_b16 v[50:51], v5 offset:37376
    v_mfma_f32_16x16x32_bf16 v[184:187], v[56:59], a[184:187], v[184:187]
    v_rcp_f32 v202, v202
    v_mfma_f32_16x16x32_bf16 v[188:191], v[56:59], v[96:99], v[188:191]
    v_rcp_f32 v203, v203
    s_waitcnt lgkmcnt(4)
    v_mfma_f32_16x16x32_bf16 v[128:131], v[60:63], a[44:47], v[128:131]
    ds_read_b64_tr_b16 v[52:53], v5 offset:45056
    v_mfma_f32_16x16x32_bf16 v[132:135], v[60:63], a[116:119], v[132:135]
    ds_read_b64_tr_b16 v[54:55], v5 offset:45568
    v_mfma_f32_16x16x32_bf16 v[136:139], v[60:63], a[188:191], v[136:139]
    v_rcp_f32 v232, v232
    v_mfma_f32_16x16x32_bf16 v[140:143], v[60:63], v[100:103], v[140:143]
    v_rcp_f32 v233, v233
    s_waitcnt lgkmcnt(4)
    v_mfma_f32_16x16x32_bf16 v[144:147], v[64:67], a[44:47], v[144:147]
    s_waitcnt vmcnt(24)
    s_barrier
    ds_read_b64_tr_b16 v[56:57], v3 offset:49152
    v_mfma_f32_16x16x32_bf16 v[148:151], v[64:67], a[116:119], v[148:151]
    ds_read_b64_tr_b16 v[58:59], v3 offset:49664
    s_add_u32 m0, s53, 0
    s_add_u32 s57, s35, 2359296
    v_mfma_f32_16x16x32_bf16 v[152:155], v[64:67], a[188:191], v[152:155]
    buffer_load_dwordx4 v1, s[12:15], s57 offen lds
    s_add_u32 m0, s53, 4096
    s_add_u32 s57, s35, 2654208
    v_mfma_f32_16x16x32_bf16 v[156:159], v[64:67], v[100:103], v[156:159]
    v_rcp_f32 v234, v234
    s_waitcnt lgkmcnt(4)
    v_mfma_f32_16x16x32_bf16 v[160:163], v[48:51], a[44:47], v[160:163]
    ds_read_b64_tr_b16 v[60:61], v3 offset:57344
    v_mfma_f32_16x16x32_bf16 v[164:167], v[48:51], a[116:119], v[164:167]
    ds_read_b64_tr_b16 v[62:63], v3 offset:57856
    buffer_load_dwordx4 v1, s[12:15], s57 offen lds
    s_add_u32 m0, s53, 8192
    v_mfma_f32_16x16x32_bf16 v[168:171], v[48:51], a[188:191], v[168:171]
    s_add_u32 s57, s35, 2359296
    v_rcp_f32 v235, v235
    v_mfma_f32_16x16x32_bf16 v[172:175], v[48:51], v[100:103], v[172:175]
    v_mul_f32 v216, v200, v216
    v_mul_f32 v217, v201, v217
    s_waitcnt lgkmcnt(4)
    v_mfma_f32_16x16x32_bf16 v[176:179], v[52:55], a[44:47], v[176:179]
    ds_read_b64_tr_b16 v[64:65], v5 offset:49152
    buffer_load_dwordx4 v1, s[16:19], s57 offen lds
    s_add_u32 m0, s53, 12288
    v_mfma_f32_16x16x32_bf16 v[180:183], v[52:55], a[116:119], v[180:183]
    ds_read_b64_tr_b16 v[66:67], v5 offset:49664
    s_add_u32 s57, s35, 2654208
    v_mul_f32 v218, v202, v218
    v_mfma_f32_16x16x32_bf16 v[184:187], v[52:55], a[188:191], v[184:187]
    v_mul_f32 v219, v203, v219
    v_mul_f32 v248, v232, v248
    v_mfma_f32_16x16x32_bf16 v[188:191], v[52:55], v[100:103], v[188:191]
    buffer_load_dwordx4 v1, s[16:19], s57 offen lds
    s_add_u32 m0, s53, 16384
    s_waitcnt lgkmcnt(4)
    v_mfma_f32_16x16x32_bf16 v[128:131], v[56:59], a[48:51], v[128:131]
    ds_read_b64_tr_b16 v[48:49], v5 offset:57344
    s_add_u32 s57, s35, 2949120
    v_mul_f32 v249, v233, v249
    v_mfma_f32_16x16x32_bf16 v[132:135], v[56:59], a[120:123], v[132:135]
    ds_read_b64_tr_b16 v[50:51], v5 offset:57856
    v_mul_f32 v250, v234, v250
    v_mfma_f32_16x16x32_bf16 v[136:139], v[56:59], a[192:195], v[136:139]
    buffer_load_dwordx4 v1, s[12:15], s57 offen lds
    s_add_u32 m0, s53, 20480
    s_add_u32 s57, s35, 3244032
    v_mfma_f32_16x16x32_bf16 v[140:143], v[56:59], v[104:107], v[140:143]
    v_mul_f32 v251, v235, v251
    v_cvt_pk_bf16_f32 v200, v216, v217
    s_waitcnt lgkmcnt(4)
    v_mfma_f32_16x16x32_bf16 v[144:147], v[60:63], a[48:51], v[144:147]
    ds_read_b64_tr_b16 v[52:53], v3 offset:53248
    v_cvt_pk_bf16_f32 v201, v218, v219
    v_mfma_f32_16x16x32_bf16 v[148:151], v[60:63], a[120:123], v[148:151]
    ds_read_b64_tr_b16 v[54:55], v3 offset:53760
    buffer_load_dwordx4 v1, s[12:15], s57 offen lds
    s_add_u32 m0, s53, 24576
    v_mfma_f32_16x16x32_bf16 v[152:155], v[60:63], a[192:195], v[152:155]
    s_add_u32 s57, s35, 2949120
    v_cvt_pk_bf16_f32 v202, v248, v249
    v_cvt_pk_bf16_f32 v203, v250, v251
    v_mfma_f32_16x16x32_bf16 v[156:159], v[60:63], v[104:107], v[156:159]
    s_add_u32 s59, s45, 294912
    s_waitcnt lgkmcnt(4)
    v_mfma_f32_16x16x32_bf16 v[160:163], v[64:67], a[48:51], v[160:163]
    ds_read_b64_tr_b16 v[56:57], v3 offset:61440
    buffer_load_dwordx4 v1, s[16:19], s57 offen lds
    s_add_u32 m0, s53, 28672
    v_mfma_f32_16x16x32_bf16 v[164:167], v[64:67], a[120:123], v[164:167]
    ds_read_b64_tr_b16 v[58:59], v3 offset:61952
    s_add_u32 s57, s35, 3244032
    v_mfma_f32_16x16x32_bf16 v[168:171], v[64:67], a[192:195], v[168:171]
    v_mfma_f32_16x16x32_bf16 v[172:175], v[64:67], v[104:107], v[172:175]
    buffer_load_dwordx4 v1, s[16:19], s57 offen lds
    s_waitcnt lgkmcnt(4)
    v_mfma_f32_16x16x32_bf16 v[176:179], v[48:51], a[48:51], v[176:179]
    ds_read_b64_tr_b16 v[60:61], v5 offset:53248
    v_mfma_f32_16x16x32_bf16 v[180:183], v[48:51], a[120:123], v[180:183]
    ds_read_b64_tr_b16 v[62:63], v5 offset:53760
    v_mfma_f32_16x16x32_bf16 v[184:187], v[48:51], a[192:195], v[184:187]
    buffer_store_dwordx4 v[200:203], v0, s[20:23], s59 offen sc1
    v_mul_f32 v204, s56, v204
    v_mfma_f32_16x16x32_bf16 v[188:191], v[48:51], v[104:107], v[188:191]
    v_mul_f32 v205, s56, v205
    v_mul_f32 v206, s56, v206
    s_waitcnt lgkmcnt(4)
    v_mfma_f32_16x16x32_bf16 v[128:131], v[52:55], a[52:55], v[128:131]
    ds_read_b64_tr_b16 v[64:65], v5 offset:61440
    v_mul_f32 v207, s56, v207
    v_mfma_f32_16x16x32_bf16 v[132:135], v[52:55], a[124:127], v[132:135]
    ds_read_b64_tr_b16 v[66:67], v5 offset:61952
    v_mul_f32 v236, s56, v236
    v_mfma_f32_16x16x32_bf16 v[136:139], v[52:55], a[196:199], v[136:139]
    v_mul_f32 v237, s56, v237
    v_mul_f32 v238, s56, v238
    v_mfma_f32_16x16x32_bf16 v[140:143], v[52:55], v[108:111], v[140:143]
    v_mul_f32 v239, s56, v239
    s_waitcnt lgkmcnt(4)
    v_mfma_f32_16x16x32_bf16 v[144:147], v[56:59], a[52:55], v[144:147]
    ds_read_b64_tr_b16 v[48:49], v4 offset:0
    v_mfma_f32_16x16x32_bf16 v[148:151], v[56:59], a[124:127], v[148:151]
    ds_read_b64_tr_b16 v[50:51], v4 offset:512
    v_mfma_f32_16x16x32_bf16 v[152:155], v[56:59], a[196:199], v[152:155]
    v_exp_f32 v204, v204
    v_mfma_f32_16x16x32_bf16 v[156:159], v[56:59], v[108:111], v[156:159]
    v_exp_f32 v205, v205
    s_waitcnt lgkmcnt(4)
    v_mfma_f32_16x16x32_bf16 v[160:163], v[60:63], a[52:55], v[160:163]
    ds_read_b64_tr_b16 v[52:53], v4 offset:8192
    v_mfma_f32_16x16x32_bf16 v[164:167], v[60:63], a[124:127], v[164:167]
    ds_read_b64_tr_b16 v[54:55], v4 offset:8704
    v_mfma_f32_16x16x32_bf16 v[168:171], v[60:63], a[196:199], v[168:171]
    v_exp_f32 v206, v206
    v_mfma_f32_16x16x32_bf16 v[172:175], v[60:63], v[108:111], v[172:175]
    v_exp_f32 v207, v207
    s_waitcnt lgkmcnt(4)
    v_mfma_f32_16x16x32_bf16 v[176:179], v[64:67], a[52:55], v[176:179]
    ds_read_b64_tr_b16 v[56:57], v6 offset:0
    v_mfma_f32_16x16x32_bf16 v[180:183], v[64:67], a[124:127], v[180:183]
    ds_read_b64_tr_b16 v[58:59], v6 offset:512
    v_mfma_f32_16x16x32_bf16 v[184:187], v[64:67], a[196:199], v[184:187]
    v_exp_f32 v236, v236
    v_mfma_f32_16x16x32_bf16 v[188:191], v[64:67], v[108:111], v[188:191]
    v_exp_f32 v237, v237
    s_waitcnt lgkmcnt(4)
    v_mfma_f32_16x16x32_bf16 v[128:131], v[48:51], a[56:59], v[128:131]
    ds_read_b64_tr_b16 v[60:61], v6 offset:8192
    v_mfma_f32_16x16x32_bf16 v[132:135], v[48:51], a[128:131], v[132:135]
    ds_read_b64_tr_b16 v[62:63], v6 offset:8704
    v_mfma_f32_16x16x32_bf16 v[136:139], v[48:51], a[200:203], v[136:139]
    v_exp_f32 v238, v238
    v_mfma_f32_16x16x32_bf16 v[140:143], v[48:51], v[112:115], v[140:143]
    v_exp_f32 v239, v239
    s_waitcnt lgkmcnt(4)
    v_mfma_f32_16x16x32_bf16 v[144:147], v[52:55], a[56:59], v[144:147]
    ds_read_b64_tr_b16 v[64:65], v4 offset:4096
    v_add_f32 v204, 1.0, v204
    v_mfma_f32_16x16x32_bf16 v[148:151], v[52:55], a[128:131], v[148:151]
    ds_read_b64_tr_b16 v[66:67], v4 offset:4608
    v_add_f32 v205, 1.0, v205
    v_mfma_f32_16x16x32_bf16 v[152:155], v[52:55], a[200:203], v[152:155]
    v_add_f32 v206, 1.0, v206
    v_add_f32 v207, 1.0, v207
    v_mfma_f32_16x16x32_bf16 v[156:159], v[52:55], v[112:115], v[156:159]
    v_add_f32 v236, 1.0, v236
    v_add_f32 v237, 1.0, v237
    s_waitcnt lgkmcnt(4)
    v_mfma_f32_16x16x32_bf16 v[160:163], v[56:59], a[56:59], v[160:163]
    ds_read_b64_tr_b16 v[48:49], v4 offset:12288
    v_add_f32 v238, 1.0, v238
    v_mfma_f32_16x16x32_bf16 v[164:167], v[56:59], a[128:131], v[164:167]
    ds_read_b64_tr_b16 v[50:51], v4 offset:12800
    v_add_f32 v239, 1.0, v239
    v_mfma_f32_16x16x32_bf16 v[168:171], v[56:59], a[200:203], v[168:171]
    v_rcp_f32 v204, v204
    v_mfma_f32_16x16x32_bf16 v[172:175], v[56:59], v[112:115], v[172:175]
    v_rcp_f32 v205, v205
    s_waitcnt lgkmcnt(4)
    v_mfma_f32_16x16x32_bf16 v[176:179], v[60:63], a[56:59], v[176:179]
    ds_read_b64_tr_b16 v[52:53], v6 offset:4096
    v_mfma_f32_16x16x32_bf16 v[180:183], v[60:63], a[128:131], v[180:183]
    ds_read_b64_tr_b16 v[54:55], v6 offset:4608
    v_mfma_f32_16x16x32_bf16 v[184:187], v[60:63], a[200:203], v[184:187]
    v_rcp_f32 v206, v206
    v_mfma_f32_16x16x32_bf16 v[188:191], v[60:63], v[112:115], v[188:191]
    v_rcp_f32 v207, v207
    s_waitcnt lgkmcnt(4)
    v_mfma_f32_16x16x32_bf16 v[128:131], v[64:67], a[60:63], v[128:131]
    ds_read_b64_tr_b16 v[56:57], v6 offset:12288
    v_mfma_f32_16x16x32_bf16 v[132:135], v[64:67], a[132:135], v[132:135]
    ds_read_b64_tr_b16 v[58:59], v6 offset:12800
    v_mfma_f32_16x16x32_bf16 v[136:139], v[64:67], a[204:207], v[136:139]
    v_rcp_f32 v236, v236
    v_mfma_f32_16x16x32_bf16 v[140:143], v[64:67], v[116:119], v[140:143]
    v_rcp_f32 v237, v237
    s_waitcnt lgkmcnt(4)
    v_mfma_f32_16x16x32_bf16 v[144:147], v[48:51], a[60:63], v[144:147]
    s_waitcnt vmcnt(23)
    s_barrier
    ds_read_b64_tr_b16 v[60:61], v4 offset:16384
    v_mfma_f32_16x16x32_bf16 v[148:151], v[48:51], a[132:135], v[148:151]
    ds_read_b64_tr_b16 v[62:63], v4 offset:16896
    s_add_u32 m0, s53, 32768
    s_add_u32 s57, s35, 3538944
    v_mfma_f32_16x16x32_bf16 v[152:155], v[48:51], a[204:207], v[152:155]
    buffer_load_dwordx4 v1, s[12:15], s57 offen lds
    s_add_u32 m0, s53, 36864
    s_add_u32 s57, s35, 3833856
    v_mfma_f32_16x16x32_bf16 v[156:159], v[48:51], v[116:119], v[156:159]
    v_rcp_f32 v238, v238
    s_waitcnt lgkmcnt(4)
    v_mfma_f32_16x16x32_bf16 v[160:163], v[52:55], a[60:63], v[160:163]
    ds_read_b64_tr_b16 v[64:65], v4 offset:24576
    v_mfma_f32_16x16x32_bf16 v[164:167], v[52:55], a[132:135], v[164:167]
    ds_read_b64_tr_b16 v[66:67], v4 offset:25088
    buffer_load_dwordx4 v1, s[12:15], s57 offen lds
    s_add_u32 m0, s53, 40960
    v_mfma_f32_16x16x32_bf16 v[168:171], v[52:55], a[204:207], v[168:171]
    s_add_u32 s57, s35, 3538944
    v_rcp_f32 v239, v239
    v_mfma_f32_16x16x32_bf16 v[172:175], v[52:55], v[116:119], v[172:175]
    v_mul_f32 v220, v204, v220
    v_mul_f32 v221, v205, v221
    s_waitcnt lgkmcnt(4)
    v_mfma_f32_16x16x32_bf16 v[176:179], v[56:59], a[60:63], v[176:179]
    ds_read_b64_tr_b16 v[48:49], v6 offset:16384
    buffer_load_dwordx4 v1, s[16:19], s57 offen lds
    s_add_u32 m0, s53, 45056
    v_mfma_f32_16x16x32_bf16 v[180:183], v[56:59], a[132:135], v[180:183]
    ds_read_b64_tr_b16 v[50:51], v6 offset:16896
    s_add_u32 s57, s35, 3833856
    v_mul_f32 v222, v206, v222
    v_mfma_f32_16x16x32_bf16 v[184:187], v[56:59], a[204:207], v[184:187]
    v_mul_f32 v223, v207, v223
    v_mul_f32 v252, v236, v252
    v_mfma_f32_16x16x32_bf16 v[188:191], v[56:59], v[116:119], v[188:191]
    buffer_load_dwordx4 v1, s[16:19], s57 offen lds
    s_add_u32 m0, s53, 49152
    s_waitcnt lgkmcnt(4)
    v_mfma_f32_16x16x32_bf16 v[128:131], v[60:63], a[64:67], v[128:131]
    ds_read_b64_tr_b16 v[52:53], v6 offset:24576
    s_add_u32 s57, s35, 4128768
    v_mul_f32 v253, v237, v253
    v_mfma_f32_16x16x32_bf16 v[132:135], v[60:63], a[136:139], v[132:135]
    ds_read_b64_tr_b16 v[54:55], v6 offset:25088
    v_mul_f32 v254, v238, v254
    v_mfma_f32_16x16x32_bf16 v[136:139], v[60:63], a[208:211], v[136:139]
    buffer_load_dwordx4 v1, s[12:15], s57 offen lds
    s_add_u32 m0, s53, 53248
    s_add_u32 s57, s35, 4423680
    v_mfma_f32_16x16x32_bf16 v[140:143], v[60:63], v[120:123], v[140:143]
    v_mul_f32 v255, v239, v255
    v_cvt_pk_bf16_f32 v204, v220, v221
    s_waitcnt lgkmcnt(4)
    v_mfma_f32_16x16x32_bf16 v[144:147], v[64:67], a[64:67], v[144:147]
    ds_read_b64_tr_b16 v[56:57], v4 offset:20480
    v_cvt_pk_bf16_f32 v205, v222, v223
    v_mfma_f32_16x16x32_bf16 v[148:151], v[64:67], a[136:139], v[148:151]
    ds_read_b64_tr_b16 v[58:59], v4 offset:20992
    buffer_load_dwordx4 v1, s[12:15], s57 offen lds
    s_add_u32 m0, s53, 57344
    v_mfma_f32_16x16x32_bf16 v[152:155], v[64:67], a[208:211], v[152:155]
    s_add_u32 s57, s35, 4128768
    v_cvt_pk_bf16_f32 v206, v252, v253
    v_cvt_pk_bf16_f32 v207, v254, v255
    v_mfma_f32_16x16x32_bf16 v[156:159], v[64:67], v[120:123], v[156:159]
    s_add_u32 s59, s45, 442368
    s_waitcnt lgkmcnt(4)
    v_mfma_f32_16x16x32_bf16 v[160:163], v[48:51], a[64:67], v[160:163]
    ds_read_b64_tr_b16 v[60:61], v4 offset:28672
    buffer_load_dwordx4 v1, s[16:19], s57 offen lds
    s_add_u32 m0, s53, 61440
    v_mfma_f32_16x16x32_bf16 v[164:167], v[48:51], a[136:139], v[164:167]
    ds_read_b64_tr_b16 v[62:63], v4 offset:29184
    s_add_u32 s57, s35, 4423680
    v_mfma_f32_16x16x32_bf16 v[168:171], v[48:51], a[208:211], v[168:171]
    v_mfma_f32_16x16x32_bf16 v[172:175], v[48:51], v[120:123], v[172:175]
    buffer_load_dwordx4 v1, s[16:19], s57 offen lds
    s_waitcnt lgkmcnt(4)
    v_mfma_f32_16x16x32_bf16 v[176:179], v[52:55], a[64:67], v[176:179]
    ds_read_b64_tr_b16 v[64:65], v6 offset:20480
    v_mfma_f32_16x16x32_bf16 v[180:183], v[52:55], a[136:139], v[180:183]
    ds_read_b64_tr_b16 v[66:67], v6 offset:20992
    v_mfma_f32_16x16x32_bf16 v[184:187], v[52:55], a[208:211], v[184:187]
    buffer_store_dwordx4 v[204:207], v0, s[20:23], s59 offen sc1
    v_mfma_f32_16x16x32_bf16 v[188:191], v[52:55], v[120:123], v[188:191]
    s_waitcnt lgkmcnt(4)
    v_mfma_f32_16x16x32_bf16 v[128:131], v[56:59], a[68:71], v[128:131]
    ds_read_b64_tr_b16 v[48:49], v6 offset:28672
    v_mfma_f32_16x16x32_bf16 v[132:135], v[56:59], a[140:143], v[132:135]
    ds_read_b64_tr_b16 v[50:51], v6 offset:29184
    v_mfma_f32_16x16x32_bf16 v[136:139], v[56:59], a[212:215], v[136:139]
    v_mfma_f32_16x16x32_bf16 v[140:143], v[56:59], v[124:127], v[140:143]
    s_waitcnt lgkmcnt(4)
    v_mfma_f32_16x16x32_bf16 v[144:147], v[60:63], a[68:71], v[144:147]
    ds_read_b64_tr_b16 v[52:53], v8 offset:32768
    v_mfma_f32_16x16x32_bf16 v[148:151], v[60:63], a[140:143], v[148:151]
    ds_read_b64_tr_b16 v[54:55], v8 offset:33280
    v_mfma_f32_16x16x32_bf16 v[152:155], v[60:63], a[212:215], v[152:155]
    v_mfma_f32_16x16x32_bf16 v[156:159], v[60:63], v[124:127], v[156:159]
    s_waitcnt lgkmcnt(4)
    v_mfma_f32_16x16x32_bf16 v[160:163], v[64:67], a[68:71], v[160:163]
    ds_read_b64_tr_b16 v[56:57], v8 offset:40960
    v_mfma_f32_16x16x32_bf16 v[164:167], v[64:67], a[140:143], v[164:167]
    ds_read_b64_tr_b16 v[58:59], v8 offset:41472
    v_mfma_f32_16x16x32_bf16 v[168:171], v[64:67], a[212:215], v[168:171]
    v_mfma_f32_16x16x32_bf16 v[172:175], v[64:67], v[124:127], v[172:175]
    s_waitcnt lgkmcnt(4)
    v_mfma_f32_16x16x32_bf16 v[176:179], v[48:51], a[68:71], v[176:179]
    ds_read_b64_tr_b16 v[60:61], v8 offset:36864
    v_mfma_f32_16x16x32_bf16 v[180:183], v[48:51], a[140:143], v[180:183]
    ds_read_b64_tr_b16 v[62:63], v8 offset:37376
    v_mfma_f32_16x16x32_bf16 v[184:187], v[48:51], a[212:215], v[184:187]
    v_mfma_f32_16x16x32_bf16 v[188:191], v[48:51], v[124:127], v[188:191]
    s_waitcnt lgkmcnt(4)
    v_mfma_f32_16x16x32_bf16 v[192:195], v[52:55], a[0:3], 0
    ds_read_b64_tr_b16 v[64:65], v8 offset:45056
    v_mfma_f32_16x16x32_bf16 v[196:199], v[52:55], a[72:75], 0
    ds_read_b64_tr_b16 v[66:67], v8 offset:45568
    v_mfma_f32_16x16x32_bf16 v[200:203], v[52:55], a[144:147], 0
    v_mfma_f32_16x16x32_bf16 v[204:207], v[52:55], a[216:219], 0
    s_waitcnt lgkmcnt(4)
    v_mfma_f32_16x16x32_bf16 v[208:211], v[56:59], a[0:3], 0
    s_waitcnt vmcnt(23)
    s_barrier
    ds_read_b64_tr_b16 v[48:49], v8 offset:49152
    v_mfma_f32_16x16x32_bf16 v[212:215], v[56:59], a[72:75], 0
    ds_read_b64_tr_b16 v[50:51], v8 offset:49664
    s_add_u32 m0, s53, 65536
    s_add_u32 s57, s35, 4718592
    v_mfma_f32_16x16x32_bf16 v[216:219], v[56:59], a[144:147], 0
    buffer_load_dwordx4 v1, s[12:15], s57 offen lds
    s_add_u32 m0, s53, 69632
    s_add_u32 s57, s35, 5013504
    v_mfma_f32_16x16x32_bf16 v[220:223], v[56:59], a[216:219], 0
    s_waitcnt lgkmcnt(4)
    v_mfma_f32_16x16x32_bf16 v[192:195], v[60:63], a[4:7], v[192:195]
    ds_read_b64_tr_b16 v[52:53], v8 offset:57344
    v_mfma_f32_16x16x32_bf16 v[196:199], v[60:63], a[76:79], v[196:199]
    ds_read_b64_tr_b16 v[54:55], v8 offset:57856
    buffer_load_dwordx4 v1, s[12:15], s57 offen lds
    s_add_u32 m0, s53, 73728
    v_mfma_f32_16x16x32_bf16 v[200:203], v[60:63], a[148:151], v[200:203]
    s_add_u32 s57, s35, 4718592
    v_mul_f32 v128, s56, v128
    v_mul_f32 v129, s56, v129
    v_mfma_f32_16x16x32_bf16 v[204:207], v[60:63], a[220:223], v[204:207]
    v_mul_f32 v130, s56, v130
    v_mul_f32 v131, s56, v131
    s_waitcnt lgkmcnt(4)
    v_mfma_f32_16x16x32_bf16 v[208:211], v[64:67], a[4:7], v[208:211]
    ds_read_b64_tr_b16 v[56:57], v8 offset:53248
    buffer_load_dwordx4 v1, s[16:19], s57 offen lds
    s_add_u32 m0, s53, 77824
    v_mfma_f32_16x16x32_bf16 v[212:215], v[64:67], a[76:79], v[212:215]
    ds_read_b64_tr_b16 v[58:59], v8 offset:53760
    s_add_u32 s57, s35, 5013504
    v_mul_f32 v160, s56, v160
    v_mfma_f32_16x16x32_bf16 v[216:219], v[64:67], a[148:151], v[216:219]
    v_mul_f32 v161, s56, v161
    v_mul_f32 v162, s56, v162
    v_mfma_f32_16x16x32_bf16 v[220:223], v[64:67], a[220:223], v[220:223]
    buffer_load_dwordx4 v1, s[16:19], s57 offen lds
    s_add_u32 m0, s53, 81920
    s_waitcnt lgkmcnt(4)
    v_mfma_f32_16x16x32_bf16 v[192:195], v[48:51], a[8:11], v[192:195]
    ds_read_b64_tr_b16 v[60:61], v8 offset:61440
    s_add_u32 s57, s36, 0
    v_mul_f32 v163, s56, v163
    v_mfma_f32_16x16x32_bf16 v[196:199], v[48:51], a[80:83], v[196:199]
    ds_read_b64_tr_b16 v[62:63], v8 offset:61952
    v_mfma_f32_16x16x32_bf16 v[200:203], v[48:51], a[152:155], v[200:203]
    buffer_load_dwordx4 v1, s[12:15], s57 offen lds
    s_add_u32 m0, s53, 86016
    s_add_u32 s57, s36, 294912
    v_mfma_f32_16x16x32_bf16 v[204:207], v[48:51], a[224:227], v[204:207]
    v_exp_f32 v128, v128
    s_waitcnt lgkmcnt(4)
    v_mfma_f32_16x16x32_bf16 v[208:211], v[52:55], a[8:11], v[208:211]
    ds_read_b64_tr_b16 v[64:65], v40 offset:0
    v_mfma_f32_16x16x32_bf16 v[212:215], v[52:55], a[80:83], v[212:215]
    ds_read_b64_tr_b16 v[66:67], v40 offset:512
    buffer_load_dwordx4 v1, s[12:15], s57 offen lds
    s_add_u32 m0, s53, 90112
    v_mfma_f32_16x16x32_bf16 v[216:219], v[52:55], a[152:155], v[216:219]
    s_add_u32 s57, s36, 0
    v_exp_f32 v129, v129
    v_mfma_f32_16x16x32_bf16 v[220:223], v[52:55], a[224:227], v[220:223]
    v_exp_f32 v130, v130
    s_waitcnt lgkmcnt(4)
    v_mfma_f32_16x16x32_bf16 v[192:195], v[56:59], a[12:15], v[192:195]
    ds_read_b64_tr_b16 v[48:49], v40 offset:8192
    buffer_load_dwordx4 v1, s[16:19], s57 offen lds
    s_add_u32 m0, s53, 94208
    v_mfma_f32_16x16x32_bf16 v[196:199], v[56:59], a[84:87], v[196:199]
    ds_read_b64_tr_b16 v[50:51], v40 offset:8704
    s_add_u32 s57, s36, 294912
    v_mfma_f32_16x16x32_bf16 v[200:203], v[56:59], a[156:159], v[200:203]
    v_exp_f32 v131, v131
    v_mfma_f32_16x16x32_bf16 v[204:207], v[56:59], a[228:231], v[204:207]
    buffer_load_dwordx4 v1, s[16:19], s57 offen lds
    s_waitcnt lgkmcnt(4)
    v_mfma_f32_16x16x32_bf16 v[208:211], v[60:63], a[12:15], v[208:211]
    ds_read_b64_tr_b16 v[52:53], v40 offset:4096
    v_mfma_f32_16x16x32_bf16 v[212:215], v[60:63], a[84:87], v[212:215]
    ds_read_b64_tr_b16 v[54:55], v40 offset:4608
    v_mfma_f32_16x16x32_bf16 v[216:219], v[60:63], a[156:159], v[216:219]
    v_exp_f32 v160, v160
    v_mfma_f32_16x16x32_bf16 v[220:223], v[60:63], a[228:231], v[220:223]
    v_exp_f32 v161, v161
    s_waitcnt lgkmcnt(4)
    v_mfma_f32_16x16x32_bf16 v[192:195], v[64:67], a[16:19], v[192:195]
    ds_read_b64_tr_b16 v[56:57], v40 offset:12288
    v_mfma_f32_16x16x32_bf16 v[196:199], v[64:67], a[88:91], v[196:199]
    ds_read_b64_tr_b16 v[58:59], v40 offset:12800
    v_mfma_f32_16x16x32_bf16 v[200:203], v[64:67], a[160:163], v[200:203]
    v_exp_f32 v162, v162
    v_mfma_f32_16x16x32_bf16 v[204:207], v[64:67], a[232:235], v[204:207]
    v_exp_f32 v163, v163
    s_waitcnt lgkmcnt(4)
    v_mfma_f32_16x16x32_bf16 v[208:211], v[48:51], a[16:19], v[208:211]
    s_waitcnt vmcnt(22)
    s_barrier
    ds_read_b64_tr_b16 v[60:61], v40 offset:16384
    v_mfma_f32_16x16x32_bf16 v[212:215], v[48:51], a[88:91], v[212:215]
    ds_read_b64_tr_b16 v[62:63], v40 offset:16896
    s_add_u32 m0, s53, 98304
    s_add_u32 s57, s36, 589824
    v_mfma_f32_16x16x32_bf16 v[216:219], v[48:51], a[160:163], v[216:219]
    buffer_load_dwordx4 v1, s[12:15], s57 offen lds
    s_add_u32 m0, s53, 102400
    s_add_u32 s57, s36, 884736
    v_mfma_f32_16x16x32_bf16 v[220:223], v[48:51], a[232:235], v[220:223]
    v_add_f32 v128, 1.0, v128
    v_add_f32 v129, 1.0, v129
    s_waitcnt lgkmcnt(4)
    v_mfma_f32_16x16x32_bf16 v[192:195], v[52:55], a[20:23], v[192:195]
    ds_read_b64_tr_b16 v[64:65], v40 offset:24576
    v_add_f32 v130, 1.0, v130
    v_mfma_f32_16x16x32_bf16 v[196:199], v[52:55], a[92:95], v[196:199]
    ds_read_b64_tr_b16 v[66:67], v40 offset:25088
    buffer_load_dwordx4 v1, s[12:15], s57 offen lds
    s_add_u32 m0, s53, 106496
    v_mfma_f32_16x16x32_bf16 v[200:203], v[52:55], a[164:167], v[200:203]
    s_add_u32 s57, s36, 589824
    v_add_f32 v131, 1.0, v131
    v_add_f32 v160, 1.0, v160
    v_mfma_f32_16x16x32_bf16 v[204:207], v[52:55], a[236:239], v[204:207]
    v_add_f32 v161, 1.0, v161
    v_add_f32 v162, 1.0, v162
    s_waitcnt lgkmcnt(4)
    v_mfma_f32_16x16x32_bf16 v[208:211], v[56:59], a[20:23], v[208:211]
    ds_read_b64_tr_b16 v[48:49], v40 offset:20480
    buffer_load_dwordx4 v1, s[16:19], s57 offen lds
    s_add_u32 m0, s53, 110592
    v_mfma_f32_16x16x32_bf16 v[212:215], v[56:59], a[92:95], v[212:215]
    ds_read_b64_tr_b16 v[50:51], v40 offset:20992
    s_add_u32 s57, s36, 884736
    v_add_f32 v163, 1.0, v163
    v_mfma_f32_16x16x32_bf16 v[216:219], v[56:59], a[164:167], v[216:219]
    v_rcp_f32 v128, v128
    v_mfma_f32_16x16x32_bf16 v[220:223], v[56:59], a[236:239], v[220:223]
    buffer_load_dwordx4 v1, s[16:19], s57 offen lds
    s_add_u32 m0, s53, 114688
    s_waitcnt lgkmcnt(4)
    v_mfma_f32_16x16x32_bf16 v[192:195], v[60:63], a[24:27], v[192:195]
    ds_read_b64_tr_b16 v[52:53], v40 offset:28672
    s_add_u32 s57, s36, 1179648
    v_mfma_f32_16x16x32_bf16 v[196:199], v[60:63], a[96:99], v[196:199]
    ds_read_b64_tr_b16 v[54:55], v40 offset:29184
    v_mfma_f32_16x16x32_bf16 v[200:203], v[60:63], a[168:171], v[200:203]
    buffer_load_dwordx4 v1, s[12:15], s57 offen lds
    s_add_u32 m0, s53, 118784
    s_add_u32 s57, s36, 1474560
    v_mfma_f32_16x16x32_bf16 v[204:207], v[60:63], a[240:243], v[204:207]
    v_rcp_f32 v129, v129
    s_waitcnt lgkmcnt(4)
    v_mfma_f32_16x16x32_bf16 v[208:211], v[64:67], a[24:27], v[208:211]
    ds_read_b64_tr_b16 v[56:57], v7 offset:0
    v_mfma_f32_16x16x32_bf16 v[212:215], v[64:67], a[96:99], v[212:215]
    ds_read_b64_tr_b16 v[58:59], v7 offset:512
    buffer_load_dwordx4 v1, s[12:15], s57 offen lds
    s_add_u32 m0, s53, 122880
    v_mfma_f32_16x16x32_bf16 v[216:219], v[64:67], a[168:171], v[216:219]
    s_add_u32 s57, s36, 1179648
    v_rcp_f32 v130, v130
    v_mfma_f32_16x16x32_bf16 v[220:223], v[64:67], a[240:243], v[220:223]
    v_rcp_f32 v131, v131
    s_waitcnt lgkmcnt(4)
    v_mfma_f32_16x16x32_bf16 v[192:195], v[48:51], a[28:31], v[192:195]
    ds_read_b64_tr_b16 v[60:61], v7 offset:8192
    buffer_load_dwordx4 v1, s[16:19], s57 offen lds
    s_add_u32 m0, s53, 126976
    v_mfma_f32_16x16x32_bf16 v[196:199], v[48:51], a[100:103], v[196:199]
    ds_read_b64_tr_b16 v[62:63], v7 offset:8704
    s_add_u32 s57, s36, 1474560
    v_mfma_f32_16x16x32_bf16 v[200:203], v[48:51], a[172:175], v[200:203]
    v_rcp_f32 v160, v160
    v_mfma_f32_16x16x32_bf16 v[204:207], v[48:51], a[244:247], v[204:207]
    buffer_load_dwordx4 v1, s[16:19], s57 offen lds
    s_waitcnt lgkmcnt(4)
    v_mfma_f32_16x16x32_bf16 v[208:211], v[52:55], a[28:31], v[208:211]
    ds_read_b64_tr_b16 v[64:65], v7 offset:4096
    v_mfma_f32_16x16x32_bf16 v[212:215], v[52:55], a[100:103], v[212:215]
    ds_read_b64_tr_b16 v[66:67], v7 offset:4608
    v_mfma_f32_16x16x32_bf16 v[216:219], v[52:55], a[172:175], v[216:219]
    v_rcp_f32 v161, v161
    v_mfma_f32_16x16x32_bf16 v[220:223], v[52:55], a[244:247], v[220:223]
    v_rcp_f32 v162, v162
    s_waitcnt lgkmcnt(4)
    v_mfma_f32_16x16x32_bf16 v[192:195], v[56:59], a[32:35], v[192:195]
    ds_read_b64_tr_b16 v[48:49], v7 offset:12288
    v_mfma_f32_16x16x32_bf16 v[196:199], v[56:59], a[104:107], v[196:199]
    ds_read_b64_tr_b16 v[50:51], v7 offset:12800
    v_mfma_f32_16x16x32_bf16 v[200:203], v[56:59], a[176:179], v[200:203]
    v_rcp_f32 v163, v163
    v_mfma_f32_16x16x32_bf16 v[204:207], v[56:59], a[248:251], v[204:207]
    v_mul_f32 v144, v128, v144
    v_mul_f32 v145, v129, v145
    s_waitcnt lgkmcnt(4)
    v_mfma_f32_16x16x32_bf16 v[208:211], v[60:63], a[32:35], v[208:211]
    s_waitcnt vmcnt(21)
    s_barrier
    ds_read_b64_tr_b16 v[52:53], v7 offset:16384
    v_mfma_f32_16x16x32_bf16 v[212:215], v[60:63], a[104:107], v[212:215]
    ds_read_b64_tr_b16 v[54:55], v7 offset:16896
    s_add_u32 m0, s53, 131072
    s_add_u32 s57, s36, 1769472
    v_mfma_f32_16x16x32_bf16 v[216:219], v[60:63], a[176:179], v[216:219]
    buffer_load_dwordx4 v1, s[12:15], s57 offen lds
    s_add_u32 m0, s53, 135168
    s_add_u32 s57, s36, 2064384
    v_mfma_f32_16x16x32_bf16 v[220:223], v[60:63], a[248:251], v[220:223]
    v_mul_f32 v146, v130, v146
    v_mul_f32 v147, v131, v147
    s_waitcnt lgkmcnt(4)
    v_mfma_f32_16x16x32_bf16 v[192:195], v[64:67], a[36:39], v[192:195]
    ds_read_b64_tr_b16 v[56:57], v7 offset:24576
    v_mul_f32 v176, v160, v176
    v_mfma_f32_16x16x32_bf16 v[196:199], v[64:67], a[108:111], v[196:199]
    ds_read_b64_tr_b16 v[58:59], v7 offset:25088
    buffer_load_dwordx4 v1, s[12:15], s57 offen lds
    s_add_u32 m0, s53, 139264
    v_mfma_f32_16x16x32_bf16 v[200:203], v[64:67], a[180:183], v[200:203]
    s_add_u32 s57, s36, 1769472
    v_mul_f32 v177, v161, v177
    v_mul_f32 v178, v162, v178
    v_mfma_f32_16x16x32_bf16 v[204:207], v[64:67], a[252:255], v[204:207]
    v_mul_f32 v179, v163, v179
    v_cvt_pk_bf16_f32 v128, v144, v145
    s_waitcnt lgkmcnt(4)
    v_mfma_f32_16x16x32_bf16 v[208:211], v[48:51], a[36:39], v[208:211]
    ds_read_b64_tr_b16 v[60:61], v7 offset:20480
    buffer_load_dwordx4 v1, s[16:19], s57 offen lds
    s_add_u32 m0, s53, 143360
    v_mfma_f32_16x16x32_bf16 v[212:215], v[48:51], a[108:111], v[212:215]
    ds_read_b64_tr_b16 v[62:63], v7 offset:20992
    s_add_u32 s57, s36, 2064384
    v_cvt_pk_bf16_f32 v129, v146, v147
    v_mfma_f32_16x16x32_bf16 v[216:219], v[48:51], a[180:183], v[216:219]
    v_cvt_pk_bf16_f32 v130, v176, v177
    v_cvt_pk_bf16_f32 v131, v178, v179
    s_add_u32 s59, s46, 0
    v_mfma_f32_16x16x32_bf16 v[220:223], v[48:51], a[252:255], v[220:223]
    buffer_load_dwordx4 v1, s[16:19], s57 offen lds
    s_add_u32 m0, s53, 147456
    s_waitcnt lgkmcnt(4)
    v_mfma_f32_16x16x32_bf16 v[192:195], v[52:55], a[40:43], v[192:195]
    ds_read_b64_tr_b16 v[64:65], v7 offset:28672
    s_add_u32 s57, s36, 2359296
    v_mfma_f32_16x16x32_bf16 v[196:199], v[52:55], a[112:115], v[196:199]
    ds_read_b64_tr_b16 v[66:67], v7 offset:29184
    v_mfma_f32_16x16x32_bf16 v[200:203], v[52:55], a[184:187], v[200:203]
    buffer_load_dwordx4 v1, s[12:15], s57 offen lds
    s_add_u32 m0, s53, 151552
    s_add_u32 s57, s36, 2654208
    v_mfma_f32_16x16x32_bf16 v[204:207], v[52:55], v[96:99], v[204:207]
    s_waitcnt lgkmcnt(4)
    v_mfma_f32_16x16x32_bf16 v[208:211], v[56:59], a[40:43], v[208:211]
    ds_read_b64_tr_b16 v[48:49], v7 offset:32768
    v_mfma_f32_16x16x32_bf16 v[212:215], v[56:59], a[112:115], v[212:215]
    ds_read_b64_tr_b16 v[50:51], v7 offset:33280
    buffer_load_dwordx4 v1, s[12:15], s57 offen lds
    s_add_u32 m0, s53, 155648
    v_mfma_f32_16x16x32_bf16 v[216:219], v[56:59], a[184:187], v[216:219]
    s_add_u32 s57, s36, 2359296
    v_mfma_f32_16x16x32_bf16 v[220:223], v[56:59], v[96:99], v[220:223]
    s_waitcnt lgkmcnt(4)
    v_mfma_f32_16x16x32_bf16 v[192:195], v[60:63], a[44:47], v[192:195]
    ds_read_b64_tr_b16 v[52:53], v7 offset:40960
    buffer_load_dwordx4 v1, s[16:19], s57 offen lds
    s_add_u32 m0, s53, 159744
    v_mfma_f32_16x16x32_bf16 v[196:199], v[60:63], a[116:119], v[196:199]
    ds_read_b64_tr_b16 v[54:55], v7 offset:41472
    s_add_u32 s57, s36, 2654208
    v_mfma_f32_16x16x32_bf16 v[200:203], v[60:63], a[188:191], v[200:203]
    v_mfma_f32_16x16x32_bf16 v[204:207], v[60:63], v[100:103], v[204:207]
    buffer_load_dwordx4 v1, s[16:19], s57 offen lds
    s_waitcnt lgkmcnt(4)
    v_mfma_f32_16x16x32_bf16 v[208:211], v[64:67], a[44:47], v[208:211]
    ds_read_b64_tr_b16 v[56:57], v7 offset:36864
    v_mfma_f32_16x16x32_bf16 v[212:215], v[64:67], a[116:119], v[212:215]
    ds_read_b64_tr_b16 v[58:59], v7 offset:37376
    v_mfma_f32_16x16x32_bf16 v[216:219], v[64:67], a[188:191], v[216:219]
    buffer_store_dwordx4 v[128:131], v0, s[20:23], s59 offen sc1
    v_mul_f32 v132, s56, v132
    v_mfma_f32_16x16x32_bf16 v[220:223], v[64:67], v[100:103], v[220:223]
    v_mul_f32 v133, s56, v133
    v_mul_f32 v134, s56, v134
    s_waitcnt lgkmcnt(4)
    v_mfma_f32_16x16x32_bf16 v[192:195], v[48:51], a[48:51], v[192:195]
    ds_read_b64_tr_b16 v[60:61], v7 offset:45056
    v_mul_f32 v135, s56, v135
    v_mfma_f32_16x16x32_bf16 v[196:199], v[48:51], a[120:123], v[196:199]
    ds_read_b64_tr_b16 v[62:63], v7 offset:45568
    v_mul_f32 v164, s56, v164
    v_mfma_f32_16x16x32_bf16 v[200:203], v[48:51], a[192:195], v[200:203]
    v_mul_f32 v165, s56, v165
    v_mul_f32 v166, s56, v166
    v_mfma_f32_16x16x32_bf16 v[204:207], v[48:51], v[104:107], v[204:207]
    v_mul_f32 v167, s56, v167
    s_waitcnt lgkmcnt(4)
    v_mfma_f32_16x16x32_bf16 v[208:211], v[52:55], a[48:51], v[208:211]
    s_waitcnt vmcnt(21)
    s_barrier
    ds_read_b64_tr_b16 v[64:65], v7 offset:49152
    v_mfma_f32_16x16x32_bf16 v[212:215], v[52:55], a[120:123], v[212:215]
    ds_read_b64_tr_b16 v[66:67], v7 offset:49664
    s_add_u32 m0, s53, 0
    s_add_u32 s57, s36, 2949120
    v_mfma_f32_16x16x32_bf16 v[216:219], v[52:55], a[192:195], v[216:219]
    buffer_load_dwordx4 v1, s[12:15], s57 offen lds
    s_add_u32 m0, s53, 4096
    s_add_u32 s57, s36, 3244032
    v_mfma_f32_16x16x32_bf16 v[220:223], v[52:55], v[104:107], v[220:223]
    v_exp_f32 v132, v132
    s_waitcnt lgkmcnt(4)
    v_mfma_f32_16x16x32_bf16 v[192:195], v[56:59], a[52:55], v[192:195]
    ds_read_b64_tr_b16 v[48:49], v7 offset:57344
    v_mfma_f32_16x16x32_bf16 v[196:199], v[56:59], a[124:127], v[196:199]
    ds_read_b64_tr_b16 v[50:51], v7 offset:57856
    buffer_load_dwordx4 v1, s[12:15], s57 offen lds
    s_add_u32 m0, s53, 8192
    v_mfma_f32_16x16x32_bf16 v[200:203], v[56:59], a[196:199], v[200:203]
    s_add_u32 s57, s36, 2949120
    v_exp_f32 v133, v133
    v_mfma_f32_16x16x32_bf16 v[204:207], v[56:59], v[108:111], v[204:207]
    v_exp_f32 v134, v134
    s_waitcnt lgkmcnt(4)
    v_mfma_f32_16x16x32_bf16 v[208:211], v[60:63], a[52:55], v[208:211]
    ds_read_b64_tr_b16 v[52:53], v7 offset:53248
    buffer_load_dwordx4 v1, s[16:19], s57 offen lds
    s_add_u32 m0, s53, 12288
    v_mfma_f32_16x16x32_bf16 v[212:215], v[60:63], a[124:127], v[212:215]
    ds_read_b64_tr_b16 v[54:55], v7 offset:53760
    s_add_u32 s57, s36, 3244032
    v_mfma_f32_16x16x32_bf16 v[216:219], v[60:63], a[196:199], v[216:219]
    v_exp_f32 v135, v135
    v_mfma_f32_16x16x32_bf16 v[220:223], v[60:63], v[108:111], v[220:223]
    buffer_load_dwordx4 v1, s[16:19], s57 offen lds
    s_add_u32 m0, s53, 16384
    s_waitcnt lgkmcnt(4)
    v_mfma_f32_16x16x32_bf16 v[192:195], v[64:67], a[56:59], v[192:195]
    ds_read_b64_tr_b16 v[56:57], v7 offset:61440
    s_add_u32 s57, s36, 3538944
    v_mfma_f32_16x16x32_bf16 v[196:199], v[64:67], a[128:131], v[196:199]
    ds_read_b64_tr_b16 v[58:59], v7 offset:61952
    v_mfma_f32_16x16x32_bf16 v[200:203], v[64:67], a[200:203], v[200:203]
    buffer_load_dwordx4 v1, s[12:15], s57 offen lds
    s_add_u32 m0, s53, 20480
    s_add_u32 s57, s36, 3833856
    v_mfma_f32_16x16x32_bf16 v[204:207], v[64:67], v[112:115], v[204:207]
    v_exp_f32 v164, v164
    s_waitcnt lgkmcnt(4)
    v_mfma_f32_16x16x32_bf16 v[208:211], v[48:51], a[56:59], v[208:211]
    ds_read_b64_tr_b16 v[60:61], v8 offset:0
    v_mfma_f32_16x16x32_bf16 v[212:215], v[48:51], a[128:131], v[212:215]
    ds_read_b64_tr_b16 v[62:63], v8 offset:512
    buffer_load_dwordx4 v1, s[12:15], s57 offen lds
    s_add_u32 m0, s53, 24576
    v_mfma_f32_16x16x32_bf16 v[216:219], v[48:51], a[200:203], v[216:219]
    s_add_u32 s57, s36, 3538944
    v_exp_f32 v165, v165
    v_mfma_f32_16x16x32_bf16 v[220:223], v[48:51], v[112:115], v[220:223]
    v_exp_f32 v166, v166
    s_waitcnt lgkmcnt(4)
    v_mfma_f32_16x16x32_bf16 v[192:195], v[52:55], a[60:63], v[192:195]
    ds_read_b64_tr_b16 v[64:65], v8 offset:8192
    buffer_load_dwordx4 v1, s[16:19], s57 offen lds
    s_add_u32 m0, s53, 28672
    v_mfma_f32_16x16x32_bf16 v[196:199], v[52:55], a[132:135], v[196:199]
    ds_read_b64_tr_b16 v[66:67], v8 offset:8704
    s_add_u32 s57, s36, 3833856
    v_mfma_f32_16x16x32_bf16 v[200:203], v[52:55], a[204:207], v[200:203]
    v_exp_f32 v167, v167
    v_mfma_f32_16x16x32_bf16 v[204:207], v[52:55], v[116:119], v[204:207]
    buffer_load_dwordx4 v1, s[16:19], s57 offen lds
    v_add_f32 v132, 1.0, v132
    s_waitcnt lgkmcnt(4)
    v_mfma_f32_16x16x32_bf16 v[208:211], v[56:59], a[60:63], v[208:211]
    ds_read_b64_tr_b16 v[48:49], v8 offset:4096
    v_add_f32 v133, 1.0, v133
    v_mfma_f32_16x16x32_bf16 v[212:215], v[56:59], a[132:135], v[212:215]
    ds_read_b64_tr_b16 v[50:51], v8 offset:4608
    v_add_f32 v134, 1.0, v134
    v_mfma_f32_16x16x32_bf16 v[216:219], v[56:59], a[204:207], v[216:219]
    v_add_f32 v135, 1.0, v135
    v_add_f32 v164, 1.0, v164
    v_mfma_f32_16x16x32_bf16 v[220:223], v[56:59], v[116:119], v[220:223]
    v_add_f32 v165, 1.0, v165
    v_add_f32 v166, 1.0, v166
    s_waitcnt lgkmcnt(4)
    v_mfma_f32_16x16x32_bf16 v[192:195], v[60:63], a[64:67], v[192:195]
    ds_read_b64_tr_b16 v[52:53], v8 offset:12288
    v_add_f32 v167, 1.0, v167
    v_mfma_f32_16x16x32_bf16 v[196:199], v[60:63], a[136:139], v[196:199]
    ds_read_b64_tr_b16 v[54:55], v8 offset:12800
    v_mfma_f32_16x16x32_bf16 v[200:203], v[60:63], a[208:211], v[200:203]
    v_rcp_f32 v132, v132
    v_mfma_f32_16x16x32_bf16 v[204:207], v[60:63], v[120:123], v[204:207]
    v_rcp_f32 v133, v133
    s_waitcnt lgkmcnt(4)
    v_mfma_f32_16x16x32_bf16 v[208:211], v[64:67], a[64:67], v[208:211]
    s_waitcnt vmcnt(21)
    s_barrier
    ds_read_b64_tr_b16 v[56:57], v4 offset:16384
    v_mfma_f32_16x16x32_bf16 v[212:215], v[64:67], a[136:139], v[212:215]
    ds_read_b64_tr_b16 v[58:59], v4 offset:16896
    s_add_u32 m0, s53, 32768
    s_add_u32 s57, s36, 4128768
    v_mfma_f32_16x16x32_bf16 v[216:219], v[64:67], a[208:211], v[216:219]
    buffer_load_dwordx4 v1, s[12:15], s57 offen lds
    s_add_u32 m0, s53, 36864
    s_add_u32 s57, s36, 4423680
    v_mfma_f32_16x16x32_bf16 v[220:223], v[64:67], v[120:123], v[220:223]
    v_rcp_f32 v134, v134
    s_waitcnt lgkmcnt(4)
    v_mfma_f32_16x16x32_bf16 v[192:195], v[48:51], a[68:71], v[192:195]
    ds_read_b64_tr_b16 v[60:61], v4 offset:24576
    v_mfma_f32_16x16x32_bf16 v[196:199], v[48:51], a[140:143], v[196:199]
    ds_read_b64_tr_b16 v[62:63], v4 offset:25088
    buffer_load_dwordx4 v1, s[12:15], s57 offen lds
    s_add_u32 m0, s53, 40960
    v_mfma_f32_16x16x32_bf16 v[200:203], v[48:51], a[212:215], v[200:203]
    s_add_u32 s57, s36, 4128768
    v_rcp_f32 v135, v135
    v_mfma_f32_16x16x32_bf16 v[204:207], v[48:51], v[124:127], v[204:207]
    v_rcp_f32 v164, v164
    s_waitcnt lgkmcnt(4)
    v_mfma_f32_16x16x32_bf16 v[208:211], v[52:55], a[68:71], v[208:211]
    ds_read_b64_tr_b16 v[64:65], v6 offset:16384
    buffer_load_dwordx4 v1, s[16:19], s57 offen lds
    s_add_u32 m0, s53, 45056
    v_mfma_f32_16x16x32_bf16 v[212:215], v[52:55], a[140:143], v[212:215]
    ds_read_b64_tr_b16 v[66:67], v6 offset:16896
    s_add_u32 s57, s36, 4423680
    v_mfma_f32_16x16x32_bf16 v[216:219], v[52:55], a[212:215], v[216:219]
    v_rcp_f32 v165, v165
    v_mfma_f32_16x16x32_bf16 v[220:223], v[52:55], v[124:127], v[220:223]
    buffer_load_dwordx4 v1, s[16:19], s57 offen lds
    s_add_u32 m0, s53, 49152
    v_rcp_f32 v166, v166
    v_rcp_f32 v167, v167
    v_mul_f32 v148, v132, v148
    v_mul_f32 v149, v133, v149
    v_mul_f32 v150, v134, v150
    v_mul_f32 v151, v135, v151
    v_mul_f32 v180, v164, v180
    v_mul_f32 v181, v165, v181
    v_mul_f32 v182, v166, v182
    v_mul_f32 v183, v167, v183
    v_cvt_pk_bf16_f32 v132, v148, v149
    v_cvt_pk_bf16_f32 v133, v150, v151
    v_cvt_pk_bf16_f32 v134, v180, v181
    v_cvt_pk_bf16_f32 v135, v182, v183
    s_add_u32 s59, s46, 147456
    buffer_store_dwordx4 v[132:135], v0, s[20:23], s59 offen sc1
    v_mul_f32 v136, s56, v136
    v_mul_f32 v137, s56, v137
    v_mul_f32 v138, s56, v138
    v_mul_f32 v139, s56, v139
    v_mul_f32 v168, s56, v168
    v_mul_f32 v169, s56, v169
    v_mul_f32 v170, s56, v170
    v_mul_f32 v171, s56, v171
    v_exp_f32 v136, v136
    v_exp_f32 v137, v137
    v_exp_f32 v138, v138
    v_exp_f32 v139, v139
    v_exp_f32 v168, v168
    v_exp_f32 v169, v169
    v_exp_f32 v170, v170
    v_exp_f32 v171, v171
    v_add_f32 v136, 1.0, v136
    v_add_f32 v137, 1.0, v137
    v_add_f32 v138, 1.0, v138
    v_add_f32 v139, 1.0, v139
    v_add_f32 v168, 1.0, v168
    v_add_f32 v169, 1.0, v169
    v_add_f32 v170, 1.0, v170
    v_add_f32 v171, 1.0, v171
    v_rcp_f32 v136, v136
    v_rcp_f32 v137, v137
    v_rcp_f32 v138, v138
    v_rcp_f32 v139, v139
    v_rcp_f32 v168, v168
    v_rcp_f32 v169, v169
    v_rcp_f32 v170, v170
    v_rcp_f32 v171, v171
    v_mul_f32 v152, v136, v152
    v_mul_f32 v153, v137, v153
    v_mul_f32 v154, v138, v154
    v_mul_f32 v155, v139, v155
    v_mul_f32 v184, v168, v184
    v_mul_f32 v185, v169, v185
    v_mul_f32 v186, v170, v186
    v_mul_f32 v187, v171, v187
    v_cvt_pk_bf16_f32 v136, v152, v153
    v_cvt_pk_bf16_f32 v137, v154, v155
    v_cvt_pk_bf16_f32 v138, v184, v185
    v_cvt_pk_bf16_f32 v139, v186, v187
    s_add_u32 s59, s46, 294912
    buffer_store_dwordx4 v[136:139], v0, s[20:23], s59 offen sc1
    v_mul_f32 v140, s56, v140
    v_mul_f32 v141, s56, v141
    v_mul_f32 v142, s56, v142
    v_mul_f32 v143, s56, v143
    v_mul_f32 v172, s56, v172
    v_mul_f32 v173, s56, v173
    v_mul_f32 v174, s56, v174
    v_mul_f32 v175, s56, v175
    v_exp_f32 v140, v140
    v_exp_f32 v141, v141
    v_exp_f32 v142, v142
    v_exp_f32 v143, v143
    v_exp_f32 v172, v172
    v_exp_f32 v173, v173
    v_exp_f32 v174, v174
    v_exp_f32 v175, v175
    v_add_f32 v140, 1.0, v140
    v_add_f32 v141, 1.0, v141
    v_add_f32 v142, 1.0, v142
    v_add_f32 v143, 1.0, v143
    v_add_f32 v172, 1.0, v172
    v_add_f32 v173, 1.0, v173
    v_add_f32 v174, 1.0, v174
    v_add_f32 v175, 1.0, v175
    v_rcp_f32 v140, v140
    v_rcp_f32 v141, v141
    v_rcp_f32 v142, v142
    v_rcp_f32 v143, v143
    v_rcp_f32 v172, v172
    v_rcp_f32 v173, v173
    v_rcp_f32 v174, v174
    v_rcp_f32 v175, v175
    v_mul_f32 v156, v140, v156
    v_mul_f32 v157, v141, v157
    v_mul_f32 v158, v142, v158
    v_mul_f32 v159, v143, v159
    v_mul_f32 v188, v172, v188
    v_mul_f32 v189, v173, v189
    v_mul_f32 v190, v174, v190
    v_mul_f32 v191, v175, v191
    v_cvt_pk_bf16_f32 v140, v156, v157
    v_cvt_pk_bf16_f32 v141, v158, v159
    v_cvt_pk_bf16_f32 v142, v188, v189
    v_cvt_pk_bf16_f32 v143, v190, v191
    s_add_u32 s59, s46, 442368
    buffer_store_dwordx4 v[140:143], v0, s[20:23], s59 offen sc1
    s_waitcnt lgkmcnt(4)
    v_mfma_f32_16x16x32_bf16 v[128:131], v[56:59], a[0:3], 0
    ds_read_b64_tr_b16 v[48:49], v6 offset:24576
    s_add_u32 s57, s36, 4718592
    v_mfma_f32_16x16x32_bf16 v[132:135], v[56:59], a[72:75], 0
    ds_read_b64_tr_b16 v[50:51], v6 offset:25088
    v_mfma_f32_16x16x32_bf16 v[136:139], v[56:59], a[144:147], 0
    buffer_load_dwordx4 v1, s[12:15], s57 offen lds
    s_add_u32 m0, s53, 53248
    s_add_u32 s57, s36, 5013504
    v_mfma_f32_16x16x32_bf16 v[140:143], v[56:59], a[216:219], 0
    s_waitcnt lgkmcnt(4)
    v_mfma_f32_16x16x32_bf16 v[144:147], v[60:63], a[0:3], 0
    ds_read_b64_tr_b16 v[52:53], v4 offset:20480
    v_mfma_f32_16x16x32_bf16 v[148:151], v[60:63], a[72:75], 0
    ds_read_b64_tr_b16 v[54:55], v4 offset:20992
    buffer_load_dwordx4 v1, s[12:15], s57 offen lds
    s_add_u32 m0, s53, 57344
    v_mfma_f32_16x16x32_bf16 v[152:155], v[60:63], a[144:147], 0
    s_add_u32 s57, s36, 4718592
    v_mfma_f32_16x16x32_bf16 v[156:159], v[60:63], a[216:219], 0
    s_waitcnt lgkmcnt(4)
    v_mfma_f32_16x16x32_bf16 v[160:163], v[64:67], a[0:3], 0
    ds_read_b64_tr_b16 v[56:57], v4 offset:28672
    buffer_load_dwordx4 v1, s[16:19], s57 offen lds
    s_add_u32 m0, s53, 61440
    v_mfma_f32_16x16x32_bf16 v[164:167], v[64:67], a[72:75], 0
    ds_read_b64_tr_b16 v[58:59], v4 offset:29184
    s_add_u32 s57, s36, 5013504
    v_mul_f32 v192, s56, v192
    v_mfma_f32_16x16x32_bf16 v[168:171], v[64:67], a[144:147], 0
    v_mul_f32 v193, s56, v193
    v_mul_f32 v194, s56, v194
    v_mfma_f32_16x16x32_bf16 v[172:175], v[64:67], a[216:219], 0
    buffer_load_dwordx4 v1, s[16:19], s57 offen lds
    v_mul_f32 v195, s56, v195
    s_waitcnt lgkmcnt(4)
    v_mfma_f32_16x16x32_bf16 v[176:179], v[48:51], a[0:3], 0
    ds_read_b64_tr_b16 v[60:61], v6 offset:20480
    v_mfma_f32_16x16x32_bf16 v[180:183], v[48:51], a[72:75], 0
    ds_read_b64_tr_b16 v[62:63], v6 offset:20992
    v_mfma_f32_16x16x32_bf16 v[184:187], v[48:51], a[144:147], 0
    v_exp_f32 v192, v192
    v_mfma_f32_16x16x32_bf16 v[188:191], v[48:51], a[216:219], 0
    v_exp_f32 v193, v193
    s_waitcnt lgkmcnt(4)
    v_mfma_f32_16x16x32_bf16 v[128:131], v[52:55], a[4:7], v[128:131]
    ds_read_b64_tr_b16 v[64:65], v6 offset:28672
    v_mfma_f32_16x16x32_bf16 v[132:135], v[52:55], a[76:79], v[132:135]
    ds_read_b64_tr_b16 v[66:67], v6 offset:29184
    v_mfma_f32_16x16x32_bf16 v[136:139], v[52:55], a[148:151], v[136:139]
    v_exp_f32 v194, v194
    v_mfma_f32_16x16x32_bf16 v[140:143], v[52:55], a[220:223], v[140:143]
    v_exp_f32 v195, v195
    s_waitcnt lgkmcnt(4)
    v_mfma_f32_16x16x32_bf16 v[144:147], v[56:59], a[4:7], v[144:147]
    ds_read_b64_tr_b16 v[48:49], v4 offset:32768
    v_add_f32 v192, 1.0, v192
    v_mfma_f32_16x16x32_bf16 v[148:151], v[56:59], a[76:79], v[148:151]
    ds_read_b64_tr_b16 v[50:51], v4 offset:33280
    v_add_f32 v193, 1.0, v193
    v_mfma_f32_16x16x32_bf16 v[152:155], v[56:59], a[148:151], v[152:155]
    v_add_f32 v194, 1.0, v194
    v_add_f32 v195, 1.0, v195
    v_mfma_f32_16x16x32_bf16 v[156:159], v[56:59], a[220:223], v[156:159]
    v_rcp_f32 v192, v192
    s_waitcnt lgkmcnt(4)
    v_mfma_f32_16x16x32_bf16 v[160:163], v[60:63], a[4:7], v[160:163]
    ds_read_b64_tr_b16 v[52:53], v4 offset:40960
    v_mfma_f32_16x16x32_bf16 v[164:167], v[60:63], a[76:79], v[164:167]
    ds_read_b64_tr_b16 v[54:55], v4 offset:41472
    v_mfma_f32_16x16x32_bf16 v[168:171], v[60:63], a[148:151], v[168:171]
    v_rcp_f32 v193, v193
    v_mfma_f32_16x16x32_bf16 v[172:175], v[60:63], a[220:223], v[172:175]
    v_rcp_f32 v194, v194
    s_waitcnt lgkmcnt(4)
    v_mfma_f32_16x16x32_bf16 v[176:179], v[64:67], a[4:7], v[176:179]
    ds_read_b64_tr_b16 v[56:57], v6 offset:32768
    v_mfma_f32_16x16x32_bf16 v[180:183], v[64:67], a[76:79], v[180:183]
    ds_read_b64_tr_b16 v[58:59], v6 offset:33280
    v_mfma_f32_16x16x32_bf16 v[184:187], v[64:67], a[148:151], v[184:187]
    v_rcp_f32 v195, v195
    v_mfma_f32_16x16x32_bf16 v[188:191], v[64:67], a[220:223], v[188:191]
    v_mul_f32 v208, v192, v208
    v_mul_f32 v209, v193, v209
    s_waitcnt lgkmcnt(4)
    v_mfma_f32_16x16x32_bf16 v[128:131], v[48:51], a[8:11], v[128:131]
    ds_read_b64_tr_b16 v[60:61], v6 offset:40960
    v_mul_f32 v210, v194, v210
    v_mfma_f32_16x16x32_bf16 v[132:135], v[48:51], a[80:83], v[132:135]
    ds_read_b64_tr_b16 v[62:63], v6 offset:41472
    v_mul_f32 v211, v195, v211
    v_mfma_f32_16x16x32_bf16 v[136:139], v[48:51], a[152:155], v[136:139]
    v_cvt_pk_bf16_f32 v192, v208, v209
    v_cvt_pk_bf16_f32 v193, v210, v211
    s_add_u32 s59, s47, 0
    v_mfma_f32_16x16x32_bf16 v[140:143], v[48:51], a[224:227], v[140:143]
    buffer_store_dwordx2 v[192:193], v2, s[20:23], s59 offen sc1
    v_mul_f32 v196, s56, v196
    s_waitcnt lgkmcnt(4)
    v_mfma_f32_16x16x32_bf16 v[144:147], v[52:55], a[8:11], v[144:147]
    ds_read_b64_tr_b16 v[64:65], v4 offset:36864
    v_mul_f32 v197, s56, v197
    v_mfma_f32_16x16x32_bf16 v[148:151], v[52:55], a[80:83], v[148:151]
    ds_read_b64_tr_b16 v[66:67], v4 offset:37376
    v_mul_f32 v198, s56, v198
    v_mfma_f32_16x16x32_bf16 v[152:155], v[52:55], a[152:155], v[152:155]
    v_mul_f32 v199, s56, v199
    v_mfma_f32_16x16x32_bf16 v[156:159], v[52:55], a[224:227], v[156:159]
    v_exp_f32 v196, v196
    s_waitcnt lgkmcnt(4)
    v_mfma_f32_16x16x32_bf16 v[160:163], v[56:59], a[8:11], v[160:163]
    ds_read_b64_tr_b16 v[48:49], v4 offset:45056
    v_mfma_f32_16x16x32_bf16 v[164:167], v[56:59], a[80:83], v[164:167]
    ds_read_b64_tr_b16 v[50:51], v4 offset:45568
    v_mfma_f32_16x16x32_bf16 v[168:171], v[56:59], a[152:155], v[168:171]
    v_exp_f32 v197, v197
    v_mfma_f32_16x16x32_bf16 v[172:175], v[56:59], a[224:227], v[172:175]
    v_exp_f32 v198, v198
    s_waitcnt lgkmcnt(4)
    v_mfma_f32_16x16x32_bf16 v[176:179], v[60:63], a[8:11], v[176:179]
    ds_read_b64_tr_b16 v[52:53], v6 offset:36864
    v_mfma_f32_16x16x32_bf16 v[180:183], v[60:63], a[80:83], v[180:183]
    ds_read_b64_tr_b16 v[54:55], v6 offset:37376
    v_mfma_f32_16x16x32_bf16 v[184:187], v[60:63], a[152:155], v[184:187]
    v_exp_f32 v199, v199
    v_mfma_f32_16x16x32_bf16 v[188:191], v[60:63], a[224:227], v[188:191]
    v_add_f32 v196, 1.0, v196
    v_add_f32 v197, 1.0, v197
    s_waitcnt lgkmcnt(4)
    v_mfma_f32_16x16x32_bf16 v[128:131], v[64:67], a[12:15], v[128:131]
    ds_read_b64_tr_b16 v[56:57], v6 offset:45056
    v_add_f32 v198, 1.0, v198
    v_mfma_f32_16x16x32_bf16 v[132:135], v[64:67], a[84:87], v[132:135]
    ds_read_b64_tr_b16 v[58:59], v6 offset:45568
    v_add_f32 v199, 1.0, v199
    v_mfma_f32_16x16x32_bf16 v[136:139], v[64:67], a[156:159], v[136:139]
    v_rcp_f32 v196, v196
    v_mfma_f32_16x16x32_bf16 v[140:143], v[64:67], a[228:231], v[140:143]
    v_rcp_f32 v197, v197
    s_waitcnt lgkmcnt(4)
    v_mfma_f32_16x16x32_bf16 v[144:147], v[48:51], a[12:15], v[144:147]
    s_waitcnt vmcnt(25)
    s_barrier
    ds_read_b64_tr_b16 v[60:61], v4 offset:49152
    v_mfma_f32_16x16x32_bf16 v[148:151], v[48:51], a[84:87], v[148:151]
    ds_read_b64_tr_b16 v[62:63], v4 offset:49664
    v_cvt_pk_bf16_f32 v84, v28, v29
    v_mfma_f32_16x16x32_bf16 v[152:155], v[48:51], a[156:159], v[152:155]
    v_cvt_pk_bf16_f32 v85, v30, v31
    v_cvt_pk_bf16_f32 v86, v32, v33
    v_mfma_f32_16x16x32_bf16 v[156:159], v[48:51], a[228:231], v[156:159]
    v_cvt_pk_bf16_f32 v87, v34, v35
    ds_write_b128 v95, v[84:87] offset:0
    s_waitcnt lgkmcnt(5)
    v_mfma_f32_16x16x32_bf16 v[160:163], v[52:55], a[12:15], v[160:163]
    ds_read_b64_tr_b16 v[64:65], v4 offset:57344
    v_fma_f32 v20, v36, v28, -v20
    v_mfma_f32_16x16x32_bf16 v[164:167], v[52:55], a[84:87], v[164:167]
    ds_read_b64_tr_b16 v[66:67], v4 offset:57856
    v_fma_f32 v21, v36, v29, -v21
    v_mfma_f32_16x16x32_bf16 v[168:171], v[52:55], a[156:159], v[168:171]
    v_fma_f32 v22, v36, v30, -v22
    v_fma_f32 v23, v36, v31, -v23
    v_mfma_f32_16x16x32_bf16 v[172:175], v[52:55], a[228:231], v[172:175]
    v_fma_f32 v24, v36, v32, -v24
    v_fma_f32 v25, v36, v33, -v25
    s_waitcnt lgkmcnt(5)
    v_mfma_f32_16x16x32_bf16 v[176:179], v[56:59], a[12:15], v[176:179]
    ds_read_b64_tr_b16 v[48:49], v6 offset:49152
    v_fma_f32 v26, v36, v34, -v26
    v_mfma_f32_16x16x32_bf16 v[180:183], v[56:59], a[84:87], v[180:183]
    ds_read_b64_tr_b16 v[50:51], v6 offset:49664
    v_fma_f32 v27, v36, v35, -v27
    v_mfma_f32_16x16x32_bf16 v[184:187], v[56:59], a[156:159], v[184:187]
    v_cvt_pk_bf16_f32 v88, v20, v21
    v_cvt_pk_bf16_f32 v89, v22, v23
    v_mfma_f32_16x16x32_bf16 v[188:191], v[56:59], a[228:231], v[188:191]
    v_cvt_pk_bf16_f32 v90, v24, v25
    v_cvt_pk_bf16_f32 v91, v26, v27
    s_waitcnt lgkmcnt(5)
    v_mfma_f32_16x16x32_bf16 v[128:131], v[60:63], a[16:19], v[128:131]
    ds_read_b64_tr_b16 v[52:53], v6 offset:57344
    ds_write_b128 v95, v[88:91] offset:1024
    v_mfma_f32_16x16x32_bf16 v[132:135], v[60:63], a[88:91], v[132:135]
    ds_read_b64_tr_b16 v[54:55], v6 offset:57856
    v_fma_f32 v28, v36, v20, -v28
    v_mfma_f32_16x16x32_bf16 v[136:139], v[60:63], a[160:163], v[136:139]
    v_fma_f32 v29, v36, v21, -v29
    v_fma_f32 v30, v36, v22, -v30
    v_mfma_f32_16x16x32_bf16 v[140:143], v[60:63], a[232:235], v[140:143]
    v_fma_f32 v31, v36, v23, -v31
    v_fma_f32 v32, v36, v24, -v32
    s_waitcnt lgkmcnt(5)
    v_mfma_f32_16x16x32_bf16 v[144:147], v[64:67], a[16:19], v[144:147]
    ds_read_b64_tr_b16 v[56:57], v4 offset:53248
    v_fma_f32 v33, v36, v25, -v33
    v_mfma_f32_16x16x32_bf16 v[148:151], v[64:67], a[88:91], v[148:151]
    ds_read_b64_tr_b16 v[58:59], v4 offset:53760
    v_fma_f32 v34, v36, v26, -v34
    v_mfma_f32_16x16x32_bf16 v[152:155], v[64:67], a[160:163], v[152:155]
    v_fma_f32 v35, v36, v27, -v35
    v_cvt_pk_bf16_f32 v84, v28, v29
    v_mfma_f32_16x16x32_bf16 v[156:159], v[64:67], a[232:235], v[156:159]
    v_cvt_pk_bf16_f32 v85, v30, v31
    v_cvt_pk_bf16_f32 v86, v32, v33
    s_waitcnt lgkmcnt(5)
    v_mfma_f32_16x16x32_bf16 v[160:163], v[48:51], a[16:19], v[160:163]
    ds_read_b64_tr_b16 v[60:61], v4 offset:61440
    v_cvt_pk_bf16_f32 v87, v34, v35
    v_mfma_f32_16x16x32_bf16 v[164:167], v[48:51], a[88:91], v[164:167]
    ds_read_b64_tr_b16 v[62:63], v4 offset:61952
    ds_write_b128 v95, v[84:87] offset:16384
    v_mfma_f32_16x16x32_bf16 v[168:171], v[48:51], a[160:163], v[168:171]
    v_fma_f32 v20, v36, v28, -v20
    v_fma_f32 v21, v36, v29, -v21
    v_mfma_f32_16x16x32_bf16 v[172:175], v[48:51], a[232:235], v[172:175]
    v_fma_f32 v22, v36, v30, -v22
    v_fma_f32 v23, v36, v31, -v23
    s_waitcnt lgkmcnt(5)
    v_mfma_f32_16x16x32_bf16 v[176:179], v[52:55], a[16:19], v[176:179]
    ds_read_b64_tr_b16 v[64:65], v6 offset:53248
    v_fma_f32 v24, v36, v32, -v24
    v_mfma_f32_16x16x32_bf16 v[180:183], v[52:55], a[88:91], v[180:183]
    ds_read_b64_tr_b16 v[66:67], v6 offset:53760
    v_fma_f32 v25, v36, v33, -v25
    v_mfma_f32_16x16x32_bf16 v[184:187], v[52:55], a[160:163], v[184:187]
    v_fma_f32 v26, v36, v34, -v26
    v_fma_f32 v27, v36, v35, -v27
    v_mfma_f32_16x16x32_bf16 v[188:191], v[52:55], a[232:235], v[188:191]
    v_cvt_pk_bf16_f32 v88, v20, v21
    v_cvt_pk_bf16_f32 v89, v22, v23
    s_waitcnt lgkmcnt(5)
    v_mfma_f32_16x16x32_bf16 v[128:131], v[56:59], a[20:23], v[128:131]
    ds_read_b64_tr_b16 v[48:49], v6 offset:61440
    v_cvt_pk_bf16_f32 v90, v24, v25
    v_mfma_f32_16x16x32_bf16 v[132:135], v[56:59], a[92:95], v[132:135]
    ds_read_b64_tr_b16 v[50:51], v6 offset:61952
    v_cvt_pk_bf16_f32 v91, v26, v27
    v_mfma_f32_16x16x32_bf16 v[136:139], v[56:59], a[164:167], v[136:139]
    ds_write_b128 v95, v[88:91] offset:17408
    v_fma_f32 v28, v36, v20, -v28
    v_mfma_f32_16x16x32_bf16 v[140:143], v[56:59], a[236:239], v[140:143]
    v_fma_f32 v29, v36, v21, -v29
    v_fma_f32 v30, v36, v22, -v30
    s_waitcnt lgkmcnt(6)
    v_mfma_f32_16x16x32_bf16 v[144:147], v[60:63], a[20:23], v[144:147]
    ds_read_b64_tr_b16 v[52:53], v38 offset:0
    v_fma_f32 v31, v36, v23, -v31
    v_mfma_f32_16x16x32_bf16 v[148:151], v[60:63], a[92:95], v[148:151]
    ds_read_b64_tr_b16 v[54:55], v38 offset:512
    v_fma_f32 v32, v36, v24, -v32
    v_mfma_f32_16x16x32_bf16 v[152:155], v[60:63], a[164:167], v[152:155]
    v_fma_f32 v33, v36, v25, -v33
    v_fma_f32 v34, v36, v26, -v34
    v_mfma_f32_16x16x32_bf16 v[156:159], v[60:63], a[236:239], v[156:159]
    v_fma_f32 v35, v36, v27, -v35
    s_waitcnt lgkmcnt(5)
    v_mfma_f32_16x16x32_bf16 v[160:163], v[64:67], a[20:23], v[160:163]
    ds_read_b64_tr_b16 v[56:57], v38 offset:8192
    v_mfma_f32_16x16x32_bf16 v[164:167], v[64:67], a[92:95], v[164:167]
    ds_read_b64_tr_b16 v[58:59], v38 offset:8704
    v_mfma_f32_16x16x32_bf16 v[168:171], v[64:67], a[164:167], v[168:171]
    v_rcp_f32 v198, v198
    v_mfma_f32_16x16x32_bf16 v[172:175], v[64:67], a[236:239], v[172:175]
    v_rcp_f32 v199, v199
    s_waitcnt lgkmcnt(5)
    v_mfma_f32_16x16x32_bf16 v[176:179], v[48:51], a[20:23], v[176:179]
    ds_read_b64_tr_b16 v[60:61], v39 offset:0
    v_mul_f32 v212, v196, v212
    v_mfma_f32_16x16x32_bf16 v[180:183], v[48:51], a[92:95], v[180:183]
    ds_read_b64_tr_b16 v[62:63], v39 offset:512
    v_mul_f32 v213, v197, v213
    v_mfma_f32_16x16x32_bf16 v[184:187], v[48:51], a[164:167], v[184:187]
    v_mul_f32 v214, v198, v214
    v_mul_f32 v215, v199, v215
    v_mfma_f32_16x16x32_bf16 v[188:191], v[48:51], a[236:239], v[188:191]
    v_cvt_pk_bf16_f32 v196, v212, v213
    v_cvt_pk_bf16_f32 v197, v214, v215
    s_waitcnt lgkmcnt(4)
    v_mfma_f32_16x16x32_bf16 v[128:131], v[52:55], a[24:27], v[128:131]
    ds_read_b64_tr_b16 v[64:65], v39 offset:8192
    s_add_u32 s59, s47, 147456
    buffer_store_dwordx2 v[196:197], v2, s[20:23], s59 offen sc1
    v_mfma_f32_16x16x32_bf16 v[132:135], v[52:55], a[96:99], v[132:135]
    ds_read_b64_tr_b16 v[66:67], v39 offset:8704
    v_mul_f32 v200, s56, v200
    v_mfma_f32_16x16x32_bf16 v[136:139], v[52:55], a[168:171], v[136:139]
    v_mul_f32 v201, s56, v201
    v_mul_f32 v202, s56, v202
    v_mfma_f32_16x16x32_bf16 v[140:143], v[52:55], a[240:243], v[140:143]
    v_mul_f32 v203, s56, v203
    s_waitcnt lgkmcnt(4)
    v_mfma_f32_16x16x32_bf16 v[144:147], v[56:59], a[24:27], v[144:147]
    ds_read_b64_tr_b16 v[48:49], v38 offset:4096
    v_mfma_f32_16x16x32_bf16 v[148:151], v[56:59], a[96:99], v[148:151]
    ds_read_b64_tr_b16 v[50:51], v38 offset:4608
    v_mfma_f32_16x16x32_bf16 v[152:155], v[56:59], a[168:171], v[152:155]
    v_exp_f32 v200, v200
    v_mfma_f32_16x16x32_bf16 v[156:159], v[56:59], a[240:243], v[156:159]
    v_exp_f32 v201, v201
    s_waitcnt lgkmcnt(4)
    v_mfma_f32_16x16x32_bf16 v[160:163], v[60:63], a[24:27], v[160:163]
    ds_read_b64_tr_b16 v[52:53], v38 offset:12288
    v_mfma_f32_16x16x32_bf16 v[164:167], v[60:63], a[96:99], v[164:167]
    ds_read_b64_tr_b16 v[54:55], v38 offset:12800
    v_mfma_f32_16x16x32_bf16 v[168:171], v[60:63], a[168:171], v[168:171]
    v_exp_f32 v202, v202
    v_mfma_f32_16x16x32_bf16 v[172:175], v[60:63], a[240:243], v[172:175]
    v_exp_f32 v203, v203
    s_waitcnt lgkmcnt(4)
    v_mfma_f32_16x16x32_bf16 v[176:179], v[64:67], a[24:27], v[176:179]
    ds_read_b64_tr_b16 v[56:57], v39 offset:4096
    v_add_f32 v200, 1.0, v200
    v_mfma_f32_16x16x32_bf16 v[180:183], v[64:67], a[96:99], v[180:183]
    ds_read_b64_tr_b16 v[58:59], v39 offset:4608
    v_add_f32 v201, 1.0, v201
    v_mfma_f32_16x16x32_bf16 v[184:187], v[64:67], a[168:171], v[184:187]
    v_add_f32 v202, 1.0, v202
    v_add_f32 v203, 1.0, v203
    v_mfma_f32_16x16x32_bf16 v[188:191], v[64:67], a[240:243], v[188:191]
    v_rcp_f32 v200, v200
    s_waitcnt lgkmcnt(4)
    v_mfma_f32_16x16x32_bf16 v[128:131], v[48:51], a[28:31], v[128:131]
    ds_read_b64_tr_b16 v[60:61], v39 offset:12288
    v_mfma_f32_16x16x32_bf16 v[132:135], v[48:51], a[100:103], v[132:135]
    ds_read_b64_tr_b16 v[62:63], v39 offset:12800
    v_mfma_f32_16x16x32_bf16 v[136:139], v[48:51], a[172:175], v[136:139]
    v_rcp_f32 v201, v201
    v_mfma_f32_16x16x32_bf16 v[140:143], v[48:51], a[244:247], v[140:143]
    v_rcp_f32 v202, v202
    s_waitcnt lgkmcnt(4)
    v_mfma_f32_16x16x32_bf16 v[144:147], v[52:55], a[28:31], v[144:147]
    s_waitcnt vmcnt(17)
    s_barrier
    ds_read_b64_tr_b16 v[64:65], v38 offset:16384
    v_mfma_f32_16x16x32_bf16 v[148:151], v[52:55], a[100:103], v[148:151]
    ds_read_b64_tr_b16 v[66:67], v38 offset:16896
    v_cvt_pk_bf16_f32 v84, v28, v29
    v_mfma_f32_16x16x32_bf16 v[152:155], v[52:55], a[172:175], v[152:155]
    v_cvt_pk_bf16_f32 v85, v30, v31
    v_cvt_pk_bf16_f32 v86, v32, v33
    v_mfma_f32_16x16x32_bf16 v[156:159], v[52:55], a[244:247], v[156:159]
    v_cvt_pk_bf16_f32 v87, v34, v35
    ds_write_b128 v95, v[84:87] offset:32768
    s_waitcnt lgkmcnt(5)
    v_mfma_f32_16x16x32_bf16 v[160:163], v[56:59], a[28:31], v[160:163]
    ds_read_b64_tr_b16 v[48:49], v38 offset:24576
    v_fma_f32 v20, v36, v28, -v20
    v_mfma_f32_16x16x32_bf16 v[164:167], v[56:59], a[100:103], v[164:167]
    ds_read_b64_tr_b16 v[50:51], v38 offset:25088
    v_fma_f32 v21, v36, v29, -v21
    v_mfma_f32_16x16x32_bf16 v[168:171], v[56:59], a[172:175], v[168:171]
    v_fma_f32 v22, v36, v30, -v22
    v_fma_f32 v23, v36, v31, -v23
    v_mfma_f32_16x16x32_bf16 v[172:175], v[56:59], a[244:247], v[172:175]
    v_fma_f32 v24, v36, v32, -v24
    v_fma_f32 v25, v36, v33, -v25
    s_waitcnt lgkmcnt(5)
    v_mfma_f32_16x16x32_bf16 v[176:179], v[60:63], a[28:31], v[176:179]
    ds_read_b64_tr_b16 v[52:53], v39 offset:16384
    v_fma_f32 v26, v36, v34, -v26
    v_mfma_f32_16x16x32_bf16 v[180:183], v[60:63], a[100:103], v[180:183]
    ds_read_b64_tr_b16 v[54:55], v39 offset:16896
    v_fma_f32 v27, v36, v35, -v27
    v_mfma_f32_16x16x32_bf16 v[184:187], v[60:63], a[172:175], v[184:187]
    v_cvt_pk_bf16_f32 v88, v20, v21
    v_cvt_pk_bf16_f32 v89, v22, v23
    v_mfma_f32_16x16x32_bf16 v[188:191], v[60:63], a[244:247], v[188:191]
    v_cvt_pk_bf16_f32 v90, v24, v25
    v_cvt_pk_bf16_f32 v91, v26, v27
    s_waitcnt lgkmcnt(5)
    v_mfma_f32_16x16x32_bf16 v[128:131], v[64:67], a[32:35], v[128:131]
    ds_read_b64_tr_b16 v[56:57], v39 offset:24576
    ds_write_b128 v95, v[88:91] offset:33792
    v_mfma_f32_16x16x32_bf16 v[132:135], v[64:67], a[104:107], v[132:135]
    ds_read_b64_tr_b16 v[58:59], v39 offset:25088
    v_fma_f32 v28, v36, v20, -v28
    v_mfma_f32_16x16x32_bf16 v[136:139], v[64:67], a[176:179], v[136:139]
    v_fma_f32 v29, v36, v21, -v29
    v_fma_f32 v30, v36, v22, -v30
    v_mfma_f32_16x16x32_bf16 v[140:143], v[64:67], a[248:251], v[140:143]
    v_fma_f32 v31, v36, v23, -v31
    v_fma_f32 v32, v36, v24, -v32
    s_waitcnt lgkmcnt(5)
    v_mfma_f32_16x16x32_bf16 v[144:147], v[48:51], a[32:35], v[144:147]
    ds_read_b64_tr_b16 v[60:61], v38 offset:20480
    v_fma_f32 v33, v36, v25, -v33
    v_mfma_f32_16x16x32_bf16 v[148:151], v[48:51], a[104:107], v[148:151]
    ds_read_b64_tr_b16 v[62:63], v38 offset:20992
    v_fma_f32 v34, v36, v26, -v34
    v_mfma_f32_16x16x32_bf16 v[152:155], v[48:51], a[176:179], v[152:155]
    v_fma_f32 v35, v36, v27, -v35
    v_cvt_pk_bf16_f32 v84, v28, v29
    v_mfma_f32_16x16x32_bf16 v[156:159], v[48:51], a[248:251], v[156:159]
    v_cvt_pk_bf16_f32 v85, v30, v31
    v_cvt_pk_bf16_f32 v86, v32, v33
    s_waitcnt lgkmcnt(5)
    v_mfma_f32_16x16x32_bf16 v[160:163], v[52:55], a[32:35], v[160:163]
    ds_read_b64_tr_b16 v[64:65], v38 offset:28672
    v_cvt_pk_bf16_f32 v87, v34, v35
    v_mfma_f32_16x16x32_bf16 v[164:167], v[52:55], a[104:107], v[164:167]
    ds_read_b64_tr_b16 v[66:67], v38 offset:29184
    ds_write_b128 v95, v[84:87] offset:49152
    v_mfma_f32_16x16x32_bf16 v[168:171], v[52:55], a[176:179], v[168:171]
    v_fma_f32 v20, v36, v28, -v20
    v_fma_f32 v21, v36, v29, -v21
    v_mfma_f32_16x16x32_bf16 v[172:175], v[52:55], a[248:251], v[172:175]
    v_fma_f32 v22, v36, v30, -v22
    v_fma_f32 v23, v36, v31, -v23
    s_waitcnt lgkmcnt(5)
    v_mfma_f32_16x16x32_bf16 v[176:179], v[56:59], a[32:35], v[176:179]
    ds_read_b64_tr_b16 v[48:49], v39 offset:20480
    v_fma_f32 v24, v36, v32, -v24
    v_mfma_f32_16x16x32_bf16 v[180:183], v[56:59], a[104:107], v[180:183]
    ds_read_b64_tr_b16 v[50:51], v39 offset:20992
    v_fma_f32 v25, v36, v33, -v25
    v_mfma_f32_16x16x32_bf16 v[184:187], v[56:59], a[176:179], v[184:187]
    v_fma_f32 v26, v36, v34, -v26
    v_fma_f32 v27, v36, v35, -v27
    v_mfma_f32_16x16x32_bf16 v[188:191], v[56:59], a[248:251], v[188:191]
    v_cvt_pk_bf16_f32 v88, v20, v21
    v_cvt_pk_bf16_f32 v89, v22, v23
    s_waitcnt lgkmcnt(5)
    v_mfma_f32_16x16x32_bf16 v[128:131], v[60:63], a[36:39], v[128:131]
    ds_read_b64_tr_b16 v[52:53], v39 offset:28672
    v_cvt_pk_bf16_f32 v90, v24, v25
    v_mfma_f32_16x16x32_bf16 v[132:135], v[60:63], a[108:111], v[132:135]
    ds_read_b64_tr_b16 v[54:55], v39 offset:29184
    v_cvt_pk_bf16_f32 v91, v26, v27
    v_mfma_f32_16x16x32_bf16 v[136:139], v[60:63], a[180:183], v[136:139]
    ds_write_b128 v95, v[88:91] offset:50176
    v_fma_f32 v28, v36, v20, -v28
    v_mfma_f32_16x16x32_bf16 v[140:143], v[60:63], a[252:255], v[140:143]
    v_fma_f32 v29, v36, v21, -v29
    v_fma_f32 v30, v36, v22, -v30
    s_waitcnt lgkmcnt(6)
    v_mfma_f32_16x16x32_bf16 v[144:147], v[64:67], a[36:39], v[144:147]
    ds_read_b64_tr_b16 v[56:57], v3 offset:0
    v_fma_f32 v31, v36, v23, -v31
    v_mfma_f32_16x16x32_bf16 v[148:151], v[64:67], a[108:111], v[148:151]
    ds_read_b64_tr_b16 v[58:59], v3 offset:512
    v_fma_f32 v32, v36, v24, -v32
    v_mfma_f32_16x16x32_bf16 v[152:155], v[64:67], a[180:183], v[152:155]
    v_fma_f32 v33, v36, v25, -v33
    v_fma_f32 v34, v36, v26, -v34
    v_mfma_f32_16x16x32_bf16 v[156:159], v[64:67], a[252:255], v[156:159]
    v_fma_f32 v35, v36, v27, -v35
    s_waitcnt lgkmcnt(5)
    v_mfma_f32_16x16x32_bf16 v[160:163], v[48:51], a[36:39], v[160:163]
    ds_read_b64_tr_b16 v[60:61], v3 offset:8192
    v_mfma_f32_16x16x32_bf16 v[164:167], v[48:51], a[108:111], v[164:167]
    ds_read_b64_tr_b16 v[62:63], v3 offset:8704
    v_mfma_f32_16x16x32_bf16 v[168:171], v[48:51], a[180:183], v[168:171]
    v_rcp_f32 v203, v203
    v_mfma_f32_16x16x32_bf16 v[172:175], v[48:51], a[252:255], v[172:175]
    v_mul_f32 v216, v200, v216
    v_mul_f32 v217, v201, v217
    s_waitcnt lgkmcnt(5)
    v_mfma_f32_16x16x32_bf16 v[176:179], v[52:55], a[36:39], v[176:179]
    ds_read_b64_tr_b16 v[64:65], v5 offset:0
    v_mul_f32 v218, v202, v218
    v_mfma_f32_16x16x32_bf16 v[180:183], v[52:55], a[108:111], v[180:183]
    ds_read_b64_tr_b16 v[66:67], v5 offset:512
    v_mul_f32 v219, v203, v219
    v_mfma_f32_16x16x32_bf16 v[184:187], v[52:55], a[180:183], v[184:187]
    v_cvt_pk_bf16_f32 v200, v216, v217
    v_cvt_pk_bf16_f32 v201, v218, v219
    s_add_u32 s59, s47, 294912
    v_mfma_f32_16x16x32_bf16 v[188:191], v[52:55], a[252:255], v[188:191]
    buffer_store_dwordx2 v[200:201], v2, s[20:23], s59 offen sc1
    v_mul_f32 v204, s56, v204
    s_waitcnt lgkmcnt(4)
    v_mfma_f32_16x16x32_bf16 v[128:131], v[56:59], a[40:43], v[128:131]
    ds_read_b64_tr_b16 v[48:49], v5 offset:8192
    v_mul_f32 v205, s56, v205
    v_mfma_f32_16x16x32_bf16 v[132:135], v[56:59], a[112:115], v[132:135]
    ds_read_b64_tr_b16 v[50:51], v5 offset:8704
    v_mul_f32 v206, s56, v206
    v_mfma_f32_16x16x32_bf16 v[136:139], v[56:59], a[184:187], v[136:139]
    v_mul_f32 v207, s56, v207
    v_mfma_f32_16x16x32_bf16 v[140:143], v[56:59], v[96:99], v[140:143]
    v_exp_f32 v204, v204
    s_waitcnt lgkmcnt(4)
    v_mfma_f32_16x16x32_bf16 v[144:147], v[60:63], a[40:43], v[144:147]
    ds_read_b64_tr_b16 v[52:53], v3 offset:4096
    v_mfma_f32_16x16x32_bf16 v[148:151], v[60:63], a[112:115], v[148:151]
    ds_read_b64_tr_b16 v[54:55], v3 offset:4608
    v_mfma_f32_16x16x32_bf16 v[152:155], v[60:63], a[184:187], v[152:155]
    v_exp_f32 v205, v205
    v_mfma_f32_16x16x32_bf16 v[156:159], v[60:63], v[96:99], v[156:159]
    v_exp_f32 v206, v206
    s_waitcnt lgkmcnt(4)
    v_mfma_f32_16x16x32_bf16 v[160:163], v[64:67], a[40:43], v[160:163]
    ds_read_b64_tr_b16 v[56:57], v3 offset:12288
    v_mfma_f32_16x16x32_bf16 v[164:167], v[64:67], a[112:115], v[164:167]
    ds_read_b64_tr_b16 v[58:59], v3 offset:12800
    v_mfma_f32_16x16x32_bf16 v[168:171], v[64:67], a[184:187], v[168:171]
    v_exp_f32 v207, v207
    v_mfma_f32_16x16x32_bf16 v[172:175], v[64:67], v[96:99], v[172:175]
    v_add_f32 v204, 1.0, v204
    v_add_f32 v205, 1.0, v205
    s_waitcnt lgkmcnt(4)
    v_mfma_f32_16x16x32_bf16 v[176:179], v[48:51], a[40:43], v[176:179]
    ds_read_b64_tr_b16 v[60:61], v5 offset:4096
    v_add_f32 v206, 1.0, v206
    v_mfma_f32_16x16x32_bf16 v[180:183], v[48:51], a[112:115], v[180:183]
    ds_read_b64_tr_b16 v[62:63], v5 offset:4608
    v_add_f32 v207, 1.0, v207
    v_mfma_f32_16x16x32_bf16 v[184:187], v[48:51], a[184:187], v[184:187]
    v_rcp_f32 v204, v204
    v_mfma_f32_16x16x32_bf16 v[188:191], v[48:51], v[96:99], v[188:191]
    v_rcp_f32 v205, v205
    s_waitcnt lgkmcnt(4)
    v_mfma_f32_16x16x32_bf16 v[128:131], v[52:55], a[44:47], v[128:131]
    ds_read_b64_tr_b16 v[64:65], v5 offset:12288
    v_mfma_f32_16x16x32_bf16 v[132:135], v[52:55], a[116:119], v[132:135]
    ds_read_b64_tr_b16 v[66:67], v5 offset:12800
    v_mfma_f32_16x16x32_bf16 v[136:139], v[52:55], a[188:191], v[136:139]
    v_rcp_f32 v206, v206
    v_mfma_f32_16x16x32_bf16 v[140:143], v[52:55], v[100:103], v[140:143]
    v_rcp_f32 v207, v207
    s_waitcnt lgkmcnt(4)
    v_mfma_f32_16x16x32_bf16 v[144:147], v[56:59], a[44:47], v[144:147]
    s_waitcnt vmcnt(10)
    s_barrier
    ds_read_b64_tr_b16 v[48:49], v3 offset:16384
    v_mfma_f32_16x16x32_bf16 v[148:151], v[56:59], a[116:119], v[148:151]
    ds_read_b64_tr_b16 v[50:51], v3 offset:16896
    v_cvt_pk_bf16_f32 v84, v28, v29
    v_mfma_f32_16x16x32_bf16 v[152:155], v[56:59], a[188:191], v[152:155]
    v_cvt_pk_bf16_f32 v85, v30, v31
    v_cvt_pk_bf16_f32 v86, v32, v33
    v_mfma_f32_16x16x32_bf16 v[156:159], v[56:59], v[100:103], v[156:159]
    v_cvt_pk_bf16_f32 v87, v34, v35
    ds_write_b128 v42, v[84:87] offset:0
    s_waitcnt lgkmcnt(5)
    v_mfma_f32_16x16x32_bf16 v[160:163], v[60:63], a[44:47], v[160:163]
    ds_read_b64_tr_b16 v[52:53], v3 offset:24576
    v_fma_f32 v20, v36, v28, -v20
    v_mfma_f32_16x16x32_bf16 v[164:167], v[60:63], a[116:119], v[164:167]
    ds_read_b64_tr_b16 v[54:55], v3 offset:25088
    v_fma_f32 v21, v36, v29, -v21
    v_mfma_f32_16x16x32_bf16 v[168:171], v[60:63], a[188:191], v[168:171]
    v_fma_f32 v22, v36, v30, -v22
    v_fma_f32 v23, v36, v31, -v23
    v_mfma_f32_16x16x32_bf16 v[172:175], v[60:63], v[100:103], v[172:175]
    v_fma_f32 v24, v36, v32, -v24
    v_fma_f32 v25, v36, v33, -v25
    s_waitcnt lgkmcnt(5)
    v_mfma_f32_16x16x32_bf16 v[176:179], v[64:67], a[44:47], v[176:179]
    ds_read_b64_tr_b16 v[56:57], v5 offset:16384
    v_fma_f32 v26, v36, v34, -v26
    v_mfma_f32_16x16x32_bf16 v[180:183], v[64:67], a[116:119], v[180:183]
    ds_read_b64_tr_b16 v[58:59], v5 offset:16896
    v_fma_f32 v27, v36, v35, -v27
    v_mfma_f32_16x16x32_bf16 v[184:187], v[64:67], a[188:191], v[184:187]
    v_cvt_pk_bf16_f32 v88, v20, v21
    v_cvt_pk_bf16_f32 v89, v22, v23
    v_mfma_f32_16x16x32_bf16 v[188:191], v[64:67], v[100:103], v[188:191]
    v_cvt_pk_bf16_f32 v90, v24, v25
    v_cvt_pk_bf16_f32 v91, v26, v27
    s_waitcnt lgkmcnt(5)
    v_mfma_f32_16x16x32_bf16 v[128:131], v[48:51], a[48:51], v[128:131]
    ds_read_b64_tr_b16 v[60:61], v5 offset:24576
    ds_write_b128 v42, v[88:91] offset:1024
    v_mfma_f32_16x16x32_bf16 v[132:135], v[48:51], a[120:123], v[132:135]
    ds_read_b64_tr_b16 v[62:63], v5 offset:25088
    v_fma_f32 v28, v36, v20, -v28
    v_mfma_f32_16x16x32_bf16 v[136:139], v[48:51], a[192:195], v[136:139]
    v_fma_f32 v29, v36, v21, -v29
    v_fma_f32 v30, v36, v22, -v30
    v_mfma_f32_16x16x32_bf16 v[140:143], v[48:51], v[104:107], v[140:143]
    v_fma_f32 v31, v36, v23, -v31
    v_fma_f32 v32, v36, v24, -v32
    s_waitcnt lgkmcnt(5)
    v_mfma_f32_16x16x32_bf16 v[144:147], v[52:55], a[48:51], v[144:147]
    ds_read_b64_tr_b16 v[64:65], v3 offset:20480
    v_fma_f32 v33, v36, v25, -v33
    v_mfma_f32_16x16x32_bf16 v[148:151], v[52:55], a[120:123], v[148:151]
    ds_read_b64_tr_b16 v[66:67], v3 offset:20992
    v_fma_f32 v34, v36, v26, -v34
    v_mfma_f32_16x16x32_bf16 v[152:155], v[52:55], a[192:195], v[152:155]
    v_fma_f32 v35, v36, v27, -v35
    v_cvt_pk_bf16_f32 v84, v28, v29
    v_mfma_f32_16x16x32_bf16 v[156:159], v[52:55], v[104:107], v[156:159]
    v_cvt_pk_bf16_f32 v85, v30, v31
    v_cvt_pk_bf16_f32 v86, v32, v33
    s_waitcnt lgkmcnt(5)
    v_mfma_f32_16x16x32_bf16 v[160:163], v[56:59], a[48:51], v[160:163]
    ds_read_b64_tr_b16 v[48:49], v3 offset:28672
    v_cvt_pk_bf16_f32 v87, v34, v35
    v_mfma_f32_16x16x32_bf16 v[164:167], v[56:59], a[120:123], v[164:167]
    ds_read_b64_tr_b16 v[50:51], v3 offset:29184
    ds_write_b128 v42, v[84:87] offset:16384
    v_mfma_f32_16x16x32_bf16 v[168:171], v[56:59], a[192:195], v[168:171]
    v_fma_f32 v20, v36, v28, -v20
    v_fma_f32 v21, v36, v29, -v21
    v_mfma_f32_16x16x32_bf16 v[172:175], v[56:59], v[104:107], v[172:175]
    v_fma_f32 v22, v36, v30, -v22
    v_fma_f32 v23, v36, v31, -v23
    s_waitcnt lgkmcnt(5)
    v_mfma_f32_16x16x32_bf16 v[176:179], v[60:63], a[48:51], v[176:179]
    ds_read_b64_tr_b16 v[52:53], v5 offset:20480
    v_fma_f32 v24, v36, v32, -v24
    v_mfma_f32_16x16x32_bf16 v[180:183], v[60:63], a[120:123], v[180:183]
    ds_read_b64_tr_b16 v[54:55], v5 offset:20992
    v_fma_f32 v25, v36, v33, -v25
    v_mfma_f32_16x16x32_bf16 v[184:187], v[60:63], a[192:195], v[184:187]
    v_fma_f32 v26, v36, v34, -v26
    v_fma_f32 v27, v36, v35, -v27
    v_mfma_f32_16x16x32_bf16 v[188:191], v[60:63], v[104:107], v[188:191]
    v_cvt_pk_bf16_f32 v88, v20, v21
    v_cvt_pk_bf16_f32 v89, v22, v23
    s_waitcnt lgkmcnt(5)
    v_mfma_f32_16x16x32_bf16 v[128:131], v[64:67], a[52:55], v[128:131]
    ds_read_b64_tr_b16 v[56:57], v5 offset:28672
    v_cvt_pk_bf16_f32 v90, v24, v25
    v_mfma_f32_16x16x32_bf16 v[132:135], v[64:67], a[124:127], v[132:135]
    ds_read_b64_tr_b16 v[58:59], v5 offset:29184
    v_cvt_pk_bf16_f32 v91, v26, v27
    v_mfma_f32_16x16x32_bf16 v[136:139], v[64:67], a[196:199], v[136:139]
    ds_write_b128 v42, v[88:91] offset:17408
    v_fma_f32 v28, v36, v20, -v28
    v_mfma_f32_16x16x32_bf16 v[140:143], v[64:67], v[108:111], v[140:143]
    v_fma_f32 v29, v36, v21, -v29
    v_fma_f32 v30, v36, v22, -v30
    s_waitcnt lgkmcnt(6)
    v_mfma_f32_16x16x32_bf16 v[144:147], v[48:51], a[52:55], v[144:147]
    ds_read_b64_tr_b16 v[60:61], v3 offset:32768
    v_fma_f32 v31, v36, v23, -v31
    v_mfma_f32_16x16x32_bf16 v[148:151], v[48:51], a[124:127], v[148:151]
    ds_read_b64_tr_b16 v[62:63], v3 offset:33280
    v_fma_f32 v32, v36, v24, -v32
    v_mfma_f32_16x16x32_bf16 v[152:155], v[48:51], a[196:199], v[152:155]
    v_fma_f32 v33, v36, v25, -v33
    v_fma_f32 v34, v36, v26, -v34
    v_mfma_f32_16x16x32_bf16 v[156:159], v[48:51], v[108:111], v[156:159]
    v_fma_f32 v35, v36, v27, -v35
    v_mul_f32 v220, v204, v220
    s_waitcnt lgkmcnt(5)
    v_mfma_f32_16x16x32_bf16 v[160:163], v[52:55], a[52:55], v[160:163]
    ds_read_b64_tr_b16 v[64:65], v3 offset:40960
    v_mul_f32 v221, v205, v221
    v_mfma_f32_16x16x32_bf16 v[164:167], v[52:55], a[124:127], v[164:167]
    ds_read_b64_tr_b16 v[66:67], v3 offset:41472
    v_mul_f32 v222, v206, v222
    v_mfma_f32_16x16x32_bf16 v[168:171], v[52:55], a[196:199], v[168:171]
    v_mul_f32 v223, v207, v223
    v_cvt_pk_bf16_f32 v204, v220, v221
    v_mfma_f32_16x16x32_bf16 v[172:175], v[52:55], v[108:111], v[172:175]
    v_cvt_pk_bf16_f32 v205, v222, v223
    s_add_u32 s59, s47, 442368
    s_waitcnt lgkmcnt(5)
    v_mfma_f32_16x16x32_bf16 v[176:179], v[56:59], a[52:55], v[176:179]
    ds_read_b64_tr_b16 v[48:49], v5 offset:32768
    buffer_store_dwordx2 v[204:205], v2, s[20:23], s59 offen sc1
    v_mfma_f32_16x16x32_bf16 v[180:183], v[56:59], a[124:127], v[180:183]
    ds_read_b64_tr_b16 v[50:51], v5 offset:33280
    v_mfma_f32_16x16x32_bf16 v[184:187], v[56:59], a[196:199], v[184:187]
    v_mfma_f32_16x16x32_bf16 v[188:191], v[56:59], v[108:111], v[188:191]
    s_waitcnt lgkmcnt(4)
    v_mfma_f32_16x16x32_bf16 v[128:131], v[60:63], a[56:59], v[128:131]
    ds_read_b64_tr_b16 v[52:53], v5 offset:40960
    v_mfma_f32_16x16x32_bf16 v[132:135], v[60:63], a[128:131], v[132:135]
    ds_read_b64_tr_b16 v[54:55], v5 offset:41472
    v_mfma_f32_16x16x32_bf16 v[136:139], v[60:63], a[200:203], v[136:139]
    v_mfma_f32_16x16x32_bf16 v[140:143], v[60:63], v[112:115], v[140:143]
    s_waitcnt lgkmcnt(4)
    v_mfma_f32_16x16x32_bf16 v[144:147], v[64:67], a[56:59], v[144:147]
    ds_read_b64_tr_b16 v[56:57], v3 offset:36864
    v_mfma_f32_16x16x32_bf16 v[148:151], v[64:67], a[128:131], v[148:151]
    ds_read_b64_tr_b16 v[58:59], v3 offset:37376
    v_mfma_f32_16x16x32_bf16 v[152:155], v[64:67], a[200:203], v[152:155]
    v_mfma_f32_16x16x32_bf16 v[156:159], v[64:67], v[112:115], v[156:159]
    s_waitcnt lgkmcnt(4)
    v_mfma_f32_16x16x32_bf16 v[160:163], v[48:51], a[56:59], v[160:163]
    ds_read_b64_tr_b16 v[60:61], v3 offset:45056
    v_mfma_f32_16x16x32_bf16 v[164:167], v[48:51], a[128:131], v[164:167]
    ds_read_b64_tr_b16 v[62:63], v3 offset:45568
    v_mfma_f32_16x16x32_bf16 v[168:171], v[48:51], a[200:203], v[168:171]
    v_mfma_f32_16x16x32_bf16 v[172:175], v[48:51], v[112:115], v[172:175]
    s_waitcnt lgkmcnt(4)
    v_mfma_f32_16x16x32_bf16 v[176:179], v[52:55], a[56:59], v[176:179]
    ds_read_b64_tr_b16 v[64:65], v5 offset:36864
    v_mfma_f32_16x16x32_bf16 v[180:183], v[52:55], a[128:131], v[180:183]
    ds_read_b64_tr_b16 v[66:67], v5 offset:37376
    v_mfma_f32_16x16x32_bf16 v[184:187], v[52:55], a[200:203], v[184:187]
    v_mfma_f32_16x16x32_bf16 v[188:191], v[52:55], v[112:115], v[188:191]
    s_waitcnt lgkmcnt(4)
    v_mfma_f32_16x16x32_bf16 v[128:131], v[56:59], a[60:63], v[128:131]
    ds_read_b64_tr_b16 v[48:49], v5 offset:45056
    v_mfma_f32_16x16x32_bf16 v[132:135], v[56:59], a[132:135], v[132:135]
    ds_read_b64_tr_b16 v[50:51], v5 offset:45568
    v_mfma_f32_16x16x32_bf16 v[136:139], v[56:59], a[204:207], v[136:139]
    v_mfma_f32_16x16x32_bf16 v[140:143], v[56:59], v[116:119], v[140:143]
    s_waitcnt lgkmcnt(4)
    v_mfma_f32_16x16x32_bf16 v[144:147], v[60:63], a[60:63], v[144:147]
    s_waitcnt vmcnt(4)
    s_barrier
    ds_read_b64_tr_b16 v[52:53], v3 offset:49152
    v_mfma_f32_16x16x32_bf16 v[148:151], v[60:63], a[132:135], v[148:151]
    ds_read_b64_tr_b16 v[54:55], v3 offset:49664
    v_cvt_pk_bf16_f32 v84, v28, v29
    v_mfma_f32_16x16x32_bf16 v[152:155], v[60:63], a[204:207], v[152:155]
    v_cvt_pk_bf16_f32 v85, v30, v31
    v_cvt_pk_bf16_f32 v86, v32, v33
    v_mfma_f32_16x16x32_bf16 v[156:159], v[60:63], v[116:119], v[156:159]
    v_cvt_pk_bf16_f32 v87, v34, v35
    ds_write_b128 v94, v[84:87] offset:0
    s_waitcnt lgkmcnt(5)
    v_mfma_f32_16x16x32_bf16 v[160:163], v[64:67], a[60:63], v[160:163]
    ds_read_b64_tr_b16 v[56:57], v3 offset:57344
    v_fma_f32 v20, v36, v28, -v20
    v_mfma_f32_16x16x32_bf16 v[164:167], v[64:67], a[132:135], v[164:167]
    ds_read_b64_tr_b16 v[58:59], v3 offset:57856
    v_fma_f32 v21, v36, v29, -v21
    v_mfma_f32_16x16x32_bf16 v[168:171], v[64:67], a[204:207], v[168:171]
    v_fma_f32 v22, v36, v30, -v22
    v_fma_f32 v23, v36, v31, -v23
    v_mfma_f32_16x16x32_bf16 v[172:175], v[64:67], v[116:119], v[172:175]
    v_fma_f32 v24, v36, v32, -v24
    v_fma_f32 v25, v36, v33, -v25
    s_waitcnt lgkmcnt(5)
    v_mfma_f32_16x16x32_bf16 v[176:179], v[48:51], a[60:63], v[176:179]
    ds_read_b64_tr_b16 v[60:61], v5 offset:49152
    v_fma_f32 v26, v36, v34, -v26
    v_mfma_f32_16x16x32_bf16 v[180:183], v[48:51], a[132:135], v[180:183]
    ds_read_b64_tr_b16 v[62:63], v5 offset:49664
    v_fma_f32 v27, v36, v35, -v27
    v_mfma_f32_16x16x32_bf16 v[184:187], v[48:51], a[204:207], v[184:187]
    v_cvt_pk_bf16_f32 v88, v20, v21
    v_cvt_pk_bf16_f32 v89, v22, v23
    v_mfma_f32_16x16x32_bf16 v[188:191], v[48:51], v[116:119], v[188:191]
    v_cvt_pk_bf16_f32 v90, v24, v25
    v_cvt_pk_bf16_f32 v91, v26, v27
    s_waitcnt lgkmcnt(5)
    v_mfma_f32_16x16x32_bf16 v[128:131], v[52:55], a[64:67], v[128:131]
    ds_read_b64_tr_b16 v[64:65], v5 offset:57344
    ds_write_b128 v94, v[88:91] offset:1024
    v_mfma_f32_16x16x32_bf16 v[132:135], v[52:55], a[136:139], v[132:135]
    ds_read_b64_tr_b16 v[66:67], v5 offset:57856
    v_fma_f32 v28, v36, v20, -v28
    v_mfma_f32_16x16x32_bf16 v[136:139], v[52:55], a[208:211], v[136:139]
    v_fma_f32 v29, v36, v21, -v29
    v_fma_f32 v30, v36, v22, -v30
    v_mfma_f32_16x16x32_bf16 v[140:143], v[52:55], v[120:123], v[140:143]
    v_fma_f32 v31, v36, v23, -v31
    v_fma_f32 v32, v36, v24, -v32
    s_waitcnt lgkmcnt(5)
    v_mfma_f32_16x16x32_bf16 v[144:147], v[56:59], a[64:67], v[144:147]
    ds_read_b64_tr_b16 v[48:49], v3 offset:53248
    v_fma_f32 v33, v36, v25, -v33
    v_mfma_f32_16x16x32_bf16 v[148:151], v[56:59], a[136:139], v[148:151]
    ds_read_b64_tr_b16 v[50:51], v3 offset:53760
    v_fma_f32 v34, v36, v26, -v34
    v_mfma_f32_16x16x32_bf16 v[152:155], v[56:59], a[208:211], v[152:155]
    v_fma_f32 v35, v36, v27, -v35
    v_cvt_pk_bf16_f32 v84, v28, v29
    v_mfma_f32_16x16x32_bf16 v[156:159], v[56:59], v[120:123], v[156:159]
    v_cvt_pk_bf16_f32 v85, v30, v31
    v_cvt_pk_bf16_f32 v86, v32, v33
    s_waitcnt lgkmcnt(5)
    v_mfma_f32_16x16x32_bf16 v[160:163], v[60:63], a[64:67], v[160:163]
    ds_read_b64_tr_b16 v[52:53], v3 offset:61440
    v_cvt_pk_bf16_f32 v87, v34, v35
    v_mfma_f32_16x16x32_bf16 v[164:167], v[60:63], a[136:139], v[164:167]
    ds_read_b64_tr_b16 v[54:55], v3 offset:61952
    ds_write_b128 v94, v[84:87] offset:16384
    v_mfma_f32_16x16x32_bf16 v[168:171], v[60:63], a[208:211], v[168:171]
    v_fma_f32 v20, v36, v28, -v20
    v_fma_f32 v21, v36, v29, -v21
    v_mfma_f32_16x16x32_bf16 v[172:175], v[60:63], v[120:123], v[172:175]
    v_fma_f32 v22, v36, v30, -v22
    v_fma_f32 v23, v36, v31, -v23
    s_waitcnt lgkmcnt(5)
    v_mfma_f32_16x16x32_bf16 v[176:179], v[64:67], a[64:67], v[176:179]
    ds_read_b64_tr_b16 v[56:57], v5 offset:53248
    v_fma_f32 v24, v36, v32, -v24
    v_mfma_f32_16x16x32_bf16 v[180:183], v[64:67], a[136:139], v[180:183]
    ds_read_b64_tr_b16 v[58:59], v5 offset:53760
    v_fma_f32 v25, v36, v33, -v25
    v_mfma_f32_16x16x32_bf16 v[184:187], v[64:67], a[208:211], v[184:187]
    v_fma_f32 v26, v36, v34, -v26
    v_fma_f32 v27, v36, v35, -v27
    v_mfma_f32_16x16x32_bf16 v[188:191], v[64:67], v[120:123], v[188:191]
    v_cvt_pk_bf16_f32 v88, v20, v21
    v_cvt_pk_bf16_f32 v89, v22, v23
    s_waitcnt lgkmcnt(5)
    v_mfma_f32_16x16x32_bf16 v[128:131], v[48:51], a[68:71], v[128:131]
    ds_read_b64_tr_b16 v[60:61], v5 offset:61440
    v_cvt_pk_bf16_f32 v90, v24, v25
    v_mfma_f32_16x16x32_bf16 v[132:135], v[48:51], a[140:143], v[132:135]
    ds_read_b64_tr_b16 v[62:63], v5 offset:61952
    v_cvt_pk_bf16_f32 v91, v26, v27
    v_mfma_f32_16x16x32_bf16 v[136:139], v[48:51], a[212:215], v[136:139]
    ds_write_b128 v94, v[88:91] offset:17408
    v_fma_f32 v28, v36, v20, -v28
    v_mfma_f32_16x16x32_bf16 v[140:143], v[48:51], v[124:127], v[140:143]
    v_fma_f32 v29, v36, v21, -v29
    v_fma_f32 v30, v36, v22, -v30
    s_waitcnt lgkmcnt(6)
    v_mfma_f32_16x16x32_bf16 v[144:147], v[52:55], a[68:71], v[144:147]
    s_cmp_lt_u32 s83, 9
    s_cbranch_scc0 l1_kernel_tail
    s_lshl_b32 s43, s29, 12
    v_add_u32 v7, s43, v0
    v_add_u32 v8, 0x10000, v7
    v_add_u32 v40, 0x20000, v7
    s_barrier
    v_mfma_f32_16x16x32_bf16 v[148:151], v[52:55], a[140:143], v[148:151]
    ds_read_b128 v[64:67], v8 offset:0
    v_fma_f32 v31, v36, v23, -v31
    v_mfma_f32_16x16x32_bf16 v[152:155], v[52:55], a[212:215], v[152:155]
    v_fma_f32 v32, v36, v24, -v32
    v_fma_f32 v33, v36, v25, -v33
    v_mfma_f32_16x16x32_bf16 v[156:159], v[52:55], v[124:127], v[156:159]
    v_fma_f32 v34, v36, v26, -v34
    v_fma_f32 v35, v36, v27, -v35
    s_waitcnt lgkmcnt(4)
    v_mfma_f32_16x16x32_bf16 v[160:163], v[56:59], a[68:71], v[160:163]
    ds_read_b128 v[48:51], v8 offset:2048
    v_cvt_pk_bf16_f32 v84, v28, v29
    v_mfma_f32_16x16x32_bf16 v[164:167], v[56:59], a[140:143], v[164:167]
    v_cvt_pk_bf16_f32 v85, v30, v31
    v_cvt_pk_bf16_f32 v86, v32, v33
    v_mfma_f32_16x16x32_bf16 v[168:171], v[56:59], a[212:215], v[168:171]
    v_cvt_pk_bf16_f32 v87, v34, v35
    ds_write_b128 v94, v[84:87] offset:32768
    v_mfma_f32_16x16x32_bf16 v[172:175], v[56:59], v[124:127], v[172:175]
    v_fma_f32 v20, v36, v28, -v20
    v_fma_f32 v21, v36, v29, -v21
    s_waitcnt lgkmcnt(4)
    v_mfma_f32_16x16x32_bf16 v[176:179], v[60:63], a[68:71], v[176:179]
    ds_read_b128 v[52:55], v8 offset:1024
    v_fma_f32 v22, v36, v30, -v22
    v_mfma_f32_16x16x32_bf16 v[180:183], v[60:63], a[140:143], v[180:183]
    v_fma_f32 v23, v36, v31, -v23
    v_fma_f32 v24, v36, v32, -v24
    v_mfma_f32_16x16x32_bf16 v[184:187], v[60:63], a[212:215], v[184:187]
    v_fma_f32 v25, v36, v33, -v25
    v_fma_f32 v26, v36, v34, -v26
    v_mfma_f32_16x16x32_bf16 v[188:191], v[60:63], v[124:127], v[188:191]
    v_fma_f32 v27, v36, v35, -v27
    v_cvt_pk_bf16_f32 v88, v20, v21
    s_waitcnt lgkmcnt(3)
    v_mfma_f32_16x16x32_bf16 v[192:195], a[0:3], v[64:67], 0
    ds_read_b128 v[56:59], v8 offset:3072
    v_cvt_pk_bf16_f32 v89, v22, v23
    v_mfma_f32_16x16x32_bf16 v[196:199], a[72:75], v[64:67], 0
    v_cvt_pk_bf16_f32 v90, v24, v25
    v_cvt_pk_bf16_f32 v91, v26, v27
    v_mfma_f32_16x16x32_bf16 v[200:203], a[144:147], v[64:67], 0
    ds_write_b128 v94, v[88:91] offset:33792
    v_fma_f32 v28, v36, v20, -v28
    v_mfma_f32_16x16x32_bf16 v[204:207], a[216:219], v[64:67], 0
    v_fma_f32 v29, v36, v21, -v29
    v_fma_f32 v30, v36, v22, -v30
    s_waitcnt lgkmcnt(4)
    v_mfma_f32_16x16x32_bf16 v[208:211], a[0:3], v[48:51], 0
    s_barrier
    ds_read_b128 v[60:63], v8 offset:16384
    v_mfma_f32_16x16x32_bf16 v[212:215], a[72:75], v[48:51], 0
    v_fma_f32 v31, v36, v23, -v31
    v_fma_f32 v32, v36, v24, -v32
    v_mfma_f32_16x16x32_bf16 v[216:219], a[144:147], v[48:51], 0
    v_fma_f32 v33, v36, v25, -v33
    v_fma_f32 v34, v36, v26, -v34
    v_mfma_f32_16x16x32_bf16 v[220:223], a[216:219], v[48:51], 0
    v_fma_f32 v35, v36, v27, -v35
    s_waitcnt lgkmcnt(3)
    v_mfma_f32_16x16x32_bf16 v[192:195], a[4:7], v[52:55], v[192:195]
    ds_read_b128 v[64:67], v8 offset:18432
    v_mfma_f32_16x16x32_bf16 v[196:199], a[76:79], v[52:55], v[196:199]
    v_mul_f32 v128, s56, v128
    v_mul_f32 v129, s56, v129
    v_mfma_f32_16x16x32_bf16 v[200:203], a[148:151], v[52:55], v[200:203]
    v_mul_f32 v130, s56, v130
    v_mul_f32 v131, s56, v131
    v_mfma_f32_16x16x32_bf16 v[204:207], a[220:223], v[52:55], v[204:207]
    v_mul_f32 v160, s56, v160
    v_mul_f32 v161, s56, v161
    s_waitcnt lgkmcnt(3)
    v_mfma_f32_16x16x32_bf16 v[208:211], a[4:7], v[56:59], v[208:211]
    ds_read_b128 v[48:51], v8 offset:17408
    v_mul_f32 v162, s56, v162
    v_mfma_f32_16x16x32_bf16 v[212:215], a[76:79], v[56:59], v[212:215]
    v_mul_f32 v163, s56, v163
    v_mfma_f32_16x16x32_bf16 v[216:219], a[148:151], v[56:59], v[216:219]
    v_exp_f32 v128, v128
    v_mfma_f32_16x16x32_bf16 v[220:223], a[220:223], v[56:59], v[220:223]
    v_exp_f32 v129, v129
    s_waitcnt lgkmcnt(2)
    v_mfma_f32_16x16x32_bf16 v[192:195], a[8:11], v[60:63], v[192:195]
    ds_read_b128 v[52:55], v8 offset:19456
    v_mfma_f32_16x16x32_bf16 v[196:199], a[80:83], v[60:63], v[196:199]
    v_exp_f32 v130, v130
    v_mfma_f32_16x16x32_bf16 v[200:203], a[152:155], v[60:63], v[200:203]
    v_exp_f32 v131, v131
    v_mfma_f32_16x16x32_bf16 v[204:207], a[224:227], v[60:63], v[204:207]
    v_exp_f32 v160, v160
    s_waitcnt lgkmcnt(2)
    v_mfma_f32_16x16x32_bf16 v[208:211], a[8:11], v[64:67], v[208:211]
    ds_read_b128 v[56:59], v8 offset:32768
    v_mfma_f32_16x16x32_bf16 v[212:215], a[80:83], v[64:67], v[212:215]
    v_exp_f32 v161, v161
    v_mfma_f32_16x16x32_bf16 v[216:219], a[152:155], v[64:67], v[216:219]
    v_exp_f32 v162, v162
    v_mfma_f32_16x16x32_bf16 v[220:223], a[224:227], v[64:67], v[220:223]
    v_exp_f32 v163, v163
    s_waitcnt lgkmcnt(2)
    v_mfma_f32_16x16x32_bf16 v[192:195], a[12:15], v[48:51], v[192:195]
    ds_read_b128 v[60:63], v8 offset:34816
    v_add_f32 v128, 1.0, v128
    v_mfma_f32_16x16x32_bf16 v[196:199], a[84:87], v[48:51], v[196:199]
    v_add_f32 v129, 1.0, v129
    v_add_f32 v130, 1.0, v130
    v_mfma_f32_16x16x32_bf16 v[200:203], a[156:159], v[48:51], v[200:203]
    v_add_f32 v131, 1.0, v131
    v_add_f32 v160, 1.0, v160
    v_mfma_f32_16x16x32_bf16 v[204:207], a[228:231], v[48:51], v[204:207]
    v_add_f32 v161, 1.0, v161
    v_add_f32 v162, 1.0, v162
    s_waitcnt lgkmcnt(2)
    v_mfma_f32_16x16x32_bf16 v[208:211], a[12:15], v[52:55], v[208:211]
    ds_read_b128 v[64:67], v8 offset:33792
    v_add_f32 v163, 1.0, v163
    v_mfma_f32_16x16x32_bf16 v[212:215], a[84:87], v[52:55], v[212:215]
    v_rcp_f32 v128, v128
    v_mfma_f32_16x16x32_bf16 v[216:219], a[156:159], v[52:55], v[216:219]
    v_rcp_f32 v129, v129
    v_mfma_f32_16x16x32_bf16 v[220:223], a[228:231], v[52:55], v[220:223]
    v_rcp_f32 v130, v130
    s_waitcnt lgkmcnt(2)
    v_mfma_f32_16x16x32_bf16 v[192:195], a[16:19], v[56:59], v[192:195]
    ds_read_b128 v[48:51], v8 offset:35840
    v_mfma_f32_16x16x32_bf16 v[196:199], a[88:91], v[56:59], v[196:199]
    v_rcp_f32 v131, v131
    v_mfma_f32_16x16x32_bf16 v[200:203], a[160:163], v[56:59], v[200:203]
    v_rcp_f32 v160, v160
    v_mfma_f32_16x16x32_bf16 v[204:207], a[232:235], v[56:59], v[204:207]
    v_rcp_f32 v161, v161
    s_waitcnt lgkmcnt(2)
    v_mfma_f32_16x16x32_bf16 v[208:211], a[16:19], v[60:63], v[208:211]
    s_barrier
    ds_read_b128 v[52:55], v8 offset:49152
    v_mfma_f32_16x16x32_bf16 v[212:215], a[88:91], v[60:63], v[212:215]
    v_rcp_f32 v162, v162
    v_mfma_f32_16x16x32_bf16 v[216:219], a[160:163], v[60:63], v[216:219]
    v_rcp_f32 v163, v163
    v_mfma_f32_16x16x32_bf16 v[220:223], a[232:235], v[60:63], v[220:223]
    v_mul_f32 v144, v128, v144
    v_mul_f32 v145, v129, v145
    s_waitcnt lgkmcnt(2)
    v_mfma_f32_16x16x32_bf16 v[192:195], a[20:23], v[64:67], v[192:195]
    ds_read_b128 v[56:59], v8 offset:51200
    v_mul_f32 v146, v130, v146
    v_mfma_f32_16x16x32_bf16 v[196:199], a[92:95], v[64:67], v[196:199]
    v_mul_f32 v147, v131, v147
    v_mul_f32 v176, v160, v176
    v_mfma_f32_16x16x32_bf16 v[200:203], a[164:167], v[64:67], v[200:203]
    v_mul_f32 v177, v161, v177
    v_mul_f32 v178, v162, v178
    v_mfma_f32_16x16x32_bf16 v[204:207], a[236:239], v[64:67], v[204:207]
    v_mul_f32 v179, v163, v179
    v_cvt_pk_bf16_f32 v128, v144, v145
    s_waitcnt lgkmcnt(2)
    v_mfma_f32_16x16x32_bf16 v[208:211], a[20:23], v[48:51], v[208:211]
    ds_read_b128 v[60:63], v8 offset:50176
    v_cvt_pk_bf16_f32 v129, v146, v147
    v_mfma_f32_16x16x32_bf16 v[212:215], a[92:95], v[48:51], v[212:215]
    v_cvt_pk_bf16_f32 v130, v176, v177
    v_cvt_pk_bf16_f32 v131, v178, v179
    s_add_u32 s59, s48, 0
    v_mfma_f32_16x16x32_bf16 v[216:219], a[164:167], v[48:51], v[216:219]
    buffer_store_dwordx4 v[128:131], v0, s[20:23], s59 offen sc1
    v_mul_f32 v132, s56, v132
    v_mfma_f32_16x16x32_bf16 v[220:223], a[236:239], v[48:51], v[220:223]
    v_mul_f32 v133, s56, v133
    v_mul_f32 v134, s56, v134
    s_waitcnt lgkmcnt(2)
    v_mfma_f32_16x16x32_bf16 v[192:195], a[24:27], v[52:55], v[192:195]
    ds_read_b128 v[64:67], v8 offset:52224
    v_mul_f32 v135, s56, v135
    v_mfma_f32_16x16x32_bf16 v[196:199], a[96:99], v[52:55], v[196:199]
    v_mul_f32 v164, s56, v164
    v_mul_f32 v165, s56, v165
    v_mfma_f32_16x16x32_bf16 v[200:203], a[168:171], v[52:55], v[200:203]
    v_mul_f32 v166, s56, v166
    v_mul_f32 v167, s56, v167
    v_mfma_f32_16x16x32_bf16 v[204:207], a[240:243], v[52:55], v[204:207]
    v_exp_f32 v132, v132
    s_waitcnt lgkmcnt(2)
    v_mfma_f32_16x16x32_bf16 v[208:211], a[24:27], v[56:59], v[208:211]
    ds_read_b128 v[48:51], v40 offset:0
    v_mfma_f32_16x16x32_bf16 v[212:215], a[96:99], v[56:59], v[212:215]
    v_exp_f32 v133, v133
    v_mfma_f32_16x16x32_bf16 v[216:219], a[168:171], v[56:59], v[216:219]
    v_exp_f32 v134, v134
    v_mfma_f32_16x16x32_bf16 v[220:223], a[240:243], v[56:59], v[220:223]
    v_exp_f32 v135, v135
    s_waitcnt lgkmcnt(2)
    v_mfma_f32_16x16x32_bf16 v[192:195], a[28:31], v[60:63], v[192:195]
    ds_read_b128 v[52:55], v40 offset:2048
    v_mfma_f32_16x16x32_bf16 v[196:199], a[100:103], v[60:63], v[196:199]
    v_exp_f32 v164, v164
    v_mfma_f32_16x16x32_bf16 v[200:203], a[172:175], v[60:63], v[200:203]
    v_exp_f32 v165, v165
    v_mfma_f32_16x16x32_bf16 v[204:207], a[244:247], v[60:63], v[204:207]
    v_exp_f32 v166, v166
    s_waitcnt lgkmcnt(2)
    v_mfma_f32_16x16x32_bf16 v[208:211], a[28:31], v[64:67], v[208:211]
    ds_read_b128 v[56:59], v40 offset:1024
    v_mfma_f32_16x16x32_bf16 v[212:215], a[100:103], v[64:67], v[212:215]
    v_exp_f32 v167, v167
    v_mfma_f32_16x16x32_bf16 v[216:219], a[172:175], v[64:67], v[216:219]
    v_add_f32 v132, 1.0, v132
    v_add_f32 v133, 1.0, v133
    v_mfma_f32_16x16x32_bf16 v[220:223], a[244:247], v[64:67], v[220:223]
    v_add_f32 v134, 1.0, v134
    v_add_f32 v135, 1.0, v135
    s_waitcnt lgkmcnt(2)
    v_mfma_f32_16x16x32_bf16 v[192:195], a[32:35], v[48:51], v[192:195]
    ds_read_b128 v[60:63], v40 offset:3072
    v_add_f32 v164, 1.0, v164
    v_mfma_f32_16x16x32_bf16 v[196:199], a[104:107], v[48:51], v[196:199]
    v_add_f32 v165, 1.0, v165
    v_add_f32 v166, 1.0, v166
    v_mfma_f32_16x16x32_bf16 v[200:203], a[176:179], v[48:51], v[200:203]
    v_add_f32 v167, 1.0, v167
    v_mfma_f32_16x16x32_bf16 v[204:207], a[248:251], v[48:51], v[204:207]
    v_rcp_f32 v132, v132
    s_waitcnt lgkmcnt(2)
    v_mfma_f32_16x16x32_bf16 v[208:211], a[32:35], v[52:55], v[208:211]
    s_barrier
    ds_read_b128 v[64:67], v40 offset:16384
    v_mfma_f32_16x16x32_bf16 v[212:215], a[104:107], v[52:55], v[212:215]
    v_rcp_f32 v133, v133
    v_mfma_f32_16x16x32_bf16 v[216:219], a[176:179], v[52:55], v[216:219]
    v_rcp_f32 v134, v134
    v_mfma_f32_16x16x32_bf16 v[220:223], a[248:251], v[52:55], v[220:223]
    v_rcp_f32 v135, v135
    s_waitcnt lgkmcnt(2)
    v_mfma_f32_16x16x32_bf16 v[192:195], a[36:39], v[56:59], v[192:195]
    ds_read_b128 v[48:51], v40 offset:18432
    v_mfma_f32_16x16x32_bf16 v[196:199], a[108:111], v[56:59], v[196:199]
    v_rcp_f32 v164, v164
    v_mfma_f32_16x16x32_bf16 v[200:203], a[180:183], v[56:59], v[200:203]
    v_rcp_f32 v165, v165
    v_mfma_f32_16x16x32_bf16 v[204:207], a[252:255], v[56:59], v[204:207]
    v_rcp_f32 v166, v166
    s_waitcnt lgkmcnt(2)
    v_mfma_f32_16x16x32_bf16 v[208:211], a[36:39], v[60:63], v[208:211]
    ds_read_b128 v[52:55], v40 offset:17408
    v_mfma_f32_16x16x32_bf16 v[212:215], a[108:111], v[60:63], v[212:215]
    v_rcp_f32 v167, v167
    v_mfma_f32_16x16x32_bf16 v[216:219], a[180:183], v[60:63], v[216:219]
    v_mul_f32 v148, v132, v148
    v_mul_f32 v149, v133, v149
    v_mfma_f32_16x16x32_bf16 v[220:223], a[252:255], v[60:63], v[220:223]
    v_mul_f32 v150, v134, v150
    v_mul_f32 v151, v135, v151
    s_waitcnt lgkmcnt(2)
    v_mfma_f32_16x16x32_bf16 v[192:195], a[40:43], v[64:67], v[192:195]
    ds_read_b128 v[56:59], v40 offset:19456
    v_mul_f32 v180, v164, v180
    v_mfma_f32_16x16x32_bf16 v[196:199], a[112:115], v[64:67], v[196:199]
    v_mul_f32 v181, v165, v181
    v_mul_f32 v182, v166, v182
    v_mfma_f32_16x16x32_bf16 v[200:203], a[184:187], v[64:67], v[200:203]
    v_mul_f32 v183, v167, v183
    v_cvt_pk_bf16_f32 v132, v148, v149
    v_mfma_f32_16x16x32_bf16 v[204:207], v[96:99], v[64:67], v[204:207]
    v_cvt_pk_bf16_f32 v133, v150, v151
    v_cvt_pk_bf16_f32 v134, v180, v181
    s_waitcnt lgkmcnt(2)
    v_mfma_f32_16x16x32_bf16 v[208:211], a[40:43], v[48:51], v[208:211]
    ds_read_b128 v[60:63], v7 offset:0
    v_cvt_pk_bf16_f32 v135, v182, v183
    s_add_u32 s59, s48, 147456
    v_mfma_f32_16x16x32_bf16 v[212:215], a[112:115], v[48:51], v[212:215]
    buffer_store_dwordx4 v[132:135], v0, s[20:23], s59 offen sc1
    v_mul_f32 v136, s56, v136
    v_mfma_f32_16x16x32_bf16 v[216:219], a[184:187], v[48:51], v[216:219]
    v_mul_f32 v137, s56, v137
    v_mul_f32 v138, s56, v138
    v_mfma_f32_16x16x32_bf16 v[220:223], v[96:99], v[48:51], v[220:223]
    v_mul_f32 v139, s56, v139
    v_mul_f32 v168, s56, v168
    s_waitcnt lgkmcnt(2)
    v_mfma_f32_16x16x32_bf16 v[192:195], a[44:47], v[52:55], v[192:195]
    ds_read_b128 v[64:67], v7 offset:2048
    v_mul_f32 v169, s56, v169
    v_mfma_f32_16x16x32_bf16 v[196:199], a[116:119], v[52:55], v[196:199]
    v_mul_f32 v170, s56, v170
    v_mul_f32 v171, s56, v171
    v_mfma_f32_16x16x32_bf16 v[200:203], a[188:191], v[52:55], v[200:203]
    v_exp_f32 v136, v136
    v_mfma_f32_16x16x32_bf16 v[204:207], v[100:103], v[52:55], v[204:207]
    v_exp_f32 v137, v137
    s_waitcnt lgkmcnt(2)
    v_mfma_f32_16x16x32_bf16 v[208:211], a[44:47], v[56:59], v[208:211]
    ds_read_b128 v[48:51], v7 offset:1024
    v_mfma_f32_16x16x32_bf16 v[212:215], a[116:119], v[56:59], v[212:215]
    v_exp_f32 v138, v138
    v_mfma_f32_16x16x32_bf16 v[216:219], a[188:191], v[56:59], v[216:219]
    v_exp_f32 v139, v139
    v_mfma_f32_16x16x32_bf16 v[220:223], v[100:103], v[56:59], v[220:223]
    v_exp_f32 v168, v168
    s_waitcnt lgkmcnt(2)
    v_mfma_f32_16x16x32_bf16 v[192:195], a[48:51], v[60:63], v[192:195]
    ds_read_b128 v[52:55], v7 offset:3072
    v_mfma_f32_16x16x32_bf16 v[196:199], a[120:123], v[60:63], v[196:199]
    v_exp_f32 v169, v169
    v_mfma_f32_16x16x32_bf16 v[200:203], a[192:195], v[60:63], v[200:203]
    v_exp_f32 v170, v170
    v_mfma_f32_16x16x32_bf16 v[204:207], v[104:107], v[60:63], v[204:207]
    v_exp_f32 v171, v171
    s_waitcnt lgkmcnt(2)
    v_mfma_f32_16x16x32_bf16 v[208:211], a[48:51], v[64:67], v[208:211]
    s_barrier
    ds_read_b128 v[56:59], v7 offset:16384
    v_mfma_f32_16x16x32_bf16 v[212:215], a[120:123], v[64:67], v[212:215]
    v_add_f32 v136, 1.0, v136
    v_add_f32 v137, 1.0, v137
    v_mfma_f32_16x16x32_bf16 v[216:219], a[192:195], v[64:67], v[216:219]
    v_add_f32 v138, 1.0, v138
    v_add_f32 v139, 1.0, v139
    v_mfma_f32_16x16x32_bf16 v[220:223], v[104:107], v[64:67], v[220:223]
    v_add_f32 v168, 1.0, v168
    v_add_f32 v169, 1.0, v169
    s_waitcnt lgkmcnt(2)
    v_mfma_f32_16x16x32_bf16 v[192:195], a[52:55], v[48:51], v[192:195]
    ds_read_b128 v[60:63], v7 offset:18432
    v_add_f32 v170, 1.0, v170
    v_mfma_f32_16x16x32_bf16 v[196:199], a[124:127], v[48:51], v[196:199]
    v_add_f32 v171, 1.0, v171
    v_mfma_f32_16x16x32_bf16 v[200:203], a[196:199], v[48:51], v[200:203]
    v_rcp_f32 v136, v136
    v_mfma_f32_16x16x32_bf16 v[204:207], v[108:111], v[48:51], v[204:207]
    v_rcp_f32 v137, v137
    s_waitcnt lgkmcnt(2)
    v_mfma_f32_16x16x32_bf16 v[208:211], a[52:55], v[52:55], v[208:211]
    ds_read_b128 v[64:67], v7 offset:17408
    v_mfma_f32_16x16x32_bf16 v[212:215], a[124:127], v[52:55], v[212:215]
    v_rcp_f32 v138, v138
    v_mfma_f32_16x16x32_bf16 v[216:219], a[196:199], v[52:55], v[216:219]
    v_rcp_f32 v139, v139
    v_mfma_f32_16x16x32_bf16 v[220:223], v[108:111], v[52:55], v[220:223]
    v_rcp_f32 v168, v168
    s_waitcnt lgkmcnt(2)
    v_mfma_f32_16x16x32_bf16 v[192:195], a[56:59], v[56:59], v[192:195]
    ds_read_b128 v[48:51], v7 offset:19456
    v_mfma_f32_16x16x32_bf16 v[196:199], a[128:131], v[56:59], v[196:199]
    v_rcp_f32 v169, v169
    v_mfma_f32_16x16x32_bf16 v[200:203], a[200:203], v[56:59], v[200:203]
    v_rcp_f32 v170, v170
    v_mfma_f32_16x16x32_bf16 v[204:207], v[112:115], v[56:59], v[204:207]
    v_rcp_f32 v171, v171
    s_waitcnt lgkmcnt(2)
    v_mfma_f32_16x16x32_bf16 v[208:211], a[56:59], v[60:63], v[208:211]
    ds_read_b128 v[52:55], v7 offset:32768
    v_mul_f32 v152, v136, v152
    v_mfma_f32_16x16x32_bf16 v[212:215], a[128:131], v[60:63], v[212:215]
    v_mul_f32 v153, v137, v153
    v_mul_f32 v154, v138, v154
    v_mfma_f32_16x16x32_bf16 v[216:219], a[200:203], v[60:63], v[216:219]
    v_mul_f32 v155, v139, v155
    v_mul_f32 v184, v168, v184
    v_mfma_f32_16x16x32_bf16 v[220:223], v[112:115], v[60:63], v[220:223]
    v_mul_f32 v185, v169, v185
    v_mul_f32 v186, v170, v186
    s_waitcnt lgkmcnt(2)
    v_mfma_f32_16x16x32_bf16 v[192:195], a[60:63], v[64:67], v[192:195]
    ds_read_b128 v[56:59], v7 offset:34816
    v_mul_f32 v187, v171, v187
    v_mfma_f32_16x16x32_bf16 v[196:199], a[132:135], v[64:67], v[196:199]
    v_cvt_pk_bf16_f32 v136, v152, v153
    v_cvt_pk_bf16_f32 v137, v154, v155
    v_mfma_f32_16x16x32_bf16 v[200:203], a[204:207], v[64:67], v[200:203]
    v_cvt_pk_bf16_f32 v138, v184, v185
    v_cvt_pk_bf16_f32 v139, v186, v187
    s_add_u32 s59, s48, 294912
    v_mfma_f32_16x16x32_bf16 v[204:207], v[116:119], v[64:67], v[204:207]
    buffer_store_dwordx4 v[136:139], v0, s[20:23], s59 offen sc1
    v_mul_f32 v140, s56, v140
    s_waitcnt lgkmcnt(2)
    v_mfma_f32_16x16x32_bf16 v[208:211], a[60:63], v[48:51], v[208:211]
    ds_read_b128 v[60:63], v7 offset:33792
    v_mul_f32 v141, s56, v141
    v_mfma_f32_16x16x32_bf16 v[212:215], a[132:135], v[48:51], v[212:215]
    v_mul_f32 v142, s56, v142
    v_mul_f32 v143, s56, v143
    v_mfma_f32_16x16x32_bf16 v[216:219], a[204:207], v[48:51], v[216:219]
    v_mul_f32 v172, s56, v172
    v_mul_f32 v173, s56, v173
    v_mfma_f32_16x16x32_bf16 v[220:223], v[116:119], v[48:51], v[220:223]
    v_mul_f32 v174, s56, v174
    v_mul_f32 v175, s56, v175
    s_waitcnt lgkmcnt(2)
    v_mfma_f32_16x16x32_bf16 v[192:195], a[64:67], v[52:55], v[192:195]
    ds_read_b128 v[64:67], v7 offset:35840
    v_mfma_f32_16x16x32_bf16 v[196:199], a[136:139], v[52:55], v[196:199]
    v_exp_f32 v140, v140
    v_mfma_f32_16x16x32_bf16 v[200:203], a[208:211], v[52:55], v[200:203]
    v_exp_f32 v141, v141
    v_mfma_f32_16x16x32_bf16 v[204:207], v[120:123], v[52:55], v[204:207]
    v_exp_f32 v142, v142
    s_waitcnt lgkmcnt(2)
    v_mfma_f32_16x16x32_bf16 v[208:211], a[64:67], v[56:59], v[208:211]
    v_exp_f32 v143, v143
    v_mfma_f32_16x16x32_bf16 v[212:215], a[136:139], v[56:59], v[212:215]
    v_exp_f32 v172, v172
    v_mfma_f32_16x16x32_bf16 v[216:219], a[208:211], v[56:59], v[216:219]
    v_exp_f32 v173, v173
    v_mfma_f32_16x16x32_bf16 v[220:223], v[120:123], v[56:59], v[220:223]
    v_exp_f32 v174, v174
    s_waitcnt lgkmcnt(1)
    v_mfma_f32_16x16x32_bf16 v[192:195], a[68:71], v[60:63], v[192:195]
    v_exp_f32 v175, v175
    v_mfma_f32_16x16x32_bf16 v[196:199], a[140:143], v[60:63], v[196:199]
    v_add_f32 v140, 1.0, v140
    v_add_f32 v141, 1.0, v141
    v_mfma_f32_16x16x32_bf16 v[200:203], a[212:215], v[60:63], v[200:203]
    v_add_f32 v142, 1.0, v142
    v_add_f32 v143, 1.0, v143
    v_mfma_f32_16x16x32_bf16 v[204:207], v[124:127], v[60:63], v[204:207]
    v_add_f32 v172, 1.0, v172
    v_add_f32 v173, 1.0, v173
    s_waitcnt lgkmcnt(0)
    v_mfma_f32_16x16x32_bf16 v[208:211], a[68:71], v[64:67], v[208:211]
    v_add_f32 v174, 1.0, v174
    v_add_f32 v175, 1.0, v175
    v_mfma_f32_16x16x32_bf16 v[212:215], a[140:143], v[64:67], v[212:215]
    v_rcp_f32 v140, v140
    v_mfma_f32_16x16x32_bf16 v[216:219], a[212:215], v[64:67], v[216:219]
    v_rcp_f32 v141, v141
    v_mfma_f32_16x16x32_bf16 v[220:223], v[124:127], v[64:67], v[220:223]
    v_rcp_f32 v142, v142
    v_rcp_f32 v143, v143
    v_rcp_f32 v172, v172
    v_rcp_f32 v173, v173
    v_rcp_f32 v174, v174
    v_rcp_f32 v175, v175
    v_mul_f32 v156, v140, v156
    v_mul_f32 v157, v141, v157
    v_mul_f32 v158, v142, v158
    v_mul_f32 v159, v143, v159
    v_mul_f32 v188, v172, v188
    v_mul_f32 v189, v173, v189
    v_mul_f32 v190, v174, v190
    v_mul_f32 v191, v175, v191
    v_cvt_pk_bf16_f32 v140, v156, v157
    v_cvt_pk_bf16_f32 v141, v158, v159
    v_cvt_pk_bf16_f32 v142, v188, v189
    v_cvt_pk_bf16_f32 v143, v190, v191
    s_add_u32 s59, s48, 442368
    buffer_store_dwordx4 v[140:143], v0, s[20:23], s59 offen sc1
    v_cvt_pk_bf16_f32 v12, v192, v193
    v_cvt_pk_bf16_f32 v13, v194, v195
    v_cvt_pk_bf16_f32 v14, v196, v197
    v_cvt_pk_bf16_f32 v15, v198, v199
    s_add_u32 s59, s55, 0
    buffer_store_dwordx4 v[12:15], v9, s[20:23], s59 offen
    v_cvt_pk_bf16_f32 v16, v200, v201
    v_cvt_pk_bf16_f32 v17, v202, v203
    v_cvt_pk_bf16_f32 v18, v204, v205
    v_cvt_pk_bf16_f32 v19, v206, v207
    s_add_u32 s59, s55, 64
    buffer_store_dwordx4 v[16:19], v9, s[20:23], s59 offen
    v_cvt_pk_bf16_f32 v12, v208, v209
    v_cvt_pk_bf16_f32 v13, v210, v211
    v_cvt_pk_bf16_f32 v14, v212, v213
    v_cvt_pk_bf16_f32 v15, v214, v215
    s_add_u32 s59, s55, 65536
    buffer_store_dwordx4 v[12:15], v9, s[20:23], s59 offen
    v_cvt_pk_bf16_f32 v16, v216, v217
    v_cvt_pk_bf16_f32 v17, v218, v219
    v_cvt_pk_bf16_f32 v18, v220, v221
    v_cvt_pk_bf16_f32 v19, v222, v223
    s_add_u32 s59, s55, 65600
    buffer_store_dwordx4 v[16:19], v9, s[20:23], s59 offen
    s_branch l1_kernel_end
l1_kernel_tail:
    v_mfma_f32_16x16x32_bf16 v[148:151], v[52:55], a[140:143], v[148:151]
    v_mfma_f32_16x16x32_bf16 v[152:155], v[52:55], a[212:215], v[152:155]
    v_mfma_f32_16x16x32_bf16 v[156:159], v[52:55], v[124:127], v[156:159]
    s_waitcnt lgkmcnt(3)
    v_mfma_f32_16x16x32_bf16 v[160:163], v[56:59], a[68:71], v[160:163]
    v_mfma_f32_16x16x32_bf16 v[164:167], v[56:59], a[140:143], v[164:167]
    v_mfma_f32_16x16x32_bf16 v[168:171], v[56:59], a[212:215], v[168:171]
    v_mfma_f32_16x16x32_bf16 v[172:175], v[56:59], v[124:127], v[172:175]
    s_waitcnt lgkmcnt(1)
    v_mfma_f32_16x16x32_bf16 v[176:179], v[60:63], a[68:71], v[176:179]
    v_mfma_f32_16x16x32_bf16 v[180:183], v[60:63], a[140:143], v[180:183]
    v_mfma_f32_16x16x32_bf16 v[184:187], v[60:63], a[212:215], v[184:187]
    v_mfma_f32_16x16x32_bf16 v[188:191], v[60:63], v[124:127], v[188:191]
    v_mul_f32 v128, s56, v128
    v_mul_f32 v129, s56, v129
    v_mul_f32 v130, s56, v130
    v_mul_f32 v131, s56, v131
    v_mul_f32 v160, s56, v160
    v_mul_f32 v161, s56, v161
    v_mul_f32 v162, s56, v162
    v_mul_f32 v163, s56, v163
    v_exp_f32 v128, v128
    v_exp_f32 v129, v129
    v_exp_f32 v130, v130
    v_exp_f32 v131, v131
    v_exp_f32 v160, v160
    v_exp_f32 v161, v161
    v_exp_f32 v162, v162
    v_exp_f32 v163, v163
    v_add_f32 v128, 1.0, v128
    v_add_f32 v129, 1.0, v129
    v_add_f32 v130, 1.0, v130
    v_add_f32 v131, 1.0, v131
    v_add_f32 v160, 1.0, v160
    v_add_f32 v161, 1.0, v161
    v_add_f32 v162, 1.0, v162
    v_add_f32 v163, 1.0, v163
    v_rcp_f32 v128, v128
    v_rcp_f32 v129, v129
    v_rcp_f32 v130, v130
    v_rcp_f32 v131, v131
    v_rcp_f32 v160, v160
    v_rcp_f32 v161, v161
    v_rcp_f32 v162, v162
    v_rcp_f32 v163, v163
    v_mul_f32 v144, v128, v144
    v_mul_f32 v145, v129, v145
    v_mul_f32 v146, v130, v146
    v_mul_f32 v147, v131, v147
    v_mul_f32 v176, v160, v176
    v_mul_f32 v177, v161, v177
    v_mul_f32 v178, v162, v178
    v_mul_f32 v179, v163, v179
    v_cvt_pk_bf16_f32 v128, v144, v145
    v_cvt_pk_bf16_f32 v129, v146, v147
    v_cvt_pk_bf16_f32 v130, v176, v177
    v_cvt_pk_bf16_f32 v131, v178, v179
    s_add_u32 s59, s48, 0
    buffer_store_dwordx4 v[128:131], v0, s[20:23], s59 offen sc1
    v_mul_f32 v132, s56, v132
    v_mul_f32 v133, s56, v133
    v_mul_f32 v134, s56, v134
    v_mul_f32 v135, s56, v135
    v_mul_f32 v164, s56, v164
    v_mul_f32 v165, s56, v165
    v_mul_f32 v166, s56, v166
    v_mul_f32 v167, s56, v167
    v_exp_f32 v132, v132
    v_exp_f32 v133, v133
    v_exp_f32 v134, v134
    v_exp_f32 v135, v135
    v_exp_f32 v164, v164
    v_exp_f32 v165, v165
    v_exp_f32 v166, v166
    v_exp_f32 v167, v167
    v_add_f32 v132, 1.0, v132
    v_add_f32 v133, 1.0, v133
    v_add_f32 v134, 1.0, v134
    v_add_f32 v135, 1.0, v135
    v_add_f32 v164, 1.0, v164
    v_add_f32 v165, 1.0, v165
    v_add_f32 v166, 1.0, v166
    v_add_f32 v167, 1.0, v167
    v_rcp_f32 v132, v132
    v_rcp_f32 v133, v133
    v_rcp_f32 v134, v134
    v_rcp_f32 v135, v135
    v_rcp_f32 v164, v164
    v_rcp_f32 v165, v165
    v_rcp_f32 v166, v166
    v_rcp_f32 v167, v167
    v_mul_f32 v148, v132, v148
    v_mul_f32 v149, v133, v149
    v_mul_f32 v150, v134, v150
    v_mul_f32 v151, v135, v151
    v_mul_f32 v180, v164, v180
    v_mul_f32 v181, v165, v181
    v_mul_f32 v182, v166, v182
    v_mul_f32 v183, v167, v183
    v_cvt_pk_bf16_f32 v132, v148, v149
    v_cvt_pk_bf16_f32 v133, v150, v151
    v_cvt_pk_bf16_f32 v134, v180, v181
    v_cvt_pk_bf16_f32 v135, v182, v183
    s_add_u32 s59, s48, 147456
    buffer_store_dwordx4 v[132:135], v0, s[20:23], s59 offen sc1
    v_mul_f32 v136, s56, v136
    v_mul_f32 v137, s56, v137
    v_mul_f32 v138, s56, v138
    v_mul_f32 v139, s56, v139
    v_mul_f32 v168, s56, v168
    v_mul_f32 v169, s56, v169
    v_mul_f32 v170, s56, v170
    v_mul_f32 v171, s56, v171
    v_exp_f32 v136, v136
    v_exp_f32 v137, v137
    v_exp_f32 v138, v138
    v_exp_f32 v139, v139
    v_exp_f32 v168, v168
    v_exp_f32 v169, v169
    v_exp_f32 v170, v170
    v_exp_f32 v171, v171
    v_add_f32 v136, 1.0, v136
    v_add_f32 v137, 1.0, v137
    v_add_f32 v138, 1.0, v138
    v_add_f32 v139, 1.0, v139
    v_add_f32 v168, 1.0, v168
    v_add_f32 v169, 1.0, v169
    v_add_f32 v170, 1.0, v170
    v_add_f32 v171, 1.0, v171
    v_rcp_f32 v136, v136
    v_rcp_f32 v137, v137
    v_rcp_f32 v138, v138
    v_rcp_f32 v139, v139
    v_rcp_f32 v168, v168
    v_rcp_f32 v169, v169
    v_rcp_f32 v170, v170
    v_rcp_f32 v171, v171
    v_mul_f32 v152, v136, v152
    v_mul_f32 v153, v137, v153
    v_mul_f32 v154, v138, v154
    v_mul_f32 v155, v139, v155
    v_mul_f32 v184, v168, v184
    v_mul_f32 v185, v169, v185
    v_mul_f32 v186, v170, v186
    v_mul_f32 v187, v171, v187
    v_cvt_pk_bf16_f32 v136, v152, v153
    v_cvt_pk_bf16_f32 v137, v154, v155
    v_cvt_pk_bf16_f32 v138, v184, v185
    v_cvt_pk_bf16_f32 v139, v186, v187
    s_add_u32 s59, s48, 294912
    buffer_store_dwordx4 v[136:139], v0, s[20:23], s59 offen sc1
    v_mul_f32 v140, s56, v140
    v_mul_f32 v141, s56, v141
    v_mul_f32 v142, s56, v142
    v_mul_f32 v143, s56, v143
    v_mul_f32 v172, s56, v172
    v_mul_f32 v173, s56, v173
    v_mul_f32 v174, s56, v174
    v_mul_f32 v175, s56, v175
    v_exp_f32 v140, v140
    v_exp_f32 v141, v141
    v_exp_f32 v142, v142
    v_exp_f32 v143, v143
    v_exp_f32 v172, v172
    v_exp_f32 v173, v173
    v_exp_f32 v174, v174
    v_exp_f32 v175, v175
    v_add_f32 v140, 1.0, v140
    v_add_f32 v141, 1.0, v141
    v_add_f32 v142, 1.0, v142
    v_add_f32 v143, 1.0, v143
    v_add_f32 v172, 1.0, v172
    v_add_f32 v173, 1.0, v173
    v_add_f32 v174, 1.0, v174
    v_add_f32 v175, 1.0, v175
    v_rcp_f32 v140, v140
    v_rcp_f32 v141, v141
    v_rcp_f32 v142, v142
    v_rcp_f32 v143, v143
    v_rcp_f32 v172, v172
    v_rcp_f32 v173, v173
    v_rcp_f32 v174, v174
    v_rcp_f32 v175, v175
    v_mul_f32 v156, v140, v156
    v_mul_f32 v157, v141, v157
    v_mul_f32 v158, v142, v158
    v_mul_f32 v159, v143, v159
    v_mul_f32 v188, v172, v188
    v_mul_f32 v189, v173, v189
    v_mul_f32 v190, v174, v190
    v_mul_f32 v191, v175, v191
    v_cvt_pk_bf16_f32 v140, v156, v157
    v_cvt_pk_bf16_f32 v141, v158, v159
    v_cvt_pk_bf16_f32 v142, v188, v189
    v_cvt_pk_bf16_f32 v143, v190, v191
    s_add_u32 s59, s48, 442368
    buffer_store_dwordx4 v[140:143], v0, s[20:23], s59 offen sc1
l1_kernel_end:
l1_kernel_exit:
    s_endpgm
.section .rodata,"a"
.p2align 6
.amdhsa_kernel l1_kernel
  .amdhsa_next_free_vgpr 512
  .amdhsa_next_free_sgpr 102
  .amdhsa_accum_offset 256
  .amdhsa_group_segment_fixed_size 0
  .amdhsa_kernarg_size 80
  .amdhsa_user_sgpr_count 2
  .amdhsa_user_sgpr_kernarg_segment_ptr 1
  .amdhsa_system_sgpr_workgroup_id_x 1
  .amdhsa_float_denorm_mode_32 3
.end_amdhsa_kernel
.text
.text
.globl l2_kernel
.p2align 8
.type l2_kernel,@function
l2_kernel:
    s_cmp_ge_u32 s2, 228
    s_cbranch_scc1 l2_kernel_exit
    s_getpc_b64 s[84:85]
l2_kernel_pc_l2_kernel:
    s_sub_u32 s84, s84, l2_kernel_pc_l2_kernel-l2_kernel
    s_subb_u32 s85, s85, 0
    v_lshlrev_b32 v28, 7, v0
    s_mov_b32 s86, l2_kernel_exit-l2_kernel
    v_cmp_gt_u32 vcc, s86, v28
    s_nop 3
    s_and_saveexec_b64 s[88:89], vcc
    global_load_dword v9, v28, s[84:85]
    s_mov_b64 exec, s[88:89]
    s_load_dwordx2 s[4:5], s[0:1], 48
    s_load_dwordx4 s[8:11], s[0:1], 56
    s_load_dwordx2 s[6:7], s[0:1], 72
    s_load_dwordx2 s[58:59], s[0:1], 0
    v_lshrrev_b32 v10, 6, v0
    v_and_b32 v11, 63, v0
    v_lshlrev_b32 v0, 4, v11
    v_readfirstlane_b32 s3, v10
    s_waitcnt lgkmcnt(0)
    s_mov_b32 s12, s4
    s_mov_b32 s13, s5
    s_mov_b32 s14, 5308416
    s_mov_b32 s15, 0x20000
    s_mov_b32 s16, s8
    s_mov_b32 s17, s9
    s_mov_b32 s18, 2359296
    s_mov_b32 s19, 0x20000
    s_mov_b32 s20, s6
    s_mov_b32 s21, s7
    s_mov_b32 s22, 47185920
    s_mov_b32 s23, 0x20000
    s_mov_b32 s64, s58
    s_mov_b32 s65, s59
    s_mov_b32 s66, 2359296
    s_mov_b32 s67, 0x20000
    s_cmp_lt_u32 s2, 36
    s_cbranch_scc1 l2_kernel_f2
    s_sub_u32 s2, s2, 36
    s_add_u32 s28, s2, 36
    s_and_b32 s28, s28, 7
    s_lshr_b32 s29, s2, 3
    s_and_b32 s30, s28, 3
    s_lshr_b32 s28, s28, 2
    s_and_b32 s31, s29, 7
    s_lshl_b32 s28, s28, 3
    s_add_u32 s31, s31, s28
    s_lshr_b32 s32, s29, 3
    s_and_b32 s34, s3, 3
    s_and_b32 s28, s30, 1
    s_lshl_b32 s29, s31, 1
    s_add_u32 s28, s28, s29
    s_lshr_b32 s29, s30, 1
    s_lshl_b32 s33, s32, 1
    s_add_u32 s29, s29, s33
    s_mul_i32 s47, s31, 3
    s_add_u32 s47, s47, s32
    s_lshl_b32 s47, s47, 7
    s_add_u32 s47, s47, 46137344
    v_mov_b32 v4, s47
    s_and_b32 s48, s2, 15
    s_lshl_b32 s48, s48, 7
    s_add_u32 s48, s48, 46143488
    v_mov_b32 v5, s48
    s_cmp_ge_u32 s3, 4
    s_cbranch_scc1 l2_kernel_loader
    s_lshl_b32 s35, s31, 2
    s_add_u32 s35, s35, s3
    s_mul_i32 s36, s35, 294912
    s_mul_i32 s37, s30, 36864
    s_add_u32 s36, s36, s37
    s_add_u32 s36, s36, 16777216
    s_add_u32 s42, s36, 0
    buffer_load_dwordx4 a[80:83], v0, s[20:23], s42 offen
    s_add_u32 s42, s36, 147456
    buffer_load_dwordx4 a[84:87], v0, s[20:23], s42 offen
    s_add_u32 s42, s36, 1024
    buffer_load_dwordx4 a[88:91], v0, s[20:23], s42 offen
    s_add_u32 s42, s36, 148480
    buffer_load_dwordx4 a[92:95], v0, s[20:23], s42 offen
    v_lshrrev_b32 v12, 4, v11
    v_bfe_u32 v13, v11, 2, 2
    v_and_b32 v14, 3, v11
    v_lshl_add_u32 v15, v12, 2, v13
    v_mul_u32_u24 v16, 384, v15
    v_bfe_u32 v15, v15, 1, 2
    v_lshl_add_u32 v16, v15, 5, v16
    v_lshrrev_b32 v15, 1, v14
    v_lshl_add_u32 v16, v15, 4, v16
    v_and_b32 v14, 1, v14
    v_lshl_add_u32 v16, v14, 3, v16
    v_xor_b32 v17, 32, v16
    v_xor_b32 v18, 64, v16
    v_xor_b32 v19, 96, v16
    v_add_u32 v20, 49152, v16
    v_add_u32 v21, 49152, v17
    v_add_u32 v22, 49152, v18
    v_add_u32 v23, 49152, v19
    v_add_u32 v24, 98304, v16
    v_add_u32 v25, 98304, v17
    v_add_u32 v26, 98304, v18
    v_add_u32 v27, 98304, v19
    s_lshl_b32 s33, s28, 2
    s_add_u32 s33, s33, s3
    s_mul_i32 s39, s33, 18432
    s_add_u32 s44, s39, 10485760
    s_mul_i32 s45, s29, 3072
    s_add_u32 s45, s45, s39
    s_barrier
    ds_read_b64_tr_b16 a[0:1], v16 offset:0
    ds_read_b64_tr_b16 a[2:3], v16 offset:6144
    ds_read_b64_tr_b16 a[4:5], v17 offset:0
    ds_read_b64_tr_b16 a[6:7], v17 offset:6144
    ds_read_b64_tr_b16 a[8:9], v18 offset:0
    ds_read_b64_tr_b16 a[10:11], v18 offset:6144
    ds_read_b64_tr_b16 a[12:13], v19 offset:0
    ds_read_b64_tr_b16 a[14:15], v19 offset:6144
    s_waitcnt vmcnt(2) lgkmcnt(6)
    v_mfma_f32_16x16x32_bf16 v[32:35], a[0:3], a[80:83], 0
    ds_read_b64_tr_b16 a[16:17], v16 offset:128
    s_add_u32 s42, s36, 2048
    buffer_load_dwordx4 a[96:99], v0, s[20:23], s42 offen
    v_mfma_f32_16x16x32_bf16 v[36:39], a[0:3], a[84:87], 0
    ds_read_b64_tr_b16 a[18:19], v16 offset:6272
    s_add_u32 s42, s36, 149504
    s_waitcnt lgkmcnt(6)
    v_mfma_f32_16x16x32_bf16 v[40:43], a[4:7], a[80:83], 0
    ds_read_b64_tr_b16 a[20:21], v17 offset:128
    buffer_load_dwordx4 a[100:103], v0, s[20:23], s42 offen
    s_add_u32 s42, s36, 3072
    v_mfma_f32_16x16x32_bf16 v[44:47], a[4:7], a[84:87], 0
    ds_read_b64_tr_b16 a[22:23], v17 offset:6272
    s_waitcnt lgkmcnt(6)
    v_mfma_f32_16x16x32_bf16 v[48:51], a[8:11], a[80:83], 0
    ds_read_b64_tr_b16 a[24:25], v18 offset:128
    buffer_load_dwordx4 a[104:107], v0, s[20:23], s42 offen
    s_add_u32 s42, s36, 150528
    v_mfma_f32_16x16x32_bf16 v[52:55], a[8:11], a[84:87], 0
    ds_read_b64_tr_b16 a[26:27], v18 offset:6272
    s_waitcnt lgkmcnt(6)
    v_mfma_f32_16x16x32_bf16 v[56:59], a[12:15], a[80:83], 0
    ds_read_b64_tr_b16 a[28:29], v19 offset:128
    buffer_load_dwordx4 a[108:111], v0, s[20:23], s42 offen
    s_add_u32 s42, s36, 4096
    v_mfma_f32_16x16x32_bf16 v[60:63], a[12:15], a[84:87], 0
    ds_read_b64_tr_b16 a[30:31], v19 offset:6272
    s_waitcnt lgkmcnt(6)
    v_mfma_f32_16x16x32_bf16 v[64:67], a[16:19], a[80:83], 0
    ds_read_b64_tr_b16 a[0:1], v16 offset:256
    buffer_load_dwordx4 a[112:115], v0, s[20:23], s42 offen
    s_add_u32 s42, s36, 151552
    v_mfma_f32_16x16x32_bf16 v[68:71], a[16:19], a[84:87], 0
    ds_read_b64_tr_b16 a[2:3], v16 offset:6400
    s_waitcnt lgkmcnt(6)
    v_mfma_f32_16x16x32_bf16 v[72:75], a[20:23], a[80:83], 0
    ds_read_b64_tr_b16 a[4:5], v17 offset:256
    buffer_load_dwordx4 a[116:119], v0, s[20:23], s42 offen
    s_add_u32 s42, s36, 5120
    v_mfma_f32_16x16x32_bf16 v[76:79], a[20:23], a[84:87], 0
    ds_read_b64_tr_b16 a[6:7], v17 offset:6400
    s_waitcnt lgkmcnt(6)
    v_mfma_f32_16x16x32_bf16 v[80:83], a[24:27], a[80:83], 0
    ds_read_b64_tr_b16 a[8:9], v18 offset:256
    buffer_load_dwordx4 a[120:123], v0, s[20:23], s42 offen
    s_add_u32 s42, s36, 152576
    v_mfma_f32_16x16x32_bf16 v[84:87], a[24:27], a[84:87], 0
    ds_read_b64_tr_b16 a[10:11], v18 offset:6400
    s_waitcnt lgkmcnt(6)
    v_mfma_f32_16x16x32_bf16 v[88:91], a[28:31], a[80:83], 0
    ds_read_b64_tr_b16 a[12:13], v19 offset:256
    buffer_load_dwordx4 a[124:127], v0, s[20:23], s42 offen
    v_mfma_f32_16x16x32_bf16 v[92:95], a[28:31], a[84:87], 0
    ds_read_b64_tr_b16 a[14:15], v19 offset:6400
    s_waitcnt lgkmcnt(6)
    v_mfma_f32_16x16x32_bf16 v[96:99], a[0:3], a[80:83], 0
    ds_read_b64_tr_b16 a[16:17], v16 offset:12288
    v_mfma_f32_16x16x32_bf16 v[100:103], a[0:3], a[84:87], 0
    ds_read_b64_tr_b16 a[18:19], v16 offset:18432
    s_waitcnt lgkmcnt(6)
    v_mfma_f32_16x16x32_bf16 v[104:107], a[4:7], a[80:83], 0
    ds_read_b64_tr_b16 a[20:21], v17 offset:12288
    v_mfma_f32_16x16x32_bf16 v[108:111], a[4:7], a[84:87], 0
    ds_read_b64_tr_b16 a[22:23], v17 offset:18432
    s_waitcnt lgkmcnt(6)
    v_mfma_f32_16x16x32_bf16 v[112:115], a[8:11], a[80:83], 0
    ds_read_b64_tr_b16 a[24:25], v18 offset:12288
    v_mfma_f32_16x16x32_bf16 v[116:119], a[8:11], a[84:87], 0
    ds_read_b64_tr_b16 a[26:27], v18 offset:18432
    s_waitcnt lgkmcnt(6)
    v_mfma_f32_16x16x32_bf16 v[120:123], a[12:15], a[80:83], 0
    ds_read_b64_tr_b16 a[28:29], v19 offset:12288
    v_mfma_f32_16x16x32_bf16 v[124:127], a[12:15], a[84:87], 0
    ds_read_b64_tr_b16 a[30:31], v19 offset:18432
    s_waitcnt vmcnt(8) lgkmcnt(6)
    v_mfma_f32_16x16x32_bf16 v[32:35], a[16:19], a[88:91], v[32:35]
    ds_read_b64_tr_b16 a[0:1], v16 offset:12416
    v_mfma_f32_16x16x32_bf16 v[36:39], a[16:19], a[92:95], v[36:39]
    ds_read_b64_tr_b16 a[2:3], v16 offset:18560
    s_add_u32 s42, s36, 6144
    s_waitcnt lgkmcnt(6)
    v_mfma_f32_16x16x32_bf16 v[40:43], a[20:23], a[88:91], v[40:43]
    ds_read_b64_tr_b16 a[4:5], v17 offset:12416
    buffer_load_dwordx4 a[80:83], v0, s[20:23], s42 offen
    s_add_u32 s42, s36, 153600
    v_mfma_f32_16x16x32_bf16 v[44:47], a[20:23], a[92:95], v[44:47]
    ds_read_b64_tr_b16 a[6:7], v17 offset:18560
    s_waitcnt lgkmcnt(6)
    v_mfma_f32_16x16x32_bf16 v[48:51], a[24:27], a[88:91], v[48:51]
    ds_read_b64_tr_b16 a[8:9], v18 offset:12416
    buffer_load_dwordx4 a[84:87], v0, s[20:23], s42 offen
    v_mfma_f32_16x16x32_bf16 v[52:55], a[24:27], a[92:95], v[52:55]
    ds_read_b64_tr_b16 a[10:11], v18 offset:18560
    s_waitcnt lgkmcnt(6)
    v_mfma_f32_16x16x32_bf16 v[56:59], a[28:31], a[88:91], v[56:59]
    ds_read_b64_tr_b16 a[12:13], v19 offset:12416
    v_mfma_f32_16x16x32_bf16 v[60:63], a[28:31], a[92:95], v[60:63]
    ds_read_b64_tr_b16 a[14:15], v19 offset:18560
    s_waitcnt lgkmcnt(6)
    v_mfma_f32_16x16x32_bf16 v[64:67], a[0:3], a[88:91], v[64:67]
    ds_read_b64_tr_b16 a[16:17], v16 offset:12544
    v_mfma_f32_16x16x32_bf16 v[68:71], a[0:3], a[92:95], v[68:71]
    ds_read_b64_tr_b16 a[18:19], v16 offset:18688
    s_waitcnt lgkmcnt(6)
    v_mfma_f32_16x16x32_bf16 v[72:75], a[4:7], a[88:91], v[72:75]
    ds_read_b64_tr_b16 a[20:21], v17 offset:12544
    v_mfma_f32_16x16x32_bf16 v[76:79], a[4:7], a[92:95], v[76:79]
    ds_read_b64_tr_b16 a[22:23], v17 offset:18688
    s_waitcnt lgkmcnt(6)
    v_mfma_f32_16x16x32_bf16 v[80:83], a[8:11], a[88:91], v[80:83]
    ds_read_b64_tr_b16 a[24:25], v18 offset:12544
    v_mfma_f32_16x16x32_bf16 v[84:87], a[8:11], a[92:95], v[84:87]
    ds_read_b64_tr_b16 a[26:27], v18 offset:18688
    s_waitcnt lgkmcnt(6)
    v_mfma_f32_16x16x32_bf16 v[88:91], a[12:15], a[88:91], v[88:91]
    ds_read_b64_tr_b16 a[28:29], v19 offset:12544
    v_mfma_f32_16x16x32_bf16 v[92:95], a[12:15], a[92:95], v[92:95]
    ds_read_b64_tr_b16 a[30:31], v19 offset:18688
    s_waitcnt lgkmcnt(6)
    v_mfma_f32_16x16x32_bf16 v[96:99], a[16:19], a[88:91], v[96:99]
    ds_read_b64_tr_b16 a[0:1], v16 offset:24576
    v_mfma_f32_16x16x32_bf16 v[100:103], a[16:19], a[92:95], v[100:103]
    ds_read_b64_tr_b16 a[2:3], v16 offset:30720
    s_waitcnt lgkmcnt(6)
    v_mfma_f32_16x16x32_bf16 v[104:107], a[20:23], a[88:91], v[104:107]
    ds_read_b64_tr_b16 a[4:5], v17 offset:24576
    v_mfma_f32_16x16x32_bf16 v[108:111], a[20:23], a[92:95], v[108:111]
    ds_read_b64_tr_b16 a[6:7], v17 offset:30720
    s_waitcnt lgkmcnt(6)
    v_mfma_f32_16x16x32_bf16 v[112:115], a[24:27], a[88:91], v[112:115]
    ds_read_b64_tr_b16 a[8:9], v18 offset:24576
    v_mfma_f32_16x16x32_bf16 v[116:119], a[24:27], a[92:95], v[116:119]
    ds_read_b64_tr_b16 a[10:11], v18 offset:30720
    s_waitcnt lgkmcnt(6)
    v_mfma_f32_16x16x32_bf16 v[120:123], a[28:31], a[88:91], v[120:123]
    ds_read_b64_tr_b16 a[12:13], v19 offset:24576
    v_mfma_f32_16x16x32_bf16 v[124:127], a[28:31], a[92:95], v[124:127]
    ds_read_b64_tr_b16 a[14:15], v19 offset:30720
    s_waitcnt vmcnt(8) lgkmcnt(6)
    v_mfma_f32_16x16x32_bf16 v[32:35], a[0:3], a[96:99], v[32:35]
    ds_read_b64_tr_b16 a[16:17], v16 offset:24704
    v_mfma_f32_16x16x32_bf16 v[36:39], a[0:3], a[100:103], v[36:39]
    ds_read_b64_tr_b16 a[18:19], v16 offset:30848
    s_add_u32 s42, s36, 7168
    s_waitcnt lgkmcnt(6)
    v_mfma_f32_16x16x32_bf16 v[40:43], a[4:7], a[96:99], v[40:43]
    ds_read_b64_tr_b16 a[20:21], v17 offset:24704
    buffer_load_dwordx4 a[88:91], v0, s[20:23], s42 offen
    s_add_u32 s42, s36, 154624
    v_mfma_f32_16x16x32_bf16 v[44:47], a[4:7], a[100:103], v[44:47]
    ds_read_b64_tr_b16 a[22:23], v17 offset:30848
    s_waitcnt lgkmcnt(6)
    v_mfma_f32_16x16x32_bf16 v[48:51], a[8:11], a[96:99], v[48:51]
    ds_read_b64_tr_b16 a[24:25], v18 offset:24704
    buffer_load_dwordx4 a[92:95], v0, s[20:23], s42 offen
    v_mfma_f32_16x16x32_bf16 v[52:55], a[8:11], a[100:103], v[52:55]
    ds_read_b64_tr_b16 a[26:27], v18 offset:30848
    s_waitcnt lgkmcnt(6)
    v_mfma_f32_16x16x32_bf16 v[56:59], a[12:15], a[96:99], v[56:59]
    ds_read_b64_tr_b16 a[28:29], v19 offset:24704
    v_mfma_f32_16x16x32_bf16 v[60:63], a[12:15], a[100:103], v[60:63]
    ds_read_b64_tr_b16 a[30:31], v19 offset:30848
    s_waitcnt lgkmcnt(6)
    v_mfma_f32_16x16x32_bf16 v[64:67], a[16:19], a[96:99], v[64:67]
    ds_read_b64_tr_b16 a[0:1], v16 offset:24832
    v_mfma_f32_16x16x32_bf16 v[68:71], a[16:19], a[100:103], v[68:71]
    ds_read_b64_tr_b16 a[2:3], v16 offset:30976
    s_waitcnt lgkmcnt(6)
    v_mfma_f32_16x16x32_bf16 v[72:75], a[20:23], a[96:99], v[72:75]
    ds_read_b64_tr_b16 a[4:5], v17 offset:24832
    v_mfma_f32_16x16x32_bf16 v[76:79], a[20:23], a[100:103], v[76:79]
    ds_read_b64_tr_b16 a[6:7], v17 offset:30976
    s_waitcnt lgkmcnt(6)
    v_mfma_f32_16x16x32_bf16 v[80:83], a[24:27], a[96:99], v[80:83]
    ds_read_b64_tr_b16 a[8:9], v18 offset:24832
    v_mfma_f32_16x16x32_bf16 v[84:87], a[24:27], a[100:103], v[84:87]
    ds_read_b64_tr_b16 a[10:11], v18 offset:30976
    s_waitcnt lgkmcnt(6)
    v_mfma_f32_16x16x32_bf16 v[88:91], a[28:31], a[96:99], v[88:91]
    ds_read_b64_tr_b16 a[12:13], v19 offset:24832
    v_mfma_f32_16x16x32_bf16 v[92:95], a[28:31], a[100:103], v[92:95]
    ds_read_b64_tr_b16 a[14:15], v19 offset:30976
    s_waitcnt lgkmcnt(6)
    v_mfma_f32_16x16x32_bf16 v[96:99], a[0:3], a[96:99], v[96:99]
    ds_read_b64_tr_b16 a[16:17], v16 offset:36864
    v_mfma_f32_16x16x32_bf16 v[100:103], a[0:3], a[100:103], v[100:103]
    ds_read_b64_tr_b16 a[18:19], v16 offset:43008
    s_waitcnt lgkmcnt(6)
    v_mfma_f32_16x16x32_bf16 v[104:107], a[4:7], a[96:99], v[104:107]
    ds_read_b64_tr_b16 a[20:21], v17 offset:36864
    v_mfma_f32_16x16x32_bf16 v[108:111], a[4:7], a[100:103], v[108:111]
    ds_read_b64_tr_b16 a[22:23], v17 offset:43008
    s_waitcnt lgkmcnt(6)
    v_mfma_f32_16x16x32_bf16 v[112:115], a[8:11], a[96:99], v[112:115]
    ds_read_b64_tr_b16 a[24:25], v18 offset:36864
    v_mfma_f32_16x16x32_bf16 v[116:119], a[8:11], a[100:103], v[116:119]
    ds_read_b64_tr_b16 a[26:27], v18 offset:43008
    s_waitcnt lgkmcnt(6)
    v_mfma_f32_16x16x32_bf16 v[120:123], a[12:15], a[96:99], v[120:123]
    ds_read_b64_tr_b16 a[28:29], v19 offset:36864
    v_mfma_f32_16x16x32_bf16 v[124:127], a[12:15], a[100:103], v[124:127]
    ds_read_b64_tr_b16 a[30:31], v19 offset:43008
    s_waitcnt vmcnt(8) lgkmcnt(6)
    v_mfma_f32_16x16x32_bf16 v[32:35], a[16:19], a[104:107], v[32:35]
    ds_read_b64_tr_b16 a[0:1], v16 offset:36992
    v_mfma_f32_16x16x32_bf16 v[36:39], a[16:19], a[108:111], v[36:39]
    ds_read_b64_tr_b16 a[2:3], v16 offset:43136
    s_add_u32 s42, s36, 8192
    s_waitcnt lgkmcnt(6)
    v_mfma_f32_16x16x32_bf16 v[40:43], a[20:23], a[104:107], v[40:43]
    ds_read_b64_tr_b16 a[4:5], v17 offset:36992
    buffer_load_dwordx4 a[96:99], v0, s[20:23], s42 offen
    s_add_u32 s42, s36, 155648
    v_mfma_f32_16x16x32_bf16 v[44:47], a[20:23], a[108:111], v[44:47]
    ds_read_b64_tr_b16 a[6:7], v17 offset:43136
    s_waitcnt lgkmcnt(6)
    v_mfma_f32_16x16x32_bf16 v[48:51], a[24:27], a[104:107], v[48:51]
    ds_read_b64_tr_b16 a[8:9], v18 offset:36992
    buffer_load_dwordx4 a[100:103], v0, s[20:23], s42 offen
    v_mfma_f32_16x16x32_bf16 v[52:55], a[24:27], a[108:111], v[52:55]
    ds_read_b64_tr_b16 a[10:11], v18 offset:43136
    s_waitcnt lgkmcnt(6)
    v_mfma_f32_16x16x32_bf16 v[56:59], a[28:31], a[104:107], v[56:59]
    ds_read_b64_tr_b16 a[12:13], v19 offset:36992
    v_mfma_f32_16x16x32_bf16 v[60:63], a[28:31], a[108:111], v[60:63]
    ds_read_b64_tr_b16 a[14:15], v19 offset:43136
    s_waitcnt lgkmcnt(6)
    v_mfma_f32_16x16x32_bf16 v[64:67], a[0:3], a[104:107], v[64:67]
    ds_read_b64_tr_b16 a[16:17], v16 offset:37120
    v_mfma_f32_16x16x32_bf16 v[68:71], a[0:3], a[108:111], v[68:71]
    ds_read_b64_tr_b16 a[18:19], v16 offset:43264
    s_waitcnt lgkmcnt(6)
    v_mfma_f32_16x16x32_bf16 v[72:75], a[4:7], a[104:107], v[72:75]
    ds_read_b64_tr_b16 a[20:21], v17 offset:37120
    v_mfma_f32_16x16x32_bf16 v[76:79], a[4:7], a[108:111], v[76:79]
    ds_read_b64_tr_b16 a[22:23], v17 offset:43264
    s_waitcnt lgkmcnt(6)
    v_mfma_f32_16x16x32_bf16 v[80:83], a[8:11], a[104:107], v[80:83]
    ds_read_b64_tr_b16 a[24:25], v18 offset:37120
    v_mfma_f32_16x16x32_bf16 v[84:87], a[8:11], a[108:111], v[84:87]
    ds_read_b64_tr_b16 a[26:27], v18 offset:43264
    s_waitcnt lgkmcnt(6)
    v_mfma_f32_16x16x32_bf16 v[88:91], a[12:15], a[104:107], v[88:91]
    ds_read_b64_tr_b16 a[28:29], v19 offset:37120
    v_mfma_f32_16x16x32_bf16 v[92:95], a[12:15], a[108:111], v[92:95]
    ds_read_b64_tr_b16 a[30:31], v19 offset:43264
    s_barrier
    s_waitcnt lgkmcnt(6)
    v_mfma_f32_16x16x32_bf16 v[96:99], a[16:19], a[104:107], v[96:99]
    ds_read_b64_tr_b16 a[0:1], v20 offset:0
    v_mfma_f32_16x16x32_bf16 v[100:103], a[16:19], a[108:111], v[100:103]
    ds_read_b64_tr_b16 a[2:3], v20 offset:6144
    s_waitcnt lgkmcnt(6)
    v_mfma_f32_16x16x32_bf16 v[104:107], a[20:23], a[104:107], v[104:107]
    ds_read_b64_tr_b16 a[4:5], v21 offset:0
    v_mfma_f32_16x16x32_bf16 v[108:111], a[20:23], a[108:111], v[108:111]
    ds_read_b64_tr_b16 a[6:7], v21 offset:6144
    s_waitcnt lgkmcnt(6)
    v_mfma_f32_16x16x32_bf16 v[112:115], a[24:27], a[104:107], v[112:115]
    ds_read_b64_tr_b16 a[8:9], v22 offset:0
    v_mfma_f32_16x16x32_bf16 v[116:119], a[24:27], a[108:111], v[116:119]
    ds_read_b64_tr_b16 a[10:11], v22 offset:6144
    s_waitcnt lgkmcnt(6)
    v_mfma_f32_16x16x32_bf16 v[120:123], a[28:31], a[104:107], v[120:123]
    ds_read_b64_tr_b16 a[12:13], v23 offset:0
    v_mfma_f32_16x16x32_bf16 v[124:127], a[28:31], a[108:111], v[124:127]
    ds_read_b64_tr_b16 a[14:15], v23 offset:6144
    s_waitcnt vmcnt(8) lgkmcnt(6)
    v_mfma_f32_16x16x32_bf16 v[32:35], a[0:3], a[112:115], v[32:35]
    ds_read_b64_tr_b16 a[16:17], v20 offset:128
    v_mfma_f32_16x16x32_bf16 v[36:39], a[0:3], a[116:119], v[36:39]
    ds_read_b64_tr_b16 a[18:19], v20 offset:6272
    s_add_u32 s42, s36, 9216
    s_waitcnt lgkmcnt(6)
    v_mfma_f32_16x16x32_bf16 v[40:43], a[4:7], a[112:115], v[40:43]
    ds_read_b64_tr_b16 a[20:21], v21 offset:128
    buffer_load_dwordx4 a[104:107], v0, s[20:23], s42 offen
    s_add_u32 s42, s36, 156672
    v_mfma_f32_16x16x32_bf16 v[44:47], a[4:7], a[116:119], v[44:47]
    ds_read_b64_tr_b16 a[22:23], v21 offset:6272
    s_waitcnt lgkmcnt(6)
    v_mfma_f32_16x16x32_bf16 v[48:51], a[8:11], a[112:115], v[48:51]
    ds_read_b64_tr_b16 a[24:25], v22 offset:128
    buffer_load_dwordx4 a[108:111], v0, s[20:23], s42 offen
    v_mfma_f32_16x16x32_bf16 v[52:55], a[8:11], a[116:119], v[52:55]
    ds_read_b64_tr_b16 a[26:27], v22 offset:6272
    s_waitcnt lgkmcnt(6)
    v_mfma_f32_16x16x32_bf16 v[56:59], a[12:15], a[112:115], v[56:59]
    ds_read_b64_tr_b16 a[28:29], v23 offset:128
    v_mfma_f32_16x16x32_bf16 v[60:63], a[12:15], a[116:119], v[60:63]
    ds_read_b64_tr_b16 a[30:31], v23 offset:6272
    s_waitcnt lgkmcnt(6)
    v_mfma_f32_16x16x32_bf16 v[64:67], a[16:19], a[112:115], v[64:67]
    ds_read_b64_tr_b16 a[0:1], v20 offset:256
    v_mfma_f32_16x16x32_bf16 v[68:71], a[16:19], a[116:119], v[68:71]
    ds_read_b64_tr_b16 a[2:3], v20 offset:6400
    s_waitcnt lgkmcnt(6)
    v_mfma_f32_16x16x32_bf16 v[72:75], a[20:23], a[112:115], v[72:75]
    ds_read_b64_tr_b16 a[4:5], v21 offset:256
    v_mfma_f32_16x16x32_bf16 v[76:79], a[20:23], a[116:119], v[76:79]
    ds_read_b64_tr_b16 a[6:7], v21 offset:6400
    s_waitcnt lgkmcnt(6)
    v_mfma_f32_16x16x32_bf16 v[80:83], a[24:27], a[112:115], v[80:83]
    ds_read_b64_tr_b16 a[8:9], v22 offset:256
    v_mfma_f32_16x16x32_bf16 v[84:87], a[24:27], a[116:119], v[84:87]
    ds_read_b64_tr_b16 a[10:11], v22 offset:6400
    s_waitcnt lgkmcnt(6)
    v_mfma_f32_16x16x32_bf16 v[88:91], a[28:31], a[112:115], v[88:91]
    ds_read_b64_tr_b16 a[12:13], v23 offset:256
    v_mfma_f32_16x16x32_bf16 v[92:95], a[28:31], a[116:119], v[92:95]
    ds_read_b64_tr_b16 a[14:15], v23 offset:6400
    s_waitcnt lgkmcnt(6)
    v_mfma_f32_16x16x32_bf16 v[96:99], a[0:3], a[112:115], v[96:99]
    ds_read_b64_tr_b16 a[16:17], v20 offset:12288
    v_mfma_f32_16x16x32_bf16 v[100:103], a[0:3], a[116:119], v[100:103]
    ds_read_b64_tr_b16 a[18:19], v20 offset:18432
    s_waitcnt lgkmcnt(6)
    v_mfma_f32_16x16x32_bf16 v[104:107], a[4:7], a[112:115], v[104:107]
    ds_read_b64_tr_b16 a[20:21], v21 offset:12288
    v_mfma_f32_16x16x32_bf16 v[108:111], a[4:7], a[116:119], v[108:111]
    ds_read_b64_tr_b16 a[22:23], v21 offset:18432
    s_waitcnt lgkmcnt(6)
    v_mfma_f32_16x16x32_bf16 v[112:115], a[8:11], a[112:115], v[112:115]
    ds_read_b64_tr_b16 a[24:25], v22 offset:12288
    v_mfma_f32_16x16x32_bf16 v[116:119], a[8:11], a[116:119], v[116:119]
    ds_read_b64_tr_b16 a[26:27], v22 offset:18432
    s_waitcnt lgkmcnt(6)
    v_mfma_f32_16x16x32_bf16 v[120:123], a[12:15], a[112:115], v[120:123]
    ds_read_b64_tr_b16 a[28:29], v23 offset:12288
    v_mfma_f32_16x16x32_bf16 v[124:127], a[12:15], a[116:119], v[124:127]
    ds_read_b64_tr_b16 a[30:31], v23 offset:18432
    s_waitcnt vmcnt(8) lgkmcnt(6)
    v_mfma_f32_16x16x32_bf16 v[32:35], a[16:19], a[120:123], v[32:35]
    ds_read_b64_tr_b16 a[0:1], v20 offset:12416
    v_mfma_f32_16x16x32_bf16 v[36:39], a[16:19], a[124:127], v[36:39]
    ds_read_b64_tr_b16 a[2:3], v20 offset:18560
    s_add_u32 s42, s36, 10240
    s_waitcnt lgkmcnt(6)
    v_mfma_f32_16x16x32_bf16 v[40:43], a[20:23], a[120:123], v[40:43]
    ds_read_b64_tr_b16 a[4:5], v21 offset:12416
    buffer_load_dwordx4 a[112:115], v0, s[20:23], s42 offen
    s_add_u32 s42, s36, 157696
    v_mfma_f32_16x16x32_bf16 v[44:47], a[20:23], a[124:127], v[44:47]
    ds_read_b64_tr_b16 a[6:7], v21 offset:18560
    s_waitcnt lgkmcnt(6)
    v_mfma_f32_16x16x32_bf16 v[48:51], a[24:27], a[120:123], v[48:51]
    ds_read_b64_tr_b16 a[8:9], v22 offset:12416
    buffer_load_dwordx4 a[116:119], v0, s[20:23], s42 offen
    v_mfma_f32_16x16x32_bf16 v[52:55], a[24:27], a[124:127], v[52:55]
    ds_read_b64_tr_b16 a[10:11], v22 offset:18560
    s_waitcnt lgkmcnt(6)
    v_mfma_f32_16x16x32_bf16 v[56:59], a[28:31], a[120:123], v[56:59]
    ds_read_b64_tr_b16 a[12:13], v23 offset:12416
    v_mfma_f32_16x16x32_bf16 v[60:63], a[28:31], a[124:127], v[60:63]
    ds_read_b64_tr_b16 a[14:15], v23 offset:18560
    s_waitcnt lgkmcnt(6)
    v_mfma_f32_16x16x32_bf16 v[64:67], a[0:3], a[120:123], v[64:67]
    ds_read_b64_tr_b16 a[16:17], v20 offset:12544
    v_mfma_f32_16x16x32_bf16 v[68:71], a[0:3], a[124:127], v[68:71]
    ds_read_b64_tr_b16 a[18:19], v20 offset:18688
    s_waitcnt lgkmcnt(6)
    v_mfma_f32_16x16x32_bf16 v[72:75], a[4:7], a[120:123], v[72:75]
    ds_read_b64_tr_b16 a[20:21], v21 offset:12544
    v_mfma_f32_16x16x32_bf16 v[76:79], a[4:7], a[124:127], v[76:79]
    ds_read_b64_tr_b16 a[22:23], v21 offset:18688
    s_waitcnt lgkmcnt(6)
    v_mfma_f32_16x16x32_bf16 v[80:83], a[8:11], a[120:123], v[80:83]
    ds_read_b64_tr_b16 a[24:25], v22 offset:12544
    v_mfma_f32_16x16x32_bf16 v[84:87], a[8:11], a[124:127], v[84:87]
    ds_read_b64_tr_b16 a[26:27], v22 offset:18688
    s_waitcnt lgkmcnt(6)
    v_mfma_f32_16x16x32_bf16 v[88:91], a[12:15], a[120:123], v[88:91]
    ds_read_b64_tr_b16 a[28:29], v23 offset:12544
    v_mfma_f32_16x16x32_bf16 v[92:95], a[12:15], a[124:127], v[92:95]
    ds_read_b64_tr_b16 a[30:31], v23 offset:18688
    s_waitcnt lgkmcnt(6)
    v_mfma_f32_16x16x32_bf16 v[96:99], a[16:19], a[120:123], v[96:99]
    ds_read_b64_tr_b16 a[0:1], v20 offset:24576
    v_mfma_f32_16x16x32_bf16 v[100:103], a[16:19], a[124:127], v[100:103]
    ds_read_b64_tr_b16 a[2:3], v20 offset:30720
    s_waitcnt lgkmcnt(6)
    v_mfma_f32_16x16x32_bf16 v[104:107], a[20:23], a[120:123], v[104:107]
    ds_read_b64_tr_b16 a[4:5], v21 offset:24576
    v_mfma_f32_16x16x32_bf16 v[108:111], a[20:23], a[124:127], v[108:111]
    ds_read_b64_tr_b16 a[6:7], v21 offset:30720
    s_waitcnt lgkmcnt(6)
    v_mfma_f32_16x16x32_bf16 v[112:115], a[24:27], a[120:123], v[112:115]
    ds_read_b64_tr_b16 a[8:9], v22 offset:24576
    v_mfma_f32_16x16x32_bf16 v[116:119], a[24:27], a[124:127], v[116:119]
    ds_read_b64_tr_b16 a[10:11], v22 offset:30720
    s_waitcnt lgkmcnt(6)
    v_mfma_f32_16x16x32_bf16 v[120:123], a[28:31], a[120:123], v[120:123]
    ds_read_b64_tr_b16 a[12:13], v23 offset:24576
    v_mfma_f32_16x16x32_bf16 v[124:127], a[28:31], a[124:127], v[124:127]
    ds_read_b64_tr_b16 a[14:15], v23 offset:30720
    s_waitcnt vmcnt(8) lgkmcnt(6)
    v_mfma_f32_16x16x32_bf16 v[32:35], a[0:3], a[80:83], v[32:35]
    ds_read_b64_tr_b16 a[16:17], v20 offset:24704
    v_mfma_f32_16x16x32_bf16 v[36:39], a[0:3], a[84:87], v[36:39]
    ds_read_b64_tr_b16 a[18:19], v20 offset:30848
    s_add_u32 s42, s36, 11264
    s_waitcnt lgkmcnt(6)
    v_mfma_f32_16x16x32_bf16 v[40:43], a[4:7], a[80:83], v[40:43]
    ds_read_b64_tr_b16 a[20:21], v21 offset:24704
    buffer_load_dwordx4 a[120:123], v0, s[20:23], s42 offen
    s_add_u32 s42, s36, 158720
    v_mfma_f32_16x16x32_bf16 v[44:47], a[4:7], a[84:87], v[44:47]
    ds_read_b64_tr_b16 a[22:23], v21 offset:30848
    s_waitcnt lgkmcnt(6)
    v_mfma_f32_16x16x32_bf16 v[48:51], a[8:11], a[80:83], v[48:51]
    ds_read_b64_tr_b16 a[24:25], v22 offset:24704
    buffer_load_dwordx4 a[124:127], v0, s[20:23], s42 offen
    v_mfma_f32_16x16x32_bf16 v[52:55], a[8:11], a[84:87], v[52:55]
    ds_read_b64_tr_b16 a[26:27], v22 offset:30848
    s_waitcnt lgkmcnt(6)
    v_mfma_f32_16x16x32_bf16 v[56:59], a[12:15], a[80:83], v[56:59]
    ds_read_b64_tr_b16 a[28:29], v23 offset:24704
    v_mfma_f32_16x16x32_bf16 v[60:63], a[12:15], a[84:87], v[60:63]
    ds_read_b64_tr_b16 a[30:31], v23 offset:30848
    s_waitcnt lgkmcnt(6)
    v_mfma_f32_16x16x32_bf16 v[64:67], a[16:19], a[80:83], v[64:67]
    ds_read_b64_tr_b16 a[0:1], v20 offset:24832
    v_mfma_f32_16x16x32_bf16 v[68:71], a[16:19], a[84:87], v[68:71]
    ds_read_b64_tr_b16 a[2:3], v20 offset:30976
    s_waitcnt lgkmcnt(6)
    v_mfma_f32_16x16x32_bf16 v[72:75], a[20:23], a[80:83], v[72:75]
    ds_read_b64_tr_b16 a[4:5], v21 offset:24832
    v_mfma_f32_16x16x32_bf16 v[76:79], a[20:23], a[84:87], v[76:79]
    ds_read_b64_tr_b16 a[6:7], v21 offset:30976
    s_waitcnt lgkmcnt(6)
    v_mfma_f32_16x16x32_bf16 v[80:83], a[24:27], a[80:83], v[80:83]
    ds_read_b64_tr_b16 a[8:9], v22 offset:24832
    v_mfma_f32_16x16x32_bf16 v[84:87], a[24:27], a[84:87], v[84:87]
    ds_read_b64_tr_b16 a[10:11], v22 offset:30976
    s_waitcnt lgkmcnt(6)
    v_mfma_f32_16x16x32_bf16 v[88:91], a[28:31], a[80:83], v[88:91]
    ds_read_b64_tr_b16 a[12:13], v23 offset:24832
    v_mfma_f32_16x16x32_bf16 v[92:95], a[28:31], a[84:87], v[92:95]
    ds_read_b64_tr_b16 a[14:15], v23 offset:30976
    s_waitcnt lgkmcnt(6)
    v_mfma_f32_16x16x32_bf16 v[96:99], a[0:3], a[80:83], v[96:99]
    ds_read_b64_tr_b16 a[16:17], v20 offset:36864
    v_mfma_f32_16x16x32_bf16 v[100:103], a[0:3], a[84:87], v[100:103]
    ds_read_b64_tr_b16 a[18:19], v20 offset:43008
    s_waitcnt lgkmcnt(6)
    v_mfma_f32_16x16x32_bf16 v[104:107], a[4:7], a[80:83], v[104:107]
    ds_read_b64_tr_b16 a[20:21], v21 offset:36864
    v_mfma_f32_16x16x32_bf16 v[108:111], a[4:7], a[84:87], v[108:111]
    ds_read_b64_tr_b16 a[22:23], v21 offset:43008
    s_waitcnt lgkmcnt(6)
    v_mfma_f32_16x16x32_bf16 v[112:115], a[8:11], a[80:83], v[112:115]
    ds_read_b64_tr_b16 a[24:25], v22 offset:36864
    v_mfma_f32_16x16x32_bf16 v[116:119], a[8:11], a[84:87], v[116:119]
    ds_read_b64_tr_b16 a[26:27], v22 offset:43008
    s_waitcnt lgkmcnt(6)
    v_mfma_f32_16x16x32_bf16 v[120:123], a[12:15], a[80:83], v[120:123]
    ds_read_b64_tr_b16 a[28:29], v23 offset:36864
    v_mfma_f32_16x16x32_bf16 v[124:127], a[12:15], a[84:87], v[124:127]
    ds_read_b64_tr_b16 a[30:31], v23 offset:43008
    s_waitcnt vmcnt(8) lgkmcnt(6)
    v_mfma_f32_16x16x32_bf16 v[32:35], a[16:19], a[88:91], v[32:35]
    ds_read_b64_tr_b16 a[0:1], v20 offset:36992
    v_mfma_f32_16x16x32_bf16 v[36:39], a[16:19], a[92:95], v[36:39]
    ds_read_b64_tr_b16 a[2:3], v20 offset:43136
    s_add_u32 s42, s36, 12288
    s_waitcnt lgkmcnt(6)
    v_mfma_f32_16x16x32_bf16 v[40:43], a[20:23], a[88:91], v[40:43]
    ds_read_b64_tr_b16 a[4:5], v21 offset:36992
    buffer_load_dwordx4 a[80:83], v0, s[20:23], s42 offen
    s_add_u32 s42, s36, 159744
    v_mfma_f32_16x16x32_bf16 v[44:47], a[20:23], a[92:95], v[44:47]
    ds_read_b64_tr_b16 a[6:7], v21 offset:43136
    s_waitcnt lgkmcnt(6)
    v_mfma_f32_16x16x32_bf16 v[48:51], a[24:27], a[88:91], v[48:51]
    ds_read_b64_tr_b16 a[8:9], v22 offset:36992
    buffer_load_dwordx4 a[84:87], v0, s[20:23], s42 offen
    v_mfma_f32_16x16x32_bf16 v[52:55], a[24:27], a[92:95], v[52:55]
    ds_read_b64_tr_b16 a[10:11], v22 offset:43136
    s_waitcnt lgkmcnt(6)
    v_mfma_f32_16x16x32_bf16 v[56:59], a[28:31], a[88:91], v[56:59]
    ds_read_b64_tr_b16 a[12:13], v23 offset:36992
    v_mfma_f32_16x16x32_bf16 v[60:63], a[28:31], a[92:95], v[60:63]
    ds_read_b64_tr_b16 a[14:15], v23 offset:43136
    s_waitcnt lgkmcnt(6)
    v_mfma_f32_16x16x32_bf16 v[64:67], a[0:3], a[88:91], v[64:67]
    ds_read_b64_tr_b16 a[16:17], v20 offset:37120
    v_mfma_f32_16x16x32_bf16 v[68:71], a[0:3], a[92:95], v[68:71]
    ds_read_b64_tr_b16 a[18:19], v20 offset:43264
    s_waitcnt lgkmcnt(6)
    v_mfma_f32_16x16x32_bf16 v[72:75], a[4:7], a[88:91], v[72:75]
    ds_read_b64_tr_b16 a[20:21], v21 offset:37120
    v_mfma_f32_16x16x32_bf16 v[76:79], a[4:7], a[92:95], v[76:79]
    ds_read_b64_tr_b16 a[22:23], v21 offset:43264
    s_waitcnt lgkmcnt(6)
    v_mfma_f32_16x16x32_bf16 v[80:83], a[8:11], a[88:91], v[80:83]
    ds_read_b64_tr_b16 a[24:25], v22 offset:37120
    v_mfma_f32_16x16x32_bf16 v[84:87], a[8:11], a[92:95], v[84:87]
    ds_read_b64_tr_b16 a[26:27], v22 offset:43264
    s_waitcnt lgkmcnt(6)
    v_mfma_f32_16x16x32_bf16 v[88:91], a[12:15], a[88:91], v[88:91]
    ds_read_b64_tr_b16 a[28:29], v23 offset:37120
    v_mfma_f32_16x16x32_bf16 v[92:95], a[12:15], a[92:95], v[92:95]
    ds_read_b64_tr_b16 a[30:31], v23 offset:43264
    s_barrier
    s_waitcnt lgkmcnt(6)
    v_mfma_f32_16x16x32_bf16 v[96:99], a[16:19], a[88:91], v[96:99]
    ds_read_b64_tr_b16 a[0:1], v24 offset:0
    v_mfma_f32_16x16x32_bf16 v[100:103], a[16:19], a[92:95], v[100:103]
    ds_read_b64_tr_b16 a[2:3], v24 offset:6144
    s_waitcnt lgkmcnt(6)
    v_mfma_f32_16x16x32_bf16 v[104:107], a[20:23], a[88:91], v[104:107]
    ds_read_b64_tr_b16 a[4:5], v25 offset:0
    v_mfma_f32_16x16x32_bf16 v[108:111], a[20:23], a[92:95], v[108:111]
    ds_read_b64_tr_b16 a[6:7], v25 offset:6144
    s_waitcnt lgkmcnt(6)
    v_mfma_f32_16x16x32_bf16 v[112:115], a[24:27], a[88:91], v[112:115]
    ds_read_b64_tr_b16 a[8:9], v26 offset:0
    v_mfma_f32_16x16x32_bf16 v[116:119], a[24:27], a[92:95], v[116:119]
    ds_read_b64_tr_b16 a[10:11], v26 offset:6144
    s_waitcnt lgkmcnt(6)
    v_mfma_f32_16x16x32_bf16 v[120:123], a[28:31], a[88:91], v[120:123]
    ds_read_b64_tr_b16 a[12:13], v27 offset:0
    v_mfma_f32_16x16x32_bf16 v[124:127], a[28:31], a[92:95], v[124:127]
    ds_read_b64_tr_b16 a[14:15], v27 offset:6144
    s_waitcnt vmcnt(8) lgkmcnt(6)
    v_mfma_f32_16x16x32_bf16 v[32:35], a[0:3], a[96:99], v[32:35]
    ds_read_b64_tr_b16 a[16:17], v24 offset:128
    v_mfma_f32_16x16x32_bf16 v[36:39], a[0:3], a[100:103], v[36:39]
    ds_read_b64_tr_b16 a[18:19], v24 offset:6272
    s_add_u32 s42, s36, 13312
    s_waitcnt lgkmcnt(6)
    v_mfma_f32_16x16x32_bf16 v[40:43], a[4:7], a[96:99], v[40:43]
    ds_read_b64_tr_b16 a[20:21], v25 offset:128
    buffer_load_dwordx4 a[88:91], v0, s[20:23], s42 offen
    s_add_u32 s42, s36, 160768
    v_mfma_f32_16x16x32_bf16 v[44:47], a[4:7], a[100:103], v[44:47]
    ds_read_b64_tr_b16 a[22:23], v25 offset:6272
    s_waitcnt lgkmcnt(6)
    v_mfma_f32_16x16x32_bf16 v[48:51], a[8:11], a[96:99], v[48:51]
    ds_read_b64_tr_b16 a[24:25], v26 offset:128
    buffer_load_dwordx4 a[92:95], v0, s[20:23], s42 offen
    v_mfma_f32_16x16x32_bf16 v[52:55], a[8:11], a[100:103], v[52:55]
    ds_read_b64_tr_b16 a[26:27], v26 offset:6272
    s_waitcnt lgkmcnt(6)
    v_mfma_f32_16x16x32_bf16 v[56:59], a[12:15], a[96:99], v[56:59]
    ds_read_b64_tr_b16 a[28:29], v27 offset:128
    v_mfma_f32_16x16x32_bf16 v[60:63], a[12:15], a[100:103], v[60:63]
    ds_read_b64_tr_b16 a[30:31], v27 offset:6272
    s_waitcnt lgkmcnt(6)
    v_mfma_f32_16x16x32_bf16 v[64:67], a[16:19], a[96:99], v[64:67]
    ds_read_b64_tr_b16 a[0:1], v24 offset:256
    v_mfma_f32_16x16x32_bf16 v[68:71], a[16:19], a[100:103], v[68:71]
    ds_read_b64_tr_b16 a[2:3], v24 offset:6400
    s_waitcnt lgkmcnt(6)
    v_mfma_f32_16x16x32_bf16 v[72:75], a[20:23], a[96:99], v[72:75]
    ds_read_b64_tr_b16 a[4:5], v25 offset:256
    v_mfma_f32_16x16x32_bf16 v[76:79], a[20:23], a[100:103], v[76:79]
    ds_read_b64_tr_b16 a[6:7], v25 offset:6400
    s_waitcnt lgkmcnt(6)
    v_mfma_f32_16x16x32_bf16 v[80:83], a[24:27], a[96:99], v[80:83]
    ds_read_b64_tr_b16 a[8:9], v26 offset:256
    v_mfma_f32_16x16x32_bf16 v[84:87], a[24:27], a[100:103], v[84:87]
    ds_read_b64_tr_b16 a[10:11], v26 offset:6400
    s_waitcnt lgkmcnt(6)
    v_mfma_f32_16x16x32_bf16 v[88:91], a[28:31], a[96:99], v[88:91]
    ds_read_b64_tr_b16 a[12:13], v27 offset:256
    v_mfma_f32_16x16x32_bf16 v[92:95], a[28:31], a[100:103], v[92:95]
    ds_read_b64_tr_b16 a[14:15], v27 offset:6400
    s_waitcnt lgkmcnt(6)
    v_mfma_f32_16x16x32_bf16 v[96:99], a[0:3], a[96:99], v[96:99]
    ds_read_b64_tr_b16 a[16:17], v24 offset:12288
    v_mfma_f32_16x16x32_bf16 v[100:103], a[0:3], a[100:103], v[100:103]
    ds_read_b64_tr_b16 a[18:19], v24 offset:18432
    s_waitcnt lgkmcnt(6)
    v_mfma_f32_16x16x32_bf16 v[104:107], a[4:7], a[96:99], v[104:107]
    ds_read_b64_tr_b16 a[20:21], v25 offset:12288
    v_mfma_f32_16x16x32_bf16 v[108:111], a[4:7], a[100:103], v[108:111]
    ds_read_b64_tr_b16 a[22:23], v25 offset:18432
    s_waitcnt lgkmcnt(6)
    v_mfma_f32_16x16x32_bf16 v[112:115], a[8:11], a[96:99], v[112:115]
    ds_read_b64_tr_b16 a[24:25], v26 offset:12288
    v_mfma_f32_16x16x32_bf16 v[116:119], a[8:11], a[100:103], v[116:119]
    ds_read_b64_tr_b16 a[26:27], v26 offset:18432
    s_waitcnt lgkmcnt(6)
    v_mfma_f32_16x16x32_bf16 v[120:123], a[12:15], a[96:99], v[120:123]
    ds_read_b64_tr_b16 a[28:29], v27 offset:12288
    v_mfma_f32_16x16x32_bf16 v[124:127], a[12:15], a[100:103], v[124:127]
    ds_read_b64_tr_b16 a[30:31], v27 offset:18432
    s_waitcnt vmcnt(8) lgkmcnt(6)
    v_mfma_f32_16x16x32_bf16 v[32:35], a[16:19], a[104:107], v[32:35]
    ds_read_b64_tr_b16 a[0:1], v24 offset:12416
    v_mfma_f32_16x16x32_bf16 v[36:39], a[16:19], a[108:111], v[36:39]
    ds_read_b64_tr_b16 a[2:3], v24 offset:18560
    s_add_u32 s42, s36, 14336
    s_waitcnt lgkmcnt(6)
    v_mfma_f32_16x16x32_bf16 v[40:43], a[20:23], a[104:107], v[40:43]
    ds_read_b64_tr_b16 a[4:5], v25 offset:12416
    buffer_load_dwordx4 a[96:99], v0, s[20:23], s42 offen
    s_add_u32 s42, s36, 161792
    v_mfma_f32_16x16x32_bf16 v[44:47], a[20:23], a[108:111], v[44:47]
    ds_read_b64_tr_b16 a[6:7], v25 offset:18560
    s_waitcnt lgkmcnt(6)
    v_mfma_f32_16x16x32_bf16 v[48:51], a[24:27], a[104:107], v[48:51]
    ds_read_b64_tr_b16 a[8:9], v26 offset:12416
    buffer_load_dwordx4 a[100:103], v0, s[20:23], s42 offen
    v_mfma_f32_16x16x32_bf16 v[52:55], a[24:27], a[108:111], v[52:55]
    ds_read_b64_tr_b16 a[10:11], v26 offset:18560
    s_waitcnt lgkmcnt(6)
    v_mfma_f32_16x16x32_bf16 v[56:59], a[28:31], a[104:107], v[56:59]
    ds_read_b64_tr_b16 a[12:13], v27 offset:12416
    v_mfma_f32_16x16x32_bf16 v[60:63], a[28:31], a[108:111], v[60:63]
    ds_read_b64_tr_b16 a[14:15], v27 offset:18560
    s_waitcnt lgkmcnt(6)
    v_mfma_f32_16x16x32_bf16 v[64:67], a[0:3], a[104:107], v[64:67]
    ds_read_b64_tr_b16 a[16:17], v24 offset:12544
    v_mfma_f32_16x16x32_bf16 v[68:71], a[0:3], a[108:111], v[68:71]
    ds_read_b64_tr_b16 a[18:19], v24 offset:18688
    s_waitcnt lgkmcnt(6)
    v_mfma_f32_16x16x32_bf16 v[72:75], a[4:7], a[104:107], v[72:75]
    ds_read_b64_tr_b16 a[20:21], v25 offset:12544
    v_mfma_f32_16x16x32_bf16 v[76:79], a[4:7], a[108:111], v[76:79]
    ds_read_b64_tr_b16 a[22:23], v25 offset:18688
    s_waitcnt lgkmcnt(6)
    v_mfma_f32_16x16x32_bf16 v[80:83], a[8:11], a[104:107], v[80:83]
    ds_read_b64_tr_b16 a[24:25], v26 offset:12544
    v_mfma_f32_16x16x32_bf16 v[84:87], a[8:11], a[108:111], v[84:87]
    ds_read_b64_tr_b16 a[26:27], v26 offset:18688
    s_waitcnt lgkmcnt(6)
    v_mfma_f32_16x16x32_bf16 v[88:91], a[12:15], a[104:107], v[88:91]
    ds_read_b64_tr_b16 a[28:29], v27 offset:12544
    v_mfma_f32_16x16x32_bf16 v[92:95], a[12:15], a[108:111], v[92:95]
    ds_read_b64_tr_b16 a[30:31], v27 offset:18688
    s_waitcnt lgkmcnt(6)
    v_mfma_f32_16x16x32_bf16 v[96:99], a[16:19], a[104:107], v[96:99]
    ds_read_b64_tr_b16 a[0:1], v24 offset:24576
    v_mfma_f32_16x16x32_bf16 v[100:103], a[16:19], a[108:111], v[100:103]
    ds_read_b64_tr_b16 a[2:3], v24 offset:30720
    s_waitcnt lgkmcnt(6)
    v_mfma_f32_16x16x32_bf16 v[104:107], a[20:23], a[104:107], v[104:107]
    ds_read_b64_tr_b16 a[4:5], v25 offset:24576
    v_mfma_f32_16x16x32_bf16 v[108:111], a[20:23], a[108:111], v[108:111]
    ds_read_b64_tr_b16 a[6:7], v25 offset:30720
    s_waitcnt lgkmcnt(6)
    v_mfma_f32_16x16x32_bf16 v[112:115], a[24:27], a[104:107], v[112:115]
    ds_read_b64_tr_b16 a[8:9], v26 offset:24576
    v_mfma_f32_16x16x32_bf16 v[116:119], a[24:27], a[108:111], v[116:119]
    ds_read_b64_tr_b16 a[10:11], v26 offset:30720
    s_waitcnt lgkmcnt(6)
    v_mfma_f32_16x16x32_bf16 v[120:123], a[28:31], a[104:107], v[120:123]
    ds_read_b64_tr_b16 a[12:13], v27 offset:24576
    v_mfma_f32_16x16x32_bf16 v[124:127], a[28:31], a[108:111], v[124:127]
    ds_read_b64_tr_b16 a[14:15], v27 offset:30720
    s_waitcnt vmcnt(8) lgkmcnt(6)
    v_mfma_f32_16x16x32_bf16 v[32:35], a[0:3], a[112:115], v[32:35]
    ds_read_b64_tr_b16 a[16:17], v24 offset:24704
    v_mfma_f32_16x16x32_bf16 v[36:39], a[0:3], a[116:119], v[36:39]
    ds_read_b64_tr_b16 a[18:19], v24 offset:30848
    s_add_u32 s42, s36, 15360
    s_waitcnt lgkmcnt(6)
    v_mfma_f32_16x16x32_bf16 v[40:43], a[4:7], a[112:115], v[40:43]
    ds_read_b64_tr_b16 a[20:21], v25 offset:24704
    buffer_load_dwordx4 a[104:107], v0, s[20:23], s42 offen
    s_add_u32 s42, s36, 162816
    v_mfma_f32_16x16x32_bf16 v[44:47], a[4:7], a[116:119], v[44:47]
    ds_read_b64_tr_b16 a[22:23], v25 offset:30848
    s_waitcnt lgkmcnt(6)
    v_mfma_f32_16x16x32_bf16 v[48:51], a[8:11], a[112:115], v[48:51]
    ds_read_b64_tr_b16 a[24:25], v26 offset:24704
    buffer_load_dwordx4 a[108:111], v0, s[20:23], s42 offen
    v_mfma_f32_16x16x32_bf16 v[52:55], a[8:11], a[116:119], v[52:55]
    ds_read_b64_tr_b16 a[26:27], v26 offset:30848
    s_waitcnt lgkmcnt(6)
    v_mfma_f32_16x16x32_bf16 v[56:59], a[12:15], a[112:115], v[56:59]
    ds_read_b64_tr_b16 a[28:29], v27 offset:24704
    v_mfma_f32_16x16x32_bf16 v[60:63], a[12:15], a[116:119], v[60:63]
    ds_read_b64_tr_b16 a[30:31], v27 offset:30848
    s_waitcnt lgkmcnt(6)
    v_mfma_f32_16x16x32_bf16 v[64:67], a[16:19], a[112:115], v[64:67]
    ds_read_b64_tr_b16 a[0:1], v24 offset:24832
    v_mfma_f32_16x16x32_bf16 v[68:71], a[16:19], a[116:119], v[68:71]
    ds_read_b64_tr_b16 a[2:3], v24 offset:30976
    s_waitcnt lgkmcnt(6)
    v_mfma_f32_16x16x32_bf16 v[72:75], a[20:23], a[112:115], v[72:75]
    ds_read_b64_tr_b16 a[4:5], v25 offset:24832
    v_mfma_f32_16x16x32_bf16 v[76:79], a[20:23], a[116:119], v[76:79]
    ds_read_b64_tr_b16 a[6:7], v25 offset:30976
    s_waitcnt lgkmcnt(6)
    v_mfma_f32_16x16x32_bf16 v[80:83], a[24:27], a[112:115], v[80:83]
    ds_read_b64_tr_b16 a[8:9], v26 offset:24832
    v_mfma_f32_16x16x32_bf16 v[84:87], a[24:27], a[116:119], v[84:87]
    ds_read_b64_tr_b16 a[10:11], v26 offset:30976
    s_waitcnt lgkmcnt(6)
    v_mfma_f32_16x16x32_bf16 v[88:91], a[28:31], a[112:115], v[88:91]
    ds_read_b64_tr_b16 a[12:13], v27 offset:24832
    v_mfma_f32_16x16x32_bf16 v[92:95], a[28:31], a[116:119], v[92:95]
    ds_read_b64_tr_b16 a[14:15], v27 offset:30976
    s_waitcnt lgkmcnt(6)
    v_mfma_f32_16x16x32_bf16 v[96:99], a[0:3], a[112:115], v[96:99]
    ds_read_b64_tr_b16 a[16:17], v24 offset:36864
    v_mfma_f32_16x16x32_bf16 v[100:103], a[0:3], a[116:119], v[100:103]
    ds_read_b64_tr_b16 a[18:19], v24 offset:43008
    s_waitcnt lgkmcnt(6)
    v_mfma_f32_16x16x32_bf16 v[104:107], a[4:7], a[112:115], v[104:107]
    ds_read_b64_tr_b16 a[20:21], v25 offset:36864
    v_mfma_f32_16x16x32_bf16 v[108:111], a[4:7], a[116:119], v[108:111]
    ds_read_b64_tr_b16 a[22:23], v25 offset:43008
    s_waitcnt lgkmcnt(6)
    v_mfma_f32_16x16x32_bf16 v[112:115], a[8:11], a[112:115], v[112:115]
    ds_read_b64_tr_b16 a[24:25], v26 offset:36864
    v_mfma_f32_16x16x32_bf16 v[116:119], a[8:11], a[116:119], v[116:119]
    ds_read_b64_tr_b16 a[26:27], v26 offset:43008
    s_waitcnt lgkmcnt(6)
    v_mfma_f32_16x16x32_bf16 v[120:123], a[12:15], a[112:115], v[120:123]
    ds_read_b64_tr_b16 a[28:29], v27 offset:36864
    v_mfma_f32_16x16x32_bf16 v[124:127], a[12:15], a[116:119], v[124:127]
    ds_read_b64_tr_b16 a[30:31], v27 offset:43008
    s_waitcnt vmcnt(8) lgkmcnt(6)
    v_mfma_f32_16x16x32_bf16 v[32:35], a[16:19], a[120:123], v[32:35]
    ds_read_b64_tr_b16 a[0:1], v24 offset:36992
    v_mfma_f32_16x16x32_bf16 v[36:39], a[16:19], a[124:127], v[36:39]
    ds_read_b64_tr_b16 a[2:3], v24 offset:43136
    s_add_u32 s42, s36, 16384
    s_waitcnt lgkmcnt(6)
    v_mfma_f32_16x16x32_bf16 v[40:43], a[20:23], a[120:123], v[40:43]
    ds_read_b64_tr_b16 a[4:5], v25 offset:36992
    buffer_load_dwordx4 a[112:115], v0, s[20:23], s42 offen
    s_add_u32 s42, s36, 163840
    v_mfma_f32_16x16x32_bf16 v[44:47], a[20:23], a[124:127], v[44:47]
    ds_read_b64_tr_b16 a[6:7], v25 offset:43136
    s_waitcnt lgkmcnt(6)
    v_mfma_f32_16x16x32_bf16 v[48:51], a[24:27], a[120:123], v[48:51]
    ds_read_b64_tr_b16 a[8:9], v26 offset:36992
    buffer_load_dwordx4 a[116:119], v0, s[20:23], s42 offen
    v_mfma_f32_16x16x32_bf16 v[52:55], a[24:27], a[124:127], v[52:55]
    ds_read_b64_tr_b16 a[10:11], v26 offset:43136
    s_waitcnt lgkmcnt(6)
    v_mfma_f32_16x16x32_bf16 v[56:59], a[28:31], a[120:123], v[56:59]
    ds_read_b64_tr_b16 a[12:13], v27 offset:36992
    v_mfma_f32_16x16x32_bf16 v[60:63], a[28:31], a[124:127], v[60:63]
    ds_read_b64_tr_b16 a[14:15], v27 offset:43136
    s_waitcnt lgkmcnt(6)
    v_mfma_f32_16x16x32_bf16 v[64:67], a[0:3], a[120:123], v[64:67]
    ds_read_b64_tr_b16 a[16:17], v24 offset:37120
    v_mfma_f32_16x16x32_bf16 v[68:71], a[0:3], a[124:127], v[68:71]
    ds_read_b64_tr_b16 a[18:19], v24 offset:43264
    s_waitcnt lgkmcnt(6)
    v_mfma_f32_16x16x32_bf16 v[72:75], a[4:7], a[120:123], v[72:75]
    ds_read_b64_tr_b16 a[20:21], v25 offset:37120
    v_mfma_f32_16x16x32_bf16 v[76:79], a[4:7], a[124:127], v[76:79]
    ds_read_b64_tr_b16 a[22:23], v25 offset:43264
    s_waitcnt lgkmcnt(6)
    v_mfma_f32_16x16x32_bf16 v[80:83], a[8:11], a[120:123], v[80:83]
    ds_read_b64_tr_b16 a[24:25], v26 offset:37120
    v_mfma_f32_16x16x32_bf16 v[84:87], a[8:11], a[124:127], v[84:87]
    ds_read_b64_tr_b16 a[26:27], v26 offset:43264
    s_waitcnt lgkmcnt(6)
    v_mfma_f32_16x16x32_bf16 v[88:91], a[12:15], a[120:123], v[88:91]
    ds_read_b64_tr_b16 a[28:29], v27 offset:37120
    v_mfma_f32_16x16x32_bf16 v[92:95], a[12:15], a[124:127], v[92:95]
    ds_read_b64_tr_b16 a[30:31], v27 offset:43264
    s_barrier
    s_waitcnt lgkmcnt(6)
    v_mfma_f32_16x16x32_bf16 v[96:99], a[16:19], a[120:123], v[96:99]
    ds_read_b64_tr_b16 a[0:1], v16 offset:0
    v_mfma_f32_16x16x32_bf16 v[100:103], a[16:19], a[124:127], v[100:103]
    ds_read_b64_tr_b16 a[2:3], v16 offset:6144
    s_waitcnt lgkmcnt(6)
    v_mfma_f32_16x16x32_bf16 v[104:107], a[20:23], a[120:123], v[104:107]
    ds_read_b64_tr_b16 a[4:5], v17 offset:0
    v_mfma_f32_16x16x32_bf16 v[108:111], a[20:23], a[124:127], v[108:111]
    ds_read_b64_tr_b16 a[6:7], v17 offset:6144
    s_waitcnt lgkmcnt(6)
    v_mfma_f32_16x16x32_bf16 v[112:115], a[24:27], a[120:123], v[112:115]
    ds_read_b64_tr_b16 a[8:9], v18 offset:0
    v_mfma_f32_16x16x32_bf16 v[116:119], a[24:27], a[124:127], v[116:119]
    ds_read_b64_tr_b16 a[10:11], v18 offset:6144
    s_waitcnt lgkmcnt(6)
    v_mfma_f32_16x16x32_bf16 v[120:123], a[28:31], a[120:123], v[120:123]
    ds_read_b64_tr_b16 a[12:13], v19 offset:0
    v_mfma_f32_16x16x32_bf16 v[124:127], a[28:31], a[124:127], v[124:127]
    ds_read_b64_tr_b16 a[14:15], v19 offset:6144
    s_waitcnt vmcnt(8) lgkmcnt(6)
    v_mfma_f32_16x16x32_bf16 v[32:35], a[0:3], a[80:83], v[32:35]
    ds_read_b64_tr_b16 a[16:17], v16 offset:128
    v_mfma_f32_16x16x32_bf16 v[36:39], a[0:3], a[84:87], v[36:39]
    ds_read_b64_tr_b16 a[18:19], v16 offset:6272
    s_add_u32 s42, s36, 17408
    s_waitcnt lgkmcnt(6)
    v_mfma_f32_16x16x32_bf16 v[40:43], a[4:7], a[80:83], v[40:43]
    ds_read_b64_tr_b16 a[20:21], v17 offset:128
    buffer_load_dwordx4 a[120:123], v0, s[20:23], s42 offen
    s_add_u32 s42, s36, 164864
    v_mfma_f32_16x16x32_bf16 v[44:47], a[4:7], a[84:87], v[44:47]
    ds_read_b64_tr_b16 a[22:23], v17 offset:6272
    s_waitcnt lgkmcnt(6)
    v_mfma_f32_16x16x32_bf16 v[48:51], a[8:11], a[80:83], v[48:51]
    ds_read_b64_tr_b16 a[24:25], v18 offset:128
    buffer_load_dwordx4 a[124:127], v0, s[20:23], s42 offen
    v_mfma_f32_16x16x32_bf16 v[52:55], a[8:11], a[84:87], v[52:55]
    ds_read_b64_tr_b16 a[26:27], v18 offset:6272
    s_waitcnt lgkmcnt(6)
    v_mfma_f32_16x16x32_bf16 v[56:59], a[12:15], a[80:83], v[56:59]
    ds_read_b64_tr_b16 a[28:29], v19 offset:128
    v_mfma_f32_16x16x32_bf16 v[60:63], a[12:15], a[84:87], v[60:63]
    ds_read_b64_tr_b16 a[30:31], v19 offset:6272
    s_waitcnt lgkmcnt(6)
    v_mfma_f32_16x16x32_bf16 v[64:67], a[16:19], a[80:83], v[64:67]
    ds_read_b64_tr_b16 a[0:1], v16 offset:256
    v_mfma_f32_16x16x32_bf16 v[68:71], a[16:19], a[84:87], v[68:71]
    ds_read_b64_tr_b16 a[2:3], v16 offset:6400
    s_waitcnt lgkmcnt(6)
    v_mfma_f32_16x16x32_bf16 v[72:75], a[20:23], a[80:83], v[72:75]
    ds_read_b64_tr_b16 a[4:5], v17 offset:256
    v_mfma_f32_16x16x32_bf16 v[76:79], a[20:23], a[84:87], v[76:79]
    ds_read_b64_tr_b16 a[6:7], v17 offset:6400
    s_waitcnt lgkmcnt(6)
    v_mfma_f32_16x16x32_bf16 v[80:83], a[24:27], a[80:83], v[80:83]
    ds_read_b64_tr_b16 a[8:9], v18 offset:256
    v_mfma_f32_16x16x32_bf16 v[84:87], a[24:27], a[84:87], v[84:87]
    ds_read_b64_tr_b16 a[10:11], v18 offset:6400
    s_waitcnt lgkmcnt(6)
    v_mfma_f32_16x16x32_bf16 v[88:91], a[28:31], a[80:83], v[88:91]
    ds_read_b64_tr_b16 a[12:13], v19 offset:256
    v_mfma_f32_16x16x32_bf16 v[92:95], a[28:31], a[84:87], v[92:95]
    ds_read_b64_tr_b16 a[14:15], v19 offset:6400
    s_waitcnt lgkmcnt(6)
    v_mfma_f32_16x16x32_bf16 v[96:99], a[0:3], a[80:83], v[96:99]
    ds_read_b64_tr_b16 a[16:17], v16 offset:12288
    v_mfma_f32_16x16x32_bf16 v[100:103], a[0:3], a[84:87], v[100:103]
    ds_read_b64_tr_b16 a[18:19], v16 offset:18432
    s_waitcnt lgkmcnt(6)
    v_mfma_f32_16x16x32_bf16 v[104:107], a[4:7], a[80:83], v[104:107]
    ds_read_b64_tr_b16 a[20:21], v17 offset:12288
    v_mfma_f32_16x16x32_bf16 v[108:111], a[4:7], a[84:87], v[108:111]
    ds_read_b64_tr_b16 a[22:23], v17 offset:18432
    s_waitcnt lgkmcnt(6)
    v_mfma_f32_16x16x32_bf16 v[112:115], a[8:11], a[80:83], v[112:115]
    ds_read_b64_tr_b16 a[24:25], v18 offset:12288
    v_mfma_f32_16x16x32_bf16 v[116:119], a[8:11], a[84:87], v[116:119]
    ds_read_b64_tr_b16 a[26:27], v18 offset:18432
    s_waitcnt lgkmcnt(6)
    v_mfma_f32_16x16x32_bf16 v[120:123], a[12:15], a[80:83], v[120:123]
    ds_read_b64_tr_b16 a[28:29], v19 offset:12288
    v_mfma_f32_16x16x32_bf16 v[124:127], a[12:15], a[84:87], v[124:127]
    ds_read_b64_tr_b16 a[30:31], v19 offset:18432
    s_waitcnt vmcnt(8) lgkmcnt(6)
    v_mfma_f32_16x16x32_bf16 v[32:35], a[16:19], a[88:91], v[32:35]
    ds_read_b64_tr_b16 a[0:1], v16 offset:12416
    v_mfma_f32_16x16x32_bf16 v[36:39], a[16:19], a[92:95], v[36:39]
    ds_read_b64_tr_b16 a[2:3], v16 offset:18560
    s_add_u32 s42, s36, 18432
    s_waitcnt lgkmcnt(6)
    v_mfma_f32_16x16x32_bf16 v[40:43], a[20:23], a[88:91], v[40:43]
    ds_read_b64_tr_b16 a[4:5], v17 offset:12416
    buffer_load_dwordx4 a[80:83], v0, s[20:23], s42 offen
    s_add_u32 s42, s36, 165888
    v_mfma_f32_16x16x32_bf16 v[44:47], a[20:23], a[92:95], v[44:47]
    ds_read_b64_tr_b16 a[6:7], v17 offset:18560
    s_waitcnt lgkmcnt(6)
    v_mfma_f32_16x16x32_bf16 v[48:51], a[24:27], a[88:91], v[48:51]
    ds_read_b64_tr_b16 a[8:9], v18 offset:12416
    buffer_load_dwordx4 a[84:87], v0, s[20:23], s42 offen
    v_mfma_f32_16x16x32_bf16 v[52:55], a[24:27], a[92:95], v[52:55]
    ds_read_b64_tr_b16 a[10:11], v18 offset:18560
    s_waitcnt lgkmcnt(6)
    v_mfma_f32_16x16x32_bf16 v[56:59], a[28:31], a[88:91], v[56:59]
    ds_read_b64_tr_b16 a[12:13], v19 offset:12416
    v_mfma_f32_16x16x32_bf16 v[60:63], a[28:31], a[92:95], v[60:63]
    ds_read_b64_tr_b16 a[14:15], v19 offset:18560
    s_waitcnt lgkmcnt(6)
    v_mfma_f32_16x16x32_bf16 v[64:67], a[0:3], a[88:91], v[64:67]
    ds_read_b64_tr_b16 a[16:17], v16 offset:12544
    v_mfma_f32_16x16x32_bf16 v[68:71], a[0:3], a[92:95], v[68:71]
    ds_read_b64_tr_b16 a[18:19], v16 offset:18688
    s_waitcnt lgkmcnt(6)
    v_mfma_f32_16x16x32_bf16 v[72:75], a[4:7], a[88:91], v[72:75]
    ds_read_b64_tr_b16 a[20:21], v17 offset:12544
    v_mfma_f32_16x16x32_bf16 v[76:79], a[4:7], a[92:95], v[76:79]
    ds_read_b64_tr_b16 a[22:23], v17 offset:18688
    s_waitcnt lgkmcnt(6)
    v_mfma_f32_16x16x32_bf16 v[80:83], a[8:11], a[88:91], v[80:83]
    ds_read_b64_tr_b16 a[24:25], v18 offset:12544
    v_mfma_f32_16x16x32_bf16 v[84:87], a[8:11], a[92:95], v[84:87]
    ds_read_b64_tr_b16 a[26:27], v18 offset:18688
    s_waitcnt lgkmcnt(6)
    v_mfma_f32_16x16x32_bf16 v[88:91], a[12:15], a[88:91], v[88:91]
    ds_read_b64_tr_b16 a[28:29], v19 offset:12544
    v_mfma_f32_16x16x32_bf16 v[92:95], a[12:15], a[92:95], v[92:95]
    ds_read_b64_tr_b16 a[30:31], v19 offset:18688
    s_waitcnt lgkmcnt(6)
    v_mfma_f32_16x16x32_bf16 v[96:99], a[16:19], a[88:91], v[96:99]
    ds_read_b64_tr_b16 a[0:1], v16 offset:24576
    v_mfma_f32_16x16x32_bf16 v[100:103], a[16:19], a[92:95], v[100:103]
    ds_read_b64_tr_b16 a[2:3], v16 offset:30720
    s_waitcnt lgkmcnt(6)
    v_mfma_f32_16x16x32_bf16 v[104:107], a[20:23], a[88:91], v[104:107]
    ds_read_b64_tr_b16 a[4:5], v17 offset:24576
    v_mfma_f32_16x16x32_bf16 v[108:111], a[20:23], a[92:95], v[108:111]
    ds_read_b64_tr_b16 a[6:7], v17 offset:30720
    s_waitcnt lgkmcnt(6)
    v_mfma_f32_16x16x32_bf16 v[112:115], a[24:27], a[88:91], v[112:115]
    ds_read_b64_tr_b16 a[8:9], v18 offset:24576
    v_mfma_f32_16x16x32_bf16 v[116:119], a[24:27], a[92:95], v[116:119]
    ds_read_b64_tr_b16 a[10:11], v18 offset:30720
    s_waitcnt lgkmcnt(6)
    v_mfma_f32_16x16x32_bf16 v[120:123], a[28:31], a[88:91], v[120:123]
    ds_read_b64_tr_b16 a[12:13], v19 offset:24576
    v_mfma_f32_16x16x32_bf16 v[124:127], a[28:31], a[92:95], v[124:127]
    ds_read_b64_tr_b16 a[14:15], v19 offset:30720
    s_waitcnt vmcnt(8) lgkmcnt(6)
    v_mfma_f32_16x16x32_bf16 v[32:35], a[0:3], a[96:99], v[32:35]
    ds_read_b64_tr_b16 a[16:17], v16 offset:24704
    v_mfma_f32_16x16x32_bf16 v[36:39], a[0:3], a[100:103], v[36:39]
    ds_read_b64_tr_b16 a[18:19], v16 offset:30848
    s_add_u32 s42, s36, 19456
    s_waitcnt lgkmcnt(6)
    v_mfma_f32_16x16x32_bf16 v[40:43], a[4:7], a[96:99], v[40:43]
    ds_read_b64_tr_b16 a[20:21], v17 offset:24704
    buffer_load_dwordx4 a[88:91], v0, s[20:23], s42 offen
    s_add_u32 s42, s36, 166912
    v_mfma_f32_16x16x32_bf16 v[44:47], a[4:7], a[100:103], v[44:47]
    ds_read_b64_tr_b16 a[22:23], v17 offset:30848
    s_waitcnt lgkmcnt(6)
    v_mfma_f32_16x16x32_bf16 v[48:51], a[8:11], a[96:99], v[48:51]
    ds_read_b64_tr_b16 a[24:25], v18 offset:24704
    buffer_load_dwordx4 a[92:95], v0, s[20:23], s42 offen
    v_mfma_f32_16x16x32_bf16 v[52:55], a[8:11], a[100:103], v[52:55]
    ds_read_b64_tr_b16 a[26:27], v18 offset:30848
    s_waitcnt lgkmcnt(6)
    v_mfma_f32_16x16x32_bf16 v[56:59], a[12:15], a[96:99], v[56:59]
    ds_read_b64_tr_b16 a[28:29], v19 offset:24704
    v_mfma_f32_16x16x32_bf16 v[60:63], a[12:15], a[100:103], v[60:63]
    ds_read_b64_tr_b16 a[30:31], v19 offset:30848
    s_waitcnt lgkmcnt(6)
    v_mfma_f32_16x16x32_bf16 v[64:67], a[16:19], a[96:99], v[64:67]
    ds_read_b64_tr_b16 a[0:1], v16 offset:24832
    v_mfma_f32_16x16x32_bf16 v[68:71], a[16:19], a[100:103], v[68:71]
    ds_read_b64_tr_b16 a[2:3], v16 offset:30976
    s_waitcnt lgkmcnt(6)
    v_mfma_f32_16x16x32_bf16 v[72:75], a[20:23], a[96:99], v[72:75]
    ds_read_b64_tr_b16 a[4:5], v17 offset:24832
    v_mfma_f32_16x16x32_bf16 v[76:79], a[20:23], a[100:103], v[76:79]
    ds_read_b64_tr_b16 a[6:7], v17 offset:30976
    s_waitcnt lgkmcnt(6)
    v_mfma_f32_16x16x32_bf16 v[80:83], a[24:27], a[96:99], v[80:83]
    ds_read_b64_tr_b16 a[8:9], v18 offset:24832
    v_mfma_f32_16x16x32_bf16 v[84:87], a[24:27], a[100:103], v[84:87]
    ds_read_b64_tr_b16 a[10:11], v18 offset:30976
    s_waitcnt lgkmcnt(6)
    v_mfma_f32_16x16x32_bf16 v[88:91], a[28:31], a[96:99], v[88:91]
    ds_read_b64_tr_b16 a[12:13], v19 offset:24832
    v_mfma_f32_16x16x32_bf16 v[92:95], a[28:31], a[100:103], v[92:95]
    ds_read_b64_tr_b16 a[14:15], v19 offset:30976
    s_waitcnt lgkmcnt(6)
    v_mfma_f32_16x16x32_bf16 v[96:99], a[0:3], a[96:99], v[96:99]
    ds_read_b64_tr_b16 a[16:17], v16 offset:36864
    v_mfma_f32_16x16x32_bf16 v[100:103], a[0:3], a[100:103], v[100:103]
    ds_read_b64_tr_b16 a[18:19], v16 offset:43008
    s_waitcnt lgkmcnt(6)
    v_mfma_f32_16x16x32_bf16 v[104:107], a[4:7], a[96:99], v[104:107]
    ds_read_b64_tr_b16 a[20:21], v17 offset:36864
    v_mfma_f32_16x16x32_bf16 v[108:111], a[4:7], a[100:103], v[108:111]
    ds_read_b64_tr_b16 a[22:23], v17 offset:43008
    s_waitcnt lgkmcnt(6)
    v_mfma_f32_16x16x32_bf16 v[112:115], a[8:11], a[96:99], v[112:115]
    ds_read_b64_tr_b16 a[24:25], v18 offset:36864
    v_mfma_f32_16x16x32_bf16 v[116:119], a[8:11], a[100:103], v[116:119]
    ds_read_b64_tr_b16 a[26:27], v18 offset:43008
    s_waitcnt lgkmcnt(6)
    v_mfma_f32_16x16x32_bf16 v[120:123], a[12:15], a[96:99], v[120:123]
    ds_read_b64_tr_b16 a[28:29], v19 offset:36864
    v_mfma_f32_16x16x32_bf16 v[124:127], a[12:15], a[100:103], v[124:127]
    ds_read_b64_tr_b16 a[30:31], v19 offset:43008
    s_waitcnt vmcnt(8) lgkmcnt(6)
    v_mfma_f32_16x16x32_bf16 v[32:35], a[16:19], a[104:107], v[32:35]
    ds_read_b64_tr_b16 a[0:1], v16 offset:36992
    v_mfma_f32_16x16x32_bf16 v[36:39], a[16:19], a[108:111], v[36:39]
    ds_read_b64_tr_b16 a[2:3], v16 offset:43136
    s_add_u32 s42, s36, 20480
    s_waitcnt lgkmcnt(6)
    v_mfma_f32_16x16x32_bf16 v[40:43], a[20:23], a[104:107], v[40:43]
    ds_read_b64_tr_b16 a[4:5], v17 offset:36992
    buffer_load_dwordx4 a[96:99], v0, s[20:23], s42 offen
    s_add_u32 s42, s36, 167936
    v_mfma_f32_16x16x32_bf16 v[44:47], a[20:23], a[108:111], v[44:47]
    ds_read_b64_tr_b16 a[6:7], v17 offset:43136
    s_waitcnt lgkmcnt(6)
    v_mfma_f32_16x16x32_bf16 v[48:51], a[24:27], a[104:107], v[48:51]
    ds_read_b64_tr_b16 a[8:9], v18 offset:36992
    buffer_load_dwordx4 a[100:103], v0, s[20:23], s42 offen
    v_mfma_f32_16x16x32_bf16 v[52:55], a[24:27], a[108:111], v[52:55]
    ds_read_b64_tr_b16 a[10:11], v18 offset:43136
    s_waitcnt lgkmcnt(6)
    v_mfma_f32_16x16x32_bf16 v[56:59], a[28:31], a[104:107], v[56:59]
    ds_read_b64_tr_b16 a[12:13], v19 offset:36992
    v_mfma_f32_16x16x32_bf16 v[60:63], a[28:31], a[108:111], v[60:63]
    ds_read_b64_tr_b16 a[14:15], v19 offset:43136
    s_waitcnt lgkmcnt(6)
    v_mfma_f32_16x16x32_bf16 v[64:67], a[0:3], a[104:107], v[64:67]
    ds_read_b64_tr_b16 a[16:17], v16 offset:37120
    v_mfma_f32_16x16x32_bf16 v[68:71], a[0:3], a[108:111], v[68:71]
    ds_read_b64_tr_b16 a[18:19], v16 offset:43264
    s_waitcnt lgkmcnt(6)
    v_mfma_f32_16x16x32_bf16 v[72:75], a[4:7], a[104:107], v[72:75]
    ds_read_b64_tr_b16 a[20:21], v17 offset:37120
    v_mfma_f32_16x16x32_bf16 v[76:79], a[4:7], a[108:111], v[76:79]
    ds_read_b64_tr_b16 a[22:23], v17 offset:43264
    s_waitcnt lgkmcnt(6)
    v_mfma_f32_16x16x32_bf16 v[80:83], a[8:11], a[104:107], v[80:83]
    ds_read_b64_tr_b16 a[24:25], v18 offset:37120
    v_mfma_f32_16x16x32_bf16 v[84:87], a[8:11], a[108:111], v[84:87]
    ds_read_b64_tr_b16 a[26:27], v18 offset:43264
    s_waitcnt lgkmcnt(6)
    v_mfma_f32_16x16x32_bf16 v[88:91], a[12:15], a[104:107], v[88:91]
    ds_read_b64_tr_b16 a[28:29], v19 offset:37120
    v_mfma_f32_16x16x32_bf16 v[92:95], a[12:15], a[108:111], v[92:95]
    ds_read_b64_tr_b16 a[30:31], v19 offset:43264
    s_barrier
    s_waitcnt lgkmcnt(6)
    v_mfma_f32_16x16x32_bf16 v[96:99], a[16:19], a[104:107], v[96:99]
    ds_read_b64_tr_b16 a[0:1], v20 offset:0
    v_mfma_f32_16x16x32_bf16 v[100:103], a[16:19], a[108:111], v[100:103]
    ds_read_b64_tr_b16 a[2:3], v20 offset:6144
    s_waitcnt lgkmcnt(6)
    v_mfma_f32_16x16x32_bf16 v[104:107], a[20:23], a[104:107], v[104:107]
    ds_read_b64_tr_b16 a[4:5], v21 offset:0
    v_mfma_f32_16x16x32_bf16 v[108:111], a[20:23], a[108:111], v[108:111]
    ds_read_b64_tr_b16 a[6:7], v21 offset:6144
    s_waitcnt lgkmcnt(6)
    v_mfma_f32_16x16x32_bf16 v[112:115], a[24:27], a[104:107], v[112:115]
    ds_read_b64_tr_b16 a[8:9], v22 offset:0
    v_mfma_f32_16x16x32_bf16 v[116:119], a[24:27], a[108:111], v[116:119]
    ds_read_b64_tr_b16 a[10:11], v22 offset:6144
    s_waitcnt lgkmcnt(6)
    v_mfma_f32_16x16x32_bf16 v[120:123], a[28:31], a[104:107], v[120:123]
    ds_read_b64_tr_b16 a[12:13], v23 offset:0
    v_mfma_f32_16x16x32_bf16 v[124:127], a[28:31], a[108:111], v[124:127]
    ds_read_b64_tr_b16 a[14:15], v23 offset:6144
    s_waitcnt vmcnt(8) lgkmcnt(6)
    v_mfma_f32_16x16x32_bf16 v[32:35], a[0:3], a[112:115], v[32:35]
    ds_read_b64_tr_b16 a[16:17], v20 offset:128
    v_mfma_f32_16x16x32_bf16 v[36:39], a[0:3], a[116:119], v[36:39]
    ds_read_b64_tr_b16 a[18:19], v20 offset:6272
    s_add_u32 s42, s36, 21504
    s_waitcnt lgkmcnt(6)
    v_mfma_f32_16x16x32_bf16 v[40:43], a[4:7], a[112:115], v[40:43]
    ds_read_b64_tr_b16 a[20:21], v21 offset:128
    buffer_load_dwordx4 a[104:107], v0, s[20:23], s42 offen
    s_add_u32 s42, s36, 168960
    v_mfma_f32_16x16x32_bf16 v[44:47], a[4:7], a[116:119], v[44:47]
    ds_read_b64_tr_b16 a[22:23], v21 offset:6272
    s_waitcnt lgkmcnt(6)
    v_mfma_f32_16x16x32_bf16 v[48:51], a[8:11], a[112:115], v[48:51]
    ds_read_b64_tr_b16 a[24:25], v22 offset:128
    buffer_load_dwordx4 a[108:111], v0, s[20:23], s42 offen
    v_mfma_f32_16x16x32_bf16 v[52:55], a[8:11], a[116:119], v[52:55]
    ds_read_b64_tr_b16 a[26:27], v22 offset:6272
    s_waitcnt lgkmcnt(6)
    v_mfma_f32_16x16x32_bf16 v[56:59], a[12:15], a[112:115], v[56:59]
    ds_read_b64_tr_b16 a[28:29], v23 offset:128
    v_mfma_f32_16x16x32_bf16 v[60:63], a[12:15], a[116:119], v[60:63]
    ds_read_b64_tr_b16 a[30:31], v23 offset:6272
    s_waitcnt lgkmcnt(6)
    v_mfma_f32_16x16x32_bf16 v[64:67], a[16:19], a[112:115], v[64:67]
    ds_read_b64_tr_b16 a[0:1], v20 offset:256
    v_mfma_f32_16x16x32_bf16 v[68:71], a[16:19], a[116:119], v[68:71]
    ds_read_b64_tr_b16 a[2:3], v20 offset:6400
    s_waitcnt lgkmcnt(6)
    v_mfma_f32_16x16x32_bf16 v[72:75], a[20:23], a[112:115], v[72:75]
    ds_read_b64_tr_b16 a[4:5], v21 offset:256
    v_mfma_f32_16x16x32_bf16 v[76:79], a[20:23], a[116:119], v[76:79]
    ds_read_b64_tr_b16 a[6:7], v21 offset:6400
    s_waitcnt lgkmcnt(6)
    v_mfma_f32_16x16x32_bf16 v[80:83], a[24:27], a[112:115], v[80:83]
    ds_read_b64_tr_b16 a[8:9], v22 offset:256
    v_mfma_f32_16x16x32_bf16 v[84:87], a[24:27], a[116:119], v[84:87]
    ds_read_b64_tr_b16 a[10:11], v22 offset:6400
    s_waitcnt lgkmcnt(6)
    v_mfma_f32_16x16x32_bf16 v[88:91], a[28:31], a[112:115], v[88:91]
    ds_read_b64_tr_b16 a[12:13], v23 offset:256
    v_mfma_f32_16x16x32_bf16 v[92:95], a[28:31], a[116:119], v[92:95]
    ds_read_b64_tr_b16 a[14:15], v23 offset:6400
    s_waitcnt lgkmcnt(6)
    v_mfma_f32_16x16x32_bf16 v[96:99], a[0:3], a[112:115], v[96:99]
    ds_read_b64_tr_b16 a[16:17], v20 offset:12288
    v_mfma_f32_16x16x32_bf16 v[100:103], a[0:3], a[116:119], v[100:103]
    ds_read_b64_tr_b16 a[18:19], v20 offset:18432
    s_waitcnt lgkmcnt(6)
    v_mfma_f32_16x16x32_bf16 v[104:107], a[4:7], a[112:115], v[104:107]
    ds_read_b64_tr_b16 a[20:21], v21 offset:12288
    v_mfma_f32_16x16x32_bf16 v[108:111], a[4:7], a[116:119], v[108:111]
    ds_read_b64_tr_b16 a[22:23], v21 offset:18432
    s_waitcnt lgkmcnt(6)
    v_mfma_f32_16x16x32_bf16 v[112:115], a[8:11], a[112:115], v[112:115]
    ds_read_b64_tr_b16 a[24:25], v22 offset:12288
    v_mfma_f32_16x16x32_bf16 v[116:119], a[8:11], a[116:119], v[116:119]
    ds_read_b64_tr_b16 a[26:27], v22 offset:18432
    s_waitcnt lgkmcnt(6)
    v_mfma_f32_16x16x32_bf16 v[120:123], a[12:15], a[112:115], v[120:123]
    ds_read_b64_tr_b16 a[28:29], v23 offset:12288
    v_mfma_f32_16x16x32_bf16 v[124:127], a[12:15], a[116:119], v[124:127]
    ds_read_b64_tr_b16 a[30:31], v23 offset:18432
    s_waitcnt vmcnt(8) lgkmcnt(6)
    v_mfma_f32_16x16x32_bf16 v[32:35], a[16:19], a[120:123], v[32:35]
    ds_read_b64_tr_b16 a[0:1], v20 offset:12416
    v_mfma_f32_16x16x32_bf16 v[36:39], a[16:19], a[124:127], v[36:39]
    ds_read_b64_tr_b16 a[2:3], v20 offset:18560
    s_add_u32 s42, s36, 22528
    s_waitcnt lgkmcnt(6)
    v_mfma_f32_16x16x32_bf16 v[40:43], a[20:23], a[120:123], v[40:43]
    ds_read_b64_tr_b16 a[4:5], v21 offset:12416
    buffer_load_dwordx4 a[112:115], v0, s[20:23], s42 offen
    s_add_u32 s42, s36, 169984
    v_mfma_f32_16x16x32_bf16 v[44:47], a[20:23], a[124:127], v[44:47]
    ds_read_b64_tr_b16 a[6:7], v21 offset:18560
    s_waitcnt lgkmcnt(6)
    v_mfma_f32_16x16x32_bf16 v[48:51], a[24:27], a[120:123], v[48:51]
    ds_read_b64_tr_b16 a[8:9], v22 offset:12416
    buffer_load_dwordx4 a[116:119], v0, s[20:23], s42 offen
    v_mfma_f32_16x16x32_bf16 v[52:55], a[24:27], a[124:127], v[52:55]
    ds_read_b64_tr_b16 a[10:11], v22 offset:18560
    s_waitcnt lgkmcnt(6)
    v_mfma_f32_16x16x32_bf16 v[56:59], a[28:31], a[120:123], v[56:59]
    ds_read_b64_tr_b16 a[12:13], v23 offset:12416
    v_mfma_f32_16x16x32_bf16 v[60:63], a[28:31], a[124:127], v[60:63]
    ds_read_b64_tr_b16 a[14:15], v23 offset:18560
    s_waitcnt lgkmcnt(6)
    v_mfma_f32_16x16x32_bf16 v[64:67], a[0:3], a[120:123], v[64:67]
    ds_read_b64_tr_b16 a[16:17], v20 offset:12544
    v_mfma_f32_16x16x32_bf16 v[68:71], a[0:3], a[124:127], v[68:71]
    ds_read_b64_tr_b16 a[18:19], v20 offset:18688
    s_waitcnt lgkmcnt(6)
    v_mfma_f32_16x16x32_bf16 v[72:75], a[4:7], a[120:123], v[72:75]
    ds_read_b64_tr_b16 a[20:21], v21 offset:12544
    v_mfma_f32_16x16x32_bf16 v[76:79], a[4:7], a[124:127], v[76:79]
    ds_read_b64_tr_b16 a[22:23], v21 offset:18688
    s_waitcnt lgkmcnt(6)
    v_mfma_f32_16x16x32_bf16 v[80:83], a[8:11], a[120:123], v[80:83]
    ds_read_b64_tr_b16 a[24:25], v22 offset:12544
    v_mfma_f32_16x16x32_bf16 v[84:87], a[8:11], a[124:127], v[84:87]
    ds_read_b64_tr_b16 a[26:27], v22 offset:18688
    s_waitcnt lgkmcnt(6)
    v_mfma_f32_16x16x32_bf16 v[88:91], a[12:15], a[120:123], v[88:91]
    ds_read_b64_tr_b16 a[28:29], v23 offset:12544
    v_mfma_f32_16x16x32_bf16 v[92:95], a[12:15], a[124:127], v[92:95]
    ds_read_b64_tr_b16 a[30:31], v23 offset:18688
    s_waitcnt lgkmcnt(6)
    v_mfma_f32_16x16x32_bf16 v[96:99], a[16:19], a[120:123], v[96:99]
    ds_read_b64_tr_b16 a[0:1], v20 offset:24576
    v_mfma_f32_16x16x32_bf16 v[100:103], a[16:19], a[124:127], v[100:103]
    ds_read_b64_tr_b16 a[2:3], v20 offset:30720
    s_waitcnt lgkmcnt(6)
    v_mfma_f32_16x16x32_bf16 v[104:107], a[20:23], a[120:123], v[104:107]
    ds_read_b64_tr_b16 a[4:5], v21 offset:24576
    v_mfma_f32_16x16x32_bf16 v[108:111], a[20:23], a[124:127], v[108:111]
    ds_read_b64_tr_b16 a[6:7], v21 offset:30720
    s_waitcnt lgkmcnt(6)
    v_mfma_f32_16x16x32_bf16 v[112:115], a[24:27], a[120:123], v[112:115]
    ds_read_b64_tr_b16 a[8:9], v22 offset:24576
    v_mfma_f32_16x16x32_bf16 v[116:119], a[24:27], a[124:127], v[116:119]
    ds_read_b64_tr_b16 a[10:11], v22 offset:30720
    s_waitcnt lgkmcnt(6)
    v_mfma_f32_16x16x32_bf16 v[120:123], a[28:31], a[120:123], v[120:123]
    ds_read_b64_tr_b16 a[12:13], v23 offset:24576
    v_mfma_f32_16x16x32_bf16 v[124:127], a[28:31], a[124:127], v[124:127]
    ds_read_b64_tr_b16 a[14:15], v23 offset:30720
    s_waitcnt vmcnt(8) lgkmcnt(6)
    v_mfma_f32_16x16x32_bf16 v[32:35], a[0:3], a[80:83], v[32:35]
    ds_read_b64_tr_b16 a[16:17], v20 offset:24704
    v_mfma_f32_16x16x32_bf16 v[36:39], a[0:3], a[84:87], v[36:39]
    ds_read_b64_tr_b16 a[18:19], v20 offset:30848
    s_add_u32 s42, s36, 23552
    s_waitcnt lgkmcnt(6)
    v_mfma_f32_16x16x32_bf16 v[40:43], a[4:7], a[80:83], v[40:43]
    ds_read_b64_tr_b16 a[20:21], v21 offset:24704
    buffer_load_dwordx4 a[120:123], v0, s[20:23], s42 offen
    s_add_u32 s42, s36, 171008
    v_mfma_f32_16x16x32_bf16 v[44:47], a[4:7], a[84:87], v[44:47]
    ds_read_b64_tr_b16 a[22:23], v21 offset:30848
    s_waitcnt lgkmcnt(6)
    v_mfma_f32_16x16x32_bf16 v[48:51], a[8:11], a[80:83], v[48:51]
    ds_read_b64_tr_b16 a[24:25], v22 offset:24704
    buffer_load_dwordx4 a[124:127], v0, s[20:23], s42 offen
    v_mfma_f32_16x16x32_bf16 v[52:55], a[8:11], a[84:87], v[52:55]
    ds_read_b64_tr_b16 a[26:27], v22 offset:30848
    s_waitcnt lgkmcnt(6)
    v_mfma_f32_16x16x32_bf16 v[56:59], a[12:15], a[80:83], v[56:59]
    ds_read_b64_tr_b16 a[28:29], v23 offset:24704
    v_mfma_f32_16x16x32_bf16 v[60:63], a[12:15], a[84:87], v[60:63]
    ds_read_b64_tr_b16 a[30:31], v23 offset:30848
    s_waitcnt lgkmcnt(6)
    v_mfma_f32_16x16x32_bf16 v[64:67], a[16:19], a[80:83], v[64:67]
    ds_read_b64_tr_b16 a[0:1], v20 offset:24832
    v_mfma_f32_16x16x32_bf16 v[68:71], a[16:19], a[84:87], v[68:71]
    ds_read_b64_tr_b16 a[2:3], v20 offset:30976
    s_waitcnt lgkmcnt(6)
    v_mfma_f32_16x16x32_bf16 v[72:75], a[20:23], a[80:83], v[72:75]
    ds_read_b64_tr_b16 a[4:5], v21 offset:24832
    v_mfma_f32_16x16x32_bf16 v[76:79], a[20:23], a[84:87], v[76:79]
    ds_read_b64_tr_b16 a[6:7], v21 offset:30976
    s_waitcnt lgkmcnt(6)
    v_mfma_f32_16x16x32_bf16 v[80:83], a[24:27], a[80:83], v[80:83]
    ds_read_b64_tr_b16 a[8:9], v22 offset:24832
    v_mfma_f32_16x16x32_bf16 v[84:87], a[24:27], a[84:87], v[84:87]
    ds_read_b64_tr_b16 a[10:11], v22 offset:30976
    s_waitcnt lgkmcnt(6)
    v_mfma_f32_16x16x32_bf16 v[88:91], a[28:31], a[80:83], v[88:91]
    ds_read_b64_tr_b16 a[12:13], v23 offset:24832
    v_mfma_f32_16x16x32_bf16 v[92:95], a[28:31], a[84:87], v[92:95]
    ds_read_b64_tr_b16 a[14:15], v23 offset:30976
    s_waitcnt lgkmcnt(6)
    v_mfma_f32_16x16x32_bf16 v[96:99], a[0:3], a[80:83], v[96:99]
    ds_read_b64_tr_b16 a[16:17], v20 offset:36864
    v_mfma_f32_16x16x32_bf16 v[100:103], a[0:3], a[84:87], v[100:103]
    ds_read_b64_tr_b16 a[18:19], v20 offset:43008
    s_waitcnt lgkmcnt(6)
    v_mfma_f32_16x16x32_bf16 v[104:107], a[4:7], a[80:83], v[104:107]
    ds_read_b64_tr_b16 a[20:21], v21 offset:36864
    v_mfma_f32_16x16x32_bf16 v[108:111], a[4:7], a[84:87], v[108:111]
    ds_read_b64_tr_b16 a[22:23], v21 offset:43008
    s_waitcnt lgkmcnt(6)
    v_mfma_f32_16x16x32_bf16 v[112:115], a[8:11], a[80:83], v[112:115]
    ds_read_b64_tr_b16 a[24:25], v22 offset:36864
    v_mfma_f32_16x16x32_bf16 v[116:119], a[8:11], a[84:87], v[116:119]
    ds_read_b64_tr_b16 a[26:27], v22 offset:43008
    s_waitcnt lgkmcnt(6)
    v_mfma_f32_16x16x32_bf16 v[120:123], a[12:15], a[80:83], v[120:123]
    ds_read_b64_tr_b16 a[28:29], v23 offset:36864
    v_mfma_f32_16x16x32_bf16 v[124:127], a[12:15], a[84:87], v[124:127]
    ds_read_b64_tr_b16 a[30:31], v23 offset:43008
    s_waitcnt vmcnt(8) lgkmcnt(6)
    v_mfma_f32_16x16x32_bf16 v[32:35], a[16:19], a[88:91], v[32:35]
    ds_read_b64_tr_b16 a[0:1], v20 offset:36992
    v_mfma_f32_16x16x32_bf16 v[36:39], a[16:19], a[92:95], v[36:39]
    ds_read_b64_tr_b16 a[2:3], v20 offset:43136
    s_add_u32 s42, s36, 24576
    s_waitcnt lgkmcnt(6)
    v_mfma_f32_16x16x32_bf16 v[40:43], a[20:23], a[88:91], v[40:43]
    ds_read_b64_tr_b16 a[4:5], v21 offset:36992
    buffer_load_dwordx4 a[80:83], v0, s[20:23], s42 offen
    s_add_u32 s42, s36, 172032
    v_mfma_f32_16x16x32_bf16 v[44:47], a[20:23], a[92:95], v[44:47]
    ds_read_b64_tr_b16 a[6:7], v21 offset:43136
    s_waitcnt lgkmcnt(6)
    v_mfma_f32_16x16x32_bf16 v[48:51], a[24:27], a[88:91], v[48:51]
    ds_read_b64_tr_b16 a[8:9], v22 offset:36992
    buffer_load_dwordx4 a[84:87], v0, s[20:23], s42 offen
    v_mfma_f32_16x16x32_bf16 v[52:55], a[24:27], a[92:95], v[52:55]
    ds_read_b64_tr_b16 a[10:11], v22 offset:43136
    s_waitcnt lgkmcnt(6)
    v_mfma_f32_16x16x32_bf16 v[56:59], a[28:31], a[88:91], v[56:59]
    ds_read_b64_tr_b16 a[12:13], v23 offset:36992
    v_mfma_f32_16x16x32_bf16 v[60:63], a[28:31], a[92:95], v[60:63]
    ds_read_b64_tr_b16 a[14:15], v23 offset:43136
    s_waitcnt lgkmcnt(6)
    v_mfma_f32_16x16x32_bf16 v[64:67], a[0:3], a[88:91], v[64:67]
    ds_read_b64_tr_b16 a[16:17], v20 offset:37120
    v_mfma_f32_16x16x32_bf16 v[68:71], a[0:3], a[92:95], v[68:71]
    ds_read_b64_tr_b16 a[18:19], v20 offset:43264
    s_waitcnt lgkmcnt(6)
    v_mfma_f32_16x16x32_bf16 v[72:75], a[4:7], a[88:91], v[72:75]
    ds_read_b64_tr_b16 a[20:21], v21 offset:37120
    v_mfma_f32_16x16x32_bf16 v[76:79], a[4:7], a[92:95], v[76:79]
    ds_read_b64_tr_b16 a[22:23], v21 offset:43264
    s_waitcnt lgkmcnt(6)
    v_mfma_f32_16x16x32_bf16 v[80:83], a[8:11], a[88:91], v[80:83]
    ds_read_b64_tr_b16 a[24:25], v22 offset:37120
    v_mfma_f32_16x16x32_bf16 v[84:87], a[8:11], a[92:95], v[84:87]
    ds_read_b64_tr_b16 a[26:27], v22 offset:43264
    s_waitcnt lgkmcnt(6)
    v_mfma_f32_16x16x32_bf16 v[88:91], a[12:15], a[88:91], v[88:91]
    ds_read_b64_tr_b16 a[28:29], v23 offset:37120
    v_mfma_f32_16x16x32_bf16 v[92:95], a[12:15], a[92:95], v[92:95]
    ds_read_b64_tr_b16 a[30:31], v23 offset:43264
    s_barrier
    s_waitcnt lgkmcnt(6)
    v_mfma_f32_16x16x32_bf16 v[96:99], a[16:19], a[88:91], v[96:99]
    ds_read_b64_tr_b16 a[0:1], v24 offset:0
    v_mfma_f32_16x16x32_bf16 v[100:103], a[16:19], a[92:95], v[100:103]
    ds_read_b64_tr_b16 a[2:3], v24 offset:6144
    s_waitcnt lgkmcnt(6)
    v_mfma_f32_16x16x32_bf16 v[104:107], a[20:23], a[88:91], v[104:107]
    ds_read_b64_tr_b16 a[4:5], v25 offset:0
    v_mfma_f32_16x16x32_bf16 v[108:111], a[20:23], a[92:95], v[108:111]
    ds_read_b64_tr_b16 a[6:7], v25 offset:6144
    s_waitcnt lgkmcnt(6)
    v_mfma_f32_16x16x32_bf16 v[112:115], a[24:27], a[88:91], v[112:115]
    ds_read_b64_tr_b16 a[8:9], v26 offset:0
    v_mfma_f32_16x16x32_bf16 v[116:119], a[24:27], a[92:95], v[116:119]
    ds_read_b64_tr_b16 a[10:11], v26 offset:6144
    s_waitcnt lgkmcnt(6)
    v_mfma_f32_16x16x32_bf16 v[120:123], a[28:31], a[88:91], v[120:123]
    ds_read_b64_tr_b16 a[12:13], v27 offset:0
    v_mfma_f32_16x16x32_bf16 v[124:127], a[28:31], a[92:95], v[124:127]
    ds_read_b64_tr_b16 a[14:15], v27 offset:6144
    s_waitcnt vmcnt(8) lgkmcnt(6)
    v_mfma_f32_16x16x32_bf16 v[32:35], a[0:3], a[96:99], v[32:35]
    ds_read_b64_tr_b16 a[16:17], v24 offset:128
    v_mfma_f32_16x16x32_bf16 v[36:39], a[0:3], a[100:103], v[36:39]
    ds_read_b64_tr_b16 a[18:19], v24 offset:6272
    s_add_u32 s42, s36, 25600
    s_waitcnt lgkmcnt(6)
    v_mfma_f32_16x16x32_bf16 v[40:43], a[4:7], a[96:99], v[40:43]
    ds_read_b64_tr_b16 a[20:21], v25 offset:128
    buffer_load_dwordx4 a[88:91], v0, s[20:23], s42 offen
    s_add_u32 s42, s36, 173056
    v_mfma_f32_16x16x32_bf16 v[44:47], a[4:7], a[100:103], v[44:47]
    ds_read_b64_tr_b16 a[22:23], v25 offset:6272
    s_waitcnt lgkmcnt(6)
    v_mfma_f32_16x16x32_bf16 v[48:51], a[8:11], a[96:99], v[48:51]
    ds_read_b64_tr_b16 a[24:25], v26 offset:128
    buffer_load_dwordx4 a[92:95], v0, s[20:23], s42 offen
    v_mfma_f32_16x16x32_bf16 v[52:55], a[8:11], a[100:103], v[52:55]
    ds_read_b64_tr_b16 a[26:27], v26 offset:6272
    s_waitcnt lgkmcnt(6)
    v_mfma_f32_16x16x32_bf16 v[56:59], a[12:15], a[96:99], v[56:59]
    ds_read_b64_tr_b16 a[28:29], v27 offset:128
    v_mfma_f32_16x16x32_bf16 v[60:63], a[12:15], a[100:103], v[60:63]
    ds_read_b64_tr_b16 a[30:31], v27 offset:6272
    s_waitcnt lgkmcnt(6)
    v_mfma_f32_16x16x32_bf16 v[64:67], a[16:19], a[96:99], v[64:67]
    ds_read_b64_tr_b16 a[0:1], v24 offset:256
    v_mfma_f32_16x16x32_bf16 v[68:71], a[16:19], a[100:103], v[68:71]
    ds_read_b64_tr_b16 a[2:3], v24 offset:6400
    s_waitcnt lgkmcnt(6)
    v_mfma_f32_16x16x32_bf16 v[72:75], a[20:23], a[96:99], v[72:75]
    ds_read_b64_tr_b16 a[4:5], v25 offset:256
    v_mfma_f32_16x16x32_bf16 v[76:79], a[20:23], a[100:103], v[76:79]
    ds_read_b64_tr_b16 a[6:7], v25 offset:6400
    s_waitcnt lgkmcnt(6)
    v_mfma_f32_16x16x32_bf16 v[80:83], a[24:27], a[96:99], v[80:83]
    ds_read_b64_tr_b16 a[8:9], v26 offset:256
    v_mfma_f32_16x16x32_bf16 v[84:87], a[24:27], a[100:103], v[84:87]
    ds_read_b64_tr_b16 a[10:11], v26 offset:6400
    s_waitcnt lgkmcnt(6)
    v_mfma_f32_16x16x32_bf16 v[88:91], a[28:31], a[96:99], v[88:91]
    ds_read_b64_tr_b16 a[12:13], v27 offset:256
    v_mfma_f32_16x16x32_bf16 v[92:95], a[28:31], a[100:103], v[92:95]
    ds_read_b64_tr_b16 a[14:15], v27 offset:6400
    s_waitcnt lgkmcnt(6)
    v_mfma_f32_16x16x32_bf16 v[96:99], a[0:3], a[96:99], v[96:99]
    ds_read_b64_tr_b16 a[16:17], v24 offset:12288
    v_mfma_f32_16x16x32_bf16 v[100:103], a[0:3], a[100:103], v[100:103]
    ds_read_b64_tr_b16 a[18:19], v24 offset:18432
    s_waitcnt lgkmcnt(6)
    v_mfma_f32_16x16x32_bf16 v[104:107], a[4:7], a[96:99], v[104:107]
    ds_read_b64_tr_b16 a[20:21], v25 offset:12288
    v_mfma_f32_16x16x32_bf16 v[108:111], a[4:7], a[100:103], v[108:111]
    ds_read_b64_tr_b16 a[22:23], v25 offset:18432
    s_waitcnt lgkmcnt(6)
    v_mfma_f32_16x16x32_bf16 v[112:115], a[8:11], a[96:99], v[112:115]
    ds_read_b64_tr_b16 a[24:25], v26 offset:12288
    v_mfma_f32_16x16x32_bf16 v[116:119], a[8:11], a[100:103], v[116:119]
    ds_read_b64_tr_b16 a[26:27], v26 offset:18432
    s_waitcnt lgkmcnt(6)
    v_mfma_f32_16x16x32_bf16 v[120:123], a[12:15], a[96:99], v[120:123]
    ds_read_b64_tr_b16 a[28:29], v27 offset:12288
    v_mfma_f32_16x16x32_bf16 v[124:127], a[12:15], a[100:103], v[124:127]
    ds_read_b64_tr_b16 a[30:31], v27 offset:18432
    s_waitcnt vmcnt(8) lgkmcnt(6)
    v_mfma_f32_16x16x32_bf16 v[32:35], a[16:19], a[104:107], v[32:35]
    ds_read_b64_tr_b16 a[0:1], v24 offset:12416
    v_mfma_f32_16x16x32_bf16 v[36:39], a[16:19], a[108:111], v[36:39]
    ds_read_b64_tr_b16 a[2:3], v24 offset:18560
    s_add_u32 s42, s36, 26624
    s_waitcnt lgkmcnt(6)
    v_mfma_f32_16x16x32_bf16 v[40:43], a[20:23], a[104:107], v[40:43]
    ds_read_b64_tr_b16 a[4:5], v25 offset:12416
    buffer_load_dwordx4 a[96:99], v0, s[20:23], s42 offen
    s_add_u32 s42, s36, 174080
    v_mfma_f32_16x16x32_bf16 v[44:47], a[20:23], a[108:111], v[44:47]
    ds_read_b64_tr_b16 a[6:7], v25 offset:18560
    s_waitcnt lgkmcnt(6)
    v_mfma_f32_16x16x32_bf16 v[48:51], a[24:27], a[104:107], v[48:51]
    ds_read_b64_tr_b16 a[8:9], v26 offset:12416
    buffer_load_dwordx4 a[100:103], v0, s[20:23], s42 offen
    v_mfma_f32_16x16x32_bf16 v[52:55], a[24:27], a[108:111], v[52:55]
    ds_read_b64_tr_b16 a[10:11], v26 offset:18560
    s_waitcnt lgkmcnt(6)
    v_mfma_f32_16x16x32_bf16 v[56:59], a[28:31], a[104:107], v[56:59]
    ds_read_b64_tr_b16 a[12:13], v27 offset:12416
    v_mfma_f32_16x16x32_bf16 v[60:63], a[28:31], a[108:111], v[60:63]
    ds_read_b64_tr_b16 a[14:15], v27 offset:18560
    s_waitcnt lgkmcnt(6)
    v_mfma_f32_16x16x32_bf16 v[64:67], a[0:3], a[104:107], v[64:67]
    ds_read_b64_tr_b16 a[16:17], v24 offset:12544
    v_mfma_f32_16x16x32_bf16 v[68:71], a[0:3], a[108:111], v[68:71]
    ds_read_b64_tr_b16 a[18:19], v24 offset:18688
    s_waitcnt lgkmcnt(6)
    v_mfma_f32_16x16x32_bf16 v[72:75], a[4:7], a[104:107], v[72:75]
    ds_read_b64_tr_b16 a[20:21], v25 offset:12544
    v_mfma_f32_16x16x32_bf16 v[76:79], a[4:7], a[108:111], v[76:79]
    ds_read_b64_tr_b16 a[22:23], v25 offset:18688
    s_waitcnt lgkmcnt(6)
    v_mfma_f32_16x16x32_bf16 v[80:83], a[8:11], a[104:107], v[80:83]
    ds_read_b64_tr_b16 a[24:25], v26 offset:12544
    v_mfma_f32_16x16x32_bf16 v[84:87], a[8:11], a[108:111], v[84:87]
    ds_read_b64_tr_b16 a[26:27], v26 offset:18688
    s_waitcnt lgkmcnt(6)
    v_mfma_f32_16x16x32_bf16 v[88:91], a[12:15], a[104:107], v[88:91]
    ds_read_b64_tr_b16 a[28:29], v27 offset:12544
    v_mfma_f32_16x16x32_bf16 v[92:95], a[12:15], a[108:111], v[92:95]
    ds_read_b64_tr_b16 a[30:31], v27 offset:18688
    s_waitcnt lgkmcnt(6)
    v_mfma_f32_16x16x32_bf16 v[96:99], a[16:19], a[104:107], v[96:99]
    ds_read_b64_tr_b16 a[0:1], v24 offset:24576
    v_mfma_f32_16x16x32_bf16 v[100:103], a[16:19], a[108:111], v[100:103]
    ds_read_b64_tr_b16 a[2:3], v24 offset:30720
    s_waitcnt lgkmcnt(6)
    v_mfma_f32_16x16x32_bf16 v[104:107], a[20:23], a[104:107], v[104:107]
    ds_read_b64_tr_b16 a[4:5], v25 offset:24576
    v_mfma_f32_16x16x32_bf16 v[108:111], a[20:23], a[108:111], v[108:111]
    ds_read_b64_tr_b16 a[6:7], v25 offset:30720
    s_waitcnt lgkmcnt(6)
    v_mfma_f32_16x16x32_bf16 v[112:115], a[24:27], a[104:107], v[112:115]
    ds_read_b64_tr_b16 a[8:9], v26 offset:24576
    v_mfma_f32_16x16x32_bf16 v[116:119], a[24:27], a[108:111], v[116:119]
    ds_read_b64_tr_b16 a[10:11], v26 offset:30720
    s_waitcnt lgkmcnt(6)
    v_mfma_f32_16x16x32_bf16 v[120:123], a[28:31], a[104:107], v[120:123]
    ds_read_b64_tr_b16 a[12:13], v27 offset:24576
    v_mfma_f32_16x16x32_bf16 v[124:127], a[28:31], a[108:111], v[124:127]
    ds_read_b64_tr_b16 a[14:15], v27 offset:30720
    s_waitcnt vmcnt(8) lgkmcnt(6)
    v_mfma_f32_16x16x32_bf16 v[32:35], a[0:3], a[112:115], v[32:35]
    ds_read_b64_tr_b16 a[16:17], v24 offset:24704
    v_mfma_f32_16x16x32_bf16 v[36:39], a[0:3], a[116:119], v[36:39]
    ds_read_b64_tr_b16 a[18:19], v24 offset:30848
    s_add_u32 s42, s36, 27648
    s_waitcnt lgkmcnt(6)
    v_mfma_f32_16x16x32_bf16 v[40:43], a[4:7], a[112:115], v[40:43]
    ds_read_b64_tr_b16 a[20:21], v25 offset:24704
    buffer_load_dwordx4 a[104:107], v0, s[20:23], s42 offen
    s_add_u32 s42, s36, 175104
    v_mfma_f32_16x16x32_bf16 v[44:47], a[4:7], a[116:119], v[44:47]
    ds_read_b64_tr_b16 a[22:23], v25 offset:30848
    s_waitcnt lgkmcnt(6)
    v_mfma_f32_16x16x32_bf16 v[48:51], a[8:11], a[112:115], v[48:51]
    ds_read_b64_tr_b16 a[24:25], v26 offset:24704
    buffer_load_dwordx4 a[108:111], v0, s[20:23], s42 offen
    v_mfma_f32_16x16x32_bf16 v[52:55], a[8:11], a[116:119], v[52:55]
    ds_read_b64_tr_b16 a[26:27], v26 offset:30848
    s_waitcnt lgkmcnt(6)
    v_mfma_f32_16x16x32_bf16 v[56:59], a[12:15], a[112:115], v[56:59]
    ds_read_b64_tr_b16 a[28:29], v27 offset:24704
    v_mfma_f32_16x16x32_bf16 v[60:63], a[12:15], a[116:119], v[60:63]
    ds_read_b64_tr_b16 a[30:31], v27 offset:30848
    s_waitcnt lgkmcnt(6)
    v_mfma_f32_16x16x32_bf16 v[64:67], a[16:19], a[112:115], v[64:67]
    ds_read_b64_tr_b16 a[0:1], v24 offset:24832
    v_mfma_f32_16x16x32_bf16 v[68:71], a[16:19], a[116:119], v[68:71]
    ds_read_b64_tr_b16 a[2:3], v24 offset:30976
    s_waitcnt lgkmcnt(6)
    v_mfma_f32_16x16x32_bf16 v[72:75], a[20:23], a[112:115], v[72:75]
    ds_read_b64_tr_b16 a[4:5], v25 offset:24832
    v_mfma_f32_16x16x32_bf16 v[76:79], a[20:23], a[116:119], v[76:79]
    ds_read_b64_tr_b16 a[6:7], v25 offset:30976
    s_waitcnt lgkmcnt(6)
    v_mfma_f32_16x16x32_bf16 v[80:83], a[24:27], a[112:115], v[80:83]
    ds_read_b64_tr_b16 a[8:9], v26 offset:24832
    v_mfma_f32_16x16x32_bf16 v[84:87], a[24:27], a[116:119], v[84:87]
    ds_read_b64_tr_b16 a[10:11], v26 offset:30976
    s_waitcnt lgkmcnt(6)
    v_mfma_f32_16x16x32_bf16 v[88:91], a[28:31], a[112:115], v[88:91]
    ds_read_b64_tr_b16 a[12:13], v27 offset:24832
    v_mfma_f32_16x16x32_bf16 v[92:95], a[28:31], a[116:119], v[92:95]
    ds_read_b64_tr_b16 a[14:15], v27 offset:30976
    s_waitcnt lgkmcnt(6)
    v_mfma_f32_16x16x32_bf16 v[96:99], a[0:3], a[112:115], v[96:99]
    ds_read_b64_tr_b16 a[16:17], v24 offset:36864
    v_mfma_f32_16x16x32_bf16 v[100:103], a[0:3], a[116:119], v[100:103]
    ds_read_b64_tr_b16 a[18:19], v24 offset:43008
    s_waitcnt lgkmcnt(6)
    v_mfma_f32_16x16x32_bf16 v[104:107], a[4:7], a[112:115], v[104:107]
    ds_read_b64_tr_b16 a[20:21], v25 offset:36864
    v_mfma_f32_16x16x32_bf16 v[108:111], a[4:7], a[116:119], v[108:111]
    ds_read_b64_tr_b16 a[22:23], v25 offset:43008
    s_waitcnt lgkmcnt(6)
    v_mfma_f32_16x16x32_bf16 v[112:115], a[8:11], a[112:115], v[112:115]
    ds_read_b64_tr_b16 a[24:25], v26 offset:36864
    v_mfma_f32_16x16x32_bf16 v[116:119], a[8:11], a[116:119], v[116:119]
    ds_read_b64_tr_b16 a[26:27], v26 offset:43008
    s_waitcnt lgkmcnt(6)
    v_mfma_f32_16x16x32_bf16 v[120:123], a[12:15], a[112:115], v[120:123]
    ds_read_b64_tr_b16 a[28:29], v27 offset:36864
    v_mfma_f32_16x16x32_bf16 v[124:127], a[12:15], a[116:119], v[124:127]
    ds_read_b64_tr_b16 a[30:31], v27 offset:43008
    s_waitcnt vmcnt(8) lgkmcnt(6)
    v_mfma_f32_16x16x32_bf16 v[32:35], a[16:19], a[120:123], v[32:35]
    ds_read_b64_tr_b16 a[0:1], v24 offset:36992
    v_mfma_f32_16x16x32_bf16 v[36:39], a[16:19], a[124:127], v[36:39]
    ds_read_b64_tr_b16 a[2:3], v24 offset:43136
    s_add_u32 s42, s36, 28672
    s_waitcnt lgkmcnt(6)
    v_mfma_f32_16x16x32_bf16 v[40:43], a[20:23], a[120:123], v[40:43]
    ds_read_b64_tr_b16 a[4:5], v25 offset:36992
    buffer_load_dwordx4 a[112:115], v0, s[20:23], s42 offen
    s_add_u32 s42, s36, 176128
    v_mfma_f32_16x16x32_bf16 v[44:47], a[20:23], a[124:127], v[44:47]
    ds_read_b64_tr_b16 a[6:7], v25 offset:43136
    s_waitcnt lgkmcnt(6)
    v_mfma_f32_16x16x32_bf16 v[48:51], a[24:27], a[120:123], v[48:51]
    ds_read_b64_tr_b16 a[8:9], v26 offset:36992
    buffer_load_dwordx4 a[116:119], v0, s[20:23], s42 offen
    v_mfma_f32_16x16x32_bf16 v[52:55], a[24:27], a[124:127], v[52:55]
    ds_read_b64_tr_b16 a[10:11], v26 offset:43136
    s_waitcnt lgkmcnt(6)
    v_mfma_f32_16x16x32_bf16 v[56:59], a[28:31], a[120:123], v[56:59]
    ds_read_b64_tr_b16 a[12:13], v27 offset:36992
    v_mfma_f32_16x16x32_bf16 v[60:63], a[28:31], a[124:127], v[60:63]
    ds_read_b64_tr_b16 a[14:15], v27 offset:43136
    s_waitcnt lgkmcnt(6)
    v_mfma_f32_16x16x32_bf16 v[64:67], a[0:3], a[120:123], v[64:67]
    ds_read_b64_tr_b16 a[16:17], v24 offset:37120
    v_mfma_f32_16x16x32_bf16 v[68:71], a[0:3], a[124:127], v[68:71]
    ds_read_b64_tr_b16 a[18:19], v24 offset:43264
    s_waitcnt lgkmcnt(6)
    v_mfma_f32_16x16x32_bf16 v[72:75], a[4:7], a[120:123], v[72:75]
    ds_read_b64_tr_b16 a[20:21], v25 offset:37120
    v_mfma_f32_16x16x32_bf16 v[76:79], a[4:7], a[124:127], v[76:79]
    ds_read_b64_tr_b16 a[22:23], v25 offset:43264
    s_waitcnt lgkmcnt(6)
    v_mfma_f32_16x16x32_bf16 v[80:83], a[8:11], a[120:123], v[80:83]
    ds_read_b64_tr_b16 a[24:25], v26 offset:37120
    v_mfma_f32_16x16x32_bf16 v[84:87], a[8:11], a[124:127], v[84:87]
    ds_read_b64_tr_b16 a[26:27], v26 offset:43264
    s_waitcnt lgkmcnt(6)
    v_mfma_f32_16x16x32_bf16 v[88:91], a[12:15], a[120:123], v[88:91]
    ds_read_b64_tr_b16 a[28:29], v27 offset:37120
    v_mfma_f32_16x16x32_bf16 v[92:95], a[12:15], a[124:127], v[92:95]
    ds_read_b64_tr_b16 a[30:31], v27 offset:43264
    s_barrier
    s_waitcnt lgkmcnt(6)
    v_mfma_f32_16x16x32_bf16 v[96:99], a[16:19], a[120:123], v[96:99]
    ds_read_b64_tr_b16 a[0:1], v16 offset:0
    v_mfma_f32_16x16x32_bf16 v[100:103], a[16:19], a[124:127], v[100:103]
    ds_read_b64_tr_b16 a[2:3], v16 offset:6144
    s_waitcnt lgkmcnt(6)
    v_mfma_f32_16x16x32_bf16 v[104:107], a[20:23], a[120:123], v[104:107]
    ds_read_b64_tr_b16 a[4:5], v17 offset:0
    v_mfma_f32_16x16x32_bf16 v[108:111], a[20:23], a[124:127], v[108:111]
    ds_read_b64_tr_b16 a[6:7], v17 offset:6144
    s_waitcnt lgkmcnt(6)
    v_mfma_f32_16x16x32_bf16 v[112:115], a[24:27], a[120:123], v[112:115]
    ds_read_b64_tr_b16 a[8:9], v18 offset:0
    v_mfma_f32_16x16x32_bf16 v[116:119], a[24:27], a[124:127], v[116:119]
    ds_read_b64_tr_b16 a[10:11], v18 offset:6144
    s_waitcnt lgkmcnt(6)
    v_mfma_f32_16x16x32_bf16 v[120:123], a[28:31], a[120:123], v[120:123]
    ds_read_b64_tr_b16 a[12:13], v19 offset:0
    v_mfma_f32_16x16x32_bf16 v[124:127], a[28:31], a[124:127], v[124:127]
    ds_read_b64_tr_b16 a[14:15], v19 offset:6144
    s_waitcnt vmcnt(8) lgkmcnt(6)
    v_mfma_f32_16x16x32_bf16 v[32:35], a[0:3], a[80:83], v[32:35]
    ds_read_b64_tr_b16 a[16:17], v16 offset:128
    v_mfma_f32_16x16x32_bf16 v[36:39], a[0:3], a[84:87], v[36:39]
    ds_read_b64_tr_b16 a[18:19], v16 offset:6272
    s_add_u32 s42, s36, 29696
    s_waitcnt lgkmcnt(6)
    v_mfma_f32_16x16x32_bf16 v[40:43], a[4:7], a[80:83], v[40:43]
    ds_read_b64_tr_b16 a[20:21], v17 offset:128
    buffer_load_dwordx4 a[120:123], v0, s[20:23], s42 offen
    s_add_u32 s42, s36, 177152
    v_mfma_f32_16x16x32_bf16 v[44:47], a[4:7], a[84:87], v[44:47]
    ds_read_b64_tr_b16 a[22:23], v17 offset:6272
    s_waitcnt lgkmcnt(6)
    v_mfma_f32_16x16x32_bf16 v[48:51], a[8:11], a[80:83], v[48:51]
    ds_read_b64_tr_b16 a[24:25], v18 offset:128
    buffer_load_dwordx4 a[124:127], v0, s[20:23], s42 offen
    v_mfma_f32_16x16x32_bf16 v[52:55], a[8:11], a[84:87], v[52:55]
    ds_read_b64_tr_b16 a[26:27], v18 offset:6272
    s_waitcnt lgkmcnt(6)
    v_mfma_f32_16x16x32_bf16 v[56:59], a[12:15], a[80:83], v[56:59]
    ds_read_b64_tr_b16 a[28:29], v19 offset:128
    v_mfma_f32_16x16x32_bf16 v[60:63], a[12:15], a[84:87], v[60:63]
    ds_read_b64_tr_b16 a[30:31], v19 offset:6272
    s_waitcnt lgkmcnt(6)
    v_mfma_f32_16x16x32_bf16 v[64:67], a[16:19], a[80:83], v[64:67]
    ds_read_b64_tr_b16 a[0:1], v16 offset:256
    v_mfma_f32_16x16x32_bf16 v[68:71], a[16:19], a[84:87], v[68:71]
    ds_read_b64_tr_b16 a[2:3], v16 offset:6400
    s_waitcnt lgkmcnt(6)
    v_mfma_f32_16x16x32_bf16 v[72:75], a[20:23], a[80:83], v[72:75]
    ds_read_b64_tr_b16 a[4:5], v17 offset:256
    v_mfma_f32_16x16x32_bf16 v[76:79], a[20:23], a[84:87], v[76:79]
    ds_read_b64_tr_b16 a[6:7], v17 offset:6400
    s_waitcnt lgkmcnt(6)
    v_mfma_f32_16x16x32_bf16 v[80:83], a[24:27], a[80:83], v[80:83]
    ds_read_b64_tr_b16 a[8:9], v18 offset:256
    v_mfma_f32_16x16x32_bf16 v[84:87], a[24:27], a[84:87], v[84:87]
    ds_read_b64_tr_b16 a[10:11], v18 offset:6400
    s_waitcnt lgkmcnt(6)
    v_mfma_f32_16x16x32_bf16 v[88:91], a[28:31], a[80:83], v[88:91]
    ds_read_b64_tr_b16 a[12:13], v19 offset:256
    v_mfma_f32_16x16x32_bf16 v[92:95], a[28:31], a[84:87], v[92:95]
    ds_read_b64_tr_b16 a[14:15], v19 offset:6400
    s_waitcnt lgkmcnt(6)
    v_mfma_f32_16x16x32_bf16 v[96:99], a[0:3], a[80:83], v[96:99]
    ds_read_b64_tr_b16 a[16:17], v16 offset:12288
    v_mfma_f32_16x16x32_bf16 v[100:103], a[0:3], a[84:87], v[100:103]
    ds_read_b64_tr_b16 a[18:19], v16 offset:18432
    s_waitcnt lgkmcnt(6)
    v_mfma_f32_16x16x32_bf16 v[104:107], a[4:7], a[80:83], v[104:107]
    ds_read_b64_tr_b16 a[20:21], v17 offset:12288
    v_mfma_f32_16x16x32_bf16 v[108:111], a[4:7], a[84:87], v[108:111]
    ds_read_b64_tr_b16 a[22:23], v17 offset:18432
    s_waitcnt lgkmcnt(6)
    v_mfma_f32_16x16x32_bf16 v[112:115], a[8:11], a[80:83], v[112:115]
    ds_read_b64_tr_b16 a[24:25], v18 offset:12288
    v_mfma_f32_16x16x32_bf16 v[116:119], a[8:11], a[84:87], v[116:119]
    ds_read_b64_tr_b16 a[26:27], v18 offset:18432
    s_waitcnt lgkmcnt(6)
    v_mfma_f32_16x16x32_bf16 v[120:123], a[12:15], a[80:83], v[120:123]
    ds_read_b64_tr_b16 a[28:29], v19 offset:12288
    v_mfma_f32_16x16x32_bf16 v[124:127], a[12:15], a[84:87], v[124:127]
    ds_read_b64_tr_b16 a[30:31], v19 offset:18432
    s_waitcnt vmcnt(8) lgkmcnt(6)
    v_mfma_f32_16x16x32_bf16 v[32:35], a[16:19], a[88:91], v[32:35]
    ds_read_b64_tr_b16 a[0:1], v16 offset:12416
    v_mfma_f32_16x16x32_bf16 v[36:39], a[16:19], a[92:95], v[36:39]
    ds_read_b64_tr_b16 a[2:3], v16 offset:18560
    s_add_u32 s42, s36, 30720
    s_waitcnt lgkmcnt(6)
    v_mfma_f32_16x16x32_bf16 v[40:43], a[20:23], a[88:91], v[40:43]
    ds_read_b64_tr_b16 a[4:5], v17 offset:12416
    buffer_load_dwordx4 a[80:83], v0, s[20:23], s42 offen
    s_add_u32 s42, s36, 178176
    v_mfma_f32_16x16x32_bf16 v[44:47], a[20:23], a[92:95], v[44:47]
    ds_read_b64_tr_b16 a[6:7], v17 offset:18560
    s_waitcnt lgkmcnt(6)
    v_mfma_f32_16x16x32_bf16 v[48:51], a[24:27], a[88:91], v[48:51]
    ds_read_b64_tr_b16 a[8:9], v18 offset:12416
    buffer_load_dwordx4 a[84:87], v0, s[20:23], s42 offen
    v_mfma_f32_16x16x32_bf16 v[52:55], a[24:27], a[92:95], v[52:55]
    ds_read_b64_tr_b16 a[10:11], v18 offset:18560
    s_waitcnt lgkmcnt(6)
    v_mfma_f32_16x16x32_bf16 v[56:59], a[28:31], a[88:91], v[56:59]
    ds_read_b64_tr_b16 a[12:13], v19 offset:12416
    v_mfma_f32_16x16x32_bf16 v[60:63], a[28:31], a[92:95], v[60:63]
    ds_read_b64_tr_b16 a[14:15], v19 offset:18560
    s_waitcnt lgkmcnt(6)
    v_mfma_f32_16x16x32_bf16 v[64:67], a[0:3], a[88:91], v[64:67]
    ds_read_b64_tr_b16 a[16:17], v16 offset:12544
    v_mfma_f32_16x16x32_bf16 v[68:71], a[0:3], a[92:95], v[68:71]
    ds_read_b64_tr_b16 a[18:19], v16 offset:18688
    s_waitcnt lgkmcnt(6)
    v_mfma_f32_16x16x32_bf16 v[72:75], a[4:7], a[88:91], v[72:75]
    ds_read_b64_tr_b16 a[20:21], v17 offset:12544
    v_mfma_f32_16x16x32_bf16 v[76:79], a[4:7], a[92:95], v[76:79]
    ds_read_b64_tr_b16 a[22:23], v17 offset:18688
    s_waitcnt lgkmcnt(6)
    v_mfma_f32_16x16x32_bf16 v[80:83], a[8:11], a[88:91], v[80:83]
    ds_read_b64_tr_b16 a[24:25], v18 offset:12544
    v_mfma_f32_16x16x32_bf16 v[84:87], a[8:11], a[92:95], v[84:87]
    ds_read_b64_tr_b16 a[26:27], v18 offset:18688
    s_waitcnt lgkmcnt(6)
    v_mfma_f32_16x16x32_bf16 v[88:91], a[12:15], a[88:91], v[88:91]
    ds_read_b64_tr_b16 a[28:29], v19 offset:12544
    v_mfma_f32_16x16x32_bf16 v[92:95], a[12:15], a[92:95], v[92:95]
    ds_read_b64_tr_b16 a[30:31], v19 offset:18688
    s_waitcnt lgkmcnt(6)
    v_mfma_f32_16x16x32_bf16 v[96:99], a[16:19], a[88:91], v[96:99]
    ds_read_b64_tr_b16 a[0:1], v16 offset:24576
    v_mfma_f32_16x16x32_bf16 v[100:103], a[16:19], a[92:95], v[100:103]
    ds_read_b64_tr_b16 a[2:3], v16 offset:30720
    s_waitcnt lgkmcnt(6)
    v_mfma_f32_16x16x32_bf16 v[104:107], a[20:23], a[88:91], v[104:107]
    ds_read_b64_tr_b16 a[4:5], v17 offset:24576
    v_mfma_f32_16x16x32_bf16 v[108:111], a[20:23], a[92:95], v[108:111]
    ds_read_b64_tr_b16 a[6:7], v17 offset:30720
    s_waitcnt lgkmcnt(6)
    v_mfma_f32_16x16x32_bf16 v[112:115], a[24:27], a[88:91], v[112:115]
    ds_read_b64_tr_b16 a[8:9], v18 offset:24576
    v_mfma_f32_16x16x32_bf16 v[116:119], a[24:27], a[92:95], v[116:119]
    ds_read_b64_tr_b16 a[10:11], v18 offset:30720
    s_waitcnt lgkmcnt(6)
    v_mfma_f32_16x16x32_bf16 v[120:123], a[28:31], a[88:91], v[120:123]
    ds_read_b64_tr_b16 a[12:13], v19 offset:24576
    v_mfma_f32_16x16x32_bf16 v[124:127], a[28:31], a[92:95], v[124:127]
    ds_read_b64_tr_b16 a[14:15], v19 offset:30720
    s_waitcnt vmcnt(8) lgkmcnt(6)
    v_mfma_f32_16x16x32_bf16 v[32:35], a[0:3], a[96:99], v[32:35]
    ds_read_b64_tr_b16 a[16:17], v16 offset:24704
    v_mfma_f32_16x16x32_bf16 v[36:39], a[0:3], a[100:103], v[36:39]
    ds_read_b64_tr_b16 a[18:19], v16 offset:30848
    s_add_u32 s42, s36, 31744
    s_waitcnt lgkmcnt(6)
    v_mfma_f32_16x16x32_bf16 v[40:43], a[4:7], a[96:99], v[40:43]
    ds_read_b64_tr_b16 a[20:21], v17 offset:24704
    buffer_load_dwordx4 a[88:91], v0, s[20:23], s42 offen
    s_add_u32 s42, s36, 179200
    v_mfma_f32_16x16x32_bf16 v[44:47], a[4:7], a[100:103], v[44:47]
    ds_read_b64_tr_b16 a[22:23], v17 offset:30848
    s_waitcnt lgkmcnt(6)
    v_mfma_f32_16x16x32_bf16 v[48:51], a[8:11], a[96:99], v[48:51]
    ds_read_b64_tr_b16 a[24:25], v18 offset:24704
    buffer_load_dwordx4 a[92:95], v0, s[20:23], s42 offen
    v_mfma_f32_16x16x32_bf16 v[52:55], a[8:11], a[100:103], v[52:55]
    ds_read_b64_tr_b16 a[26:27], v18 offset:30848
    s_waitcnt lgkmcnt(6)
    v_mfma_f32_16x16x32_bf16 v[56:59], a[12:15], a[96:99], v[56:59]
    ds_read_b64_tr_b16 a[28:29], v19 offset:24704
    v_mfma_f32_16x16x32_bf16 v[60:63], a[12:15], a[100:103], v[60:63]
    ds_read_b64_tr_b16 a[30:31], v19 offset:30848
    s_waitcnt lgkmcnt(6)
    v_mfma_f32_16x16x32_bf16 v[64:67], a[16:19], a[96:99], v[64:67]
    ds_read_b64_tr_b16 a[0:1], v16 offset:24832
    v_mfma_f32_16x16x32_bf16 v[68:71], a[16:19], a[100:103], v[68:71]
    ds_read_b64_tr_b16 a[2:3], v16 offset:30976
    s_waitcnt lgkmcnt(6)
    v_mfma_f32_16x16x32_bf16 v[72:75], a[20:23], a[96:99], v[72:75]
    ds_read_b64_tr_b16 a[4:5], v17 offset:24832
    v_mfma_f32_16x16x32_bf16 v[76:79], a[20:23], a[100:103], v[76:79]
    ds_read_b64_tr_b16 a[6:7], v17 offset:30976
    s_waitcnt lgkmcnt(6)
    v_mfma_f32_16x16x32_bf16 v[80:83], a[24:27], a[96:99], v[80:83]
    ds_read_b64_tr_b16 a[8:9], v18 offset:24832
    v_mfma_f32_16x16x32_bf16 v[84:87], a[24:27], a[100:103], v[84:87]
    ds_read_b64_tr_b16 a[10:11], v18 offset:30976
    s_waitcnt lgkmcnt(6)
    v_mfma_f32_16x16x32_bf16 v[88:91], a[28:31], a[96:99], v[88:91]
    ds_read_b64_tr_b16 a[12:13], v19 offset:24832
    v_mfma_f32_16x16x32_bf16 v[92:95], a[28:31], a[100:103], v[92:95]
    ds_read_b64_tr_b16 a[14:15], v19 offset:30976
    s_waitcnt lgkmcnt(6)
    v_mfma_f32_16x16x32_bf16 v[96:99], a[0:3], a[96:99], v[96:99]
    ds_read_b64_tr_b16 a[16:17], v16 offset:36864
    v_mfma_f32_16x16x32_bf16 v[100:103], a[0:3], a[100:103], v[100:103]
    ds_read_b64_tr_b16 a[18:19], v16 offset:43008
    s_waitcnt lgkmcnt(6)
    v_mfma_f32_16x16x32_bf16 v[104:107], a[4:7], a[96:99], v[104:107]
    ds_read_b64_tr_b16 a[20:21], v17 offset:36864
    v_mfma_f32_16x16x32_bf16 v[108:111], a[4:7], a[100:103], v[108:111]
    ds_read_b64_tr_b16 a[22:23], v17 offset:43008
    s_waitcnt lgkmcnt(6)
    v_mfma_f32_16x16x32_bf16 v[112:115], a[8:11], a[96:99], v[112:115]
    ds_read_b64_tr_b16 a[24:25], v18 offset:36864
    v_mfma_f32_16x16x32_bf16 v[116:119], a[8:11], a[100:103], v[116:119]
    ds_read_b64_tr_b16 a[26:27], v18 offset:43008
    s_waitcnt lgkmcnt(6)
    v_mfma_f32_16x16x32_bf16 v[120:123], a[12:15], a[96:99], v[120:123]
    ds_read_b64_tr_b16 a[28:29], v19 offset:36864
    v_mfma_f32_16x16x32_bf16 v[124:127], a[12:15], a[100:103], v[124:127]
    ds_read_b64_tr_b16 a[30:31], v19 offset:43008
    s_waitcnt vmcnt(8) lgkmcnt(6)
    v_mfma_f32_16x16x32_bf16 v[32:35], a[16:19], a[104:107], v[32:35]
    ds_read_b64_tr_b16 a[0:1], v16 offset:36992
    v_mfma_f32_16x16x32_bf16 v[36:39], a[16:19], a[108:111], v[36:39]
    ds_read_b64_tr_b16 a[2:3], v16 offset:43136
    s_add_u32 s42, s36, 32768
    s_waitcnt lgkmcnt(6)
    v_mfma_f32_16x16x32_bf16 v[40:43], a[20:23], a[104:107], v[40:43]
    ds_read_b64_tr_b16 a[4:5], v17 offset:36992
    buffer_load_dwordx4 a[96:99], v0, s[20:23], s42 offen
    s_add_u32 s42, s36, 180224
    v_mfma_f32_16x16x32_bf16 v[44:47], a[20:23], a[108:111], v[44:47]
    ds_read_b64_tr_b16 a[6:7], v17 offset:43136
    s_waitcnt lgkmcnt(6)
    v_mfma_f32_16x16x32_bf16 v[48:51], a[24:27], a[104:107], v[48:51]
    ds_read_b64_tr_b16 a[8:9], v18 offset:36992
    buffer_load_dwordx4 a[100:103], v0, s[20:23], s42 offen
    v_mfma_f32_16x16x32_bf16 v[52:55], a[24:27], a[108:111], v[52:55]
    ds_read_b64_tr_b16 a[10:11], v18 offset:43136
    s_waitcnt lgkmcnt(6)
    v_mfma_f32_16x16x32_bf16 v[56:59], a[28:31], a[104:107], v[56:59]
    ds_read_b64_tr_b16 a[12:13], v19 offset:36992
    v_mfma_f32_16x16x32_bf16 v[60:63], a[28:31], a[108:111], v[60:63]
    ds_read_b64_tr_b16 a[14:15], v19 offset:43136
    s_waitcnt lgkmcnt(6)
    v_mfma_f32_16x16x32_bf16 v[64:67], a[0:3], a[104:107], v[64:67]
    ds_read_b64_tr_b16 a[16:17], v16 offset:37120
    v_mfma_f32_16x16x32_bf16 v[68:71], a[0:3], a[108:111], v[68:71]
    ds_read_b64_tr_b16 a[18:19], v16 offset:43264
    s_waitcnt lgkmcnt(6)
    v_mfma_f32_16x16x32_bf16 v[72:75], a[4:7], a[104:107], v[72:75]
    ds_read_b64_tr_b16 a[20:21], v17 offset:37120
    v_mfma_f32_16x16x32_bf16 v[76:79], a[4:7], a[108:111], v[76:79]
    ds_read_b64_tr_b16 a[22:23], v17 offset:43264
    s_waitcnt lgkmcnt(6)
    v_mfma_f32_16x16x32_bf16 v[80:83], a[8:11], a[104:107], v[80:83]
    ds_read_b64_tr_b16 a[24:25], v18 offset:37120
    v_mfma_f32_16x16x32_bf16 v[84:87], a[8:11], a[108:111], v[84:87]
    ds_read_b64_tr_b16 a[26:27], v18 offset:43264
    s_waitcnt lgkmcnt(6)
    v_mfma_f32_16x16x32_bf16 v[88:91], a[12:15], a[104:107], v[88:91]
    ds_read_b64_tr_b16 a[28:29], v19 offset:37120
    v_mfma_f32_16x16x32_bf16 v[92:95], a[12:15], a[108:111], v[92:95]
    ds_read_b64_tr_b16 a[30:31], v19 offset:43264
    s_barrier
    s_waitcnt lgkmcnt(6)
    v_mfma_f32_16x16x32_bf16 v[96:99], a[16:19], a[104:107], v[96:99]
    ds_read_b64_tr_b16 a[0:1], v20 offset:0
    v_mfma_f32_16x16x32_bf16 v[100:103], a[16:19], a[108:111], v[100:103]
    ds_read_b64_tr_b16 a[2:3], v20 offset:6144
    s_waitcnt lgkmcnt(6)
    v_mfma_f32_16x16x32_bf16 v[104:107], a[20:23], a[104:107], v[104:107]
    ds_read_b64_tr_b16 a[4:5], v21 offset:0
    v_mfma_f32_16x16x32_bf16 v[108:111], a[20:23], a[108:111], v[108:111]
    ds_read_b64_tr_b16 a[6:7], v21 offset:6144
    s_waitcnt lgkmcnt(6)
    v_mfma_f32_16x16x32_bf16 v[112:115], a[24:27], a[104:107], v[112:115]
    ds_read_b64_tr_b16 a[8:9], v22 offset:0
    v_mfma_f32_16x16x32_bf16 v[116:119], a[24:27], a[108:111], v[116:119]
    ds_read_b64_tr_b16 a[10:11], v22 offset:6144
    s_waitcnt lgkmcnt(6)
    v_mfma_f32_16x16x32_bf16 v[120:123], a[28:31], a[104:107], v[120:123]
    ds_read_b64_tr_b16 a[12:13], v23 offset:0
    v_mfma_f32_16x16x32_bf16 v[124:127], a[28:31], a[108:111], v[124:127]
    ds_read_b64_tr_b16 a[14:15], v23 offset:6144
    s_waitcnt vmcnt(8) lgkmcnt(6)
    v_mfma_f32_16x16x32_bf16 v[32:35], a[0:3], a[112:115], v[32:35]
    ds_read_b64_tr_b16 a[16:17], v20 offset:128
    v_mfma_f32_16x16x32_bf16 v[36:39], a[0:3], a[116:119], v[36:39]
    ds_read_b64_tr_b16 a[18:19], v20 offset:6272
    s_add_u32 s42, s36, 33792
    s_waitcnt lgkmcnt(6)
    v_mfma_f32_16x16x32_bf16 v[40:43], a[4:7], a[112:115], v[40:43]
    ds_read_b64_tr_b16 a[20:21], v21 offset:128
    buffer_load_dwordx4 a[104:107], v0, s[20:23], s42 offen
    s_add_u32 s42, s36, 181248
    v_mfma_f32_16x16x32_bf16 v[44:47], a[4:7], a[116:119], v[44:47]
    ds_read_b64_tr_b16 a[22:23], v21 offset:6272
    s_waitcnt lgkmcnt(6)
    v_mfma_f32_16x16x32_bf16 v[48:51], a[8:11], a[112:115], v[48:51]
    ds_read_b64_tr_b16 a[24:25], v22 offset:128
    buffer_load_dwordx4 a[108:111], v0, s[20:23], s42 offen
    v_mfma_f32_16x16x32_bf16 v[52:55], a[8:11], a[116:119], v[52:55]
    ds_read_b64_tr_b16 a[26:27], v22 offset:6272
    s_waitcnt lgkmcnt(6)
    v_mfma_f32_16x16x32_bf16 v[56:59], a[12:15], a[112:115], v[56:59]
    ds_read_b64_tr_b16 a[28:29], v23 offset:128
    v_mfma_f32_16x16x32_bf16 v[60:63], a[12:15], a[116:119], v[60:63]
    ds_read_b64_tr_b16 a[30:31], v23 offset:6272
    s_waitcnt lgkmcnt(6)
    v_mfma_f32_16x16x32_bf16 v[64:67], a[16:19], a[112:115], v[64:67]
    ds_read_b64_tr_b16 a[0:1], v20 offset:256
    v_mfma_f32_16x16x32_bf16 v[68:71], a[16:19], a[116:119], v[68:71]
    ds_read_b64_tr_b16 a[2:3], v20 offset:6400
    s_waitcnt lgkmcnt(6)
    v_mfma_f32_16x16x32_bf16 v[72:75], a[20:23], a[112:115], v[72:75]
    ds_read_b64_tr_b16 a[4:5], v21 offset:256
    v_mfma_f32_16x16x32_bf16 v[76:79], a[20:23], a[116:119], v[76:79]
    ds_read_b64_tr_b16 a[6:7], v21 offset:6400
    s_waitcnt lgkmcnt(6)
    v_mfma_f32_16x16x32_bf16 v[80:83], a[24:27], a[112:115], v[80:83]
    ds_read_b64_tr_b16 a[8:9], v22 offset:256
    v_mfma_f32_16x16x32_bf16 v[84:87], a[24:27], a[116:119], v[84:87]
    ds_read_b64_tr_b16 a[10:11], v22 offset:6400
    s_waitcnt lgkmcnt(6)
    v_mfma_f32_16x16x32_bf16 v[88:91], a[28:31], a[112:115], v[88:91]
    ds_read_b64_tr_b16 a[12:13], v23 offset:256
    v_mfma_f32_16x16x32_bf16 v[92:95], a[28:31], a[116:119], v[92:95]
    ds_read_b64_tr_b16 a[14:15], v23 offset:6400
    s_waitcnt lgkmcnt(6)
    v_mfma_f32_16x16x32_bf16 v[96:99], a[0:3], a[112:115], v[96:99]
    ds_read_b64_tr_b16 a[16:17], v20 offset:12288
    v_mfma_f32_16x16x32_bf16 v[100:103], a[0:3], a[116:119], v[100:103]
    ds_read_b64_tr_b16 a[18:19], v20 offset:18432
    s_waitcnt lgkmcnt(6)
    v_mfma_f32_16x16x32_bf16 v[104:107], a[4:7], a[112:115], v[104:107]
    ds_read_b64_tr_b16 a[20:21], v21 offset:12288
    v_mfma_f32_16x16x32_bf16 v[108:111], a[4:7], a[116:119], v[108:111]
    ds_read_b64_tr_b16 a[22:23], v21 offset:18432
    s_waitcnt lgkmcnt(6)
    v_mfma_f32_16x16x32_bf16 v[112:115], a[8:11], a[112:115], v[112:115]
    ds_read_b64_tr_b16 a[24:25], v22 offset:12288
    v_mfma_f32_16x16x32_bf16 v[116:119], a[8:11], a[116:119], v[116:119]
    ds_read_b64_tr_b16 a[26:27], v22 offset:18432
    s_waitcnt lgkmcnt(6)
    v_mfma_f32_16x16x32_bf16 v[120:123], a[12:15], a[112:115], v[120:123]
    ds_read_b64_tr_b16 a[28:29], v23 offset:12288
    v_mfma_f32_16x16x32_bf16 v[124:127], a[12:15], a[116:119], v[124:127]
    ds_read_b64_tr_b16 a[30:31], v23 offset:18432
    s_waitcnt vmcnt(8) lgkmcnt(6)
    v_mfma_f32_16x16x32_bf16 v[32:35], a[16:19], a[120:123], v[32:35]
    ds_read_b64_tr_b16 a[0:1], v20 offset:12416
    v_mfma_f32_16x16x32_bf16 v[36:39], a[16:19], a[124:127], v[36:39]
    ds_read_b64_tr_b16 a[2:3], v20 offset:18560
    s_add_u32 s42, s36, 34816
    s_waitcnt lgkmcnt(6)
    v_mfma_f32_16x16x32_bf16 v[40:43], a[20:23], a[120:123], v[40:43]
    ds_read_b64_tr_b16 a[4:5], v21 offset:12416
    buffer_load_dwordx4 a[112:115], v0, s[20:23], s42 offen
    s_add_u32 s42, s36, 182272
    v_mfma_f32_16x16x32_bf16 v[44:47], a[20:23], a[124:127], v[44:47]
    ds_read_b64_tr_b16 a[6:7], v21 offset:18560
    s_waitcnt lgkmcnt(6)
    v_mfma_f32_16x16x32_bf16 v[48:51], a[24:27], a[120:123], v[48:51]
    ds_read_b64_tr_b16 a[8:9], v22 offset:12416
    buffer_load_dwordx4 a[116:119], v0, s[20:23], s42 offen
    v_mfma_f32_16x16x32_bf16 v[52:55], a[24:27], a[124:127], v[52:55]
    ds_read_b64_tr_b16 a[10:11], v22 offset:18560
    s_waitcnt lgkmcnt(6)
    v_mfma_f32_16x16x32_bf16 v[56:59], a[28:31], a[120:123], v[56:59]
    ds_read_b64_tr_b16 a[12:13], v23 offset:12416
    v_mfma_f32_16x16x32_bf16 v[60:63], a[28:31], a[124:127], v[60:63]
    ds_read_b64_tr_b16 a[14:15], v23 offset:18560
    s_waitcnt lgkmcnt(6)
    v_mfma_f32_16x16x32_bf16 v[64:67], a[0:3], a[120:123], v[64:67]
    ds_read_b64_tr_b16 a[16:17], v20 offset:12544
    v_mfma_f32_16x16x32_bf16 v[68:71], a[0:3], a[124:127], v[68:71]
    ds_read_b64_tr_b16 a[18:19], v20 offset:18688
    s_waitcnt lgkmcnt(6)
    v_mfma_f32_16x16x32_bf16 v[72:75], a[4:7], a[120:123], v[72:75]
    ds_read_b64_tr_b16 a[20:21], v21 offset:12544
    v_mfma_f32_16x16x32_bf16 v[76:79], a[4:7], a[124:127], v[76:79]
    ds_read_b64_tr_b16 a[22:23], v21 offset:18688
    s_waitcnt lgkmcnt(6)
    v_mfma_f32_16x16x32_bf16 v[80:83], a[8:11], a[120:123], v[80:83]
    ds_read_b64_tr_b16 a[24:25], v22 offset:12544
    v_mfma_f32_16x16x32_bf16 v[84:87], a[8:11], a[124:127], v[84:87]
    ds_read_b64_tr_b16 a[26:27], v22 offset:18688
    s_waitcnt lgkmcnt(6)
    v_mfma_f32_16x16x32_bf16 v[88:91], a[12:15], a[120:123], v[88:91]
    ds_read_b64_tr_b16 a[28:29], v23 offset:12544
    v_mfma_f32_16x16x32_bf16 v[92:95], a[12:15], a[124:127], v[92:95]
    ds_read_b64_tr_b16 a[30:31], v23 offset:18688
    s_waitcnt lgkmcnt(6)
    v_mfma_f32_16x16x32_bf16 v[96:99], a[16:19], a[120:123], v[96:99]
    ds_read_b64_tr_b16 a[0:1], v20 offset:24576
    v_mfma_f32_16x16x32_bf16 v[100:103], a[16:19], a[124:127], v[100:103]
    ds_read_b64_tr_b16 a[2:3], v20 offset:30720
    s_waitcnt lgkmcnt(6)
    v_mfma_f32_16x16x32_bf16 v[104:107], a[20:23], a[120:123], v[104:107]
    ds_read_b64_tr_b16 a[4:5], v21 offset:24576
    v_mfma_f32_16x16x32_bf16 v[108:111], a[20:23], a[124:127], v[108:111]
    ds_read_b64_tr_b16 a[6:7], v21 offset:30720
    s_waitcnt lgkmcnt(6)
    v_mfma_f32_16x16x32_bf16 v[112:115], a[24:27], a[120:123], v[112:115]
    ds_read_b64_tr_b16 a[8:9], v22 offset:24576
    v_mfma_f32_16x16x32_bf16 v[116:119], a[24:27], a[124:127], v[116:119]
    ds_read_b64_tr_b16 a[10:11], v22 offset:30720
    s_waitcnt lgkmcnt(6)
    v_mfma_f32_16x16x32_bf16 v[120:123], a[28:31], a[120:123], v[120:123]
    ds_read_b64_tr_b16 a[12:13], v23 offset:24576
    v_mfma_f32_16x16x32_bf16 v[124:127], a[28:31], a[124:127], v[124:127]
    ds_read_b64_tr_b16 a[14:15], v23 offset:30720
    s_waitcnt vmcnt(8) lgkmcnt(6)
    v_mfma_f32_16x16x32_bf16 v[32:35], a[0:3], a[80:83], v[32:35]
    ds_read_b64_tr_b16 a[16:17], v20 offset:24704
    v_mfma_f32_16x16x32_bf16 v[36:39], a[0:3], a[84:87], v[36:39]
    ds_read_b64_tr_b16 a[18:19], v20 offset:30848
    s_add_u32 s42, s36, 35840
    s_waitcnt lgkmcnt(6)
    v_mfma_f32_16x16x32_bf16 v[40:43], a[4:7], a[80:83], v[40:43]
    ds_read_b64_tr_b16 a[20:21], v21 offset:24704
    buffer_load_dwordx4 a[120:123], v0, s[20:23], s42 offen
    s_add_u32 s42, s36, 183296
    v_mfma_f32_16x16x32_bf16 v[44:47], a[4:7], a[84:87], v[44:47]
    ds_read_b64_tr_b16 a[22:23], v21 offset:30848
    s_waitcnt lgkmcnt(6)
    v_mfma_f32_16x16x32_bf16 v[48:51], a[8:11], a[80:83], v[48:51]
    ds_read_b64_tr_b16 a[24:25], v22 offset:24704
    buffer_load_dwordx4 a[124:127], v0, s[20:23], s42 offen
    v_mfma_f32_16x16x32_bf16 v[52:55], a[8:11], a[84:87], v[52:55]
    ds_read_b64_tr_b16 a[26:27], v22 offset:30848
    s_waitcnt lgkmcnt(6)
    v_mfma_f32_16x16x32_bf16 v[56:59], a[12:15], a[80:83], v[56:59]
    ds_read_b64_tr_b16 a[28:29], v23 offset:24704
    v_mfma_f32_16x16x32_bf16 v[60:63], a[12:15], a[84:87], v[60:63]
    ds_read_b64_tr_b16 a[30:31], v23 offset:30848
    s_waitcnt lgkmcnt(6)
    v_mfma_f32_16x16x32_bf16 v[64:67], a[16:19], a[80:83], v[64:67]
    ds_read_b64_tr_b16 a[0:1], v20 offset:24832
    v_mfma_f32_16x16x32_bf16 v[68:71], a[16:19], a[84:87], v[68:71]
    ds_read_b64_tr_b16 a[2:3], v20 offset:30976
    s_waitcnt lgkmcnt(6)
    v_mfma_f32_16x16x32_bf16 v[72:75], a[20:23], a[80:83], v[72:75]
    ds_read_b64_tr_b16 a[4:5], v21 offset:24832
    v_mfma_f32_16x16x32_bf16 v[76:79], a[20:23], a[84:87], v[76:79]
    ds_read_b64_tr_b16 a[6:7], v21 offset:30976
    s_waitcnt lgkmcnt(6)
    v_mfma_f32_16x16x32_bf16 v[80:83], a[24:27], a[80:83], v[80:83]
    ds_read_b64_tr_b16 a[8:9], v22 offset:24832
    v_mfma_f32_16x16x32_bf16 v[84:87], a[24:27], a[84:87], v[84:87]
    ds_read_b64_tr_b16 a[10:11], v22 offset:30976
    s_waitcnt lgkmcnt(6)
    v_mfma_f32_16x16x32_bf16 v[88:91], a[28:31], a[80:83], v[88:91]
    ds_read_b64_tr_b16 a[12:13], v23 offset:24832
    v_mfma_f32_16x16x32_bf16 v[92:95], a[28:31], a[84:87], v[92:95]
    ds_read_b64_tr_b16 a[14:15], v23 offset:30976
    s_waitcnt lgkmcnt(6)
    v_mfma_f32_16x16x32_bf16 v[96:99], a[0:3], a[80:83], v[96:99]
    ds_read_b64_tr_b16 a[16:17], v20 offset:36864
    v_mfma_f32_16x16x32_bf16 v[100:103], a[0:3], a[84:87], v[100:103]
    ds_read_b64_tr_b16 a[18:19], v20 offset:43008
    s_waitcnt lgkmcnt(6)
    v_mfma_f32_16x16x32_bf16 v[104:107], a[4:7], a[80:83], v[104:107]
    ds_read_b64_tr_b16 a[20:21], v21 offset:36864
    v_mfma_f32_16x16x32_bf16 v[108:111], a[4:7], a[84:87], v[108:111]
    ds_read_b64_tr_b16 a[22:23], v21 offset:43008
    s_waitcnt lgkmcnt(6)
    v_mfma_f32_16x16x32_bf16 v[112:115], a[8:11], a[80:83], v[112:115]
    ds_read_b64_tr_b16 a[24:25], v22 offset:36864
    v_mfma_f32_16x16x32_bf16 v[116:119], a[8:11], a[84:87], v[116:119]
    ds_read_b64_tr_b16 a[26:27], v22 offset:43008
    s_waitcnt lgkmcnt(6)
    v_mfma_f32_16x16x32_bf16 v[120:123], a[12:15], a[80:83], v[120:123]
    ds_read_b64_tr_b16 a[28:29], v23 offset:36864
    v_mfma_f32_16x16x32_bf16 v[124:127], a[12:15], a[84:87], v[124:127]
    ds_read_b64_tr_b16 a[30:31], v23 offset:43008
    s_waitcnt vmcnt(8) lgkmcnt(6)
    v_mfma_f32_16x16x32_bf16 v[32:35], a[16:19], a[88:91], v[32:35]
    ds_read_b64_tr_b16 a[0:1], v20 offset:36992
    v_mfma_f32_16x16x32_bf16 v[36:39], a[16:19], a[92:95], v[36:39]
    ds_read_b64_tr_b16 a[2:3], v20 offset:43136
    s_waitcnt lgkmcnt(6)
    v_mfma_f32_16x16x32_bf16 v[40:43], a[20:23], a[88:91], v[40:43]
    ds_read_b64_tr_b16 a[4:5], v21 offset:36992
    v_mfma_f32_16x16x32_bf16 v[44:47], a[20:23], a[92:95], v[44:47]
    ds_read_b64_tr_b16 a[6:7], v21 offset:43136
    s_waitcnt lgkmcnt(6)
    v_mfma_f32_16x16x32_bf16 v[48:51], a[24:27], a[88:91], v[48:51]
    ds_read_b64_tr_b16 a[8:9], v22 offset:36992
    v_mfma_f32_16x16x32_bf16 v[52:55], a[24:27], a[92:95], v[52:55]
    ds_read_b64_tr_b16 a[10:11], v22 offset:43136
    s_waitcnt lgkmcnt(6)
    v_mfma_f32_16x16x32_bf16 v[56:59], a[28:31], a[88:91], v[56:59]
    ds_read_b64_tr_b16 a[12:13], v23 offset:36992
    v_mfma_f32_16x16x32_bf16 v[60:63], a[28:31], a[92:95], v[60:63]
    ds_read_b64_tr_b16 a[14:15], v23 offset:43136
    s_waitcnt lgkmcnt(6)
    v_mfma_f32_16x16x32_bf16 v[64:67], a[0:3], a[88:91], v[64:67]
    ds_read_b64_tr_b16 a[16:17], v20 offset:37120
    v_mfma_f32_16x16x32_bf16 v[68:71], a[0:3], a[92:95], v[68:71]
    ds_read_b64_tr_b16 a[18:19], v20 offset:43264
    s_waitcnt lgkmcnt(6)
    v_mfma_f32_16x16x32_bf16 v[72:75], a[4:7], a[88:91], v[72:75]
    ds_read_b64_tr_b16 a[20:21], v21 offset:37120
    v_mfma_f32_16x16x32_bf16 v[76:79], a[4:7], a[92:95], v[76:79]
    ds_read_b64_tr_b16 a[22:23], v21 offset:43264
    s_waitcnt lgkmcnt(6)
    v_mfma_f32_16x16x32_bf16 v[80:83], a[8:11], a[88:91], v[80:83]
    ds_read_b64_tr_b16 a[24:25], v22 offset:37120
    v_mfma_f32_16x16x32_bf16 v[84:87], a[8:11], a[92:95], v[84:87]
    ds_read_b64_tr_b16 a[26:27], v22 offset:43264
    s_waitcnt lgkmcnt(6)
    v_mfma_f32_16x16x32_bf16 v[88:91], a[12:15], a[88:91], v[88:91]
    ds_read_b64_tr_b16 a[28:29], v23 offset:37120
    v_mfma_f32_16x16x32_bf16 v[92:95], a[12:15], a[92:95], v[92:95]
    ds_read_b64_tr_b16 a[30:31], v23 offset:43264
    s_barrier
    s_waitcnt lgkmcnt(6)
    v_mfma_f32_16x16x32_bf16 v[96:99], a[16:19], a[88:91], v[96:99]
    ds_read_b64_tr_b16 a[0:1], v24 offset:0
    v_mfma_f32_16x16x32_bf16 v[100:103], a[16:19], a[92:95], v[100:103]
    ds_read_b64_tr_b16 a[2:3], v24 offset:6144
    s_waitcnt lgkmcnt(6)
    v_mfma_f32_16x16x32_bf16 v[104:107], a[20:23], a[88:91], v[104:107]
    ds_read_b64_tr_b16 a[4:5], v25 offset:0
    v_mfma_f32_16x16x32_bf16 v[108:111], a[20:23], a[92:95], v[108:111]
    ds_read_b64_tr_b16 a[6:7], v25 offset:6144
    s_waitcnt lgkmcnt(6)
    v_mfma_f32_16x16x32_bf16 v[112:115], a[24:27], a[88:91], v[112:115]
    ds_read_b64_tr_b16 a[8:9], v26 offset:0
    v_mfma_f32_16x16x32_bf16 v[116:119], a[24:27], a[92:95], v[116:119]
    ds_read_b64_tr_b16 a[10:11], v26 offset:6144
    s_waitcnt lgkmcnt(6)
    v_mfma_f32_16x16x32_bf16 v[120:123], a[28:31], a[88:91], v[120:123]
    ds_read_b64_tr_b16 a[12:13], v27 offset:0
    v_mfma_f32_16x16x32_bf16 v[124:127], a[28:31], a[92:95], v[124:127]
    ds_read_b64_tr_b16 a[14:15], v27 offset:6144
    s_waitcnt vmcnt(6) lgkmcnt(6)
    v_mfma_f32_16x16x32_bf16 v[32:35], a[0:3], a[96:99], v[32:35]
    ds_read_b64_tr_b16 a[16:17], v24 offset:128
    v_mfma_f32_16x16x32_bf16 v[36:39], a[0:3], a[100:103], v[36:39]
    ds_read_b64_tr_b16 a[18:19], v24 offset:6272
    s_waitcnt lgkmcnt(6)
    v_mfma_f32_16x16x32_bf16 v[40:43], a[4:7], a[96:99], v[40:43]
    ds_read_b64_tr_b16 a[20:21], v25 offset:128
    v_mfma_f32_16x16x32_bf16 v[44:47], a[4:7], a[100:103], v[44:47]
    ds_read_b64_tr_b16 a[22:23], v25 offset:6272
    s_waitcnt lgkmcnt(6)
    v_mfma_f32_16x16x32_bf16 v[48:51], a[8:11], a[96:99], v[48:51]
    ds_read_b64_tr_b16 a[24:25], v26 offset:128
    v_mfma_f32_16x16x32_bf16 v[52:55], a[8:11], a[100:103], v[52:55]
    ds_read_b64_tr_b16 a[26:27], v26 offset:6272
    s_waitcnt lgkmcnt(6)
    v_mfma_f32_16x16x32_bf16 v[56:59], a[12:15], a[96:99], v[56:59]
    ds_read_b64_tr_b16 a[28:29], v27 offset:128
    v_mfma_f32_16x16x32_bf16 v[60:63], a[12:15], a[100:103], v[60:63]
    ds_read_b64_tr_b16 a[30:31], v27 offset:6272
    s_waitcnt lgkmcnt(6)
    v_mfma_f32_16x16x32_bf16 v[64:67], a[16:19], a[96:99], v[64:67]
    ds_read_b64_tr_b16 a[0:1], v24 offset:256
    v_mfma_f32_16x16x32_bf16 v[68:71], a[16:19], a[100:103], v[68:71]
    ds_read_b64_tr_b16 a[2:3], v24 offset:6400
    s_waitcnt lgkmcnt(6)
    v_mfma_f32_16x16x32_bf16 v[72:75], a[20:23], a[96:99], v[72:75]
    ds_read_b64_tr_b16 a[4:5], v25 offset:256
    v_mfma_f32_16x16x32_bf16 v[76:79], a[20:23], a[100:103], v[76:79]
    ds_read_b64_tr_b16 a[6:7], v25 offset:6400
    s_waitcnt lgkmcnt(6)
    v_mfma_f32_16x16x32_bf16 v[80:83], a[24:27], a[96:99], v[80:83]
    ds_read_b64_tr_b16 a[8:9], v26 offset:256
    v_mfma_f32_16x16x32_bf16 v[84:87], a[24:27], a[100:103], v[84:87]
    ds_read_b64_tr_b16 a[10:11], v26 offset:6400
    s_waitcnt lgkmcnt(6)
    v_mfma_f32_16x16x32_bf16 v[88:91], a[28:31], a[96:99], v[88:91]
    ds_read_b64_tr_b16 a[12:13], v27 offset:256
    v_mfma_f32_16x16x32_bf16 v[92:95], a[28:31], a[100:103], v[92:95]
    ds_read_b64_tr_b16 a[14:15], v27 offset:6400
    s_waitcnt lgkmcnt(6)
    v_mfma_f32_16x16x32_bf16 v[96:99], a[0:3], a[96:99], v[96:99]
    ds_read_b64_tr_b16 a[16:17], v24 offset:12288
    v_mfma_f32_16x16x32_bf16 v[100:103], a[0:3], a[100:103], v[100:103]
    ds_read_b64_tr_b16 a[18:19], v24 offset:18432
    s_waitcnt lgkmcnt(6)
    v_mfma_f32_16x16x32_bf16 v[104:107], a[4:7], a[96:99], v[104:107]
    ds_read_b64_tr_b16 a[20:21], v25 offset:12288
    v_mfma_f32_16x16x32_bf16 v[108:111], a[4:7], a[100:103], v[108:111]
    ds_read_b64_tr_b16 a[22:23], v25 offset:18432
    s_waitcnt lgkmcnt(6)
    v_mfma_f32_16x16x32_bf16 v[112:115], a[8:11], a[96:99], v[112:115]
    ds_read_b64_tr_b16 a[24:25], v26 offset:12288
    v_mfma_f32_16x16x32_bf16 v[116:119], a[8:11], a[100:103], v[116:119]
    ds_read_b64_tr_b16 a[26:27], v26 offset:18432
    s_waitcnt lgkmcnt(6)
    v_mfma_f32_16x16x32_bf16 v[120:123], a[12:15], a[96:99], v[120:123]
    ds_read_b64_tr_b16 a[28:29], v27 offset:12288
    v_mfma_f32_16x16x32_bf16 v[124:127], a[12:15], a[100:103], v[124:127]
    ds_read_b64_tr_b16 a[30:31], v27 offset:18432
    s_waitcnt vmcnt(4) lgkmcnt(6)
    v_mfma_f32_16x16x32_bf16 v[32:35], a[16:19], a[104:107], v[32:35]
    ds_read_b64_tr_b16 a[0:1], v24 offset:12416
    v_mfma_f32_16x16x32_bf16 v[36:39], a[16:19], a[108:111], v[36:39]
    ds_read_b64_tr_b16 a[2:3], v24 offset:18560
    s_waitcnt lgkmcnt(6)
    v_mfma_f32_16x16x32_bf16 v[40:43], a[20:23], a[104:107], v[40:43]
    ds_read_b64_tr_b16 a[4:5], v25 offset:12416
    v_mfma_f32_16x16x32_bf16 v[44:47], a[20:23], a[108:111], v[44:47]
    ds_read_b64_tr_b16 a[6:7], v25 offset:18560
    s_waitcnt lgkmcnt(6)
    v_mfma_f32_16x16x32_bf16 v[48:51], a[24:27], a[104:107], v[48:51]
    ds_read_b64_tr_b16 a[8:9], v26 offset:12416
    v_mfma_f32_16x16x32_bf16 v[52:55], a[24:27], a[108:111], v[52:55]
    ds_read_b64_tr_b16 a[10:11], v26 offset:18560
    s_waitcnt lgkmcnt(6)
    v_mfma_f32_16x16x32_bf16 v[56:59], a[28:31], a[104:107], v[56:59]
    ds_read_b64_tr_b16 a[12:13], v27 offset:12416
    v_mfma_f32_16x16x32_bf16 v[60:63], a[28:31], a[108:111], v[60:63]
    ds_read_b64_tr_b16 a[14:15], v27 offset:18560
    s_waitcnt lgkmcnt(6)
    v_mfma_f32_16x16x32_bf16 v[64:67], a[0:3], a[104:107], v[64:67]
    ds_read_b64_tr_b16 a[16:17], v24 offset:12544
    v_mfma_f32_16x16x32_bf16 v[68:71], a[0:3], a[108:111], v[68:71]
    ds_read_b64_tr_b16 a[18:19], v24 offset:18688
    s_waitcnt lgkmcnt(6)
    v_mfma_f32_16x16x32_bf16 v[72:75], a[4:7], a[104:107], v[72:75]
    ds_read_b64_tr_b16 a[20:21], v25 offset:12544
    v_mfma_f32_16x16x32_bf16 v[76:79], a[4:7], a[108:111], v[76:79]
    ds_read_b64_tr_b16 a[22:23], v25 offset:18688
    s_waitcnt lgkmcnt(6)
    v_mfma_f32_16x16x32_bf16 v[80:83], a[8:11], a[104:107], v[80:83]
    ds_read_b64_tr_b16 a[24:25], v26 offset:12544
    v_mfma_f32_16x16x32_bf16 v[84:87], a[8:11], a[108:111], v[84:87]
    ds_read_b64_tr_b16 a[26:27], v26 offset:18688
    s_waitcnt lgkmcnt(6)
    v_mfma_f32_16x16x32_bf16 v[88:91], a[12:15], a[104:107], v[88:91]
    ds_read_b64_tr_b16 a[28:29], v27 offset:12544
    v_mfma_f32_16x16x32_bf16 v[92:95], a[12:15], a[108:111], v[92:95]
    ds_read_b64_tr_b16 a[30:31], v27 offset:18688
    s_waitcnt lgkmcnt(6)
    v_mfma_f32_16x16x32_bf16 v[96:99], a[16:19], a[104:107], v[96:99]
    ds_read_b64_tr_b16 a[0:1], v24 offset:24576
    v_mfma_f32_16x16x32_bf16 v[100:103], a[16:19], a[108:111], v[100:103]
    ds_read_b64_tr_b16 a[2:3], v24 offset:30720
    s_waitcnt lgkmcnt(6)
    v_mfma_f32_16x16x32_bf16 v[104:107], a[20:23], a[104:107], v[104:107]
    ds_read_b64_tr_b16 a[4:5], v25 offset:24576
    v_mfma_f32_16x16x32_bf16 v[108:111], a[20:23], a[108:111], v[108:111]
    ds_read_b64_tr_b16 a[6:7], v25 offset:30720
    s_waitcnt lgkmcnt(6)
    v_mfma_f32_16x16x32_bf16 v[112:115], a[24:27], a[104:107], v[112:115]
    ds_read_b64_tr_b16 a[8:9], v26 offset:24576
    v_mfma_f32_16x16x32_bf16 v[116:119], a[24:27], a[108:111], v[116:119]
    ds_read_b64_tr_b16 a[10:11], v26 offset:30720
    s_waitcnt lgkmcnt(6)
    v_mfma_f32_16x16x32_bf16 v[120:123], a[28:31], a[104:107], v[120:123]
    ds_read_b64_tr_b16 a[12:13], v27 offset:24576
    v_mfma_f32_16x16x32_bf16 v[124:127], a[28:31], a[108:111], v[124:127]
    ds_read_b64_tr_b16 a[14:15], v27 offset:30720
    s_waitcnt vmcnt(2) lgkmcnt(6)
    v_mfma_f32_16x16x32_bf16 v[32:35], a[0:3], a[112:115], v[32:35]
    ds_read_b64_tr_b16 a[16:17], v24 offset:24704
    v_mfma_f32_16x16x32_bf16 v[36:39], a[0:3], a[116:119], v[36:39]
    ds_read_b64_tr_b16 a[18:19], v24 offset:30848
    s_waitcnt lgkmcnt(6)
    v_mfma_f32_16x16x32_bf16 v[40:43], a[4:7], a[112:115], v[40:43]
    ds_read_b64_tr_b16 a[20:21], v25 offset:24704
    v_mfma_f32_16x16x32_bf16 v[44:47], a[4:7], a[116:119], v[44:47]
    ds_read_b64_tr_b16 a[22:23], v25 offset:30848
    s_waitcnt lgkmcnt(6)
    v_mfma_f32_16x16x32_bf16 v[48:51], a[8:11], a[112:115], v[48:51]
    ds_read_b64_tr_b16 a[24:25], v26 offset:24704
    v_mfma_f32_16x16x32_bf16 v[52:55], a[8:11], a[116:119], v[52:55]
    ds_read_b64_tr_b16 a[26:27], v26 offset:30848
    s_waitcnt lgkmcnt(6)
    v_mfma_f32_16x16x32_bf16 v[56:59], a[12:15], a[112:115], v[56:59]
    ds_read_b64_tr_b16 a[28:29], v27 offset:24704
    v_mfma_f32_16x16x32_bf16 v[60:63], a[12:15], a[116:119], v[60:63]
    ds_read_b64_tr_b16 a[30:31], v27 offset:30848
    s_waitcnt lgkmcnt(6)
    v_mfma_f32_16x16x32_bf16 v[64:67], a[16:19], a[112:115], v[64:67]
    ds_read_b64_tr_b16 a[0:1], v24 offset:24832
    v_mfma_f32_16x16x32_bf16 v[68:71], a[16:19], a[116:119], v[68:71]
    ds_read_b64_tr_b16 a[2:3], v24 offset:30976
    s_waitcnt lgkmcnt(6)
    v_mfma_f32_16x16x32_bf16 v[72:75], a[20:23], a[112:115], v[72:75]
    ds_read_b64_tr_b16 a[4:5], v25 offset:24832
    v_mfma_f32_16x16x32_bf16 v[76:79], a[20:23], a[116:119], v[76:79]
    ds_read_b64_tr_b16 a[6:7], v25 offset:30976
    s_waitcnt lgkmcnt(6)
    v_mfma_f32_16x16x32_bf16 v[80:83], a[24:27], a[112:115], v[80:83]
    ds_read_b64_tr_b16 a[8:9], v26 offset:24832
    v_mfma_f32_16x16x32_bf16 v[84:87], a[24:27], a[116:119], v[84:87]
    ds_read_b64_tr_b16 a[10:11], v26 offset:30976
    s_waitcnt lgkmcnt(6)
    v_mfma_f32_16x16x32_bf16 v[88:91], a[28:31], a[112:115], v[88:91]
    ds_read_b64_tr_b16 a[12:13], v27 offset:24832
    v_mfma_f32_16x16x32_bf16 v[92:95], a[28:31], a[116:119], v[92:95]
    ds_read_b64_tr_b16 a[14:15], v27 offset:30976
    s_waitcnt lgkmcnt(6)
    v_mfma_f32_16x16x32_bf16 v[96:99], a[0:3], a[112:115], v[96:99]
    ds_read_b64_tr_b16 a[16:17], v24 offset:36864
    v_mfma_f32_16x16x32_bf16 v[100:103], a[0:3], a[116:119], v[100:103]
    ds_read_b64_tr_b16 a[18:19], v24 offset:43008
    s_waitcnt lgkmcnt(6)
    v_mfma_f32_16x16x32_bf16 v[104:107], a[4:7], a[112:115], v[104:107]
    ds_read_b64_tr_b16 a[20:21], v25 offset:36864
    v_mfma_f32_16x16x32_bf16 v[108:111], a[4:7], a[116:119], v[108:111]
    ds_read_b64_tr_b16 a[22:23], v25 offset:43008
    s_waitcnt lgkmcnt(6)
    v_mfma_f32_16x16x32_bf16 v[112:115], a[8:11], a[112:115], v[112:115]
    ds_read_b64_tr_b16 a[24:25], v26 offset:36864
    v_mfma_f32_16x16x32_bf16 v[116:119], a[8:11], a[116:119], v[116:119]
    ds_read_b64_tr_b16 a[26:27], v26 offset:43008
    s_waitcnt lgkmcnt(6)
    v_mfma_f32_16x16x32_bf16 v[120:123], a[12:15], a[112:115], v[120:123]
    ds_read_b64_tr_b16 a[28:29], v27 offset:36864
    v_mfma_f32_16x16x32_bf16 v[124:127], a[12:15], a[116:119], v[124:127]
    ds_read_b64_tr_b16 a[30:31], v27 offset:43008
    s_waitcnt vmcnt(0) lgkmcnt(6)
    v_mfma_f32_16x16x32_bf16 v[32:35], a[16:19], a[120:123], v[32:35]
    ds_read_b64_tr_b16 a[0:1], v24 offset:36992
    v_mfma_f32_16x16x32_bf16 v[36:39], a[16:19], a[124:127], v[36:39]
    ds_read_b64_tr_b16 a[2:3], v24 offset:43136
    s_waitcnt lgkmcnt(6)
    v_mfma_f32_16x16x32_bf16 v[40:43], a[20:23], a[120:123], v[40:43]
    ds_read_b64_tr_b16 a[4:5], v25 offset:36992
    v_mfma_f32_16x16x32_bf16 v[44:47], a[20:23], a[124:127], v[44:47]
    ds_read_b64_tr_b16 a[6:7], v25 offset:43136
    s_waitcnt lgkmcnt(6)
    v_mfma_f32_16x16x32_bf16 v[48:51], a[24:27], a[120:123], v[48:51]
    ds_read_b64_tr_b16 a[8:9], v26 offset:36992
    v_mfma_f32_16x16x32_bf16 v[52:55], a[24:27], a[124:127], v[52:55]
    ds_read_b64_tr_b16 a[10:11], v26 offset:43136
    s_waitcnt lgkmcnt(6)
    v_mfma_f32_16x16x32_bf16 v[56:59], a[28:31], a[120:123], v[56:59]
    ds_read_b64_tr_b16 a[12:13], v27 offset:36992
    v_mfma_f32_16x16x32_bf16 v[60:63], a[28:31], a[124:127], v[60:63]
    ds_read_b64_tr_b16 a[14:15], v27 offset:43136
    s_waitcnt lgkmcnt(6)
    v_mfma_f32_16x16x32_bf16 v[64:67], a[0:3], a[120:123], v[64:67]
    ds_read_b64_tr_b16 a[16:17], v24 offset:37120
    v_mfma_f32_16x16x32_bf16 v[68:71], a[0:3], a[124:127], v[68:71]
    ds_read_b64_tr_b16 a[18:19], v24 offset:43264
    s_waitcnt lgkmcnt(6)
    v_mfma_f32_16x16x32_bf16 v[72:75], a[4:7], a[120:123], v[72:75]
    ds_read_b64_tr_b16 a[20:21], v25 offset:37120
    v_mfma_f32_16x16x32_bf16 v[76:79], a[4:7], a[124:127], v[76:79]
    ds_read_b64_tr_b16 a[22:23], v25 offset:43264
    s_waitcnt lgkmcnt(6)
    v_mfma_f32_16x16x32_bf16 v[80:83], a[8:11], a[120:123], v[80:83]
    ds_read_b64_tr_b16 a[24:25], v26 offset:37120
    v_mfma_f32_16x16x32_bf16 v[84:87], a[8:11], a[124:127], v[84:87]
    ds_read_b64_tr_b16 a[26:27], v26 offset:43264
    s_waitcnt lgkmcnt(6)
    v_mfma_f32_16x16x32_bf16 v[88:91], a[12:15], a[120:123], v[88:91]
    ds_read_b64_tr_b16 a[28:29], v27 offset:37120
    v_mfma_f32_16x16x32_bf16 v[92:95], a[12:15], a[124:127], v[92:95]
    ds_read_b64_tr_b16 a[30:31], v27 offset:43264
    s_waitcnt lgkmcnt(6)
    v_mfma_f32_16x16x32_bf16 v[96:99], a[16:19], a[120:123], v[96:99]
    v_mfma_f32_16x16x32_bf16 v[100:103], a[16:19], a[124:127], v[100:103]
    s_waitcnt lgkmcnt(4)
    v_mfma_f32_16x16x32_bf16 v[104:107], a[20:23], a[120:123], v[104:107]
    v_mfma_f32_16x16x32_bf16 v[108:111], a[20:23], a[124:127], v[108:111]
    s_waitcnt lgkmcnt(2)
    v_mfma_f32_16x16x32_bf16 v[112:115], a[24:27], a[120:123], v[112:115]
    v_mfma_f32_16x16x32_bf16 v[116:119], a[24:27], a[124:127], v[116:119]
    s_waitcnt lgkmcnt(0)
    v_mfma_f32_16x16x32_bf16 v[120:123], a[28:31], a[120:123], v[120:123]
    v_mfma_f32_16x16x32_bf16 v[124:127], a[28:31], a[124:127], v[124:127]
    s_barrier
    s_mul_i32 s40, s35, 36864
    s_mul_i32 s41, s32, 6144
    s_add_u32 s40, s40, s41
    s_lshr_b32 s41, s3, 1
    s_and_b32 s42, s30, 1
    s_lshr_b32 s43, s30, 1
    s_cmp_eq_u32 s41, s42
    s_cselect_b32 s38, 1, 0
    s_cselect_b32 s41, 0x40000000, 0
    s_cmp_eq_u32 s43, 0
    s_cselect_b32 s46, s41, 0
    s_cselect_b32 s47, 0, s41
    s_add_u32 s46, s46, s40
    s_add_u32 s47, s47, s40
    s_lshr_b32 s41, s3, 1
    s_add_u32 s41, s41, 0
    s_cmp_gt_u32 s30, s41
    s_cselect_b32 s41, 1, 0
    s_sub_u32 s41, s30, s41
    s_mov_b32 s42, 0
    s_cmp_eq_u32 s41, 1
    s_cselect_b32 s42, 7340032, s42
    s_cmp_eq_u32 s41, 2
    s_cselect_b32 s42, 4194304, s42
    s_add_u32 s46, s46, s42
    s_lshr_b32 s41, s3, 1
    s_add_u32 s41, s41, 2
    s_cmp_gt_u32 s30, s41
    s_cselect_b32 s41, 1, 0
    s_sub_u32 s41, s30, s41
    s_mov_b32 s42, 0
    s_cmp_eq_u32 s41, 1
    s_cselect_b32 s42, 7340032, s42
    s_cmp_eq_u32 s41, 2
    s_cselect_b32 s42, 4194304, s42
    s_add_u32 s47, s47, s42
    s_and_b32 s41, s3, 1
    s_mul_i32 s41, s41, 6144
    s_add_u32 s41, s41, 110592
    v_add_u32 v6, s41, v0
    v_cvt_pk_bf16_f32 v32, v32, v33
    v_cvt_pk_bf16_f32 v33, v34, v35
    v_cvt_pk_bf16_f32 v34, v40, v41
    v_cvt_pk_bf16_f32 v35, v42, v43
    s_add_u32 s41, s46, 0
    buffer_store_dwordx4 v[32:35], v0, s[20:23], s41 offen sc1
    v_cvt_pk_bf16_f32 v48, v48, v49
    v_cvt_pk_bf16_f32 v49, v50, v51
    v_cvt_pk_bf16_f32 v50, v56, v57
    v_cvt_pk_bf16_f32 v51, v58, v59
    s_add_u32 s41, s46, 1024
    buffer_store_dwordx4 v[48:51], v0, s[20:23], s41 offen sc1
    v_cvt_pk_bf16_f32 v64, v64, v65
    v_cvt_pk_bf16_f32 v65, v66, v67
    v_cvt_pk_bf16_f32 v66, v72, v73
    v_cvt_pk_bf16_f32 v67, v74, v75
    s_add_u32 s41, s46, 2048
    buffer_store_dwordx4 v[64:67], v0, s[20:23], s41 offen sc1
    v_cvt_pk_bf16_f32 v80, v80, v81
    v_cvt_pk_bf16_f32 v81, v82, v83
    v_cvt_pk_bf16_f32 v82, v88, v89
    v_cvt_pk_bf16_f32 v83, v90, v91
    s_add_u32 s41, s47, 3072
    buffer_store_dwordx4 v[80:83], v0, s[20:23], s41 offen sc1
    v_cvt_pk_bf16_f32 v96, v96, v97
    v_cvt_pk_bf16_f32 v97, v98, v99
    v_cvt_pk_bf16_f32 v98, v104, v105
    v_cvt_pk_bf16_f32 v99, v106, v107
    s_add_u32 s41, s47, 4096
    buffer_store_dwordx4 v[96:99], v0, s[20:23], s41 offen sc1
    v_cvt_pk_bf16_f32 v112, v112, v113
    v_cvt_pk_bf16_f32 v113, v114, v115
    v_cvt_pk_bf16_f32 v114, v120, v121
    v_cvt_pk_bf16_f32 v115, v122, v123
    s_add_u32 s41, s47, 5120
    buffer_store_dwordx4 v[112:115], v0, s[20:23], s41 offen sc1
    v_cvt_pk_bf16_f32 v36, v36, v37
    v_cvt_pk_bf16_f32 v37, v38, v39
    v_cvt_pk_bf16_f32 v38, v44, v45
    v_cvt_pk_bf16_f32 v39, v46, v47
    s_add_u32 s41, s46, 18432
    buffer_store_dwordx4 v[36:39], v0, s[20:23], s41 offen sc1
    v_cvt_pk_bf16_f32 v52, v52, v53
    v_cvt_pk_bf16_f32 v53, v54, v55
    v_cvt_pk_bf16_f32 v54, v60, v61
    v_cvt_pk_bf16_f32 v55, v62, v63
    s_add_u32 s41, s46, 19456
    buffer_store_dwordx4 v[52:55], v0, s[20:23], s41 offen sc1
    v_cvt_pk_bf16_f32 v68, v68, v69
    v_cvt_pk_bf16_f32 v69, v70, v71
    v_cvt_pk_bf16_f32 v70, v76, v77
    v_cvt_pk_bf16_f32 v71, v78, v79
    s_add_u32 s41, s46, 20480
    buffer_store_dwordx4 v[68:71], v0, s[20:23], s41 offen sc1
    v_cvt_pk_bf16_f32 v84, v84, v85
    v_cvt_pk_bf16_f32 v85, v86, v87
    v_cvt_pk_bf16_f32 v86, v92, v93
    v_cvt_pk_bf16_f32 v87, v94, v95
    s_add_u32 s41, s47, 21504
    buffer_store_dwordx4 v[84:87], v0, s[20:23], s41 offen sc1
    v_cvt_pk_bf16_f32 v100, v100, v101
    v_cvt_pk_bf16_f32 v101, v102, v103
    v_cvt_pk_bf16_f32 v102, v108, v109
    v_cvt_pk_bf16_f32 v103, v110, v111
    s_add_u32 s41, s47, 22528
    buffer_store_dwordx4 v[100:103], v0, s[20:23], s41 offen sc1
    v_cvt_pk_bf16_f32 v116, v116, v117
    v_cvt_pk_bf16_f32 v117, v118, v119
    v_cvt_pk_bf16_f32 v118, v124, v125
    v_cvt_pk_bf16_f32 v119, v126, v127
    s_add_u32 s41, s47, 23552
    buffer_store_dwordx4 v[116:119], v0, s[20:23], s41 offen sc1
    s_cmp_eq_u32 s38, 1
    s_cbranch_scc0 l2_kernel_noown
    s_cmp_eq_u32 s43, 0
    s_cbranch_scc0 l2_kernel_own1
    ds_write_b128 v6, v[32:35] offset:0
    ds_write_b128 v6, v[48:51] offset:1024
    ds_write_b128 v6, v[64:67] offset:2048
    ds_write_b128 v6, v[36:39] offset:3072
    ds_write_b128 v6, v[52:55] offset:4096
    ds_write_b128 v6, v[68:71] offset:5120
    s_branch l2_kernel_noown
l2_kernel_own1:
    ds_write_b128 v6, v[80:83] offset:0
    ds_write_b128 v6, v[96:99] offset:1024
    ds_write_b128 v6, v[112:115] offset:2048
    ds_write_b128 v6, v[84:87] offset:3072
    ds_write_b128 v6, v[100:103] offset:4096
    ds_write_b128 v6, v[116:119] offset:5120
l2_kernel_noown:
    s_add_u32 s43, s44, 0
    buffer_load_dwordx4 a[32:35], v0, s[20:23], s43 offen sc1
    s_add_u32 s43, s44, 1024
    buffer_load_dwordx4 a[36:39], v0, s[20:23], s43 offen sc1
    s_add_u32 s43, s44, 2048
    buffer_load_dwordx4 a[40:43], v0, s[20:23], s43 offen sc1
    s_add_u32 s43, s44, 3072
    buffer_load_dwordx4 a[44:47], v0, s[20:23], s43 offen sc1
    s_add_u32 s43, s44, 4096
    buffer_load_dwordx4 a[48:51], v0, s[20:23], s43 offen sc1
    s_add_u32 s43, s44, 5120
    buffer_load_dwordx4 a[52:55], v0, s[20:23], s43 offen sc1
    s_add_u32 s43, s44, 6144
    buffer_load_dwordx4 a[56:59], v0, s[20:23], s43 offen sc1
    s_add_u32 s43, s44, 7168
    buffer_load_dwordx4 a[60:63], v0, s[20:23], s43 offen sc1
    s_add_u32 s43, s44, 8192
    buffer_load_dwordx4 a[64:67], v0, s[20:23], s43 offen sc1
    s_add_u32 s43, s44, 9216
    buffer_load_dwordx4 a[68:71], v0, s[20:23], s43 offen sc1
    s_add_u32 s43, s44, 10240
    buffer_load_dwordx4 a[72:75], v0, s[20:23], s43 offen sc1
    s_add_u32 s43, s44, 11264
    buffer_load_dwordx4 a[76:79], v0, s[20:23], s43 offen sc1
    s_add_u32 s43, s44, 12288
    buffer_load_dwordx4 a[80:83], v0, s[20:23], s43 offen sc1
    s_add_u32 s43, s44, 13312
    buffer_load_dwordx4 a[84:87], v0, s[20:23], s43 offen sc1
    s_add_u32 s43, s44, 14336
    buffer_load_dwordx4 a[88:91], v0, s[20:23], s43 offen sc1
    s_add_u32 s43, s44, 15360
    buffer_load_dwordx4 a[92:95], v0, s[20:23], s43 offen sc1
    s_add_u32 s43, s44, 16384
    buffer_load_dwordx4 a[96:99], v0, s[20:23], s43 offen sc1
    s_add_u32 s43, s44, 17408
    buffer_load_dwordx4 a[100:103], v0, s[20:23], s43 offen sc1
    v_and_b32 v12, 15, v11
    v_lshrrev_b32 v13, 4, v11
    s_and_b32 s40, s33, 1
    s_lshl_b32 s40, s40, 4
    v_add_u32 v12, s40, v12
    v_lshlrev_b32 v12, 6, v12
    s_lshr_b32 s40, s33, 1
    v_add_u32 v12, s40, v12
    v_mul_u32_u24 v12, 1152, v12
    v_lshl_add_u32 v7, v13, 3, v12
    s_mul_i32 s40, s29, 192
    v_add_u32 v7, s40, v7
    v_add_u32 v8, 55296, v0
    buffer_load_dwordx2 v[44:45], v7, s[64:67], 0 offen offset:0
    buffer_load_dwordx2 v[46:47], v7, s[64:67], 0 offen offset:32
    buffer_load_dwordx2 v[60:61], v7, s[64:67], 0 offen offset:64
    buffer_load_dwordx2 v[62:63], v7, s[64:67], 0 offen offset:96
    buffer_load_dwordx2 v[76:77], v7, s[64:67], 0 offen offset:128
    buffer_load_dwordx2 v[78:79], v7, s[64:67], 0 offen offset:160
    s_waitcnt vmcnt(24)
    s_waitcnt lgkmcnt(0)
    s_barrier
    s_waitcnt vmcnt(6)
    ds_read_b128 a[0:3], v0 offset:0
    ds_read_b128 a[4:7], v0 offset:1024
    ds_read_b128 a[8:11], v0 offset:2048
    ds_read_b128 a[12:15], v0 offset:3072
    ds_read_b128 a[16:19], v0 offset:4096
    ds_read_b128 a[20:23], v0 offset:5120
    s_waitcnt lgkmcnt(5)
    v_mfma_f32_16x16x32_bf16 v[40:43], a[0:3], a[32:35], 0
    ds_read_b128 a[24:27], v0 offset:6144
    s_waitcnt lgkmcnt(5)
    v_mfma_f32_16x16x32_bf16 v[56:59], a[4:7], a[32:35], 0
    ds_read_b128 a[28:31], v0 offset:7168
    s_waitcnt lgkmcnt(5)
    v_mfma_f32_16x16x32_bf16 v[72:75], a[8:11], a[32:35], 0
    ds_read_b128 a[0:3], v0 offset:8192
    s_waitcnt lgkmcnt(5)
    v_mfma_f32_16x16x32_bf16 v[88:91], a[12:15], a[32:35], 0
    ds_read_b128 a[4:7], v0 offset:9216
    s_waitcnt lgkmcnt(5)
    v_mfma_f32_16x16x32_bf16 v[104:107], a[16:19], a[32:35], 0
    ds_read_b128 a[8:11], v0 offset:10240
    s_waitcnt lgkmcnt(5)
    v_mfma_f32_16x16x32_bf16 v[120:123], a[20:23], a[32:35], 0
    ds_read_b128 a[12:15], v0 offset:11264
    s_waitcnt lgkmcnt(5)
    v_mfma_f32_16x16x32_bf16 v[40:43], a[24:27], a[36:39], v[40:43]
    ds_read_b128 a[16:19], v0 offset:12288
    s_waitcnt lgkmcnt(5)
    v_mfma_f32_16x16x32_bf16 v[56:59], a[28:31], a[36:39], v[56:59]
    ds_read_b128 a[20:23], v0 offset:13312
    s_waitcnt lgkmcnt(5)
    v_mfma_f32_16x16x32_bf16 v[72:75], a[0:3], a[36:39], v[72:75]
    ds_read_b128 a[24:27], v0 offset:14336
    s_waitcnt lgkmcnt(5)
    v_mfma_f32_16x16x32_bf16 v[88:91], a[4:7], a[36:39], v[88:91]
    ds_read_b128 a[28:31], v0 offset:15360
    s_waitcnt lgkmcnt(5)
    v_mfma_f32_16x16x32_bf16 v[104:107], a[8:11], a[36:39], v[104:107]
    ds_read_b128 a[0:3], v0 offset:16384
    s_waitcnt lgkmcnt(5)
    v_mfma_f32_16x16x32_bf16 v[120:123], a[12:15], a[36:39], v[120:123]
    ds_read_b128 a[4:7], v0 offset:17408
    s_waitcnt lgkmcnt(5)
    v_mfma_f32_16x16x32_bf16 v[40:43], a[16:19], a[40:43], v[40:43]
    ds_read_b128 a[8:11], v0 offset:18432
    s_waitcnt lgkmcnt(5)
    v_mfma_f32_16x16x32_bf16 v[56:59], a[20:23], a[40:43], v[56:59]
    ds_read_b128 a[12:15], v0 offset:19456
    s_waitcnt lgkmcnt(5)
    v_mfma_f32_16x16x32_bf16 v[72:75], a[24:27], a[40:43], v[72:75]
    ds_read_b128 a[16:19], v0 offset:20480
    s_waitcnt lgkmcnt(5)
    v_mfma_f32_16x16x32_bf16 v[88:91], a[28:31], a[40:43], v[88:91]
    ds_read_b128 a[20:23], v0 offset:21504
    s_waitcnt lgkmcnt(5)
    v_mfma_f32_16x16x32_bf16 v[104:107], a[0:3], a[40:43], v[104:107]
    ds_read_b128 a[24:27], v0 offset:22528
    s_waitcnt lgkmcnt(5)
    v_mfma_f32_16x16x32_bf16 v[120:123], a[4:7], a[40:43], v[120:123]
    ds_read_b128 a[28:31], v0 offset:23552
    s_waitcnt lgkmcnt(5)
    v_mfma_f32_16x16x32_bf16 v[40:43], a[8:11], a[44:47], v[40:43]
    ds_read_b128 a[0:3], v0 offset:24576
    s_waitcnt lgkmcnt(5)
    v_mfma_f32_16x16x32_bf16 v[56:59], a[12:15], a[44:47], v[56:59]
    ds_read_b128 a[4:7], v0 offset:25600
    s_waitcnt lgkmcnt(5)
    v_mfma_f32_16x16x32_bf16 v[72:75], a[16:19], a[44:47], v[72:75]
    ds_read_b128 a[8:11], v0 offset:26624
    s_waitcnt lgkmcnt(5)
    v_mfma_f32_16x16x32_bf16 v[88:91], a[20:23], a[44:47], v[88:91]
    ds_read_b128 a[12:15], v0 offset:27648
    s_waitcnt lgkmcnt(5)
    v_mfma_f32_16x16x32_bf16 v[104:107], a[24:27], a[44:47], v[104:107]
    ds_read_b128 a[16:19], v0 offset:28672
    s_waitcnt lgkmcnt(5)
    v_mfma_f32_16x16x32_bf16 v[120:123], a[28:31], a[44:47], v[120:123]
    ds_read_b128 a[20:23], v0 offset:29696
    s_waitcnt lgkmcnt(5)
    v_mfma_f32_16x16x32_bf16 v[40:43], a[0:3], a[48:51], v[40:43]
    ds_read_b128 a[24:27], v0 offset:30720
    s_waitcnt lgkmcnt(5)
    v_mfma_f32_16x16x32_bf16 v[56:59], a[4:7], a[48:51], v[56:59]
    ds_read_b128 a[28:31], v0 offset:31744
    s_waitcnt lgkmcnt(5)
    v_mfma_f32_16x16x32_bf16 v[72:75], a[8:11], a[48:51], v[72:75]
    ds_read_b128 a[0:3], v0 offset:32768
    s_waitcnt lgkmcnt(5)
    v_mfma_f32_16x16x32_bf16 v[88:91], a[12:15], a[48:51], v[88:91]
    ds_read_b128 a[4:7], v0 offset:33792
    s_waitcnt lgkmcnt(5)
    v_mfma_f32_16x16x32_bf16 v[104:107], a[16:19], a[48:51], v[104:107]
    ds_read_b128 a[8:11], v0 offset:34816
    s_waitcnt lgkmcnt(5)
    v_mfma_f32_16x16x32_bf16 v[120:123], a[20:23], a[48:51], v[120:123]
    ds_read_b128 a[12:15], v0 offset:35840
    s_waitcnt lgkmcnt(5)
    v_mfma_f32_16x16x32_bf16 v[40:43], a[24:27], a[52:55], v[40:43]
    ds_read_b128 a[16:19], v0 offset:36864
    s_waitcnt lgkmcnt(5)
    v_mfma_f32_16x16x32_bf16 v[56:59], a[28:31], a[52:55], v[56:59]
    ds_read_b128 a[20:23], v0 offset:37888
    s_waitcnt lgkmcnt(5)
    v_mfma_f32_16x16x32_bf16 v[72:75], a[0:3], a[52:55], v[72:75]
    ds_read_b128 a[24:27], v0 offset:38912
    s_waitcnt lgkmcnt(5)
    v_mfma_f32_16x16x32_bf16 v[88:91], a[4:7], a[52:55], v[88:91]
    ds_read_b128 a[28:31], v0 offset:39936
    s_waitcnt lgkmcnt(5)
    v_mfma_f32_16x16x32_bf16 v[104:107], a[8:11], a[52:55], v[104:107]
    ds_read_b128 a[0:3], v0 offset:40960
    s_waitcnt lgkmcnt(5)
    v_mfma_f32_16x16x32_bf16 v[120:123], a[12:15], a[52:55], v[120:123]
    ds_read_b128 a[4:7], v0 offset:41984
    s_waitcnt lgkmcnt(5)
    v_mfma_f32_16x16x32_bf16 v[40:43], a[16:19], a[56:59], v[40:43]
    ds_read_b128 a[8:11], v0 offset:43008
    s_waitcnt lgkmcnt(5)
    v_mfma_f32_16x16x32_bf16 v[56:59], a[20:23], a[56:59], v[56:59]
    ds_read_b128 a[12:15], v0 offset:44032
    s_waitcnt lgkmcnt(5)
    v_mfma_f32_16x16x32_bf16 v[72:75], a[24:27], a[56:59], v[72:75]
    ds_read_b128 a[16:19], v0 offset:45056
    s_waitcnt lgkmcnt(5)
    v_mfma_f32_16x16x32_bf16 v[88:91], a[28:31], a[56:59], v[88:91]
    ds_read_b128 a[20:23], v0 offset:46080
    s_waitcnt lgkmcnt(5)
    v_mfma_f32_16x16x32_bf16 v[104:107], a[0:3], a[56:59], v[104:107]
    ds_read_b128 a[24:27], v0 offset:47104
    s_waitcnt lgkmcnt(5)
    v_mfma_f32_16x16x32_bf16 v[120:123], a[4:7], a[56:59], v[120:123]
    ds_read_b128 a[28:31], v0 offset:48128
    s_waitcnt lgkmcnt(5)
    v_mfma_f32_16x16x32_bf16 v[40:43], a[8:11], a[60:63], v[40:43]
    ds_read_b128 a[0:3], v0 offset:49152
    s_waitcnt lgkmcnt(5)
    v_mfma_f32_16x16x32_bf16 v[56:59], a[12:15], a[60:63], v[56:59]
    ds_read_b128 a[4:7], v0 offset:50176
    s_waitcnt lgkmcnt(5)
    v_mfma_f32_16x16x32_bf16 v[72:75], a[16:19], a[60:63], v[72:75]
    ds_read_b128 a[8:11], v0 offset:51200
    s_waitcnt lgkmcnt(5)
    v_mfma_f32_16x16x32_bf16 v[88:91], a[20:23], a[60:63], v[88:91]
    ds_read_b128 a[12:15], v0 offset:52224
    s_waitcnt lgkmcnt(5)
    v_mfma_f32_16x16x32_bf16 v[104:107], a[24:27], a[60:63], v[104:107]
    ds_read_b128 a[16:19], v0 offset:53248
    s_waitcnt lgkmcnt(5)
    v_mfma_f32_16x16x32_bf16 v[120:123], a[28:31], a[60:63], v[120:123]
    ds_read_b128 a[20:23], v0 offset:54272
    s_waitcnt lgkmcnt(5)
    v_mfma_f32_16x16x32_bf16 v[40:43], a[0:3], a[64:67], v[40:43]
    ds_read_b128 a[24:27], v8 offset:0
    s_waitcnt lgkmcnt(5)
    v_mfma_f32_16x16x32_bf16 v[56:59], a[4:7], a[64:67], v[56:59]
    ds_read_b128 a[28:31], v8 offset:1024
    s_waitcnt lgkmcnt(5)
    v_mfma_f32_16x16x32_bf16 v[72:75], a[8:11], a[64:67], v[72:75]
    ds_read_b128 a[0:3], v8 offset:2048
    s_waitcnt lgkmcnt(5)
    v_mfma_f32_16x16x32_bf16 v[88:91], a[12:15], a[64:67], v[88:91]
    ds_read_b128 a[4:7], v8 offset:3072
    s_waitcnt lgkmcnt(5)
    v_mfma_f32_16x16x32_bf16 v[104:107], a[16:19], a[64:67], v[104:107]
    ds_read_b128 a[8:11], v8 offset:4096
    s_waitcnt lgkmcnt(5)
    v_mfma_f32_16x16x32_bf16 v[120:123], a[20:23], a[64:67], v[120:123]
    ds_read_b128 a[12:15], v8 offset:5120
    s_waitcnt lgkmcnt(5)
    v_mfma_f32_16x16x32_bf16 v[40:43], a[24:27], a[68:71], v[40:43]
    ds_read_b128 a[16:19], v8 offset:6144
    s_waitcnt lgkmcnt(5)
    v_mfma_f32_16x16x32_bf16 v[56:59], a[28:31], a[68:71], v[56:59]
    ds_read_b128 a[20:23], v8 offset:7168
    s_waitcnt lgkmcnt(5)
    v_mfma_f32_16x16x32_bf16 v[72:75], a[0:3], a[68:71], v[72:75]
    ds_read_b128 a[24:27], v8 offset:8192
    s_waitcnt lgkmcnt(5)
    v_mfma_f32_16x16x32_bf16 v[88:91], a[4:7], a[68:71], v[88:91]
    ds_read_b128 a[28:31], v8 offset:9216
    s_waitcnt lgkmcnt(5)
    v_mfma_f32_16x16x32_bf16 v[104:107], a[8:11], a[68:71], v[104:107]
    ds_read_b128 a[0:3], v8 offset:10240
    s_waitcnt lgkmcnt(5)
    v_mfma_f32_16x16x32_bf16 v[120:123], a[12:15], a[68:71], v[120:123]
    ds_read_b128 a[4:7], v8 offset:11264
    s_waitcnt lgkmcnt(5)
    v_mfma_f32_16x16x32_bf16 v[40:43], a[16:19], a[72:75], v[40:43]
    ds_read_b128 a[8:11], v8 offset:12288
    s_waitcnt lgkmcnt(5)
    v_mfma_f32_16x16x32_bf16 v[56:59], a[20:23], a[72:75], v[56:59]
    ds_read_b128 a[12:15], v8 offset:13312
    s_waitcnt lgkmcnt(5)
    v_mfma_f32_16x16x32_bf16 v[72:75], a[24:27], a[72:75], v[72:75]
    ds_read_b128 a[16:19], v8 offset:14336
    s_waitcnt lgkmcnt(5)
    v_mfma_f32_16x16x32_bf16 v[88:91], a[28:31], a[72:75], v[88:91]
    ds_read_b128 a[20:23], v8 offset:15360
    s_waitcnt lgkmcnt(5)
    v_mfma_f32_16x16x32_bf16 v[104:107], a[0:3], a[72:75], v[104:107]
    ds_read_b128 a[24:27], v8 offset:16384
    s_waitcnt lgkmcnt(5)
    v_mfma_f32_16x16x32_bf16 v[120:123], a[4:7], a[72:75], v[120:123]
    ds_read_b128 a[28:31], v8 offset:17408
    s_waitcnt lgkmcnt(5)
    v_mfma_f32_16x16x32_bf16 v[40:43], a[8:11], a[76:79], v[40:43]
    ds_read_b128 a[0:3], v8 offset:18432
    s_waitcnt lgkmcnt(5)
    v_mfma_f32_16x16x32_bf16 v[56:59], a[12:15], a[76:79], v[56:59]
    ds_read_b128 a[4:7], v8 offset:19456
    s_waitcnt lgkmcnt(5)
    v_mfma_f32_16x16x32_bf16 v[72:75], a[16:19], a[76:79], v[72:75]
    ds_read_b128 a[8:11], v8 offset:20480
    s_waitcnt lgkmcnt(5)
    v_mfma_f32_16x16x32_bf16 v[88:91], a[20:23], a[76:79], v[88:91]
    ds_read_b128 a[12:15], v8 offset:21504
    s_waitcnt lgkmcnt(5)
    v_mfma_f32_16x16x32_bf16 v[104:107], a[24:27], a[76:79], v[104:107]
    ds_read_b128 a[16:19], v8 offset:22528
    s_waitcnt lgkmcnt(5)
    v_mfma_f32_16x16x32_bf16 v[120:123], a[28:31], a[76:79], v[120:123]
    ds_read_b128 a[20:23], v8 offset:23552
    s_waitcnt lgkmcnt(5)
    v_mfma_f32_16x16x32_bf16 v[40:43], a[0:3], a[80:83], v[40:43]
    ds_read_b128 a[24:27], v8 offset:24576
    s_waitcnt lgkmcnt(5)
    v_mfma_f32_16x16x32_bf16 v[56:59], a[4:7], a[80:83], v[56:59]
    ds_read_b128 a[28:31], v8 offset:25600
    s_waitcnt lgkmcnt(5)
    v_mfma_f32_16x16x32_bf16 v[72:75], a[8:11], a[80:83], v[72:75]
    ds_read_b128 a[0:3], v8 offset:26624
    s_waitcnt lgkmcnt(5)
    v_mfma_f32_16x16x32_bf16 v[88:91], a[12:15], a[80:83], v[88:91]
    ds_read_b128 a[4:7], v8 offset:27648
    s_waitcnt lgkmcnt(5)
    v_mfma_f32_16x16x32_bf16 v[104:107], a[16:19], a[80:83], v[104:107]
    ds_read_b128 a[8:11], v8 offset:28672
    s_waitcnt lgkmcnt(5)
    v_mfma_f32_16x16x32_bf16 v[120:123], a[20:23], a[80:83], v[120:123]
    ds_read_b128 a[12:15], v8 offset:29696
    s_waitcnt lgkmcnt(5)
    v_mfma_f32_16x16x32_bf16 v[40:43], a[24:27], a[84:87], v[40:43]
    ds_read_b128 a[16:19], v8 offset:30720
    s_waitcnt lgkmcnt(5)
    v_mfma_f32_16x16x32_bf16 v[56:59], a[28:31], a[84:87], v[56:59]
    ds_read_b128 a[20:23], v8 offset:31744
    s_waitcnt lgkmcnt(5)
    v_mfma_f32_16x16x32_bf16 v[72:75], a[0:3], a[84:87], v[72:75]
    ds_read_b128 a[24:27], v8 offset:32768
    s_waitcnt lgkmcnt(5)
    v_mfma_f32_16x16x32_bf16 v[88:91], a[4:7], a[84:87], v[88:91]
    ds_read_b128 a[28:31], v8 offset:33792
    s_waitcnt lgkmcnt(5)
    v_mfma_f32_16x16x32_bf16 v[104:107], a[8:11], a[84:87], v[104:107]
    ds_read_b128 a[0:3], v8 offset:34816
    s_waitcnt lgkmcnt(5)
    v_mfma_f32_16x16x32_bf16 v[120:123], a[12:15], a[84:87], v[120:123]
    ds_read_b128 a[4:7], v8 offset:35840
    s_waitcnt lgkmcnt(5)
    v_mfma_f32_16x16x32_bf16 v[40:43], a[16:19], a[88:91], v[40:43]
    ds_read_b128 a[8:11], v8 offset:36864
    s_waitcnt lgkmcnt(5)
    v_mfma_f32_16x16x32_bf16 v[56:59], a[20:23], a[88:91], v[56:59]
    ds_read_b128 a[12:15], v8 offset:37888
    s_waitcnt lgkmcnt(5)
    v_mfma_f32_16x16x32_bf16 v[72:75], a[24:27], a[88:91], v[72:75]
    ds_read_b128 a[16:19], v8 offset:38912
    s_waitcnt lgkmcnt(5)
    v_mfma_f32_16x16x32_bf16 v[88:91], a[28:31], a[88:91], v[88:91]
    ds_read_b128 a[20:23], v8 offset:39936
    s_waitcnt lgkmcnt(5)
    v_mfma_f32_16x16x32_bf16 v[104:107], a[0:3], a[88:91], v[104:107]
    ds_read_b128 a[24:27], v8 offset:40960
    s_waitcnt lgkmcnt(5)
    v_mfma_f32_16x16x32_bf16 v[120:123], a[4:7], a[88:91], v[120:123]
    ds_read_b128 a[28:31], v8 offset:41984
    s_waitcnt lgkmcnt(5)
    v_mfma_f32_16x16x32_bf16 v[40:43], a[8:11], a[92:95], v[40:43]
    ds_read_b128 a[0:3], v8 offset:43008
    s_waitcnt lgkmcnt(5)
    v_mfma_f32_16x16x32_bf16 v[56:59], a[12:15], a[92:95], v[56:59]
    ds_read_b128 a[4:7], v8 offset:44032
    s_waitcnt lgkmcnt(5)
    v_mfma_f32_16x16x32_bf16 v[72:75], a[16:19], a[92:95], v[72:75]
    ds_read_b128 a[8:11], v8 offset:45056
    s_waitcnt lgkmcnt(5)
    v_mfma_f32_16x16x32_bf16 v[88:91], a[20:23], a[92:95], v[88:91]
    ds_read_b128 a[12:15], v8 offset:46080
    s_waitcnt lgkmcnt(5)
    v_mfma_f32_16x16x32_bf16 v[104:107], a[24:27], a[92:95], v[104:107]
    ds_read_b128 a[16:19], v8 offset:47104
    s_waitcnt lgkmcnt(5)
    v_mfma_f32_16x16x32_bf16 v[120:123], a[28:31], a[92:95], v[120:123]
    ds_read_b128 a[20:23], v8 offset:48128
    s_waitcnt lgkmcnt(5)
    v_mfma_f32_16x16x32_bf16 v[40:43], a[0:3], a[96:99], v[40:43]
    ds_read_b128 a[24:27], v8 offset:49152
    s_waitcnt lgkmcnt(5)
    v_mfma_f32_16x16x32_bf16 v[56:59], a[4:7], a[96:99], v[56:59]
    ds_read_b128 a[28:31], v8 offset:50176
    s_waitcnt lgkmcnt(5)
    v_mfma_f32_16x16x32_bf16 v[72:75], a[8:11], a[96:99], v[72:75]
    ds_read_b128 a[0:3], v8 offset:51200
    s_waitcnt lgkmcnt(5)
    v_mfma_f32_16x16x32_bf16 v[88:91], a[12:15], a[96:99], v[88:91]
    ds_read_b128 a[4:7], v8 offset:52224
    s_waitcnt lgkmcnt(5)
    v_mfma_f32_16x16x32_bf16 v[104:107], a[16:19], a[96:99], v[104:107]
    ds_read_b128 a[8:11], v8 offset:53248
    s_waitcnt lgkmcnt(5)
    v_mfma_f32_16x16x32_bf16 v[120:123], a[20:23], a[96:99], v[120:123]
    ds_read_b128 a[12:15], v8 offset:54272
    s_waitcnt lgkmcnt(5)
    v_mfma_f32_16x16x32_bf16 v[40:43], a[24:27], a[100:103], v[40:43]
    s_waitcnt lgkmcnt(4)
    v_mfma_f32_16x16x32_bf16 v[56:59], a[28:31], a[100:103], v[56:59]
    s_waitcnt lgkmcnt(3)
    v_mfma_f32_16x16x32_bf16 v[72:75], a[0:3], a[100:103], v[72:75]
    s_waitcnt lgkmcnt(2)
    v_mfma_f32_16x16x32_bf16 v[88:91], a[4:7], a[100:103], v[88:91]
    s_waitcnt lgkmcnt(1)
    v_mfma_f32_16x16x32_bf16 v[104:107], a[8:11], a[100:103], v[104:107]
    s_waitcnt lgkmcnt(0)
    v_mfma_f32_16x16x32_bf16 v[120:123], a[12:15], a[100:103], v[120:123]
    s_barrier
    s_add_u32 s48, s45, 0
    s_add_u32 s49, s45, 7340032
    s_add_u32 s50, s45, 4194304
    s_mul_i32 s41, s3, 3072
    s_add_u32 s41, s41, 110592
    v_add_u32 v6, s41, v0
    s_add_u32 s42, s48, 0
    buffer_load_dwordx4 v[32:35], v0, s[20:23], s42 offen sc1
    s_add_u32 s42, s49, 0
    buffer_load_dwordx4 v[80:83], v0, s[20:23], s42 offen sc1
    s_add_u32 s42, s50, 0
    buffer_load_dwordx4 v[36:39], v0, s[20:23], s42 offen sc1
    ds_read_b128 v[84:87], v6 offset:0
    s_add_u32 s42, s48, 1024
    buffer_load_dwordx4 v[48:51], v0, s[20:23], s42 offen sc1
    s_add_u32 s42, s49, 1024
    buffer_load_dwordx4 v[96:99], v0, s[20:23], s42 offen sc1
    s_add_u32 s42, s50, 1024
    buffer_load_dwordx4 v[52:55], v0, s[20:23], s42 offen sc1
    ds_read_b128 v[100:103], v6 offset:1024
    s_add_u32 s42, s48, 2048
    buffer_load_dwordx4 v[64:67], v0, s[20:23], s42 offen sc1
    s_add_u32 s42, s49, 2048
    buffer_load_dwordx4 v[112:115], v0, s[20:23], s42 offen sc1
    s_add_u32 s42, s50, 2048
    buffer_load_dwordx4 v[68:71], v0, s[20:23], s42 offen sc1
    ds_read_b128 v[116:119], v6 offset:2048
    s_mov_b32 s40, 0xbfb8aa3b
    s_mov_b32 s41, 0x3f80
    s_mov_b32 s42, 0x3f800000
    s_waitcnt vmcnt(6) lgkmcnt(2)
    v_dot2_f32_bf16 v12, v32, s41, 0
    v_dot2_f32_bf16 v13, v32, s42, 0
    v_dot2_f32_bf16 v12, v80, s41, v12
    v_dot2_f32_bf16 v13, v80, s42, v13
    v_dot2_f32_bf16 v12, v36, s41, v12
    v_dot2_f32_bf16 v13, v36, s42, v13
    v_dot2_f32_bf16 v12, v84, s41, v12
    v_dot2_f32_bf16 v13, v84, s42, v13
    v_dot2_f32_bf16 v14, v33, s41, 0
    v_dot2_f32_bf16 v15, v33, s42, 0
    v_dot2_f32_bf16 v14, v81, s41, v14
    v_dot2_f32_bf16 v15, v81, s42, v15
    v_dot2_f32_bf16 v14, v37, s41, v14
    v_dot2_f32_bf16 v15, v37, s42, v15
    v_dot2_f32_bf16 v14, v85, s41, v14
    v_dot2_f32_bf16 v15, v85, s42, v15
    v_mul_f32 v92, s40, v12
    v_mul_f32 v93, s40, v13
    v_mul_f32 v94, s40, v14
    v_mul_f32 v95, s40, v15
    v_exp_f32 v92, v92
    v_exp_f32 v93, v93
    v_exp_f32 v94, v94
    v_exp_f32 v95, v95
    v_add_f32 v92, 1.0, v92
    v_add_f32 v93, 1.0, v93
    v_add_f32 v94, 1.0, v94
    v_add_f32 v95, 1.0, v95
    v_rcp_f32 v92, v92
    v_rcp_f32 v93, v93
    v_rcp_f32 v94, v94
    v_rcp_f32 v95, v95
    v_mul_f32 v12, v12, v40
    v_mul_f32 v13, v13, v41
    v_mul_f32 v14, v14, v42
    v_mul_f32 v15, v15, v43
    v_lshlrev_b32 v108, 16, v44
    v_and_b32 v109, 0xffff0000, v44
    v_lshlrev_b32 v110, 16, v45
    v_and_b32 v111, 0xffff0000, v45
    v_fma_f32 v12, v12, v92, v108
    v_fma_f32 v13, v13, v93, v109
    v_fma_f32 v14, v14, v94, v110
    v_fma_f32 v15, v15, v95, v111
    v_cvt_pk_bf16_f32 v124, v12, v13
    v_cvt_pk_bf16_f32 v125, v14, v15
    buffer_store_dwordx2 v[124:125], v7, s[16:19], 0 offen offset:0
    v_dot2_f32_bf16 v12, v34, s41, 0
    v_dot2_f32_bf16 v13, v34, s42, 0
    v_dot2_f32_bf16 v12, v82, s41, v12
    v_dot2_f32_bf16 v13, v82, s42, v13
    v_dot2_f32_bf16 v12, v38, s41, v12
    v_dot2_f32_bf16 v13, v38, s42, v13
    v_dot2_f32_bf16 v12, v86, s41, v12
    v_dot2_f32_bf16 v13, v86, s42, v13
    v_dot2_f32_bf16 v14, v35, s41, 0
    v_dot2_f32_bf16 v15, v35, s42, 0
    v_dot2_f32_bf16 v14, v83, s41, v14
    v_dot2_f32_bf16 v15, v83, s42, v15
    v_dot2_f32_bf16 v14, v39, s41, v14
    v_dot2_f32_bf16 v15, v39, s42, v15
    v_dot2_f32_bf16 v14, v87, s41, v14
    v_dot2_f32_bf16 v15, v87, s42, v15
    v_mul_f32 v92, s40, v12
    v_mul_f32 v93, s40, v13
    v_mul_f32 v94, s40, v14
    v_mul_f32 v95, s40, v15
    v_exp_f32 v92, v92
    v_exp_f32 v93, v93
    v_exp_f32 v94, v94
    v_exp_f32 v95, v95
    v_add_f32 v92, 1.0, v92
    v_add_f32 v93, 1.0, v93
    v_add_f32 v94, 1.0, v94
    v_add_f32 v95, 1.0, v95
    v_rcp_f32 v92, v92
    v_rcp_f32 v93, v93
    v_rcp_f32 v94, v94
    v_rcp_f32 v95, v95
    v_mul_f32 v12, v12, v56
    v_mul_f32 v13, v13, v57
    v_mul_f32 v14, v14, v58
    v_mul_f32 v15, v15, v59
    v_lshlrev_b32 v108, 16, v46
    v_and_b32 v109, 0xffff0000, v46
    v_lshlrev_b32 v110, 16, v47
    v_and_b32 v111, 0xffff0000, v47
    v_fma_f32 v12, v12, v92, v108
    v_fma_f32 v13, v13, v93, v109
    v_fma_f32 v14, v14, v94, v110
    v_fma_f32 v15, v15, v95, v111
    v_cvt_pk_bf16_f32 v126, v12, v13
    v_cvt_pk_bf16_f32 v127, v14, v15
    buffer_store_dwordx2 v[126:127], v7, s[16:19], 0 offen offset:32
    s_waitcnt vmcnt(5) lgkmcnt(1)
    v_dot2_f32_bf16 v12, v48, s41, 0
    v_dot2_f32_bf16 v13, v48, s42, 0
    v_dot2_f32_bf16 v12, v96, s41, v12
    v_dot2_f32_bf16 v13, v96, s42, v13
    v_dot2_f32_bf16 v12, v52, s41, v12
    v_dot2_f32_bf16 v13, v52, s42, v13
    v_dot2_f32_bf16 v12, v100, s41, v12
    v_dot2_f32_bf16 v13, v100, s42, v13
    v_dot2_f32_bf16 v14, v49, s41, 0
    v_dot2_f32_bf16 v15, v49, s42, 0
    v_dot2_f32_bf16 v14, v97, s41, v14
    v_dot2_f32_bf16 v15, v97, s42, v15
    v_dot2_f32_bf16 v14, v53, s41, v14
    v_dot2_f32_bf16 v15, v53, s42, v15
    v_dot2_f32_bf16 v14, v101, s41, v14
    v_dot2_f32_bf16 v15, v101, s42, v15
    v_mul_f32 v92, s40, v12
    v_mul_f32 v93, s40, v13
    v_mul_f32 v94, s40, v14
    v_mul_f32 v95, s40, v15
    v_exp_f32 v92, v92
    v_exp_f32 v93, v93
    v_exp_f32 v94, v94
    v_exp_f32 v95, v95
    v_add_f32 v92, 1.0, v92
    v_add_f32 v93, 1.0, v93
    v_add_f32 v94, 1.0, v94
    v_add_f32 v95, 1.0, v95
    v_rcp_f32 v92, v92
    v_rcp_f32 v93, v93
    v_rcp_f32 v94, v94
    v_rcp_f32 v95, v95
    v_mul_f32 v12, v12, v72
    v_mul_f32 v13, v13, v73
    v_mul_f32 v14, v14, v74
    v_mul_f32 v15, v15, v75
    v_lshlrev_b32 v108, 16, v60
    v_and_b32 v109, 0xffff0000, v60
    v_lshlrev_b32 v110, 16, v61
    v_and_b32 v111, 0xffff0000, v61
    v_fma_f32 v12, v12, v92, v108
    v_fma_f32 v13, v13, v93, v109
    v_fma_f32 v14, v14, v94, v110
    v_fma_f32 v15, v15, v95, v111
    v_cvt_pk_bf16_f32 v124, v12, v13
    v_cvt_pk_bf16_f32 v125, v14, v15
    buffer_store_dwordx2 v[124:125], v7, s[16:19], 0 offen offset:64
    v_dot2_f32_bf16 v12, v50, s41, 0
    v_dot2_f32_bf16 v13, v50, s42, 0
    v_dot2_f32_bf16 v12, v98, s41, v12
    v_dot2_f32_bf16 v13, v98, s42, v13
    v_dot2_f32_bf16 v12, v54, s41, v12
    v_dot2_f32_bf16 v13, v54, s42, v13
    v_dot2_f32_bf16 v12, v102, s41, v12
    v_dot2_f32_bf16 v13, v102, s42, v13
    v_dot2_f32_bf16 v14, v51, s41, 0
    v_dot2_f32_bf16 v15, v51, s42, 0
    v_dot2_f32_bf16 v14, v99, s41, v14
    v_dot2_f32_bf16 v15, v99, s42, v15
    v_dot2_f32_bf16 v14, v55, s41, v14
    v_dot2_f32_bf16 v15, v55, s42, v15
    v_dot2_f32_bf16 v14, v103, s41, v14
    v_dot2_f32_bf16 v15, v103, s42, v15
    v_mul_f32 v92, s40, v12
    v_mul_f32 v93, s40, v13
    v_mul_f32 v94, s40, v14
    v_mul_f32 v95, s40, v15
    v_exp_f32 v92, v92
    v_exp_f32 v93, v93
    v_exp_f32 v94, v94
    v_exp_f32 v95, v95
    v_add_f32 v92, 1.0, v92
    v_add_f32 v93, 1.0, v93
    v_add_f32 v94, 1.0, v94
    v_add_f32 v95, 1.0, v95
    v_rcp_f32 v92, v92
    v_rcp_f32 v93, v93
    v_rcp_f32 v94, v94
    v_rcp_f32 v95, v95
    v_mul_f32 v12, v12, v88
    v_mul_f32 v13, v13, v89
    v_mul_f32 v14, v14, v90
    v_mul_f32 v15, v15, v91
    v_lshlrev_b32 v108, 16, v62
    v_and_b32 v109, 0xffff0000, v62
    v_lshlrev_b32 v110, 16, v63
    v_and_b32 v111, 0xffff0000, v63
    v_fma_f32 v12, v12, v92, v108
    v_fma_f32 v13, v13, v93, v109
    v_fma_f32 v14, v14, v94, v110
    v_fma_f32 v15, v15, v95, v111
    v_cvt_pk_bf16_f32 v126, v12, v13
    v_cvt_pk_bf16_f32 v127, v14, v15
    buffer_store_dwordx2 v[126:127], v7, s[16:19], 0 offen offset:96
    s_waitcnt vmcnt(4) lgkmcnt(0)
    v_dot2_f32_bf16 v12, v64, s41, 0
    v_dot2_f32_bf16 v13, v64, s42, 0
    v_dot2_f32_bf16 v12, v112, s41, v12
    v_dot2_f32_bf16 v13, v112, s42, v13
    v_dot2_f32_bf16 v12, v68, s41, v12
    v_dot2_f32_bf16 v13, v68, s42, v13
    v_dot2_f32_bf16 v12, v116, s41, v12
    v_dot2_f32_bf16 v13, v116, s42, v13
    v_dot2_f32_bf16 v14, v65, s41, 0
    v_dot2_f32_bf16 v15, v65, s42, 0
    v_dot2_f32_bf16 v14, v113, s41, v14
    v_dot2_f32_bf16 v15, v113, s42, v15
    v_dot2_f32_bf16 v14, v69, s41, v14
    v_dot2_f32_bf16 v15, v69, s42, v15
    v_dot2_f32_bf16 v14, v117, s41, v14
    v_dot2_f32_bf16 v15, v117, s42, v15
    v_mul_f32 v92, s40, v12
    v_mul_f32 v93, s40, v13
    v_mul_f32 v94, s40, v14
    v_mul_f32 v95, s40, v15
    v_exp_f32 v92, v92
    v_exp_f32 v93, v93
    v_exp_f32 v94, v94
    v_exp_f32 v95, v95
    v_add_f32 v92, 1.0, v92
    v_add_f32 v93, 1.0, v93
    v_add_f32 v94, 1.0, v94
    v_add_f32 v95, 1.0, v95
    v_rcp_f32 v92, v92
    v_rcp_f32 v93, v93
    v_rcp_f32 v94, v94
    v_rcp_f32 v95, v95
    v_mul_f32 v12, v12, v104
    v_mul_f32 v13, v13, v105
    v_mul_f32 v14, v14, v106
    v_mul_f32 v15, v15, v107
    v_lshlrev_b32 v108, 16, v76
    v_and_b32 v109, 0xffff0000, v76
    v_lshlrev_b32 v110, 16, v77
    v_and_b32 v111, 0xffff0000, v77
    v_fma_f32 v12, v12, v92, v108
    v_fma_f32 v13, v13, v93, v109
    v_fma_f32 v14, v14, v94, v110
    v_fma_f32 v15, v15, v95, v111
    v_cvt_pk_bf16_f32 v124, v12, v13
    v_cvt_pk_bf16_f32 v125, v14, v15
    buffer_store_dwordx2 v[124:125], v7, s[16:19], 0 offen offset:128
    v_dot2_f32_bf16 v12, v66, s41, 0
    v_dot2_f32_bf16 v13, v66, s42, 0
    v_dot2_f32_bf16 v12, v114, s41, v12
    v_dot2_f32_bf16 v13, v114, s42, v13
    v_dot2_f32_bf16 v12, v70, s41, v12
    v_dot2_f32_bf16 v13, v70, s42, v13
    v_dot2_f32_bf16 v12, v118, s41, v12
    v_dot2_f32_bf16 v13, v118, s42, v13
    v_dot2_f32_bf16 v14, v67, s41, 0
    v_dot2_f32_bf16 v15, v67, s42, 0
    v_dot2_f32_bf16 v14, v115, s41, v14
    v_dot2_f32_bf16 v15, v115, s42, v15
    v_dot2_f32_bf16 v14, v71, s41, v14
    v_dot2_f32_bf16 v15, v71, s42, v15
    v_dot2_f32_bf16 v14, v119, s41, v14
    v_dot2_f32_bf16 v15, v119, s42, v15
    v_mul_f32 v92, s40, v12
    v_mul_f32 v93, s40, v13
    v_mul_f32 v94, s40, v14
    v_mul_f32 v95, s40, v15
    v_exp_f32 v92, v92
    v_exp_f32 v93, v93
    v_exp_f32 v94, v94
    v_exp_f32 v95, v95
    v_add_f32 v92, 1.0, v92
    v_add_f32 v93, 1.0, v93
    v_add_f32 v94, 1.0, v94
    v_add_f32 v95, 1.0, v95
    v_rcp_f32 v92, v92
    v_rcp_f32 v93, v93
    v_rcp_f32 v94, v94
    v_rcp_f32 v95, v95
    v_mul_f32 v12, v12, v120
    v_mul_f32 v13, v13, v121
    v_mul_f32 v14, v14, v122
    v_mul_f32 v15, v15, v123
    v_lshlrev_b32 v108, 16, v78
    v_and_b32 v109, 0xffff0000, v78
    v_lshlrev_b32 v110, 16, v79
    v_and_b32 v111, 0xffff0000, v79
    v_fma_f32 v12, v12, v92, v108
    v_fma_f32 v13, v13, v93, v109
    v_fma_f32 v14, v14, v94, v110
    v_fma_f32 v15, v15, v95, v111
    v_cvt_pk_bf16_f32 v126, v12, v13
    v_cvt_pk_bf16_f32 v127, v14, v15
    buffer_store_dwordx2 v[126:127], v7, s[16:19], 0 offen offset:160
    s_branch l2_kernel_end
l2_kernel_loader:
    s_mul_i32 s37, s30, 1327104
    s_mul_i32 s38, s32, 384
    s_add_u32 s37, s37, s38
    s_mul_i32 s38, s34, 9216
    s_add_u32 s37, s37, s38
    s_mul_i32 s39, s34, 3072
    v_add_u32 v12, 0, v11
    s_mov_b32 s40, 178956971
    v_mul_hi_u32 v13, v12, s40
    v_mul_u32_u24 v14, 24, v13
    v_sub_u32 v14, v12, v14
    v_and_b32 v15, 6, v13
    v_xor_b32 v14, v14, v15
    v_mul_u32_u24 v13, 1152, v13
    v_lshl_add_u32 v1, v14, 4, v13
    v_add_u32 v12, 64, v11
    s_mov_b32 s40, 178956971
    v_mul_hi_u32 v13, v12, s40
    v_mul_u32_u24 v14, 24, v13
    v_sub_u32 v14, v12, v14
    v_and_b32 v15, 6, v13
    v_xor_b32 v14, v14, v15
    v_mul_u32_u24 v13, 1152, v13
    v_lshl_add_u32 v2, v14, 4, v13
    v_add_u32 v12, 128, v11
    s_mov_b32 s40, 178956971
    v_mul_hi_u32 v13, v12, s40
    v_mul_u32_u24 v14, 24, v13
    v_sub_u32 v14, v12, v14
    v_and_b32 v15, 6, v13
    v_xor_b32 v14, v14, v15
    v_mul_u32_u24 v13, 1152, v13
    v_lshl_add_u32 v3, v14, 4, v13
    s_add_u32 m0, s39, 0
    s_add_u32 s41, s37, 0
    buffer_load_dwordx4 v1, s[12:15], s41 offen lds
    s_add_u32 m0, s39, 1024
    s_nop 0
    buffer_load_dwordx4 v2, s[12:15], s41 offen lds
    s_add_u32 m0, s39, 2048
    s_nop 0
    buffer_load_dwordx4 v3, s[12:15], s41 offen lds
    s_add_u32 m0, s39, 12288
    s_add_u32 s41, s37, 36864
    buffer_load_dwordx4 v1, s[12:15], s41 offen lds
    s_add_u32 m0, s39, 13312
    s_nop 0
    buffer_load_dwordx4 v2, s[12:15], s41 offen lds
    s_add_u32 m0, s39, 14336
    s_nop 0
    buffer_load_dwordx4 v3, s[12:15], s41 offen lds
    s_add_u32 m0, s39, 24576
    s_add_u32 s41, s37, 73728
    buffer_load_dwordx4 v1, s[12:15], s41 offen lds
    s_add_u32 m0, s39, 25600
    s_nop 0
    buffer_load_dwordx4 v2, s[12:15], s41 offen lds
    s_add_u32 m0, s39, 26624
    s_nop 0
    buffer_load_dwordx4 v3, s[12:15], s41 offen lds
    s_add_u32 m0, s39, 36864
    s_add_u32 s41, s37, 110592
    buffer_load_dwordx4 v1, s[12:15], s41 offen lds
    s_add_u32 m0, s39, 37888
    s_nop 0
    buffer_load_dwordx4 v2, s[12:15], s41 offen lds
    s_add_u32 m0, s39, 38912
    s_nop 0
    buffer_load_dwordx4 v3, s[12:15], s41 offen lds
    s_mul_i32 s46, s29, 110592
    s_add_u32 s46, s46, 3145728
    s_add_u32 s40, s34, 0
    s_mul_i32 s41, s40, 43
    s_lshr_b32 s41, s41, 8
    s_mul_i32 s42, s41, 6
    s_sub_u32 s42, s40, s42
    s_mul_i32 s42, s42, 18432
    s_lshl_b32 s41, s41, 10
    s_add_u32 s42, s42, s41
    s_add_u32 s48, s42, s46
    s_add_u32 s40, s34, 4
    s_mul_i32 s41, s40, 43
    s_lshr_b32 s41, s41, 8
    s_mul_i32 s42, s41, 6
    s_sub_u32 s42, s40, s42
    s_mul_i32 s42, s42, 18432
    s_lshl_b32 s41, s41, 10
    s_add_u32 s42, s42, s41
    s_add_u32 s49, s42, s46
    s_add_u32 s40, s34, 8
    s_mul_i32 s41, s40, 43
    s_lshr_b32 s41, s41, 8
    s_mul_i32 s42, s41, 6
    s_sub_u32 s42, s40, s42
    s_mul_i32 s42, s42, 18432
    s_lshl_b32 s41, s41, 10
    s_add_u32 s42, s42, s41
    s_add_u32 s50, s42, s46
    s_add_u32 s40, s34, 12
    s_mul_i32 s41, s40, 43
    s_lshr_b32 s41, s41, 8
    s_mul_i32 s42, s41, 6
    s_sub_u32 s42, s40, s42
    s_mul_i32 s42, s42, 18432
    s_lshl_b32 s41, s41, 10
    s_add_u32 s42, s42, s41
    s_add_u32 s51, s42, s46
    s_add_u32 s40, s34, 16
    s_mul_i32 s41, s40, 43
    s_lshr_b32 s41, s41, 8
    s_mul_i32 s42, s41, 6
    s_sub_u32 s42, s40, s42
    s_mul_i32 s42, s42, 18432
    s_lshl_b32 s41, s41, 10
    s_add_u32 s42, s42, s41
    s_add_u32 s52, s42, s46
    s_add_u32 s40, s34, 20
    s_mul_i32 s41, s40, 43
    s_lshr_b32 s41, s41, 8
    s_mul_i32 s42, s41, 6
    s_sub_u32 s42, s40, s42
    s_mul_i32 s42, s42, 18432
    s_lshl_b32 s41, s41, 10
    s_add_u32 s42, s42, s41
    s_add_u32 s53, s42, s46
    s_add_u32 s40, s34, 24
    s_mul_i32 s41, s40, 43
    s_lshr_b32 s41, s41, 8
    s_mul_i32 s42, s41, 6
    s_sub_u32 s42, s40, s42
    s_mul_i32 s42, s42, 18432
    s_lshl_b32 s41, s41, 10
    s_add_u32 s42, s42, s41
    s_add_u32 s54, s42, s46
    s_add_u32 s40, s34, 28
    s_mul_i32 s41, s40, 43
    s_lshr_b32 s41, s41, 8
    s_mul_i32 s42, s41, 6
    s_sub_u32 s42, s40, s42
    s_mul_i32 s42, s42, 18432
    s_lshl_b32 s41, s41, 10
    s_add_u32 s42, s42, s41
    s_add_u32 s55, s42, s46
    s_add_u32 s40, s34, 32
    s_mul_i32 s41, s40, 43
    s_lshr_b32 s41, s41, 8
    s_mul_i32 s42, s41, 6
    s_sub_u32 s42, s40, s42
    s_mul_i32 s42, s42, 18432
    s_lshl_b32 s41, s41, 10
    s_add_u32 s42, s42, s41
    s_add_u32 s56, s42, s46
    s_lshl_b32 s57, s34, 10
    s_waitcnt vmcnt(0)
    s_barrier
    s_add_u32 m0, s39, 49152
    s_add_u32 s41, s37, 147456
    buffer_load_dwordx4 v1, s[12:15], s41 offen lds
    s_add_u32 m0, s39, 50176
    s_nop 0
    buffer_load_dwordx4 v2, s[12:15], s41 offen lds
    s_add_u32 m0, s39, 51200
    s_nop 0
    buffer_load_dwordx4 v3, s[12:15], s41 offen lds
    s_add_u32 m0, s39, 61440
    s_add_u32 s41, s37, 184320
    buffer_load_dwordx4 v1, s[12:15], s41 offen lds
    s_add_u32 m0, s39, 62464
    s_nop 0
    buffer_load_dwordx4 v2, s[12:15], s41 offen lds
    s_add_u32 m0, s39, 63488
    s_nop 0
    buffer_load_dwordx4 v3, s[12:15], s41 offen lds
    s_add_u32 m0, s39, 73728
    s_add_u32 s41, s37, 221184
    buffer_load_dwordx4 v1, s[12:15], s41 offen lds
    s_add_u32 m0, s39, 74752
    s_nop 0
    buffer_load_dwordx4 v2, s[12:15], s41 offen lds
    s_add_u32 m0, s39, 75776
    s_nop 0
    buffer_load_dwordx4 v3, s[12:15], s41 offen lds
    s_add_u32 m0, s39, 86016
    s_add_u32 s41, s37, 258048
    buffer_load_dwordx4 v1, s[12:15], s41 offen lds
    s_add_u32 m0, s39, 87040
    s_nop 0
    buffer_load_dwordx4 v2, s[12:15], s41 offen lds
    s_add_u32 m0, s39, 88064
    s_nop 0
    buffer_load_dwordx4 v3, s[12:15], s41 offen lds
    s_add_u32 m0, s39, 98304
    s_add_u32 s41, s37, 294912
    buffer_load_dwordx4 v1, s[12:15], s41 offen lds
    s_add_u32 m0, s39, 99328
    s_nop 0
    buffer_load_dwordx4 v2, s[12:15], s41 offen lds
    s_add_u32 m0, s39, 100352
    s_nop 0
    buffer_load_dwordx4 v3, s[12:15], s41 offen lds
    s_add_u32 m0, s39, 110592
    s_add_u32 s41, s37, 331776
    buffer_load_dwordx4 v1, s[12:15], s41 offen lds
    s_add_u32 m0, s39, 111616
    s_nop 0
    buffer_load_dwordx4 v2, s[12:15], s41 offen lds
    s_add_u32 m0, s39, 112640
    s_nop 0
    buffer_load_dwordx4 v3, s[12:15], s41 offen lds
    s_add_u32 m0, s39, 122880
    s_add_u32 s41, s37, 368640
    buffer_load_dwordx4 v1, s[12:15], s41 offen lds
    s_add_u32 m0, s39, 123904
    s_nop 0
    buffer_load_dwordx4 v2, s[12:15], s41 offen lds
    s_add_u32 m0, s39, 124928
    s_nop 0
    buffer_load_dwordx4 v3, s[12:15], s41 offen lds
    s_add_u32 m0, s39, 135168
    s_add_u32 s41, s37, 405504
    buffer_load_dwordx4 v1, s[12:15], s41 offen lds
    s_add_u32 m0, s39, 136192
    s_nop 0
    buffer_load_dwordx4 v2, s[12:15], s41 offen lds
    s_add_u32 m0, s39, 137216
    s_nop 0
    buffer_load_dwordx4 v3, s[12:15], s41 offen lds
    s_waitcnt vmcnt(12)
    s_barrier
    s_add_u32 m0, s39, 0
    s_add_u32 s41, s37, 442368
    buffer_load_dwordx4 v1, s[12:15], s41 offen lds
    s_add_u32 m0, s39, 1024
    s_nop 0
    buffer_load_dwordx4 v2, s[12:15], s41 offen lds
    s_add_u32 m0, s39, 2048
    s_nop 0
    buffer_load_dwordx4 v3, s[12:15], s41 offen lds
    s_add_u32 m0, s39, 12288
    s_add_u32 s41, s37, 479232
    buffer_load_dwordx4 v1, s[12:15], s41 offen lds
    s_add_u32 m0, s39, 13312
    s_nop 0
    buffer_load_dwordx4 v2, s[12:15], s41 offen lds
    s_add_u32 m0, s39, 14336
    s_nop 0
    buffer_load_dwordx4 v3, s[12:15], s41 offen lds
    s_add_u32 m0, s39, 24576
    s_add_u32 s41, s37, 516096
    buffer_load_dwordx4 v1, s[12:15], s41 offen lds
    s_add_u32 m0, s39, 25600
    s_nop 0
    buffer_load_dwordx4 v2, s[12:15], s41 offen lds
    s_add_u32 m0, s39, 26624
    s_nop 0
    buffer_load_dwordx4 v3, s[12:15], s41 offen lds
    s_waitcnt vmcnt(9)
    s_barrier
    s_add_u32 m0, s39, 36864
    s_add_u32 s41, s37, 552960
    buffer_load_dwordx4 v1, s[12:15], s41 offen lds
    s_add_u32 m0, s39, 37888
    s_nop 0
    buffer_load_dwordx4 v2, s[12:15], s41 offen lds
    s_add_u32 m0, s39, 38912
    s_nop 0
    buffer_load_dwordx4 v3, s[12:15], s41 offen lds
    s_add_u32 m0, s39, 49152
    s_add_u32 s41, s37, 589824
    buffer_load_dwordx4 v1, s[12:15], s41 offen lds
    s_add_u32 m0, s39, 50176
    s_nop 0
    buffer_load_dwordx4 v2, s[12:15], s41 offen lds
    s_add_u32 m0, s39, 51200
    s_nop 0
    buffer_load_dwordx4 v3, s[12:15], s41 offen lds
    s_add_u32 m0, s39, 61440
    s_add_u32 s41, s37, 626688
    buffer_load_dwordx4 v1, s[12:15], s41 offen lds
    s_add_u32 m0, s39, 62464
    s_nop 0
    buffer_load_dwordx4 v2, s[12:15], s41 offen lds
    s_add_u32 m0, s39, 63488
    s_nop 0
    buffer_load_dwordx4 v3, s[12:15], s41 offen lds
    s_add_u32 m0, s39, 73728
    s_add_u32 s41, s37, 663552
    buffer_load_dwordx4 v1, s[12:15], s41 offen lds
    s_add_u32 m0, s39, 74752
    s_nop 0
    buffer_load_dwordx4 v2, s[12:15], s41 offen lds
    s_add_u32 m0, s39, 75776
    s_nop 0
    buffer_load_dwordx4 v3, s[12:15], s41 offen lds
    s_waitcnt vmcnt(9)
    s_barrier
    s_add_u32 m0, s39, 86016
    s_add_u32 s41, s37, 700416
    buffer_load_dwordx4 v1, s[12:15], s41 offen lds
    s_add_u32 m0, s39, 87040
    s_nop 0
    buffer_load_dwordx4 v2, s[12:15], s41 offen lds
    s_add_u32 m0, s39, 88064
    s_nop 0
    buffer_load_dwordx4 v3, s[12:15], s41 offen lds
    s_add_u32 m0, s39, 98304
    s_add_u32 s41, s37, 737280
    buffer_load_dwordx4 v1, s[12:15], s41 offen lds
    s_add_u32 m0, s39, 99328
    s_nop 0
    buffer_load_dwordx4 v2, s[12:15], s41 offen lds
    s_add_u32 m0, s39, 100352
    s_nop 0
    buffer_load_dwordx4 v3, s[12:15], s41 offen lds
    s_add_u32 m0, s39, 110592
    s_add_u32 s41, s37, 774144
    buffer_load_dwordx4 v1, s[12:15], s41 offen lds
    s_add_u32 m0, s39, 111616
    s_nop 0
    buffer_load_dwordx4 v2, s[12:15], s41 offen lds
    s_add_u32 m0, s39, 112640
    s_nop 0
    buffer_load_dwordx4 v3, s[12:15], s41 offen lds
    s_add_u32 m0, s39, 122880
    s_add_u32 s41, s37, 811008
    buffer_load_dwordx4 v1, s[12:15], s41 offen lds
    s_add_u32 m0, s39, 123904
    s_nop 0
    buffer_load_dwordx4 v2, s[12:15], s41 offen lds
    s_add_u32 m0, s39, 124928
    s_nop 0
    buffer_load_dwordx4 v3, s[12:15], s41 offen lds
    s_waitcnt vmcnt(9)
    s_barrier
    s_add_u32 m0, s39, 135168
    s_add_u32 s41, s37, 847872
    buffer_load_dwordx4 v1, s[12:15], s41 offen lds
    s_add_u32 m0, s39, 136192
    s_nop 0
    buffer_load_dwordx4 v2, s[12:15], s41 offen lds
    s_add_u32 m0, s39, 137216
    s_nop 0
    buffer_load_dwordx4 v3, s[12:15], s41 offen lds
    s_add_u32 m0, s39, 0
    s_add_u32 s41, s37, 884736
    buffer_load_dwordx4 v1, s[12:15], s41 offen lds
    s_add_u32 m0, s39, 1024
    s_nop 0
    buffer_load_dwordx4 v2, s[12:15], s41 offen lds
    s_add_u32 m0, s39, 2048
    s_nop 0
    buffer_load_dwordx4 v3, s[12:15], s41 offen lds
    s_add_u32 m0, s39, 12288
    s_add_u32 s41, s37, 921600
    buffer_load_dwordx4 v1, s[12:15], s41 offen lds
    s_add_u32 m0, s39, 13312
    s_nop 0
    buffer_load_dwordx4 v2, s[12:15], s41 offen lds
    s_add_u32 m0, s39, 14336
    s_nop 0
    buffer_load_dwordx4 v3, s[12:15], s41 offen lds
    s_add_u32 m0, s39, 24576
    s_add_u32 s41, s37, 958464
    buffer_load_dwordx4 v1, s[12:15], s41 offen lds
    s_add_u32 m0, s39, 25600
    s_nop 0
    buffer_load_dwordx4 v2, s[12:15], s41 offen lds
    s_add_u32 m0, s39, 26624
    s_nop 0
    buffer_load_dwordx4 v3, s[12:15], s41 offen lds
    s_waitcnt vmcnt(9)
    s_barrier
    s_add_u32 m0, s39, 36864
    s_add_u32 s41, s37, 995328
    buffer_load_dwordx4 v1, s[12:15], s41 offen lds
    s_add_u32 m0, s39, 37888
    s_nop 0
    buffer_load_dwordx4 v2, s[12:15], s41 offen lds
    s_add_u32 m0, s39, 38912
    s_nop 0
    buffer_load_dwordx4 v3, s[12:15], s41 offen lds
    s_add_u32 m0, s39, 49152
    s_add_u32 s41, s37, 1032192
    buffer_load_dwordx4 v1, s[12:15], s41 offen lds
    s_add_u32 m0, s39, 50176
    s_nop 0
    buffer_load_dwordx4 v2, s[12:15], s41 offen lds
    s_add_u32 m0, s39, 51200
    s_nop 0
    buffer_load_dwordx4 v3, s[12:15], s41 offen lds
    s_add_u32 m0, s39, 61440
    s_add_u32 s41, s37, 1069056
    buffer_load_dwordx4 v1, s[12:15], s41 offen lds
    s_add_u32 m0, s39, 62464
    s_nop 0
    buffer_load_dwordx4 v2, s[12:15], s41 offen lds
    s_add_u32 m0, s39, 63488
    s_nop 0
    buffer_load_dwordx4 v3, s[12:15], s41 offen lds
    s_add_u32 m0, s39, 73728
    s_add_u32 s41, s37, 1105920
    buffer_load_dwordx4 v1, s[12:15], s41 offen lds
    s_add_u32 m0, s39, 74752
    s_nop 0
    buffer_load_dwordx4 v2, s[12:15], s41 offen lds
    s_add_u32 m0, s39, 75776
    s_nop 0
    buffer_load_dwordx4 v3, s[12:15], s41 offen lds
    s_waitcnt vmcnt(9)
    s_barrier
    s_add_u32 m0, s39, 86016
    s_add_u32 s41, s37, 1142784
    buffer_load_dwordx4 v1, s[12:15], s41 offen lds
    s_add_u32 m0, s39, 87040
    s_nop 0
    buffer_load_dwordx4 v2, s[12:15], s41 offen lds
    s_add_u32 m0, s39, 88064
    s_nop 0
    buffer_load_dwordx4 v3, s[12:15], s41 offen lds
    s_add_u32 m0, s39, 98304
    s_add_u32 s41, s37, 1179648
    buffer_load_dwordx4 v1, s[12:15], s41 offen lds
    s_add_u32 m0, s39, 99328
    s_nop 0
    buffer_load_dwordx4 v2, s[12:15], s41 offen lds
    s_add_u32 m0, s39, 100352
    s_nop 0
    buffer_load_dwordx4 v3, s[12:15], s41 offen lds
    s_add_u32 m0, s39, 110592
    s_add_u32 s41, s37, 1216512
    buffer_load_dwordx4 v1, s[12:15], s41 offen lds
    s_add_u32 m0, s39, 111616
    s_nop 0
    buffer_load_dwordx4 v2, s[12:15], s41 offen lds
    s_add_u32 m0, s39, 112640
    s_nop 0
    buffer_load_dwordx4 v3, s[12:15], s41 offen lds
    s_add_u32 m0, s39, 122880
    s_add_u32 s41, s37, 1253376
    buffer_load_dwordx4 v1, s[12:15], s41 offen lds
    s_add_u32 m0, s39, 123904
    s_nop 0
    buffer_load_dwordx4 v2, s[12:15], s41 offen lds
    s_add_u32 m0, s39, 124928
    s_nop 0
    buffer_load_dwordx4 v3, s[12:15], s41 offen lds
    s_waitcnt vmcnt(9)
    s_barrier
    s_add_u32 m0, s39, 135168
    s_add_u32 s41, s37, 1290240
    buffer_load_dwordx4 v1, s[12:15], s41 offen lds
    s_add_u32 m0, s39, 136192
    s_nop 0
    buffer_load_dwordx4 v2, s[12:15], s41 offen lds
    s_add_u32 m0, s39, 137216
    s_nop 0
    buffer_load_dwordx4 v3, s[12:15], s41 offen lds
    s_waitcnt vmcnt(0)
    s_barrier
    s_add_u32 m0, s57, 0
    s_add_u32 s41, s48, 0
    buffer_load_dwordx4 v0, s[20:23], s41 offen lds
    s_add_u32 m0, s57, 4096
    s_add_u32 s41, s49, 0
    buffer_load_dwordx4 v0, s[20:23], s41 offen lds
    s_add_u32 m0, s57, 8192
    s_add_u32 s41, s50, 0
    buffer_load_dwordx4 v0, s[20:23], s41 offen lds
    s_add_u32 m0, s57, 12288
    s_add_u32 s41, s51, 0
    buffer_load_dwordx4 v0, s[20:23], s41 offen lds
    s_add_u32 m0, s57, 16384
    s_add_u32 s41, s52, 0
    buffer_load_dwordx4 v0, s[20:23], s41 offen lds
    s_add_u32 m0, s57, 20480
    s_add_u32 s41, s53, 0
    buffer_load_dwordx4 v0, s[20:23], s41 offen lds
    s_add_u32 m0, s57, 24576
    s_add_u32 s41, s54, 0
    buffer_load_dwordx4 v0, s[20:23], s41 offen lds
    s_add_u32 m0, s57, 28672
    s_add_u32 s41, s55, 0
    buffer_load_dwordx4 v0, s[20:23], s41 offen lds
    s_add_u32 m0, s57, 32768
    s_add_u32 s41, s56, 0
    buffer_load_dwordx4 v0, s[20:23], s41 offen lds
    s_add_u32 m0, s57, 36864
    s_add_u32 s41, s48, 6144
    buffer_load_dwordx4 v0, s[20:23], s41 offen lds
    s_add_u32 m0, s57, 40960
    s_add_u32 s41, s49, 6144
    buffer_load_dwordx4 v0, s[20:23], s41 offen lds
    s_add_u32 m0, s57, 45056
    s_add_u32 s41, s50, 6144
    buffer_load_dwordx4 v0, s[20:23], s41 offen lds
    s_add_u32 m0, s57, 49152
    s_add_u32 s41, s51, 6144
    buffer_load_dwordx4 v0, s[20:23], s41 offen lds
    s_add_u32 m0, s57, 53248
    s_add_u32 s41, s52, 6144
    buffer_load_dwordx4 v0, s[20:23], s41 offen lds
    s_add_u32 m0, s57, 57344
    s_add_u32 s41, s53, 6144
    buffer_load_dwordx4 v0, s[20:23], s41 offen lds
    s_add_u32 m0, s57, 61440
    s_add_u32 s41, s54, 6144
    buffer_load_dwordx4 v0, s[20:23], s41 offen lds
    s_add_u32 m0, s57, 65536
    s_add_u32 s41, s55, 6144
    buffer_load_dwordx4 v0, s[20:23], s41 offen lds
    s_add_u32 m0, s57, 69632
    s_add_u32 s41, s56, 6144
    buffer_load_dwordx4 v0, s[20:23], s41 offen lds
    s_cmp_eq_u32 s3, 4
    s_cbranch_scc0 l2_kernel_zskip
    s_mov_b32 s41, 2097152
    buffer_load_dword v14, v5, s[20:23], 0 offen sc1
    s_sleep 3
    buffer_load_dword v15, v5, s[20:23], 0 offen sc1
l2_kernel_z_spin:
    s_waitcnt vmcnt(1)
    v_cmp_gt_u32 vcc, 36, v14
    s_sub_u32 s41, s41, 1
    s_cmp_eq_u32 s41, 0
    s_cbranch_scc1 l2_kernel_z_done
    s_nop 0
    s_cmp_eq_u64 vcc, 0
    s_cbranch_scc1 l2_kernel_z_done
    s_sleep 3
    buffer_load_dword v14, v5, s[20:23], 0 offen sc1
    s_waitcnt vmcnt(1)
    v_cmp_gt_u32 vcc, 36, v15
    s_sub_u32 s41, s41, 1
    s_cmp_eq_u32 s41, 0
    s_cbranch_scc1 l2_kernel_z_done
    s_nop 0
    s_cmp_eq_u64 vcc, 0
    s_cbranch_scc1 l2_kernel_z_done
    s_sleep 3
    buffer_load_dword v15, v5, s[20:23], 0 offen sc1
    s_branch l2_kernel_z_spin
l2_kernel_z_done:
    s_branch l2_kernel_zjoin
l2_kernel_zskip:
    s_waitcnt vmcnt(0)
l2_kernel_zjoin:
    s_barrier
    s_add_u32 m0, s57, 73728
    s_add_u32 s41, s48, 12288
    buffer_load_dwordx4 v0, s[20:23], s41 offen lds
    s_add_u32 m0, s57, 77824
    s_add_u32 s41, s49, 12288
    buffer_load_dwordx4 v0, s[20:23], s41 offen lds
    s_add_u32 m0, s57, 81920
    s_add_u32 s41, s50, 12288
    buffer_load_dwordx4 v0, s[20:23], s41 offen lds
    s_add_u32 m0, s57, 86016
    s_add_u32 s41, s51, 12288
    buffer_load_dwordx4 v0, s[20:23], s41 offen lds
    s_add_u32 m0, s57, 90112
    s_add_u32 s41, s52, 12288
    buffer_load_dwordx4 v0, s[20:23], s41 offen lds
    s_add_u32 m0, s57, 94208
    s_add_u32 s41, s53, 12288
    buffer_load_dwordx4 v0, s[20:23], s41 offen lds
    s_add_u32 m0, s57, 98304
    s_add_u32 s41, s54, 12288
    buffer_load_dwordx4 v0, s[20:23], s41 offen lds
    s_add_u32 m0, s57, 102400
    s_add_u32 s41, s55, 12288
    buffer_load_dwordx4 v0, s[20:23], s41 offen lds
    s_add_u32 m0, s57, 106496
    s_add_u32 s41, s56, 12288
    buffer_load_dwordx4 v0, s[20:23], s41 offen lds
    s_waitcnt vmcnt(0)
    s_barrier
    v_mov_b32 v10, 1
    v_cmp_gt_u32 vcc, 1, v11
    s_cmp_eq_u32 s3, 4
    s_nop 2
    s_cselect_b64 vcc, vcc, 0
    s_and_saveexec_b64 s[42:43], vcc
    buffer_atomic_add v10, v4, s[20:23], 0 offen sc1
    s_mov_b64 exec, s[42:43]
    s_cmp_eq_u32 s3, 4
    s_cbranch_scc0 l2_kernel_pskip
    s_mov_b32 s41, 2097152
    buffer_load_dword v14, v4, s[20:23], 0 offen sc1
    s_sleep 2
    buffer_load_dword v15, v4, s[20:23], 0 offen sc1
l2_kernel_p_spin:
    s_waitcnt vmcnt(1)
    v_cmp_gt_u32 vcc, 4, v14
    s_sub_u32 s41, s41, 1
    s_cmp_eq_u32 s41, 0
    s_cbranch_scc1 l2_kernel_p_done
    s_nop 0
    s_cmp_eq_u64 vcc, 0
    s_cbranch_scc1 l2_kernel_p_done
    s_sleep 2
    buffer_load_dword v14, v4, s[20:23], 0 offen sc1
    s_waitcnt vmcnt(1)
    v_cmp_gt_u32 vcc, 4, v15
    s_sub_u32 s41, s41, 1
    s_cmp_eq_u32 s41, 0
    s_cbranch_scc1 l2_kernel_p_done
    s_nop 0
    s_cmp_eq_u64 vcc, 0
    s_cbranch_scc1 l2_kernel_p_done
    s_sleep 2
    buffer_load_dword v15, v4, s[20:23], 0 offen sc1
    s_branch l2_kernel_p_spin
l2_kernel_p_done:
l2_kernel_pskip:
    s_barrier
    s_branch l2_kernel_exit
l2_kernel_f2:
    s_mov_b32 s28, s2
    s_add_u32 s2, s2, 192
    s_lshl_b32 s29, s28, 3
    s_add_u32 s29, s29, s3
    s_lshl_b32 s30, s29, 13
    s_add_u32 s31, s30, 7340032
    s_add_u32 s32, s30, 4194304
    v_and_b32 v12, 15, v11
    v_lshrrev_b32 v13, 4, v11
    v_lshlrev_b32 v1, 6, v12
    v_lshl_add_u32 v1, v13, 4, v1
    s_lshl_b32 s33, s3, 10
    s_lshl_b32 s35, s3, 11
    s_lshl_b32 s34, s3, 13
    s_add_u32 m0, s33, 0
    s_add_u32 s40, s33, 3932160
    buffer_load_dwordx4 v0, s[20:23], s40 offen lds
    s_add_u32 s40, s31, 0
    buffer_load_dwordx4 v[96:99], v1, s[20:23], s40 offen
    s_add_u32 s40, s31, 1024
    buffer_load_dwordx4 v[100:103], v1, s[20:23], s40 offen
    s_add_u32 s40, s31, 2048
    buffer_load_dwordx4 v[104:107], v1, s[20:23], s40 offen
    s_add_u32 s40, s31, 3072
    buffer_load_dwordx4 v[108:111], v1, s[20:23], s40 offen
    s_add_u32 s40, s31, 4096
    buffer_load_dwordx4 v[112:115], v1, s[20:23], s40 offen
    s_add_u32 s40, s31, 5120
    buffer_load_dwordx4 v[116:119], v1, s[20:23], s40 offen
    s_add_u32 s40, s31, 6144
    buffer_load_dwordx4 v[120:123], v1, s[20:23], s40 offen
    s_add_u32 s40, s31, 7168
    buffer_load_dwordx4 v[124:127], v1, s[20:23], s40 offen
    s_add_u32 s40, s34, 65536
    v_add_u32 v6, s40, v0
    v_lshlrev_b32 v5, 7, v11
    v_add_u32 v5, 46143488, v5
    s_waitcnt vmcnt(8)
    s_barrier
    ds_read_b128 a[0:3], v0 offset:0
    ds_read_b128 a[4:7], v0 offset:1024
    ds_read_b128 a[8:11], v0 offset:2048
    ds_read_b128 a[12:15], v0 offset:3072
    ds_read_b128 a[16:19], v0 offset:4096
    ds_read_b128 a[20:23], v0 offset:5120
    s_waitcnt vmcnt(0) lgkmcnt(0)
    v_mfma_f32_16x16x32_bf16 v[32:35], v[96:99], a[0:3], 0
    v_mfma_f32_16x16x32_bf16 v[36:39], v[112:115], a[0:3], 0
    s_add_u32 m0, s35, 32768
    s_add_u32 s40, s35, 3964928
    buffer_load_dwordx4 v0, s[20:23], s40 offen lds
    buffer_load_dwordx4 v0, s[20:23], s40 offen offset:1024 lds
    v_mfma_f32_16x16x32_bf16 v[40:43], v[96:99], a[4:7], 0
    v_mfma_f32_16x16x32_bf16 v[44:47], v[112:115], a[4:7], 0
    s_add_u32 m0, s33, 8192
    s_add_u32 s40, s33, 3940352
    buffer_load_dwordx4 v0, s[20:23], s40 offen lds
    v_mfma_f32_16x16x32_bf16 v[48:51], v[100:103], a[0:3], 0
    v_mfma_f32_16x16x32_bf16 v[52:55], v[116:119], a[0:3], 0
    s_add_u32 m0, s33, 16384
    s_add_u32 s40, s33, 3948544
    buffer_load_dwordx4 v0, s[20:23], s40 offen lds
    v_mfma_f32_16x16x32_bf16 v[56:59], v[100:103], a[4:7], 0
    v_mfma_f32_16x16x32_bf16 v[60:63], v[116:119], a[4:7], 0
    s_add_u32 m0, s33, 24576
    s_add_u32 s40, s33, 3956736
    buffer_load_dwordx4 v0, s[20:23], s40 offen lds
    v_mfma_f32_16x16x32_bf16 v[64:67], v[104:107], a[0:3], 0
    v_mfma_f32_16x16x32_bf16 v[68:71], v[120:123], a[0:3], 0
    s_add_u32 m0, s34, 65536
    s_add_u32 s40, s32, 0
    buffer_load_dwordx4 v0, s[20:23], s40 offen lds
    buffer_load_dwordx4 v0, s[20:23], s40 offen offset:1024 lds
    v_mfma_f32_16x16x32_bf16 v[72:75], v[104:107], a[4:7], 0
    v_mfma_f32_16x16x32_bf16 v[76:79], v[120:123], a[4:7], 0
    s_add_u32 m0, s34, 67584
    s_add_u32 s40, s32, 2048
    buffer_load_dwordx4 v0, s[20:23], s40 offen lds
    buffer_load_dwordx4 v0, s[20:23], s40 offen offset:1024 lds
    v_mfma_f32_16x16x32_bf16 v[80:83], v[108:111], a[0:3], 0
    v_mfma_f32_16x16x32_bf16 v[84:87], v[124:127], a[0:3], 0
    s_add_u32 m0, s34, 69632
    s_add_u32 s40, s32, 4096
    buffer_load_dwordx4 v0, s[20:23], s40 offen lds
    buffer_load_dwordx4 v0, s[20:23], s40 offen offset:1024 lds
    v_mfma_f32_16x16x32_bf16 v[88:91], v[108:111], a[4:7], 0
    v_mfma_f32_16x16x32_bf16 v[92:95], v[124:127], a[4:7], 0
    s_add_u32 m0, s34, 71680
    s_add_u32 s40, s32, 6144
    buffer_load_dwordx4 v0, s[20:23], s40 offen lds
    buffer_load_dwordx4 v0, s[20:23], s40 offen offset:1024 lds
    v_mfma_f32_16x16x32_bf16 v[32:35], v[112:115], a[8:11], v[32:35]
    v_mfma_f32_16x16x32_bf16 v[36:39], v[96:99], a[16:19], v[36:39]
    s_add_u32 m0, s35, 49152
    s_add_u32 s40, s35, 3981312
    buffer_load_dwordx4 v0, s[20:23], s40 offen lds
    buffer_load_dwordx4 v0, s[20:23], s40 offen offset:1024 lds
    v_mfma_f32_16x16x32_bf16 v[40:43], v[112:115], a[12:15], v[40:43]
    v_mfma_f32_16x16x32_bf16 v[44:47], v[96:99], a[20:23], v[44:47]
    v_mfma_f32_16x16x32_bf16 v[48:51], v[116:119], a[8:11], v[48:51]
    v_mfma_f32_16x16x32_bf16 v[52:55], v[100:103], a[16:19], v[52:55]
    v_mfma_f32_16x16x32_bf16 v[56:59], v[116:119], a[12:15], v[56:59]
    v_mfma_f32_16x16x32_bf16 v[60:63], v[100:103], a[20:23], v[60:63]
    v_mfma_f32_16x16x32_bf16 v[64:67], v[120:123], a[8:11], v[64:67]
    v_mfma_f32_16x16x32_bf16 v[68:71], v[104:107], a[16:19], v[68:71]
    v_mfma_f32_16x16x32_bf16 v[72:75], v[120:123], a[12:15], v[72:75]
    v_mfma_f32_16x16x32_bf16 v[76:79], v[104:107], a[20:23], v[76:79]
    v_mfma_f32_16x16x32_bf16 v[80:83], v[124:127], a[8:11], v[80:83]
    v_mfma_f32_16x16x32_bf16 v[84:87], v[108:111], a[16:19], v[84:87]
    v_mfma_f32_16x16x32_bf16 v[88:91], v[124:127], a[12:15], v[88:91]
    v_mfma_f32_16x16x32_bf16 v[92:95], v[108:111], a[20:23], v[92:95]
    s_waitcnt vmcnt(10)
    s_barrier
    s_cmp_lt_u32 s3, 4
    s_cbranch_scc0 l2_kernel_f2lo
    s_setprio 1
l2_kernel_f2lo:
    ds_read_b128 a[24:27], v0 offset:8192
    ds_read_b128 a[28:31], v0 offset:9216
    ds_read_b128 a[32:35], v0 offset:10240
    ds_read_b128 a[36:39], v0 offset:11264
    ds_read_b128 a[40:43], v0 offset:12288
    ds_read_b128 a[44:47], v0 offset:13312
    ds_read_b128 a[48:51], v0 offset:14336
    ds_read_b128 a[52:55], v0 offset:15360
    ds_read_b128 a[56:59], v0 offset:16384
    ds_read_b128 a[60:63], v0 offset:17408
    ds_read_b128 a[64:67], v0 offset:18432
    ds_read_b128 a[68:71], v0 offset:19456
    s_waitcnt lgkmcnt(0)
    ds_read_b128 a[72:75], v0 offset:20480
    ds_read_b128 a[76:79], v0 offset:21504
    ds_read_b128 a[80:83], v0 offset:22528
    ds_read_b128 a[84:87], v0 offset:23552
    ds_read_b128 a[88:91], v0 offset:24576
    ds_read_b128 a[92:95], v0 offset:25600
    ds_read_b128 a[96:99], v0 offset:26624
    ds_read_b128 a[100:103], v0 offset:27648
    ds_read_b128 a[104:107], v0 offset:28672
    ds_read_b128 a[108:111], v0 offset:29696
    ds_read_b128 a[112:115], v0 offset:30720
    ds_read_b128 a[116:119], v0 offset:31744
    s_waitcnt lgkmcnt(0)
    ds_read_b128 v[16:19], v0 offset:32768
    ds_read_b128 v[20:23], v0 offset:33792
    ds_read_b128 v[24:27], v0 offset:34816
    ds_read_b128 v[28:31], v0 offset:35840
    s_waitcnt lgkmcnt(2)
    v_mul_f32 v12, v20, v32
    v_mul_f32 v13, v21, v33
    v_mul_f32 v14, v22, v34
    v_mul_f32 v15, v23, v35
    v_mul_f32 v32, v16, v32
    v_mul_f32 v33, v17, v33
    v_mul_f32 v34, v18, v34
    v_mul_f32 v35, v19, v35
    v_fma_f32 v32, v36, v20, v32
    v_fma_f32 v33, v37, v21, v33
    v_fma_f32 v34, v38, v22, v34
    v_fma_f32 v35, v39, v23, v35
    v_fma_f32 v36, v36, v16, -v12
    v_fma_f32 v37, v37, v17, -v13
    v_fma_f32 v38, v38, v18, -v14
    v_fma_f32 v39, v39, v19, -v15
    ds_read_b128 v[16:19], v0 offset:36864
    ds_read_b128 v[20:23], v0 offset:37888
    s_waitcnt lgkmcnt(2)
    v_mul_f32 v12, v28, v40
    v_mul_f32 v13, v29, v41
    v_mul_f32 v14, v30, v42
    v_mul_f32 v15, v31, v43
    v_mul_f32 v40, v24, v40
    v_mul_f32 v41, v25, v41
    v_mul_f32 v42, v26, v42
    v_mul_f32 v43, v27, v43
    v_fma_f32 v40, v44, v28, v40
    v_fma_f32 v41, v45, v29, v41
    v_fma_f32 v42, v46, v30, v42
    v_fma_f32 v43, v47, v31, v43
    v_fma_f32 v44, v44, v24, -v12
    v_fma_f32 v45, v45, v25, -v13
    v_fma_f32 v46, v46, v26, -v14
    v_fma_f32 v47, v47, v27, -v15
    ds_read_b128 v[24:27], v0 offset:38912
    ds_read_b128 v[28:31], v0 offset:39936
    s_waitcnt lgkmcnt(2)
    v_mul_f32 v12, v20, v48
    v_mul_f32 v13, v21, v49
    v_mul_f32 v14, v22, v50
    v_mul_f32 v15, v23, v51
    v_mul_f32 v48, v16, v48
    v_mul_f32 v49, v17, v49
    v_mul_f32 v50, v18, v50
    v_mul_f32 v51, v19, v51
    v_fma_f32 v48, v52, v20, v48
    v_fma_f32 v49, v53, v21, v49
    v_fma_f32 v50, v54, v22, v50
    v_fma_f32 v51, v55, v23, v51
    v_fma_f32 v52, v52, v16, -v12
    v_fma_f32 v53, v53, v17, -v13
    v_fma_f32 v54, v54, v18, -v14
    v_fma_f32 v55, v55, v19, -v15
    ds_read_b128 v[16:19], v0 offset:40960
    ds_read_b128 v[20:23], v0 offset:41984
    s_waitcnt lgkmcnt(2)
    v_mul_f32 v12, v28, v56
    v_mul_f32 v13, v29, v57
    v_mul_f32 v14, v30, v58
    v_mul_f32 v15, v31, v59
    v_mul_f32 v56, v24, v56
    v_mul_f32 v57, v25, v57
    v_mul_f32 v58, v26, v58
    v_mul_f32 v59, v27, v59
    v_fma_f32 v56, v60, v28, v56
    v_fma_f32 v57, v61, v29, v57
    v_fma_f32 v58, v62, v30, v58
    v_fma_f32 v59, v63, v31, v59
    v_fma_f32 v60, v60, v24, -v12
    v_fma_f32 v61, v61, v25, -v13
    v_fma_f32 v62, v62, v26, -v14
    v_fma_f32 v63, v63, v27, -v15
    v_cvt_pk_bf16_f32 v96, v32, v33
    v_cvt_pk_bf16_f32 v97, v34, v35
    v_cvt_pk_bf16_f32 v98, v48, v49
    v_cvt_pk_bf16_f32 v99, v50, v51
    v_cvt_pk_bf16_f32 v100, v36, v37
    v_cvt_pk_bf16_f32 v101, v38, v39
    v_cvt_pk_bf16_f32 v102, v52, v53
    v_cvt_pk_bf16_f32 v103, v54, v55
    v_cvt_pk_bf16_f32 v112, v40, v41
    v_cvt_pk_bf16_f32 v113, v42, v43
    v_cvt_pk_bf16_f32 v114, v56, v57
    v_cvt_pk_bf16_f32 v115, v58, v59
    v_cvt_pk_bf16_f32 v116, v44, v45
    v_cvt_pk_bf16_f32 v117, v46, v47
    v_cvt_pk_bf16_f32 v118, v60, v61
    v_cvt_pk_bf16_f32 v119, v62, v63
    ds_read_b128 v[24:27], v0 offset:43008
    ds_read_b128 v[28:31], v0 offset:44032
    s_waitcnt lgkmcnt(2)
    v_mul_f32 v12, v20, v64
    v_mul_f32 v13, v21, v65
    v_mul_f32 v14, v22, v66
    v_mul_f32 v15, v23, v67
    v_mul_f32 v64, v16, v64
    v_mul_f32 v65, v17, v65
    v_mul_f32 v66, v18, v66
    v_mul_f32 v67, v19, v67
    v_fma_f32 v64, v68, v20, v64
    v_fma_f32 v65, v69, v21, v65
    v_fma_f32 v66, v70, v22, v66
    v_fma_f32 v67, v71, v23, v67
    v_fma_f32 v68, v68, v16, -v12
    v_fma_f32 v69, v69, v17, -v13
    v_fma_f32 v70, v70, v18, -v14
    v_fma_f32 v71, v71, v19, -v15
    ds_read_b128 v[16:19], v0 offset:45056
    ds_read_b128 v[20:23], v0 offset:46080
    s_waitcnt lgkmcnt(2)
    v_mul_f32 v12, v28, v72
    v_mul_f32 v13, v29, v73
    v_mul_f32 v14, v30, v74
    v_mul_f32 v15, v31, v75
    v_mul_f32 v72, v24, v72
    v_mul_f32 v73, v25, v73
    v_mul_f32 v74, v26, v74
    v_mul_f32 v75, v27, v75
    v_fma_f32 v72, v76, v28, v72
    v_fma_f32 v73, v77, v29, v73
    v_fma_f32 v74, v78, v30, v74
    v_fma_f32 v75, v79, v31, v75
    v_fma_f32 v76, v76, v24, -v12
    v_fma_f32 v77, v77, v25, -v13
    v_fma_f32 v78, v78, v26, -v14
    v_fma_f32 v79, v79, v27, -v15
    ds_read_b128 v[24:27], v0 offset:47104
    ds_read_b128 v[28:31], v0 offset:48128
    s_waitcnt lgkmcnt(2)
    v_mul_f32 v12, v20, v80
    v_mul_f32 v13, v21, v81
    v_mul_f32 v14, v22, v82
    v_mul_f32 v15, v23, v83
    v_mul_f32 v80, v16, v80
    v_mul_f32 v81, v17, v81
    v_mul_f32 v82, v18, v82
    v_mul_f32 v83, v19, v83
    v_fma_f32 v80, v84, v20, v80
    v_fma_f32 v81, v85, v21, v81
    v_fma_f32 v82, v86, v22, v82
    v_fma_f32 v83, v87, v23, v83
    v_fma_f32 v84, v84, v16, -v12
    v_fma_f32 v85, v85, v17, -v13
    v_fma_f32 v86, v86, v18, -v14
    v_fma_f32 v87, v87, v19, -v15
    s_waitcnt lgkmcnt(0)
    v_mul_f32 v12, v28, v88
    v_mul_f32 v13, v29, v89
    v_mul_f32 v14, v30, v90
    v_mul_f32 v15, v31, v91
    v_mul_f32 v88, v24, v88
    v_mul_f32 v89, v25, v89
    v_mul_f32 v90, v26, v90
    v_mul_f32 v91, v27, v91
    v_fma_f32 v88, v92, v28, v88
    v_fma_f32 v89, v93, v29, v89
    v_fma_f32 v90, v94, v30, v90
    v_fma_f32 v91, v95, v31, v91
    v_fma_f32 v92, v92, v24, -v12
    v_fma_f32 v93, v93, v25, -v13
    v_fma_f32 v94, v94, v26, -v14
    v_fma_f32 v95, v95, v27, -v15
    v_cvt_pk_bf16_f32 v104, v64, v65
    v_cvt_pk_bf16_f32 v105, v66, v67
    v_cvt_pk_bf16_f32 v106, v80, v81
    v_cvt_pk_bf16_f32 v107, v82, v83
    v_cvt_pk_bf16_f32 v108, v68, v69
    v_cvt_pk_bf16_f32 v109, v70, v71
    v_cvt_pk_bf16_f32 v110, v84, v85
    v_cvt_pk_bf16_f32 v111, v86, v87
    v_cvt_pk_bf16_f32 v120, v72, v73
    v_cvt_pk_bf16_f32 v121, v74, v75
    v_cvt_pk_bf16_f32 v122, v88, v89
    v_cvt_pk_bf16_f32 v123, v90, v91
    v_cvt_pk_bf16_f32 v124, v76, v77
    v_cvt_pk_bf16_f32 v125, v78, v79
    v_cvt_pk_bf16_f32 v126, v92, v93
    v_cvt_pk_bf16_f32 v127, v94, v95
    v_mfma_f32_16x16x32_bf16 v[32:35], a[24:27], v[96:99], 0
    v_mfma_f32_16x16x32_bf16 v[36:39], a[24:27], v[100:103], 0
    v_mfma_f32_16x16x32_bf16 v[40:43], a[24:27], v[112:115], 0
    v_mfma_f32_16x16x32_bf16 v[44:47], a[24:27], v[116:119], 0
    v_mfma_f32_16x16x32_bf16 v[48:51], a[32:35], v[96:99], 0
    v_mfma_f32_16x16x32_bf16 v[52:55], a[32:35], v[100:103], 0
    v_mfma_f32_16x16x32_bf16 v[56:59], a[32:35], v[112:115], 0
    v_mfma_f32_16x16x32_bf16 v[60:63], a[32:35], v[116:119], 0
    v_mfma_f32_16x16x32_bf16 v[64:67], a[40:43], v[96:99], 0
    v_mfma_f32_16x16x32_bf16 v[68:71], a[40:43], v[100:103], 0
    v_mfma_f32_16x16x32_bf16 v[72:75], a[40:43], v[112:115], 0
    v_mfma_f32_16x16x32_bf16 v[76:79], a[40:43], v[116:119], 0
    v_mfma_f32_16x16x32_bf16 v[80:83], a[48:51], v[96:99], 0
    v_mfma_f32_16x16x32_bf16 v[84:87], a[48:51], v[100:103], 0
    v_mfma_f32_16x16x32_bf16 v[88:91], a[48:51], v[112:115], 0
    v_mfma_f32_16x16x32_bf16 v[92:95], a[48:51], v[116:119], 0
    v_mfma_f32_16x16x32_bf16 v[32:35], a[56:59], v[100:103], v[32:35]
    v_mfma_f32_16x16x32_bf16 v[36:39], a[88:91], v[96:99], v[36:39]
    v_mfma_f32_16x16x32_bf16 v[40:43], a[56:59], v[116:119], v[40:43]
    v_mfma_f32_16x16x32_bf16 v[44:47], a[88:91], v[112:115], v[44:47]
    v_mfma_f32_16x16x32_bf16 v[48:51], a[64:67], v[100:103], v[48:51]
    v_mfma_f32_16x16x32_bf16 v[52:55], a[96:99], v[96:99], v[52:55]
    v_mfma_f32_16x16x32_bf16 v[56:59], a[64:67], v[116:119], v[56:59]
    v_mfma_f32_16x16x32_bf16 v[60:63], a[96:99], v[112:115], v[60:63]
    v_mfma_f32_16x16x32_bf16 v[64:67], a[72:75], v[100:103], v[64:67]
    v_mfma_f32_16x16x32_bf16 v[68:71], a[104:107], v[96:99], v[68:71]
    v_mfma_f32_16x16x32_bf16 v[72:75], a[72:75], v[116:119], v[72:75]
    v_mfma_f32_16x16x32_bf16 v[76:79], a[104:107], v[112:115], v[76:79]
    v_mfma_f32_16x16x32_bf16 v[80:83], a[80:83], v[100:103], v[80:83]
    v_mfma_f32_16x16x32_bf16 v[84:87], a[112:115], v[96:99], v[84:87]
    v_mfma_f32_16x16x32_bf16 v[88:91], a[80:83], v[116:119], v[88:91]
    v_mfma_f32_16x16x32_bf16 v[92:95], a[112:115], v[112:115], v[92:95]
    v_mfma_f32_16x16x32_bf16 v[32:35], a[28:31], v[104:107], v[32:35]
    v_mfma_f32_16x16x32_bf16 v[36:39], a[28:31], v[108:111], v[36:39]
    v_mfma_f32_16x16x32_bf16 v[40:43], a[28:31], v[120:123], v[40:43]
    v_mfma_f32_16x16x32_bf16 v[44:47], a[28:31], v[124:127], v[44:47]
    v_mfma_f32_16x16x32_bf16 v[48:51], a[36:39], v[104:107], v[48:51]
    v_mfma_f32_16x16x32_bf16 v[52:55], a[36:39], v[108:111], v[52:55]
    v_mfma_f32_16x16x32_bf16 v[56:59], a[36:39], v[120:123], v[56:59]
    v_mfma_f32_16x16x32_bf16 v[60:63], a[36:39], v[124:127], v[60:63]
    v_mfma_f32_16x16x32_bf16 v[64:67], a[44:47], v[104:107], v[64:67]
    v_mfma_f32_16x16x32_bf16 v[68:71], a[44:47], v[108:111], v[68:71]
    v_mfma_f32_16x16x32_bf16 v[72:75], a[44:47], v[120:123], v[72:75]
    v_mfma_f32_16x16x32_bf16 v[76:79], a[44:47], v[124:127], v[76:79]
    v_mfma_f32_16x16x32_bf16 v[80:83], a[52:55], v[104:107], v[80:83]
    v_mfma_f32_16x16x32_bf16 v[84:87], a[52:55], v[108:111], v[84:87]
    v_mfma_f32_16x16x32_bf16 v[88:91], a[52:55], v[120:123], v[88:91]
    v_mfma_f32_16x16x32_bf16 v[92:95], a[52:55], v[124:127], v[92:95]
    v_mfma_f32_16x16x32_bf16 v[32:35], a[60:63], v[108:111], v[32:35]
    v_mfma_f32_16x16x32_bf16 v[36:39], a[92:95], v[104:107], v[36:39]
    v_mfma_f32_16x16x32_bf16 v[40:43], a[60:63], v[124:127], v[40:43]
    v_mfma_f32_16x16x32_bf16 v[44:47], a[92:95], v[120:123], v[44:47]
    v_mfma_f32_16x16x32_bf16 v[48:51], a[68:71], v[108:111], v[48:51]
    v_mfma_f32_16x16x32_bf16 v[52:55], a[100:103], v[104:107], v[52:55]
    v_mfma_f32_16x16x32_bf16 v[56:59], a[68:71], v[124:127], v[56:59]
    v_mfma_f32_16x16x32_bf16 v[60:63], a[100:103], v[120:123], v[60:63]
    v_mfma_f32_16x16x32_bf16 v[64:67], a[76:79], v[108:111], v[64:67]
    v_mfma_f32_16x16x32_bf16 v[68:71], a[108:111], v[104:107], v[68:71]
    v_mfma_f32_16x16x32_bf16 v[72:75], a[76:79], v[124:127], v[72:75]
    v_mfma_f32_16x16x32_bf16 v[76:79], a[108:111], v[120:123], v[76:79]
    v_mfma_f32_16x16x32_bf16 v[80:83], a[84:87], v[108:111], v[80:83]
    v_mfma_f32_16x16x32_bf16 v[84:87], a[116:119], v[104:107], v[84:87]
    v_mfma_f32_16x16x32_bf16 v[88:91], a[84:87], v[124:127], v[88:91]
    v_mfma_f32_16x16x32_bf16 v[92:95], a[116:119], v[120:123], v[92:95]
    s_waitcnt vmcnt(0)
    s_barrier
    ds_read_b128 v[16:19], v6 offset:0
    ds_read_b128 v[24:27], v6 offset:1024
    s_waitcnt lgkmcnt(1)
    v_and_b32 v20, 0xffff0000, v16
    v_and_b32 v21, 0xffff0000, v17
    v_and_b32 v22, 0xffff0000, v18
    v_and_b32 v23, 0xffff0000, v19
    v_lshlrev_b32 v16, 16, v16
    v_lshlrev_b32 v17, 16, v17
    v_lshlrev_b32 v18, 16, v18
    v_lshlrev_b32 v19, 16, v19
    v_mul_f32 v12, v20, v32
    v_mul_f32 v13, v21, v33
    v_mul_f32 v14, v22, v34
    v_mul_f32 v15, v23, v35
    v_mul_f32 v32, v16, v32
    v_mul_f32 v33, v17, v33
    v_mul_f32 v34, v18, v34
    v_mul_f32 v35, v19, v35
    v_fma_f32 v32, -v36, v20, v32
    v_fma_f32 v33, -v37, v21, v33
    v_fma_f32 v34, -v38, v22, v34
    v_fma_f32 v35, -v39, v23, v35
    v_fma_f32 v36, v36, v16, v12
    v_fma_f32 v37, v37, v17, v13
    v_fma_f32 v38, v38, v18, v14
    v_fma_f32 v39, v39, v19, v15
    ds_read_b128 v[16:19], v6 offset:2048
    s_waitcnt lgkmcnt(1)
    v_and_b32 v28, 0xffff0000, v24
    v_and_b32 v29, 0xffff0000, v25
    v_and_b32 v30, 0xffff0000, v26
    v_and_b32 v31, 0xffff0000, v27
    v_lshlrev_b32 v24, 16, v24
    v_lshlrev_b32 v25, 16, v25
    v_lshlrev_b32 v26, 16, v26
    v_lshlrev_b32 v27, 16, v27
    v_mul_f32 v12, v28, v40
    v_mul_f32 v13, v29, v41
    v_mul_f32 v14, v30, v42
    v_mul_f32 v15, v31, v43
    v_mul_f32 v40, v24, v40
    v_mul_f32 v41, v25, v41
    v_mul_f32 v42, v26, v42
    v_mul_f32 v43, v27, v43
    v_fma_f32 v40, -v44, v28, v40
    v_fma_f32 v41, -v45, v29, v41
    v_fma_f32 v42, -v46, v30, v42
    v_fma_f32 v43, -v47, v31, v43
    v_fma_f32 v44, v44, v24, v12
    v_fma_f32 v45, v45, v25, v13
    v_fma_f32 v46, v46, v26, v14
    v_fma_f32 v47, v47, v27, v15
    ds_read_b128 v[24:27], v6 offset:3072
    s_waitcnt lgkmcnt(1)
    v_and_b32 v20, 0xffff0000, v16
    v_and_b32 v21, 0xffff0000, v17
    v_and_b32 v22, 0xffff0000, v18
    v_and_b32 v23, 0xffff0000, v19
    v_lshlrev_b32 v16, 16, v16
    v_lshlrev_b32 v17, 16, v17
    v_lshlrev_b32 v18, 16, v18
    v_lshlrev_b32 v19, 16, v19
    v_mul_f32 v12, v20, v48
    v_mul_f32 v13, v21, v49
    v_mul_f32 v14, v22, v50
    v_mul_f32 v15, v23, v51
    v_mul_f32 v48, v16, v48
    v_mul_f32 v49, v17, v49
    v_mul_f32 v50, v18, v50
    v_mul_f32 v51, v19, v51
    v_fma_f32 v48, -v52, v20, v48
    v_fma_f32 v49, -v53, v21, v49
    v_fma_f32 v50, -v54, v22, v50
    v_fma_f32 v51, -v55, v23, v51
    v_fma_f32 v52, v52, v16, v12
    v_fma_f32 v53, v53, v17, v13
    v_fma_f32 v54, v54, v18, v14
    v_fma_f32 v55, v55, v19, v15
    ds_read_b128 v[16:19], v6 offset:4096
    s_waitcnt lgkmcnt(1)
    v_and_b32 v28, 0xffff0000, v24
    v_and_b32 v29, 0xffff0000, v25
    v_and_b32 v30, 0xffff0000, v26
    v_and_b32 v31, 0xffff0000, v27
    v_lshlrev_b32 v24, 16, v24
    v_lshlrev_b32 v25, 16, v25
    v_lshlrev_b32 v26, 16, v26
    v_lshlrev_b32 v27, 16, v27
    v_mul_f32 v12, v28, v56
    v_mul_f32 v13, v29, v57
    v_mul_f32 v14, v30, v58
    v_mul_f32 v15, v31, v59
    v_mul_f32 v56, v24, v56
    v_mul_f32 v57, v25, v57
    v_mul_f32 v58, v26, v58
    v_mul_f32 v59, v27, v59
    v_fma_f32 v56, -v60, v28, v56
    v_fma_f32 v57, -v61, v29, v57
    v_fma_f32 v58, -v62, v30, v58
    v_fma_f32 v59, -v63, v31, v59
    v_fma_f32 v60, v60, v24, v12
    v_fma_f32 v61, v61, v25, v13
    v_fma_f32 v62, v62, v26, v14
    v_fma_f32 v63, v63, v27, v15
    v_cvt_pk_bf16_f32 v96, v32, v33
    v_cvt_pk_bf16_f32 v97, v34, v35
    v_cvt_pk_bf16_f32 v98, v48, v49
    v_cvt_pk_bf16_f32 v99, v50, v51
    v_cvt_pk_bf16_f32 v100, v36, v37
    v_cvt_pk_bf16_f32 v101, v38, v39
    v_cvt_pk_bf16_f32 v102, v52, v53
    v_cvt_pk_bf16_f32 v103, v54, v55
    v_cvt_pk_bf16_f32 v112, v40, v41
    v_cvt_pk_bf16_f32 v113, v42, v43
    v_cvt_pk_bf16_f32 v114, v56, v57
    v_cvt_pk_bf16_f32 v115, v58, v59
    v_cvt_pk_bf16_f32 v116, v44, v45
    v_cvt_pk_bf16_f32 v117, v46, v47
    v_cvt_pk_bf16_f32 v118, v60, v61
    v_cvt_pk_bf16_f32 v119, v62, v63
    ds_read_b128 v[24:27], v6 offset:5120
    s_waitcnt lgkmcnt(1)
    v_and_b32 v20, 0xffff0000, v16
    v_and_b32 v21, 0xffff0000, v17
    v_and_b32 v22, 0xffff0000, v18
    v_and_b32 v23, 0xffff0000, v19
    v_lshlrev_b32 v16, 16, v16
    v_lshlrev_b32 v17, 16, v17
    v_lshlrev_b32 v18, 16, v18
    v_lshlrev_b32 v19, 16, v19
    v_mul_f32 v12, v20, v64
    v_mul_f32 v13, v21, v65
    v_mul_f32 v14, v22, v66
    v_mul_f32 v15, v23, v67
    v_mul_f32 v64, v16, v64
    v_mul_f32 v65, v17, v65
    v_mul_f32 v66, v18, v66
    v_mul_f32 v67, v19, v67
    v_fma_f32 v64, -v68, v20, v64
    v_fma_f32 v65, -v69, v21, v65
    v_fma_f32 v66, -v70, v22, v66
    v_fma_f32 v67, -v71, v23, v67
    v_fma_f32 v68, v68, v16, v12
    v_fma_f32 v69, v69, v17, v13
    v_fma_f32 v70, v70, v18, v14
    v_fma_f32 v71, v71, v19, v15
    ds_read_b128 v[16:19], v6 offset:6144
    s_waitcnt lgkmcnt(1)
    v_and_b32 v28, 0xffff0000, v24
    v_and_b32 v29, 0xffff0000, v25
    v_and_b32 v30, 0xffff0000, v26
    v_and_b32 v31, 0xffff0000, v27
    v_lshlrev_b32 v24, 16, v24
    v_lshlrev_b32 v25, 16, v25
    v_lshlrev_b32 v26, 16, v26
    v_lshlrev_b32 v27, 16, v27
    v_mul_f32 v12, v28, v72
    v_mul_f32 v13, v29, v73
    v_mul_f32 v14, v30, v74
    v_mul_f32 v15, v31, v75
    v_mul_f32 v72, v24, v72
    v_mul_f32 v73, v25, v73
    v_mul_f32 v74, v26, v74
    v_mul_f32 v75, v27, v75
    v_fma_f32 v72, -v76, v28, v72
    v_fma_f32 v73, -v77, v29, v73
    v_fma_f32 v74, -v78, v30, v74
    v_fma_f32 v75, -v79, v31, v75
    v_fma_f32 v76, v76, v24, v12
    v_fma_f32 v77, v77, v25, v13
    v_fma_f32 v78, v78, v26, v14
    v_fma_f32 v79, v79, v27, v15
    ds_read_b128 v[24:27], v6 offset:7168
    s_waitcnt lgkmcnt(1)
    v_and_b32 v20, 0xffff0000, v16
    v_and_b32 v21, 0xffff0000, v17
    v_and_b32 v22, 0xffff0000, v18
    v_and_b32 v23, 0xffff0000, v19
    v_lshlrev_b32 v16, 16, v16
    v_lshlrev_b32 v17, 16, v17
    v_lshlrev_b32 v18, 16, v18
    v_lshlrev_b32 v19, 16, v19
    v_mul_f32 v12, v20, v80
    v_mul_f32 v13, v21, v81
    v_mul_f32 v14, v22, v82
    v_mul_f32 v15, v23, v83
    v_mul_f32 v80, v16, v80
    v_mul_f32 v81, v17, v81
    v_mul_f32 v82, v18, v82
    v_mul_f32 v83, v19, v83
    v_fma_f32 v80, -v84, v20, v80
    v_fma_f32 v81, -v85, v21, v81
    v_fma_f32 v82, -v86, v22, v82
    v_fma_f32 v83, -v87, v23, v83
    v_fma_f32 v84, v84, v16, v12
    v_fma_f32 v85, v85, v17, v13
    v_fma_f32 v86, v86, v18, v14
    v_fma_f32 v87, v87, v19, v15
    s_waitcnt lgkmcnt(0)
    v_and_b32 v28, 0xffff0000, v24
    v_and_b32 v29, 0xffff0000, v25
    v_and_b32 v30, 0xffff0000, v26
    v_and_b32 v31, 0xffff0000, v27
    v_lshlrev_b32 v24, 16, v24
    v_lshlrev_b32 v25, 16, v25
    v_lshlrev_b32 v26, 16, v26
    v_lshlrev_b32 v27, 16, v27
    v_mul_f32 v12, v28, v88
    v_mul_f32 v13, v29, v89
    v_mul_f32 v14, v30, v90
    v_mul_f32 v15, v31, v91
    v_mul_f32 v88, v24, v88
    v_mul_f32 v89, v25, v89
    v_mul_f32 v90, v26, v90
    v_mul_f32 v91, v27, v91
    v_fma_f32 v88, -v92, v28, v88
    v_fma_f32 v89, -v93, v29, v89
    v_fma_f32 v90, -v94, v30, v90
    v_fma_f32 v91, -v95, v31, v91
    v_fma_f32 v92, v92, v24, v12
    v_fma_f32 v93, v93, v25, v13
    v_fma_f32 v94, v94, v26, v14
    v_fma_f32 v95, v95, v27, v15
    v_cvt_pk_bf16_f32 v104, v64, v65
    v_cvt_pk_bf16_f32 v105, v66, v67
    v_cvt_pk_bf16_f32 v106, v80, v81
    v_cvt_pk_bf16_f32 v107, v82, v83
    v_cvt_pk_bf16_f32 v108, v68, v69
    v_cvt_pk_bf16_f32 v109, v70, v71
    v_cvt_pk_bf16_f32 v110, v84, v85
    v_cvt_pk_bf16_f32 v111, v86, v87
    v_cvt_pk_bf16_f32 v120, v72, v73
    v_cvt_pk_bf16_f32 v121, v74, v75
    v_cvt_pk_bf16_f32 v122, v88, v89
    v_cvt_pk_bf16_f32 v123, v90, v91
    v_cvt_pk_bf16_f32 v124, v76, v77
    v_cvt_pk_bf16_f32 v125, v78, v79
    v_cvt_pk_bf16_f32 v126, v92, v93
    v_cvt_pk_bf16_f32 v127, v94, v95
    v_mfma_f32_16x16x32_bf16 v[32:35], v[96:99], a[24:27], 0
    v_mfma_f32_16x16x32_bf16 v[36:39], v[100:103], a[24:27], 0
    v_mfma_f32_16x16x32_bf16 v[40:43], v[112:115], a[24:27], 0
    v_mfma_f32_16x16x32_bf16 v[44:47], v[116:119], a[24:27], 0
    v_mfma_f32_16x16x32_bf16 v[48:51], v[96:99], a[32:35], 0
    v_mfma_f32_16x16x32_bf16 v[52:55], v[100:103], a[32:35], 0
    v_mfma_f32_16x16x32_bf16 v[56:59], v[112:115], a[32:35], 0
    v_mfma_f32_16x16x32_bf16 v[60:63], v[116:119], a[32:35], 0
    v_mfma_f32_16x16x32_bf16 v[64:67], v[96:99], a[40:43], 0
    v_mfma_f32_16x16x32_bf16 v[68:71], v[100:103], a[40:43], 0
    v_mfma_f32_16x16x32_bf16 v[72:75], v[112:115], a[40:43], 0
    v_mfma_f32_16x16x32_bf16 v[76:79], v[116:119], a[40:43], 0
    v_mfma_f32_16x16x32_bf16 v[80:83], v[96:99], a[48:51], 0
    v_mfma_f32_16x16x32_bf16 v[84:87], v[100:103], a[48:51], 0
    v_mfma_f32_16x16x32_bf16 v[88:91], v[112:115], a[48:51], 0
    v_mfma_f32_16x16x32_bf16 v[92:95], v[116:119], a[48:51], 0
    v_mfma_f32_16x16x32_bf16 v[32:35], v[100:103], a[88:91], v[32:35]
    v_mfma_f32_16x16x32_bf16 v[36:39], v[96:99], a[56:59], v[36:39]
    v_mfma_f32_16x16x32_bf16 v[40:43], v[116:119], a[88:91], v[40:43]
    v_mfma_f32_16x16x32_bf16 v[44:47], v[112:115], a[56:59], v[44:47]
    v_mfma_f32_16x16x32_bf16 v[48:51], v[100:103], a[96:99], v[48:51]
    v_mfma_f32_16x16x32_bf16 v[52:55], v[96:99], a[64:67], v[52:55]
    v_mfma_f32_16x16x32_bf16 v[56:59], v[116:119], a[96:99], v[56:59]
    v_mfma_f32_16x16x32_bf16 v[60:63], v[112:115], a[64:67], v[60:63]
    v_mfma_f32_16x16x32_bf16 v[64:67], v[100:103], a[104:107], v[64:67]
    v_mfma_f32_16x16x32_bf16 v[68:71], v[96:99], a[72:75], v[68:71]
    v_mfma_f32_16x16x32_bf16 v[72:75], v[116:119], a[104:107], v[72:75]
    v_mfma_f32_16x16x32_bf16 v[76:79], v[112:115], a[72:75], v[76:79]
    v_mfma_f32_16x16x32_bf16 v[80:83], v[100:103], a[112:115], v[80:83]
    v_mfma_f32_16x16x32_bf16 v[84:87], v[96:99], a[80:83], v[84:87]
    v_mfma_f32_16x16x32_bf16 v[88:91], v[116:119], a[112:115], v[88:91]
    v_mfma_f32_16x16x32_bf16 v[92:95], v[112:115], a[80:83], v[92:95]
    v_mfma_f32_16x16x32_bf16 v[32:35], v[104:107], a[28:31], v[32:35]
    v_mfma_f32_16x16x32_bf16 v[36:39], v[108:111], a[28:31], v[36:39]
    v_mfma_f32_16x16x32_bf16 v[40:43], v[120:123], a[28:31], v[40:43]
    v_mfma_f32_16x16x32_bf16 v[44:47], v[124:127], a[28:31], v[44:47]
    v_mfma_f32_16x16x32_bf16 v[48:51], v[104:107], a[36:39], v[48:51]
    v_mfma_f32_16x16x32_bf16 v[52:55], v[108:111], a[36:39], v[52:55]
    v_mfma_f32_16x16x32_bf16 v[56:59], v[120:123], a[36:39], v[56:59]
    v_mfma_f32_16x16x32_bf16 v[60:63], v[124:127], a[36:39], v[60:63]
    v_mfma_f32_16x16x32_bf16 v[64:67], v[104:107], a[44:47], v[64:67]
    v_mfma_f32_16x16x32_bf16 v[68:71], v[108:111], a[44:47], v[68:71]
    v_mfma_f32_16x16x32_bf16 v[72:75], v[120:123], a[44:47], v[72:75]
    v_mfma_f32_16x16x32_bf16 v[76:79], v[124:127], a[44:47], v[76:79]
    v_mfma_f32_16x16x32_bf16 v[80:83], v[104:107], a[52:55], v[80:83]
    v_mfma_f32_16x16x32_bf16 v[84:87], v[108:111], a[52:55], v[84:87]
    v_mfma_f32_16x16x32_bf16 v[88:91], v[120:123], a[52:55], v[88:91]
    v_mfma_f32_16x16x32_bf16 v[92:95], v[124:127], a[52:55], v[92:95]
    v_mfma_f32_16x16x32_bf16 v[32:35], v[108:111], a[92:95], v[32:35]
    v_mfma_f32_16x16x32_bf16 v[36:39], v[104:107], a[60:63], v[36:39]
    v_mfma_f32_16x16x32_bf16 v[40:43], v[124:127], a[92:95], v[40:43]
    v_mfma_f32_16x16x32_bf16 v[44:47], v[120:123], a[60:63], v[44:47]
    v_mfma_f32_16x16x32_bf16 v[48:51], v[108:111], a[100:103], v[48:51]
    v_mfma_f32_16x16x32_bf16 v[52:55], v[104:107], a[68:71], v[52:55]
    v_mfma_f32_16x16x32_bf16 v[56:59], v[124:127], a[100:103], v[56:59]
    v_mfma_f32_16x16x32_bf16 v[60:63], v[120:123], a[68:71], v[60:63]
    v_mfma_f32_16x16x32_bf16 v[64:67], v[108:111], a[108:111], v[64:67]
    v_mfma_f32_16x16x32_bf16 v[68:71], v[104:107], a[76:79], v[68:71]
    v_mfma_f32_16x16x32_bf16 v[72:75], v[124:127], a[108:111], v[72:75]
    v_mfma_f32_16x16x32_bf16 v[76:79], v[120:123], a[76:79], v[76:79]
    v_mfma_f32_16x16x32_bf16 v[80:83], v[108:111], a[116:119], v[80:83]
    v_mfma_f32_16x16x32_bf16 v[84:87], v[104:107], a[84:87], v[84:87]
    v_mfma_f32_16x16x32_bf16 v[88:91], v[124:127], a[116:119], v[88:91]
    v_mfma_f32_16x16x32_bf16 v[92:95], v[120:123], a[84:87], v[92:95]
    ds_read_b128 v[16:19], v0 offset:49152
    ds_read_b128 v[20:23], v0 offset:50176
    ds_read_b128 v[24:27], v0 offset:57344
    ds_read_b128 v[28:31], v0 offset:58368
    s_waitcnt lgkmcnt(2)
    v_mul_f32 v12, v20, v32
    v_mul_f32 v13, v21, v33
    v_mul_f32 v14, v22, v34
    v_mul_f32 v15, v23, v35
    v_mul_f32 v32, v16, v32
    v_mul_f32 v33, v17, v33
    v_mul_f32 v34, v18, v34
    v_mul_f32 v35, v19, v35
    v_fma_f32 v32, -v36, v20, v32
    v_fma_f32 v33, -v37, v21, v33
    v_fma_f32 v34, -v38, v22, v34
    v_fma_f32 v35, -v39, v23, v35
    v_fma_f32 v36, v36, v16, v12
    v_fma_f32 v37, v37, v17, v13
    v_fma_f32 v38, v38, v18, v14
    v_fma_f32 v39, v39, v19, v15
    ds_read_b128 v[16:19], v0 offset:51200
    ds_read_b128 v[20:23], v0 offset:52224
    s_waitcnt lgkmcnt(2)
    v_mul_f32 v12, v28, v40
    v_mul_f32 v13, v29, v41
    v_mul_f32 v14, v30, v42
    v_mul_f32 v15, v31, v43
    v_mul_f32 v40, v24, v40
    v_mul_f32 v41, v25, v41
    v_mul_f32 v42, v26, v42
    v_mul_f32 v43, v27, v43
    v_fma_f32 v40, -v44, v28, v40
    v_fma_f32 v41, -v45, v29, v41
    v_fma_f32 v42, -v46, v30, v42
    v_fma_f32 v43, -v47, v31, v43
    v_fma_f32 v44, v44, v24, v12
    v_fma_f32 v45, v45, v25, v13
    v_fma_f32 v46, v46, v26, v14
    v_fma_f32 v47, v47, v27, v15
    v_cvt_pk_bf16_f32 v96, v32, v33
    v_cvt_pk_bf16_f32 v97, v34, v35
    v_cvt_pk_bf16_f32 v98, v40, v41
    v_cvt_pk_bf16_f32 v99, v42, v43
    v_cvt_pk_bf16_f32 v100, v36, v37
    v_cvt_pk_bf16_f32 v101, v38, v39
    v_cvt_pk_bf16_f32 v102, v44, v45
    v_cvt_pk_bf16_f32 v103, v46, v47
    ds_read_b128 v[24:27], v0 offset:59392
    ds_read_b128 v[28:31], v0 offset:60416
    s_waitcnt lgkmcnt(2)
    v_mul_f32 v12, v20, v48
    v_mul_f32 v13, v21, v49
    v_mul_f32 v14, v22, v50
    v_mul_f32 v15, v23, v51
    v_mul_f32 v48, v16, v48
    v_mul_f32 v49, v17, v49
    v_mul_f32 v50, v18, v50
    v_mul_f32 v51, v19, v51
    v_fma_f32 v48, -v52, v20, v48
    v_fma_f32 v49, -v53, v21, v49
    v_fma_f32 v50, -v54, v22, v50
    v_fma_f32 v51, -v55, v23, v51
    v_fma_f32 v52, v52, v16, v12
    v_fma_f32 v53, v53, v17, v13
    v_fma_f32 v54, v54, v18, v14
    v_fma_f32 v55, v55, v19, v15
    ds_read_b128 v[16:19], v0 offset:53248
    ds_read_b128 v[20:23], v0 offset:54272
    s_waitcnt lgkmcnt(2)
    v_mul_f32 v12, v28, v56
    v_mul_f32 v13, v29, v57
    v_mul_f32 v14, v30, v58
    v_mul_f32 v15, v31, v59
    v_mul_f32 v56, v24, v56
    v_mul_f32 v57, v25, v57
    v_mul_f32 v58, v26, v58
    v_mul_f32 v59, v27, v59
    v_fma_f32 v56, -v60, v28, v56
    v_fma_f32 v57, -v61, v29, v57
    v_fma_f32 v58, -v62, v30, v58
    v_fma_f32 v59, -v63, v31, v59
    v_fma_f32 v60, v60, v24, v12
    v_fma_f32 v61, v61, v25, v13
    v_fma_f32 v62, v62, v26, v14
    v_fma_f32 v63, v63, v27, v15
    v_cvt_pk_bf16_f32 v104, v48, v49
    v_cvt_pk_bf16_f32 v105, v50, v51
    v_cvt_pk_bf16_f32 v106, v56, v57
    v_cvt_pk_bf16_f32 v107, v58, v59
    v_cvt_pk_bf16_f32 v108, v52, v53
    v_cvt_pk_bf16_f32 v109, v54, v55
    v_cvt_pk_bf16_f32 v110, v60, v61
    v_cvt_pk_bf16_f32 v111, v62, v63
    ds_read_b128 v[24:27], v0 offset:61440
    ds_read_b128 v[28:31], v0 offset:62464
    s_waitcnt lgkmcnt(2)
    v_mul_f32 v12, v20, v64
    v_mul_f32 v13, v21, v65
    v_mul_f32 v14, v22, v66
    v_mul_f32 v15, v23, v67
    v_mul_f32 v64, v16, v64
    v_mul_f32 v65, v17, v65
    v_mul_f32 v66, v18, v66
    v_mul_f32 v67, v19, v67
    v_fma_f32 v64, -v68, v20, v64
    v_fma_f32 v65, -v69, v21, v65
    v_fma_f32 v66, -v70, v22, v66
    v_fma_f32 v67, -v71, v23, v67
    v_fma_f32 v68, v68, v16, v12
    v_fma_f32 v69, v69, v17, v13
    v_fma_f32 v70, v70, v18, v14
    v_fma_f32 v71, v71, v19, v15
    ds_read_b128 v[16:19], v0 offset:55296
    ds_read_b128 v[20:23], v0 offset:56320
    s_waitcnt lgkmcnt(2)
    v_mul_f32 v12, v28, v72
    v_mul_f32 v13, v29, v73
    v_mul_f32 v14, v30, v74
    v_mul_f32 v15, v31, v75
    v_mul_f32 v72, v24, v72
    v_mul_f32 v73, v25, v73
    v_mul_f32 v74, v26, v74
    v_mul_f32 v75, v27, v75
    v_fma_f32 v72, -v76, v28, v72
    v_fma_f32 v73, -v77, v29, v73
    v_fma_f32 v74, -v78, v30, v74
    v_fma_f32 v75, -v79, v31, v75
    v_fma_f32 v76, v76, v24, v12
    v_fma_f32 v77, v77, v25, v13
    v_fma_f32 v78, v78, v26, v14
    v_fma_f32 v79, v79, v27, v15
    v_cvt_pk_bf16_f32 v112, v64, v65
    v_cvt_pk_bf16_f32 v113, v66, v67
    v_cvt_pk_bf16_f32 v114, v72, v73
    v_cvt_pk_bf16_f32 v115, v74, v75
    v_cvt_pk_bf16_f32 v116, v68, v69
    v_cvt_pk_bf16_f32 v117, v70, v71
    v_cvt_pk_bf16_f32 v118, v76, v77
    v_cvt_pk_bf16_f32 v119, v78, v79
    ds_read_b128 v[24:27], v0 offset:63488
    ds_read_b128 v[28:31], v0 offset:64512
    s_waitcnt lgkmcnt(2)
    v_mul_f32 v12, v20, v80
    v_mul_f32 v13, v21, v81
    v_mul_f32 v14, v22, v82
    v_mul_f32 v15, v23, v83
    v_mul_f32 v80, v16, v80
    v_mul_f32 v81, v17, v81
    v_mul_f32 v82, v18, v82
    v_mul_f32 v83, v19, v83
    v_fma_f32 v80, -v84, v20, v80
    v_fma_f32 v81, -v85, v21, v81
    v_fma_f32 v82, -v86, v22, v82
    v_fma_f32 v83, -v87, v23, v83
    v_fma_f32 v84, v84, v16, v12
    v_fma_f32 v85, v85, v17, v13
    v_fma_f32 v86, v86, v18, v14
    v_fma_f32 v87, v87, v19, v15
    s_waitcnt lgkmcnt(0)
    v_mul_f32 v12, v28, v88
    v_mul_f32 v13, v29, v89
    v_mul_f32 v14, v30, v90
    v_mul_f32 v15, v31, v91
    v_mul_f32 v88, v24, v88
    v_mul_f32 v89, v25, v89
    v_mul_f32 v90, v26, v90
    v_mul_f32 v91, v27, v91
    v_fma_f32 v88, -v92, v28, v88
    v_fma_f32 v89, -v93, v29, v89
    v_fma_f32 v90, -v94, v30, v90
    v_fma_f32 v91, -v95, v31, v91
    v_fma_f32 v92, v92, v24, v12
    v_fma_f32 v93, v93, v25, v13
    v_fma_f32 v94, v94, v26, v14
    v_fma_f32 v95, v95, v27, v15
    v_cvt_pk_bf16_f32 v120, v80, v81
    v_cvt_pk_bf16_f32 v121, v82, v83
    v_cvt_pk_bf16_f32 v122, v88, v89
    v_cvt_pk_bf16_f32 v123, v90, v91
    v_cvt_pk_bf16_f32 v124, v84, v85
    v_cvt_pk_bf16_f32 v125, v86, v87
    v_cvt_pk_bf16_f32 v126, v92, v93
    v_cvt_pk_bf16_f32 v127, v94, v95
    v_mfma_f32_16x16x32_bf16 v[32:35], a[0:3], v[96:99], 0
    v_mfma_f32_16x16x32_bf16 v[36:39], a[0:3], v[100:103], 0
    v_mfma_f32_16x16x32_bf16 v[40:43], a[4:7], v[96:99], 0
    v_mfma_f32_16x16x32_bf16 v[44:47], a[4:7], v[100:103], 0
    v_mfma_f32_16x16x32_bf16 v[48:51], a[0:3], v[104:107], 0
    v_mfma_f32_16x16x32_bf16 v[52:55], a[0:3], v[108:111], 0
    v_mfma_f32_16x16x32_bf16 v[56:59], a[4:7], v[104:107], 0
    v_mfma_f32_16x16x32_bf16 v[60:63], a[4:7], v[108:111], 0
    v_mfma_f32_16x16x32_bf16 v[64:67], a[0:3], v[112:115], 0
    v_mfma_f32_16x16x32_bf16 v[68:71], a[0:3], v[116:119], 0
    v_mfma_f32_16x16x32_bf16 v[72:75], a[4:7], v[112:115], 0
    v_mfma_f32_16x16x32_bf16 v[76:79], a[4:7], v[116:119], 0
    v_mfma_f32_16x16x32_bf16 v[80:83], a[0:3], v[120:123], 0
    v_mfma_f32_16x16x32_bf16 v[84:87], a[0:3], v[124:127], 0
    v_mfma_f32_16x16x32_bf16 v[88:91], a[4:7], v[120:123], 0
    v_mfma_f32_16x16x32_bf16 v[92:95], a[4:7], v[124:127], 0
    v_mfma_f32_16x16x32_bf16 v[32:35], a[16:19], v[100:103], v[32:35]
    v_mfma_f32_16x16x32_bf16 v[36:39], a[8:11], v[96:99], v[36:39]
    v_mfma_f32_16x16x32_bf16 v[40:43], a[20:23], v[100:103], v[40:43]
    v_mfma_f32_16x16x32_bf16 v[44:47], a[12:15], v[96:99], v[44:47]
    v_mfma_f32_16x16x32_bf16 v[48:51], a[16:19], v[108:111], v[48:51]
    v_mfma_f32_16x16x32_bf16 v[52:55], a[8:11], v[104:107], v[52:55]
    v_mfma_f32_16x16x32_bf16 v[56:59], a[20:23], v[108:111], v[56:59]
    v_mfma_f32_16x16x32_bf16 v[60:63], a[12:15], v[104:107], v[60:63]
    v_mfma_f32_16x16x32_bf16 v[64:67], a[16:19], v[116:119], v[64:67]
    v_mfma_f32_16x16x32_bf16 v[68:71], a[8:11], v[112:115], v[68:71]
    v_mfma_f32_16x16x32_bf16 v[72:75], a[20:23], v[116:119], v[72:75]
    v_mfma_f32_16x16x32_bf16 v[76:79], a[12:15], v[112:115], v[76:79]
    v_mfma_f32_16x16x32_bf16 v[80:83], a[16:19], v[124:127], v[80:83]
    v_mfma_f32_16x16x32_bf16 v[84:87], a[8:11], v[120:123], v[84:87]
    v_mfma_f32_16x16x32_bf16 v[88:91], a[20:23], v[124:127], v[88:91]
    v_mfma_f32_16x16x32_bf16 v[92:95], a[12:15], v[120:123], v[92:95]
    v_and_b32 v12, 15, v11
    v_lshrrev_b32 v13, 4, v11
    v_mul_u32_u24 v2, 1040, v12
    v_lshl_add_u32 v2, v13, 6, v2
    v_lshrrev_b32 v14, 2, v12
    s_and_b32 s40, s3, 3
    v_xor_b32 v14, s40, v14
    v_lshl_add_u32 v2, v14, 2, v2
    s_lshr_b32 s41, s3, 2
    s_lshl_b32 s41, s41, 9
    v_add_u32 v2, s41, v2
    s_barrier
    v_cvt_pk_bf16_f32 v16, v32, v36
    ds_write_b32 v2, v16 offset:0
    v_cvt_pk_bf16_f32 v17, v33, v37
    ds_write_b32 v2, v17 offset:16
    v_cvt_pk_bf16_f32 v18, v34, v38
    ds_write_b32 v2, v18 offset:32
    v_cvt_pk_bf16_f32 v19, v35, v39
    ds_write_b32 v2, v19 offset:48
    v_cvt_pk_bf16_f32 v20, v40, v44
    ds_write_b32 v2, v20 offset:256
    v_cvt_pk_bf16_f32 v21, v41, v45
    ds_write_b32 v2, v21 offset:272
    v_cvt_pk_bf16_f32 v22, v42, v46
    ds_write_b32 v2, v22 offset:288
    v_cvt_pk_bf16_f32 v23, v43, v47
    ds_write_b32 v2, v23 offset:304
    v_cvt_pk_bf16_f32 v16, v48, v52
    ds_write_b32 v2, v16 offset:16640
    v_cvt_pk_bf16_f32 v17, v49, v53
    ds_write_b32 v2, v17 offset:16656
    v_cvt_pk_bf16_f32 v18, v50, v54
    ds_write_b32 v2, v18 offset:16672
    v_cvt_pk_bf16_f32 v19, v51, v55
    ds_write_b32 v2, v19 offset:16688
    v_cvt_pk_bf16_f32 v20, v56, v60
    ds_write_b32 v2, v20 offset:16896
    v_cvt_pk_bf16_f32 v21, v57, v61
    ds_write_b32 v2, v21 offset:16912
    v_cvt_pk_bf16_f32 v22, v58, v62
    ds_write_b32 v2, v22 offset:16928
    v_cvt_pk_bf16_f32 v23, v59, v63
    ds_write_b32 v2, v23 offset:16944
    v_cvt_pk_bf16_f32 v16, v64, v68
    ds_write_b32 v2, v16 offset:33280
    v_cvt_pk_bf16_f32 v17, v65, v69
    ds_write_b32 v2, v17 offset:33296
    v_cvt_pk_bf16_f32 v18, v66, v70
    ds_write_b32 v2, v18 offset:33312
    v_cvt_pk_bf16_f32 v19, v67, v71
    ds_write_b32 v2, v19 offset:33328
    v_cvt_pk_bf16_f32 v20, v72, v76
    ds_write_b32 v2, v20 offset:33536
    v_cvt_pk_bf16_f32 v21, v73, v77
    ds_write_b32 v2, v21 offset:33552
    v_cvt_pk_bf16_f32 v22, v74, v78
    ds_write_b32 v2, v22 offset:33568
    v_cvt_pk_bf16_f32 v23, v75, v79
    ds_write_b32 v2, v23 offset:33584
    v_cvt_pk_bf16_f32 v16, v80, v84
    ds_write_b32 v2, v16 offset:49920
    v_cvt_pk_bf16_f32 v17, v81, v85
    ds_write_b32 v2, v17 offset:49936
    v_cvt_pk_bf16_f32 v18, v82, v86
    ds_write_b32 v2, v18 offset:49952
    v_cvt_pk_bf16_f32 v19, v83, v87
    ds_write_b32 v2, v19 offset:49968
    v_cvt_pk_bf16_f32 v20, v88, v92
    ds_write_b32 v2, v20 offset:50176
    v_cvt_pk_bf16_f32 v21, v89, v93
    ds_write_b32 v2, v21 offset:50192
    v_cvt_pk_bf16_f32 v22, v90, v94
    ds_write_b32 v2, v22 offset:50208
    v_cvt_pk_bf16_f32 v23, v91, v95
    ds_write_b32 v2, v23 offset:50224
    s_lshr_b32 s43, s3, 1
    s_lshl_b32 s43, s43, 4
    s_and_b32 s44, s3, 1
    s_lshl_b32 s44, s44, 1
    s_add_u32 s43, s43, s44
    s_mul_i32 s40, s43, 1040
    v_add_u32 v3, s40, v0
    v_lshrrev_b32 v12, 5, v11
    v_lshlrev_b32 v4, 8, v12
    v_bfe_u32 v14, v11, 4, 1
    v_mul_u32_u24 v14, 18432, v14
    v_add_u32 v4, v4, v14
    v_and_b32 v14, 15, v11
    v_lshl_add_u32 v4, v14, 4, v4
    s_lshr_b32 s41, s28, 1
    s_lshl_b32 s41, s41, 10
    s_and_b32 s42, s28, 1
    s_lshl_b32 s42, s42, 9
    s_add_u32 s41, s41, s42
    s_mul_i32 s42, s43, 36864
    s_add_u32 s41, s41, s42
    s_add_u32 s33, s41, 10485760
    s_waitcnt lgkmcnt(0)
    s_barrier
    ds_read_b128 v[32:35], v3 offset:0
    ds_read_b128 v[36:39], v3 offset:1040
    ds_read_b128 v[40:43], v3 offset:4160
    ds_read_b128 v[44:47], v3 offset:5200
    ds_read_b128 v[48:51], v3 offset:8320
    ds_read_b128 v[52:55], v3 offset:9360
    ds_read_b128 v[56:59], v3 offset:12480
    ds_read_b128 v[60:63], v3 offset:13520
    s_waitcnt lgkmcnt(7)
    s_add_u32 s42, s33, 0
    buffer_store_dwordx4 v[32:35], v4, s[20:23], s42 offen sc1
    s_waitcnt lgkmcnt(6)
    s_add_u32 s42, s33, 36864
    buffer_store_dwordx4 v[36:39], v4, s[20:23], s42 offen sc1
    s_waitcnt lgkmcnt(5)
    v_swap_b32 v40, v41
    v_swap_b32 v42, v43
    s_add_u32 s42, s33, 147456
    buffer_store_dwordx4 v[40:43], v4, s[20:23], s42 offen sc1
    s_waitcnt lgkmcnt(4)
    v_swap_b32 v44, v45
    v_swap_b32 v46, v47
    s_add_u32 s42, s33, 184320
    buffer_store_dwordx4 v[44:47], v4, s[20:23], s42 offen sc1
    s_waitcnt lgkmcnt(3)
    v_swap_b32 v48, v50
    v_swap_b32 v49, v51
    s_add_u32 s42, s33, 294912
    buffer_store_dwordx4 v[48:51], v4, s[20:23], s42 offen sc1
    s_waitcnt lgkmcnt(2)
    v_swap_b32 v52, v54
    v_swap_b32 v53, v55
    s_add_u32 s42, s33, 331776
    buffer_store_dwordx4 v[52:55], v4, s[20:23], s42 offen sc1
    s_waitcnt lgkmcnt(1)
    v_swap_b32 v56, v59
    v_swap_b32 v57, v58
    s_add_u32 s42, s33, 442368
    buffer_store_dwordx4 v[56:59], v4, s[20:23], s42 offen sc1
    s_waitcnt lgkmcnt(0)
    v_swap_b32 v60, v63
    v_swap_b32 v61, v62
    s_add_u32 s42, s33, 479232
    buffer_store_dwordx4 v[60:63], v4, s[20:23], s42 offen sc1
    s_waitcnt vmcnt(0)
    s_barrier
    v_mov_b32 v10, 1
    v_cmp_gt_u32 vcc, 16, v11
    s_cmp_eq_u32 s3, 0
    s_nop 2
    s_cselect_b64 vcc, vcc, 0
    s_and_saveexec_b64 s[42:43], vcc
    buffer_atomic_add v10, v5, s[20:23], 0 offen sc1
    s_mov_b64 exec, s[42:43]
l2_kernel_end:
l2_kernel_exit:
    s_endpgm
.section .rodata,"a"
.p2align 6
.amdhsa_kernel l2_kernel
  .amdhsa_next_free_vgpr 256
  .amdhsa_next_free_sgpr 102
  .amdhsa_accum_offset 128
  .amdhsa_group_segment_fixed_size 0
  .amdhsa_kernarg_size 80
  .amdhsa_user_sgpr_count 2
  .amdhsa_user_sgpr_kernarg_segment_ptr 1
  .amdhsa_system_sgpr_workgroup_id_x 1
  .amdhsa_float_denorm_mode_32 3
.end_amdhsa_kernel
.text
```
